```python
import torch

def _softmax(x, axis=-1):
    return torch.softmax(x, dim=axis)
def _gelu(x):
    return torch.nn.functional.gelu(x, approximate="tanh")
def _silu(x):
    return torch.nn.functional.silu(x)
def _sigmoid(x):
    return torch.sigmoid(x)
def _layernorm(x, axis=-1, eps=1e-5):
    m = x.mean(dim=axis, keepdim=True)
    v = x.var(dim=axis, keepdim=True, unbiased=False)
    return (x - m) / torch.sqrt(v + eps)
def _scatter_add(tgt, idx, src, axis=0):
    return tgt.clone().index_add_(axis, idx, src)
def _segment_sum(src, seg, n):
    out = torch.zeros((n,) + src.shape[1:], dtype=src.dtype)
    return out.index_add_(0, seg, src)
def _pad(x, pw):
    flat = tuple(v for pair in reversed(pw) for v in pair)
    return torch.nn.functional.pad(x, flat)

kernel_name = 'parallel_sum__sliding_local_dilated__dense_activation_relu__prompt'

def setup_inputs():

    _w = (lambda a: (lambda t: t.to(torch.bfloat16) if t.is_floating_point() else t)(torch.as_tensor(a)))
    def _A_setup():
        B, S, D = 1, 2048, 640
        return {
            "x": _w((lambda *s: torch.randn(*s, dtype=torch.bfloat16) * 0.05)(B, S, D)),
            "wqkv": _w((lambda *s: torch.randn(*s, dtype=torch.bfloat16) * 0.05)(D, 3 * D)),
            "wo": _w((lambda *s: torch.randn(*s, dtype=torch.bfloat16) * 0.05)(D, D)),
        }
    _A_in = _A_setup()

    def _B_setup():
        B, S, D, Dff = 1, 2048, 640, 1728
        return {
            "x": _w((lambda *s: torch.randn(*s, dtype=torch.bfloat16) * 0.05)(B, S, D)),
            "w1": _w((lambda *s: torch.randn(*s, dtype=torch.bfloat16) * 0.05)(D, Dff)),
            "w2": _w((lambda *s: torch.randn(*s, dtype=torch.bfloat16) * 0.05)(Dff, D)),
        }
    _B_in = _B_setup()

    return {
        "A_x": _A_in["x"],
        "A_wqkv": _A_in["wqkv"],
        "A_wo": _A_in["wo"],
        "B_x": _B_in["x"],
        "B_w1": _B_in["w1"],
        "B_w2": _B_in["w2"],
    }

def reference(A_x, A_wqkv, A_wo, B_x, B_w1, B_w2):
    def _A_ref(x, wqkv, wo):
        B, S, D = x.shape
        H = 32; Dh = D // H
        W, dil = 8, 2
        qkv = (lambda x, *d: x.permute(*d))((x @ wqkv).reshape(B, S, 3, H, Dh), 2, 0, 3, 1, 4)
        q, k, v = qkv[0], qkv[1], qkv[2]
        scale = Dh ** -0.5
        pos = torch.arange(S)
        off = torch.arange(W) * dil
        idx = pos[:, None] - off[None, :]
        mask = idx >= 0
        idx_c = torch.where(mask, idx, 0).reshape(-1)
        kg = k[:, :, idx_c, :].reshape(B, H, S, W, Dh)
        vg = v[:, :, idx_c, :].reshape(B, H, S, W, Dh)
        logits = torch.einsum("bhsd,bhswd->bhsw", q, kg) * scale
        logits = torch.where(mask[None, None, :, :], logits, -1e9)
        attn = _softmax(logits, axis=-1)
        o = torch.einsum("bhsw,bhswd->bhsd", attn, vg)
        return (lambda x, *d: x.permute(*d))(o, 0, 2, 1, 3).reshape(B, S, D) @ wo

    def _B_ref(x, w1, w2):
        h = torch.einsum("bsd,df->bsf", x, w1)
        zero = torch.zeros_like(h)
        h = torch.maximum(h, zero)
        return torch.einsum("bsf,fd->bsd", h, w2)

    x = A_x
    xn = _layernorm(x, axis=-1)
    return x + _A_ref(xn, A_wqkv, A_wo) + _B_ref(xn, B_w1, B_w2)
```

```asm
; @launch grid=(256,1,1) block=(256,1,1) lds=163840
.amdgcn_target "amdgcn-amd-amdhsa--gfx950"
.text
.globl parallel_sum__sliding_local_dilated__dense_activation_relu__prompt_kernel
.p2align 8
.type parallel_sum__sliding_local_dilated__dense_activation_relu__prompt_kernel,@function
parallel_sum__sliding_local_dilated__dense_activation_relu__prompt_kernel:
  s_load_dwordx16 s[4:19], s[0:1], 0
  s_load_dwordx2 s[20:21], s[0:1], 64
  s_cmp_ge_u32 s2, 256
  s_cbranch_scc1 L_end
  s_getpc_b64 s[60:61]
L_pcbase:
  s_lshr_b32 s3, s2, 3
  s_lshl_b32 s3, s3, 12
  v_lshl_add_u32 v2, v0, 4, s3
  v_min_u32 v2, L_codeend-L_pcbase-16, v2
  global_load_dwordx4 v[236:239], v2, s[60:61]
  v_and_b32 v255, 63, v0
  v_lshrrev_b32 v1, 6, v0
  s_and_b32 s3, s2, 7
  v_readfirstlane_b32 s22, v1
  s_lshr_b32 s46, s2, 3
  s_and_b32 s47, s3, 1
  s_lshr_b32 s48, s3, 1
  s_lshl_b32 s47, s47, 3
  s_cmp_ge_u32 s46, 30
  s_cbranch_scc1 L_role_pf
  s_cmp_ge_u32 s46, 16
  s_cbranch_scc1 L_role_ffn
  s_lshl_b32 s37, s48, 1
  s_lshr_b32 s49, s46, 3
  s_add_u32 s37, s37, s49
  s_and_b32 s38, s46, 7
  s_add_u32 s36, s47, s38
  s_mul_i32 s49, s49, 5
  s_add_u32 s38, s38, s49
  s_cmp_ge_u32 s38, 10
  s_cselect_b32 s49, 10, 0
  s_sub_u32 s38, s38, s49
  s_and_b32 s49, s37, 1
  s_lshl_b32 s49, s49, 1
  s_add_u32 s49, s49, s36
  s_and_b32 s49, s49, 3
  s_mul_i32 s49, s49, 5
  s_lshr_b32 s38, s49, 1
  s_mul_i32 s92, s36, 163840
  s_sub_u32 s93, s92, 20480
  s_cmp_eq_u32 s36, 0
  s_cselect_b32 s93, 0, s93
  s_add_u32 s82, s37, 8
  v_lshrrev_b32 v1, 3, v255
  v_and_b32 v2, 7, v255
  v_lshrrev_b32 v3, 4, v255
  v_mul_u32_u24 v4, 1280, v1
  v_xor_b32_e64 v5, v2, v3
  v_lshl_add_u32 v163, v5, 4, v4
  v_xor_b32 v164, 64, v163
  v_cmp_le_u32 vcc, 30, v255
  v_mov_b32 v9, 0x40000000
  s_nop 0
  v_cndmask_b32_e64 v6, 0, 1, vcc
  v_cmp_le_u32 vcc, 60, v255
  v_mul_u32_u24 v7, 30, v6
  v_sub_u32 v7, v255, v7
  v_mul_u32_u24 v8, 26, v7
  v_lshrrev_b32_e64 v8, 8, v8
  v_mul_u32_u24 v8, 1120, v8
  v_mul_u32_u24 v6, 3840, v6
  v_lshlrev_b32_e64 v7, 4, v7
  v_add3_u32 v6, v6, v7, v8
  s_mul_i32 s46, s37, 160
  v_add_u32_e64 v6, s46, v6
  v_cndmask_b32_e64 v165, v6, v9, vcc
  s_waitcnt lgkmcnt(0)
  s_mov_b32 s24, s4
  s_and_b32 s25, s5, 0xffff
  s_mov_b32 s26, 2621440
  s_mov_b32 s27, 0x20000
  s_mov_b32 s28, s6
  s_and_b32 s29, s7, 0xffff
  s_mov_b32 s30, 2457600
  s_mov_b32 s31, 0x20000
  s_mov_b32 s32, s20
  s_and_b32 s33, s21, 0xffff
  s_mov_b32 s34, 17825792
  s_mov_b32 s35, 0x20000
  s_mov_b32 s76, s18
  s_and_b32 s77, s19, 0xffff
  s_mov_b32 s78, 256
  s_mov_b32 s79, 0x20000
  s_and_b32 s46, s22, 1
  s_cmp_eq_u32 s46, 1
  s_cselect_b32 s47, 64, 0
  v_xor_b32_e64 v10, s47, v163
  s_mul_i32 s47, s22, 10240
  s_add_u32 s48, s93, s47
  s_add_u32 s49, s92, s47
  s_sub_u32 s49, s49, 20480
  s_cmp_lt_u32 s22, 2
  s_cselect_b32 s90, s48, s49
  s_cselect_b32 s91, 0, 0x7f000000
  s_cmp_eq_u32 s22, 0
  s_cselect_b32 s88, 0xffffff00, -1
  s_lshl_b32 s87, s22, 10
  s_lshr_b32 s47, s22, 1
  s_lshl_b32 s47, s47, 5
  s_lshl_b32 s46, s46, 2
  s_add_u32 s47, s47, s46
  s_mul_i32 s47, s47, 3840
  s_mul_i32 s46, s22, 8704
  s_lshl_b32 s39, s38, 7
  s_mul_i32 s40, s38, 245760
  s_add_u32 s40, s40, s47
  s_add_u32 s48, s90, s39
  s_add_u32 m0, s87, 0
  s_mov_b32 exec_lo, s88
  buffer_load_dwordx4 v10, s[24:27], s48 offen lds
  s_mov_b32 exec_lo, -1
  s_add_u32 s48, s49, s39
  s_add_u32 s48, s48, 40960
  s_add_u32 m0, s87, 4096
  s_nop 0
  buffer_load_dwordx4 v10, s[24:27], s48 offen lds
  s_add_u32 s48, s49, s39
  s_add_u32 s48, s48, 81920
  s_add_u32 m0, s87, 8192
  s_nop 0
  buffer_load_dwordx4 v10, s[24:27], s48 offen lds
  s_add_u32 s48, s49, s39
  s_add_u32 s48, s48, 122880
  s_add_u32 m0, s87, 12288
  s_nop 0
  buffer_load_dwordx4 v10, s[24:27], s48 offen lds
  s_add_u32 s48, s49, s39
  s_add_u32 s48, s48, 163840
  s_add_u32 s48, s48, s91
  s_add_u32 s43, s87, 16384
  s_cmp_lt_u32 s22, 2
  s_cselect_b32 m0, s43, 161792
  s_nop 0
  buffer_load_dwordx4 v10, s[24:27], s48 offen lds
  s_add_u32 m0, s46, 18432
  s_add_u32 s48, s40, 0
  buffer_load_dwordx4 v165, s[28:31], s48 offen offset:0 lds
  s_add_u32 s48, s40, 6592
  buffer_load_dwordx4 v165, s[28:31], s48 offen offset:1088 lds
  s_add_u32 s48, s40, 28544
  buffer_load_dwordx4 v165, s[28:31], s48 offen offset:2176 lds
  s_add_u32 s48, s40, 35136
  buffer_load_dwordx4 v165, s[28:31], s48 offen offset:3264 lds
  s_add_u32 m0, s46, 22784
  s_add_u32 s48, s40, 61440
  buffer_load_dwordx4 v165, s[28:31], s48 offen offset:0 lds
  s_add_u32 s48, s40, 68032
  buffer_load_dwordx4 v165, s[28:31], s48 offen offset:1088 lds
  s_add_u32 s48, s40, 89984
  buffer_load_dwordx4 v165, s[28:31], s48 offen offset:2176 lds
  s_add_u32 s48, s40, 96576
  buffer_load_dwordx4 v165, s[28:31], s48 offen offset:3264 lds
  s_add_u32 s38, s38, 1
  s_cmp_eq_u32 s38, 10
  s_cselect_b32 s38, 0, s38
  s_cmp_eq_u32 s22, 0
  s_cbranch_scc1 L_attn_0
  s_cmp_eq_u32 s22, 1
  s_cbranch_scc1 L_attn_1
  s_cmp_eq_u32 s22, 2
  s_cbranch_scc1 L_attn_2
  s_branch L_attn_3
L_role_ffn:
  s_mul_i32 s48, s48, 14
  s_add_u32 s48, s48, s46
  s_sub_u32 s48, s48, 16
  s_lshr_b32 s37, s48, 3
  s_and_b32 s38, s48, 7
  s_add_u32 s36, s47, s38
  s_and_b32 s49, s37, 1
  s_mul_i32 s49, s49, 5
  s_add_u32 s38, s38, s49
  s_add_u32 s38, s38, 2
  s_cmp_ge_u32 s38, 10
  s_cselect_b32 s49, 10, 0
  s_sub_u32 s38, s38, s49
  s_and_b32 s49, s37, 1
  s_lshl_b32 s49, s49, 1
  s_add_u32 s49, s49, s36
  s_add_u32 s49, s49, 1
  s_and_b32 s49, s49, 3
  s_mul_i32 s49, s49, 5
  s_lshr_b32 s38, s49, 1
  s_mul_i32 s92, s36, 163840
  s_mov_b32 s82, s37
  s_mul_i32 s68, s47, 7
  s_add_u32 s68, s68, s48
  v_lshrrev_b32 v1, 3, v255
  v_and_b32 v2, 7, v255
  v_lshrrev_b32_e64 v3, 4, v255
  v_mul_u32_u24 v4, 1280, v1
  v_xor_b32_e64 v5, v2, v3
  v_lshl_add_u32 v166, v5, 4, v4
  v_xor_b32 v167, 64, v166
  v_lshrrev_b32 v6, 2, v1
  v_lshlrev_b32 v6, 3, v6
  v_and_b32 v7, 3, v1
  v_add_u32_e64 v6, v6, v7
  v_mul_u32_u24 v6, 3456, v6
  v_lshrrev_b32 v7, 1, v2
  v_xor_b32 v7, v7, v3
  v_lshlrev_b32 v7, 5, v7
  v_and_b32 v8, 1, v2
  v_lshlrev_b32_e64 v8, 4, v8
  v_add3_u32 v6, v6, v7, v8
  s_lshl_b32 s46, s37, 9
  v_add_u32 v168, s46, v6
  s_waitcnt lgkmcnt(0)
  s_mov_b32 s24, s4
  s_and_b32 s25, s5, 0xffff
  s_mov_b32 s26, 2621440
  s_mov_b32 s27, 0x20000
  s_mov_b32 s28, s12
  s_and_b32 s29, s13, 0xffff
  s_mov_b32 s30, 2211840
  s_mov_b32 s31, 0x20000
  s_mov_b32 s32, s20
  s_and_b32 s33, s21, 0xffff
  s_mov_b32 s34, 17825792
  s_mov_b32 s35, 0x20000
  s_mov_b32 s76, s18
  s_and_b32 s77, s19, 0xffff
  s_mov_b32 s78, 256
  s_mov_b32 s79, 0x20000
  s_mov_b32 s72, s6
  s_and_b32 s73, s7, 0xffff
  s_mov_b32 s74, 2457600
  s_mov_b32 s75, 0x20000
  s_mul_i32 s49, s22, 40960
  s_add_u32 s49, s49, s92
  s_lshl_b32 s87, s22, 12
  s_lshl_b32 s47, s22, 7
  s_lshl_b32 s46, s22, 13
  s_lshl_b32 s39, s38, 7
  s_add_u32 s39, s39, s49
  s_mul_i32 s40, s38, 221184
  s_add_u32 s40, s40, s47
  s_add_u32 m0, s87, 0
  s_add_u32 s48, s39, 0
  buffer_load_dwordx4 v166, s[24:27], s48 offen offset:0 lds
  s_add_u32 s48, s39, 9216
  buffer_load_dwordx4 v167, s[24:27], s48 offen offset:1024 lds
  s_add_u32 s48, s39, 18432
  buffer_load_dwordx4 v166, s[24:27], s48 offen offset:2048 lds
  s_add_u32 s48, s39, 27648
  buffer_load_dwordx4 v167, s[24:27], s48 offen offset:3072 lds
  s_add_u32 m0, s46, 16384
  s_add_u32 s48, s40, 0
  buffer_load_dwordx4 v168, s[28:31], s48 offen offset:0 lds
  s_add_u32 s48, s40, 54272
  buffer_load_dwordx4 v168, s[28:31], s48 offen offset:1024 lds
  s_add_u32 s48, s40, 11776
  buffer_load_dwordx4 v168, s[28:31], s48 offen offset:2048 lds
  s_add_u32 s48, s40, 66048
  buffer_load_dwordx4 v168, s[28:31], s48 offen offset:3072 lds
  s_add_u32 m0, s46, 20480
  s_add_u32 s48, s40, 110592
  buffer_load_dwordx4 v168, s[28:31], s48 offen offset:0 lds
  s_add_u32 s48, s40, 164864
  buffer_load_dwordx4 v168, s[28:31], s48 offen offset:1024 lds
  s_add_u32 s48, s40, 122368
  buffer_load_dwordx4 v168, s[28:31], s48 offen offset:2048 lds
  s_add_u32 s48, s40, 176640
  buffer_load_dwordx4 v168, s[28:31], s48 offen offset:3072 lds
  s_add_u32 s38, s38, 1
  s_cmp_eq_u32 s38, 10
  s_cselect_b32 s38, 0, s38
  s_cmp_eq_u32 s22, 0
  s_cbranch_scc1 L_ffn_0
  s_cmp_eq_u32 s22, 1
  s_cbranch_scc1 L_ffn_1
  s_cmp_eq_u32 s22, 2
  s_cbranch_scc1 L_ffn_2
  s_branch L_ffn_3
L_role_pf:
  s_lshl_b32 s37, s3, 1
  s_add_u32 s37, s37, s46
  s_sub_u32 s37, s37, 30
  s_waitcnt lgkmcnt(0)
  s_mov_b32 s24, s4
  s_and_b32 s25, s5, 0xffff
  s_mov_b32 s26, 2621440
  s_mov_b32 s27, 0x20000
  s_mov_b32 s32, s20
  s_and_b32 s33, s21, 0xffff
  s_mov_b32 s34, 17825792
  s_mov_b32 s35, 0x20000
  s_mov_b32 s76, s18
  s_and_b32 s77, s19, 0xffff
  s_mov_b32 s78, 256
  s_mov_b32 s79, 0x20000
  v_lshlrev_b32_e64 v241, 4, v255
  s_mov_b32 s60, s14
  s_and_b32 s61, s15, 0xffff
  s_mov_b32 s62, 2211840
  s_mov_b32 s63, 0x20000
  s_mul_i32 s46, s22, 640
  v_add_u32_e64 v1, s46, v255
  v_mul_u32_u24 v2, 3277, v1
  v_lshrrev_b32_e64 v2, 18, v2
  v_mul_u32_u24 v3, 80, v2
  v_sub_u32 v3, v1, v3
  v_and_b32 v4, 7, v2
  v_lshlrev_b32 v4, 1, v4
  v_xor_b32 v3, v3, v4
  v_mul_u32_u24 v2, 1280, v2
  v_lshl_add_u32 v216, v3, 4, v2
  v_add_u32 v1, s46, v255
  v_add_u32 v1, 64, v1
  v_mul_u32_u24 v2, 3277, v1
  v_lshrrev_b32_e64 v2, 18, v2
  v_mul_u32_u24 v3, 80, v2
  v_sub_u32 v3, v1, v3
  v_and_b32 v4, 7, v2
  v_lshlrev_b32 v4, 1, v4
  v_xor_b32 v3, v3, v4
  v_mul_u32_u24 v2, 1280, v2
  v_lshl_add_u32 v217, v3, 4, v2
  v_add_u32_e64 v1, s46, v255
  v_add_u32 v1, 128, v1
  v_mul_u32_u24 v2, 3277, v1
  v_lshrrev_b32_e64 v2, 18, v2
  v_mul_u32_u24 v3, 80, v2
  v_sub_u32 v3, v1, v3
  v_and_b32 v4, 7, v2
  v_lshlrev_b32 v4, 1, v4
  v_xor_b32 v3, v3, v4
  v_mul_u32_u24 v2, 1280, v2
  v_lshl_add_u32 v218, v3, 4, v2
  v_add_u32_e64 v1, s46, v255
  v_add_u32 v1, 192, v1
  v_mul_u32_u24 v2, 3277, v1
  v_lshrrev_b32_e64 v2, 18, v2
  v_mul_u32_u24 v3, 80, v2
  v_sub_u32 v3, v1, v3
  v_and_b32 v4, 7, v2
  v_lshlrev_b32 v4, 1, v4
  v_xor_b32 v3, v3, v4
  v_mul_u32_u24 v2, 1280, v2
  v_lshl_add_u32 v219, v3, 4, v2
  v_add_u32_e64 v1, s46, v255
  v_add_u32 v1, 256, v1
  v_mul_u32_u24 v2, 3277, v1
  v_lshrrev_b32_e64 v2, 18, v2
  v_mul_u32_u24 v3, 80, v2
  v_sub_u32 v3, v1, v3
  v_and_b32 v4, 7, v2
  v_lshlrev_b32 v4, 1, v4
  v_xor_b32 v3, v3, v4
  v_mul_u32_u24 v2, 1280, v2
  v_lshl_add_u32 v220, v3, 4, v2
  v_add_u32_e64 v1, s46, v255
  v_add_u32 v1, 320, v1
  v_mul_u32_u24 v2, 3277, v1
  v_lshrrev_b32_e64 v2, 18, v2
  v_mul_u32_u24 v3, 80, v2
  v_sub_u32 v3, v1, v3
  v_and_b32 v4, 7, v2
  v_lshlrev_b32 v4, 1, v4
  v_xor_b32 v3, v3, v4
  v_mul_u32_u24 v2, 1280, v2
  v_lshl_add_u32 v221, v3, 4, v2
  v_add_u32_e64 v1, s46, v255
  v_add_u32 v1, 384, v1
  v_mul_u32_u24 v2, 3277, v1
  v_lshrrev_b32_e64 v2, 18, v2
  v_mul_u32_u24 v3, 80, v2
  v_sub_u32 v3, v1, v3
  v_and_b32 v4, 7, v2
  v_lshlrev_b32 v4, 1, v4
  v_xor_b32 v3, v3, v4
  v_mul_u32_u24 v2, 1280, v2
  v_lshl_add_u32 v222, v3, 4, v2
  v_add_u32_e64 v1, s46, v255
  v_add_u32 v1, 448, v1
  v_mul_u32_u24 v2, 3277, v1
  v_lshrrev_b32_e64 v2, 18, v2
  v_mul_u32_u24 v3, 80, v2
  v_sub_u32 v3, v1, v3
  v_and_b32 v4, 7, v2
  v_lshlrev_b32 v4, 1, v4
  v_xor_b32 v3, v3, v4
  v_mul_u32_u24 v2, 1280, v2
  v_lshl_add_u32 v223, v3, 4, v2
  v_add_u32_e64 v1, s46, v255
  v_add_u32 v1, 512, v1
  v_mul_u32_u24 v2, 3277, v1
  v_lshrrev_b32_e64 v2, 18, v2
  v_mul_u32_u24 v3, 80, v2
  v_sub_u32 v3, v1, v3
  v_and_b32 v4, 7, v2
  v_lshlrev_b32 v4, 1, v4
  v_xor_b32 v3, v3, v4
  v_mul_u32_u24 v2, 1280, v2
  v_lshl_add_u32 v224, v3, 4, v2
  v_add_u32_e64 v1, s46, v255
  v_add_u32 v1, 576, v1
  v_mul_u32_u24 v2, 3277, v1
  v_lshrrev_b32_e64 v2, 18, v2
  v_mul_u32_u24 v3, 80, v2
  v_sub_u32 v3, v1, v3
  v_and_b32 v4, 7, v2
  v_lshlrev_b32 v4, 1, v4
  v_xor_b32 v3, v3, v4
  v_mul_u32_u24 v2, 1280, v2
  v_lshl_add_u32 v225, v3, 4, v2
  s_add_u32 s68, s37, 28
  s_sub_u32 s46, s68, 20
  s_mul_i32 s46, s46, 40960
  s_cmp_ge_u32 s68, 74
  s_cselect_b32 s46, 0x7f000000, s46
  s_mul_i32 s47, s22, 10240
  s_add_u32 m0, s47, 0
  s_nop 0
  buffer_load_dwordx4 v216, s[60:63], s46 offen lds
  s_add_u32 m0, s47, 1024
  s_nop 0
  buffer_load_dwordx4 v217, s[60:63], s46 offen lds
  s_add_u32 m0, s47, 2048
  s_nop 0
  buffer_load_dwordx4 v218, s[60:63], s46 offen lds
  s_add_u32 m0, s47, 3072
  s_nop 0
  buffer_load_dwordx4 v219, s[60:63], s46 offen lds
  s_add_u32 m0, s47, 4096
  s_nop 0
  buffer_load_dwordx4 v220, s[60:63], s46 offen lds
  s_add_u32 m0, s47, 5120
  s_nop 0
  buffer_load_dwordx4 v221, s[60:63], s46 offen lds
  s_add_u32 m0, s47, 6144
  s_nop 0
  buffer_load_dwordx4 v222, s[60:63], s46 offen lds
  s_add_u32 m0, s47, 7168
  s_nop 0
  buffer_load_dwordx4 v223, s[60:63], s46 offen lds
  s_add_u32 m0, s47, 8192
  s_nop 0
  buffer_load_dwordx4 v224, s[60:63], s46 offen lds
  s_add_u32 m0, s47, 9216
  s_nop 0
  buffer_load_dwordx4 v225, s[60:63], s46 offen lds
  s_add_u32 s69, s37, 44
  s_sub_u32 s46, s69, 20
  s_mul_i32 s46, s46, 40960
  s_cmp_ge_u32 s69, 74
  s_cselect_b32 s46, 0x7f000000, s46
  s_mul_i32 s47, s22, 10240
  s_add_u32 m0, s47, 40960
  s_nop 0
  buffer_load_dwordx4 v216, s[60:63], s46 offen lds
  s_add_u32 m0, s47, 41984
  s_nop 0
  buffer_load_dwordx4 v217, s[60:63], s46 offen lds
  s_add_u32 m0, s47, 43008
  s_nop 0
  buffer_load_dwordx4 v218, s[60:63], s46 offen lds
  s_add_u32 m0, s47, 44032
  s_nop 0
  buffer_load_dwordx4 v219, s[60:63], s46 offen lds
  s_add_u32 m0, s47, 45056
  s_nop 0
  buffer_load_dwordx4 v220, s[60:63], s46 offen lds
  s_add_u32 m0, s47, 46080
  s_nop 0
  buffer_load_dwordx4 v221, s[60:63], s46 offen lds
  s_add_u32 m0, s47, 47104
  s_nop 0
  buffer_load_dwordx4 v222, s[60:63], s46 offen lds
  s_add_u32 m0, s47, 48128
  s_nop 0
  buffer_load_dwordx4 v223, s[60:63], s46 offen lds
  s_add_u32 m0, s47, 49152
  s_nop 0
  buffer_load_dwordx4 v224, s[60:63], s46 offen lds
  s_add_u32 m0, s47, 50176
  s_nop 0
  buffer_load_dwordx4 v225, s[60:63], s46 offen lds
  s_add_u32 s70, s37, 60
  s_sub_u32 s46, s70, 20
  s_mul_i32 s46, s46, 40960
  s_cmp_ge_u32 s70, 74
  s_cselect_b32 s46, 0x7f000000, s46
  s_mul_i32 s47, s22, 10240
  s_add_u32 m0, s47, 81920
  s_nop 0
  buffer_load_dwordx4 v216, s[60:63], s46 offen lds
  s_add_u32 m0, s47, 82944
  s_nop 0
  buffer_load_dwordx4 v217, s[60:63], s46 offen lds
  s_add_u32 m0, s47, 83968
  s_nop 0
  buffer_load_dwordx4 v218, s[60:63], s46 offen lds
  s_add_u32 m0, s47, 84992
  s_nop 0
  buffer_load_dwordx4 v219, s[60:63], s46 offen lds
  s_add_u32 m0, s47, 86016
  s_nop 0
  buffer_load_dwordx4 v220, s[60:63], s46 offen lds
  s_add_u32 m0, s47, 87040
  s_nop 0
  buffer_load_dwordx4 v221, s[60:63], s46 offen lds
  s_add_u32 m0, s47, 88064
  s_nop 0
  buffer_load_dwordx4 v222, s[60:63], s46 offen lds
  s_add_u32 m0, s47, 89088
  s_nop 0
  buffer_load_dwordx4 v223, s[60:63], s46 offen lds
  s_add_u32 m0, s47, 90112
  s_nop 0
  buffer_load_dwordx4 v224, s[60:63], s46 offen lds
  s_add_u32 m0, s47, 91136
  s_nop 0
  buffer_load_dwordx4 v225, s[60:63], s46 offen lds
  v_and_b32 v1, 15, v255
  v_lshrrev_b32 v2, 2, v1
  v_and_b32 v3, 3, v1
  v_lshrrev_b32_e64 v4, 4, v255
  v_lshl_add_u32 v2, v4, 2, v2
  v_and_b32 v5, 7, v2
  v_lshlrev_b32 v5, 5, v5
  v_mul_u32_u24 v2, 1280, v2
  s_mul_i32 s46, s22, 320
  v_lshlrev_b32 v6, 4, v3
  s_add_u32 s47, s46, 0
  v_add_u32 v6, s47, v6
  v_xor_b32 v6, v6, v5
  v_add_u32 v226, v6, v2
  v_lshlrev_b32 v6, 4, v3
  s_add_u32 s47, s46, 8
  v_add_u32 v6, s47, v6
  v_xor_b32 v6, v6, v5
  v_add_u32 v227, v6, v2
  v_lshlrev_b32 v6, 4, v3
  s_add_u32 s47, s46, 64
  v_add_u32 v6, s47, v6
  v_xor_b32 v6, v6, v5
  v_add_u32 v228, v6, v2
  v_lshlrev_b32 v6, 4, v3
  s_add_u32 s47, s46, 72
  v_add_u32 v6, s47, v6
  v_xor_b32 v6, v6, v5
  v_add_u32 v229, v6, v2
  v_lshlrev_b32 v6, 3, v3
  s_add_u32 s47, s46, 128
  v_add_u32 v6, s47, v6
  v_xor_b32 v6, v6, v5
  v_add_u32 v230, v6, v2
  v_lshlrev_b32 v6, 4, v3
  s_add_u32 s47, s46, 160
  v_add_u32 v6, s47, v6
  v_xor_b32 v6, v6, v5
  v_add_u32 v231, v6, v2
  v_lshlrev_b32 v6, 4, v3
  s_add_u32 s47, s46, 168
  v_add_u32 v6, s47, v6
  v_xor_b32 v6, v6, v5
  v_add_u32 v232, v6, v2
  v_lshlrev_b32 v6, 4, v3
  s_add_u32 s47, s46, 224
  v_add_u32 v6, s47, v6
  v_xor_b32 v6, v6, v5
  v_add_u32 v233, v6, v2
  v_lshlrev_b32 v6, 4, v3
  s_add_u32 s47, s46, 232
  v_add_u32 v6, s47, v6
  v_xor_b32 v6, v6, v5
  v_add_u32 v234, v6, v2
  v_lshlrev_b32 v6, 3, v3
  s_add_u32 s47, s46, 288
  v_add_u32 v6, s47, v6
  v_xor_b32 v6, v6, v5
  v_add_u32 v235, v6, v2
  s_mov_b32 s47, 0
  v_mov_b32_e64 v251, 0
L_nspin_pfs:
  buffer_load_dword v250, v251, s[76:79], 0 offen sc1
  s_waitcnt vmcnt(0)
  v_readfirstlane_b32 s23, v250
  s_nop 3
  s_cmp_lg_u32 s23, 0
  s_cbranch_scc1 L_nok_pfs
  s_sleep 8
  s_add_u32 s47, s47, 1
  s_cmp_lt_u32 s47, 200000
  s_cbranch_scc1 L_nspin_pfs
L_nok_pfs:
  s_waitcnt vmcnt(0)
  s_barrier
  s_mul_i32 s46, s68, 5120
  s_mul_i32 s47, s22, 757760
  s_add_u32 s46, s46, s47
  s_add_u32 s46, s46, 10485760
  s_cmp_ge_u32 s68, 74
  s_cselect_b32 s46, 0x40000000, s46
  ds_read_b64_tr_b16 v[176:177], v226
  ds_read_b64_tr_b16 v[178:179], v226 offset:20480
  ds_read_b64_tr_b16 v[180:181], v227
  ds_read_b64_tr_b16 v[182:183], v227 offset:20480
  ds_read_b64_tr_b16 v[184:185], v228
  ds_read_b64_tr_b16 v[186:187], v228 offset:20480
  ds_read_b64_tr_b16 v[188:189], v229
  ds_read_b64_tr_b16 v[190:191], v229 offset:20480
  ds_read_b64_tr_b16 v[192:193], v230
  ds_read_b64_tr_b16 v[194:195], v230 offset:20480
  ds_read_b64_tr_b16 v[196:197], v231
  ds_read_b64_tr_b16 v[198:199], v231 offset:20480
  ds_read_b64_tr_b16 v[200:201], v232
  ds_read_b64_tr_b16 v[202:203], v232 offset:20480
  ds_read_b64_tr_b16 v[204:205], v233
  ds_read_b64_tr_b16 v[206:207], v233 offset:20480
  ds_read_b64_tr_b16 v[208:209], v234
  ds_read_b64_tr_b16 v[210:211], v234 offset:20480
  ds_read_b64_tr_b16 v[212:213], v235
  ds_read_b64_tr_b16 v[214:215], v235 offset:20480
  v_add_u32 v226, 40960, v226
  v_add_u32 v227, 40960, v227
  v_add_u32 v228, 40960, v228
  v_add_u32 v229, 40960, v229
  v_add_u32 v230, 40960, v230
  v_add_u32 v231, 40960, v231
  v_add_u32 v232, 40960, v232
  v_add_u32 v233, 40960, v233
  v_add_u32 v234, 40960, v234
  v_add_u32 v235, 40960, v235
  s_add_u32 s47, s46, 0
  s_waitcnt lgkmcnt(15)
  buffer_store_dwordx4 v[176:179], v241, s[32:35], s47 offen sc1
  s_add_u32 s47, s46, 1024
  buffer_store_dwordx4 v[180:183], v241, s[32:35], s47 offen sc1
  s_add_u32 s47, s46, 2048
  s_waitcnt lgkmcnt(14)
  buffer_store_dwordx4 v[184:187], v241, s[32:35], s47 offen sc1
  s_add_u32 s47, s46, 3072
  s_waitcnt lgkmcnt(12)
  buffer_store_dwordx4 v[188:191], v241, s[32:35], s47 offen sc1
  s_add_u32 s47, s46, 4096
  s_waitcnt lgkmcnt(10)
  buffer_store_dwordx4 v[192:195], v241, s[32:35], s47 offen sc1
  s_add_u32 s47, s46, 378880
  s_waitcnt lgkmcnt(8)
  buffer_store_dwordx4 v[196:199], v241, s[32:35], s47 offen sc1
  s_add_u32 s47, s46, 379904
  s_waitcnt lgkmcnt(6)
  buffer_store_dwordx4 v[200:203], v241, s[32:35], s47 offen sc1
  s_add_u32 s47, s46, 380928
  s_waitcnt lgkmcnt(4)
  buffer_store_dwordx4 v[204:207], v241, s[32:35], s47 offen sc1
  s_add_u32 s47, s46, 381952
  s_waitcnt lgkmcnt(2)
  buffer_store_dwordx4 v[208:211], v241, s[32:35], s47 offen sc1
  s_add_u32 s47, s46, 382976
  s_waitcnt lgkmcnt(0)
  buffer_store_dwordx4 v[212:215], v241, s[32:35], s47 offen sc1
  s_mul_i32 s46, s69, 5120
  s_mul_i32 s47, s22, 757760
  s_add_u32 s46, s46, s47
  s_add_u32 s46, s46, 10485760
  s_cmp_ge_u32 s69, 74
  s_cselect_b32 s46, 0x40000000, s46
  ds_read_b64_tr_b16 v[176:177], v226
  ds_read_b64_tr_b16 v[178:179], v226 offset:20480
  ds_read_b64_tr_b16 v[180:181], v227
  ds_read_b64_tr_b16 v[182:183], v227 offset:20480
  ds_read_b64_tr_b16 v[184:185], v228
  ds_read_b64_tr_b16 v[186:187], v228 offset:20480
  ds_read_b64_tr_b16 v[188:189], v229
  ds_read_b64_tr_b16 v[190:191], v229 offset:20480
  ds_read_b64_tr_b16 v[192:193], v230
  ds_read_b64_tr_b16 v[194:195], v230 offset:20480
  ds_read_b64_tr_b16 v[196:197], v231
  ds_read_b64_tr_b16 v[198:199], v231 offset:20480
  ds_read_b64_tr_b16 v[200:201], v232
  ds_read_b64_tr_b16 v[202:203], v232 offset:20480
  ds_read_b64_tr_b16 v[204:205], v233
  ds_read_b64_tr_b16 v[206:207], v233 offset:20480
  ds_read_b64_tr_b16 v[208:209], v234
  ds_read_b64_tr_b16 v[210:211], v234 offset:20480
  ds_read_b64_tr_b16 v[212:213], v235
  ds_read_b64_tr_b16 v[214:215], v235 offset:20480
  v_add_u32 v226, 40960, v226
  v_add_u32 v227, 40960, v227
  v_add_u32 v228, 40960, v228
  v_add_u32 v229, 40960, v229
  v_add_u32 v230, 40960, v230
  v_add_u32 v231, 40960, v231
  v_add_u32 v232, 40960, v232
  v_add_u32 v233, 40960, v233
  v_add_u32 v234, 40960, v234
  v_add_u32 v235, 40960, v235
  s_add_u32 s47, s46, 0
  s_waitcnt lgkmcnt(15)
  buffer_store_dwordx4 v[176:179], v241, s[32:35], s47 offen sc1
  s_add_u32 s47, s46, 1024
  buffer_store_dwordx4 v[180:183], v241, s[32:35], s47 offen sc1
  s_add_u32 s47, s46, 2048
  s_waitcnt lgkmcnt(14)
  buffer_store_dwordx4 v[184:187], v241, s[32:35], s47 offen sc1
  s_add_u32 s47, s46, 3072
  s_waitcnt lgkmcnt(12)
  buffer_store_dwordx4 v[188:191], v241, s[32:35], s47 offen sc1
  s_add_u32 s47, s46, 4096
  s_waitcnt lgkmcnt(10)
  buffer_store_dwordx4 v[192:195], v241, s[32:35], s47 offen sc1
  s_add_u32 s47, s46, 378880
  s_waitcnt lgkmcnt(8)
  buffer_store_dwordx4 v[196:199], v241, s[32:35], s47 offen sc1
  s_add_u32 s47, s46, 379904
  s_waitcnt lgkmcnt(6)
  buffer_store_dwordx4 v[200:203], v241, s[32:35], s47 offen sc1
  s_add_u32 s47, s46, 380928
  s_waitcnt lgkmcnt(4)
  buffer_store_dwordx4 v[204:207], v241, s[32:35], s47 offen sc1
  s_add_u32 s47, s46, 381952
  s_waitcnt lgkmcnt(2)
  buffer_store_dwordx4 v[208:211], v241, s[32:35], s47 offen sc1
  s_add_u32 s47, s46, 382976
  s_waitcnt lgkmcnt(0)
  buffer_store_dwordx4 v[212:215], v241, s[32:35], s47 offen sc1
  s_mul_i32 s46, s70, 5120
  s_mul_i32 s47, s22, 757760
  s_add_u32 s46, s46, s47
  s_add_u32 s46, s46, 10485760
  s_cmp_ge_u32 s70, 74
  s_cselect_b32 s46, 0x40000000, s46
  ds_read_b64_tr_b16 v[176:177], v226
  ds_read_b64_tr_b16 v[178:179], v226 offset:20480
  ds_read_b64_tr_b16 v[180:181], v227
  ds_read_b64_tr_b16 v[182:183], v227 offset:20480
  ds_read_b64_tr_b16 v[184:185], v228
  ds_read_b64_tr_b16 v[186:187], v228 offset:20480
  ds_read_b64_tr_b16 v[188:189], v229
  ds_read_b64_tr_b16 v[190:191], v229 offset:20480
  ds_read_b64_tr_b16 v[192:193], v230
  ds_read_b64_tr_b16 v[194:195], v230 offset:20480
  ds_read_b64_tr_b16 v[196:197], v231
  ds_read_b64_tr_b16 v[198:199], v231 offset:20480
  ds_read_b64_tr_b16 v[200:201], v232
  ds_read_b64_tr_b16 v[202:203], v232 offset:20480
  ds_read_b64_tr_b16 v[204:205], v233
  ds_read_b64_tr_b16 v[206:207], v233 offset:20480
  ds_read_b64_tr_b16 v[208:209], v234
  ds_read_b64_tr_b16 v[210:211], v234 offset:20480
  ds_read_b64_tr_b16 v[212:213], v235
  ds_read_b64_tr_b16 v[214:215], v235 offset:20480
  s_add_u32 s47, s46, 0
  s_waitcnt lgkmcnt(15)
  buffer_store_dwordx4 v[176:179], v241, s[32:35], s47 offen sc1
  s_add_u32 s47, s46, 1024
  buffer_store_dwordx4 v[180:183], v241, s[32:35], s47 offen sc1
  s_add_u32 s47, s46, 2048
  s_waitcnt lgkmcnt(14)
  buffer_store_dwordx4 v[184:187], v241, s[32:35], s47 offen sc1
  s_add_u32 s47, s46, 3072
  s_waitcnt lgkmcnt(12)
  buffer_store_dwordx4 v[188:191], v241, s[32:35], s47 offen sc1
  s_add_u32 s47, s46, 4096
  s_waitcnt lgkmcnt(10)
  buffer_store_dwordx4 v[192:195], v241, s[32:35], s47 offen sc1
  s_add_u32 s47, s46, 378880
  s_waitcnt lgkmcnt(8)
  buffer_store_dwordx4 v[196:199], v241, s[32:35], s47 offen sc1
  s_add_u32 s47, s46, 379904
  s_waitcnt lgkmcnt(6)
  buffer_store_dwordx4 v[200:203], v241, s[32:35], s47 offen sc1
  s_add_u32 s47, s46, 380928
  s_waitcnt lgkmcnt(4)
  buffer_store_dwordx4 v[204:207], v241, s[32:35], s47 offen sc1
  s_add_u32 s47, s46, 381952
  s_waitcnt lgkmcnt(2)
  buffer_store_dwordx4 v[208:211], v241, s[32:35], s47 offen sc1
  s_add_u32 s47, s46, 382976
  s_waitcnt lgkmcnt(0)
  buffer_store_dwordx4 v[212:215], v241, s[32:35], s47 offen sc1
  s_waitcnt vmcnt(0)
  s_barrier
  s_cmp_lg_u32 s22, 0
  s_cbranch_scc1 L_pf_nosig
  v_mov_b32 v250, 1
  v_mov_b32 v251, 0
  s_mov_b32 exec_lo, 1
  s_mov_b32 exec_hi, 0
  buffer_atomic_add v250, v251, s[76:79], 0 offen offset:4 sc1
  s_mov_b64 exec, -1
L_pf_nosig:
  v_lshrrev_b32 v1, 4, v255
  v_mul_u32_u24 v1, 1280, v1
  v_and_b32_e64 v2, 15, v255
  v_lshl_add_u32 v14, v2, 4, v1
  s_lshl_b32 s46, s37, 7
  s_lshl_b32 s47, s22, 5
  s_add_u32 s46, s46, s47
  s_mul_i32 s46, s46, 1280
  buffer_load_dwordx4 v[16:19], v14, s[24:27], s46 offen offset:0
  buffer_load_dwordx4 v[20:23], v14, s[24:27], s46 offen offset:256
  buffer_load_dwordx4 v[24:27], v14, s[24:27], s46 offen offset:512
  buffer_load_dwordx4 v[28:31], v14, s[24:27], s46 offen offset:768
  buffer_load_dwordx4 v[32:35], v14, s[24:27], s46 offen offset:1024
  s_add_u32 s46, s46, 5120
  buffer_load_dwordx4 v[36:39], v14, s[24:27], s46 offen offset:0
  buffer_load_dwordx4 v[40:43], v14, s[24:27], s46 offen offset:256
  buffer_load_dwordx4 v[44:47], v14, s[24:27], s46 offen offset:512
  buffer_load_dwordx4 v[48:51], v14, s[24:27], s46 offen offset:768
  buffer_load_dwordx4 v[52:55], v14, s[24:27], s46 offen offset:1024
  s_add_u32 s46, s46, 5120
  buffer_load_dwordx4 v[56:59], v14, s[24:27], s46 offen offset:0
  buffer_load_dwordx4 v[60:63], v14, s[24:27], s46 offen offset:256
  buffer_load_dwordx4 v[64:67], v14, s[24:27], s46 offen offset:512
  buffer_load_dwordx4 v[68:71], v14, s[24:27], s46 offen offset:768
  buffer_load_dwordx4 v[72:75], v14, s[24:27], s46 offen offset:1024
  s_add_u32 s46, s46, 5120
  buffer_load_dwordx4 v[76:79], v14, s[24:27], s46 offen offset:0
  buffer_load_dwordx4 v[80:83], v14, s[24:27], s46 offen offset:256
  buffer_load_dwordx4 v[84:87], v14, s[24:27], s46 offen offset:512
  buffer_load_dwordx4 v[88:91], v14, s[24:27], s46 offen offset:768
  buffer_load_dwordx4 v[92:95], v14, s[24:27], s46 offen offset:1024
  s_add_u32 s46, s46, 5120
  buffer_load_dwordx4 v[96:99], v14, s[24:27], s46 offen offset:0
  buffer_load_dwordx4 v[100:103], v14, s[24:27], s46 offen offset:256
  buffer_load_dwordx4 v[104:107], v14, s[24:27], s46 offen offset:512
  buffer_load_dwordx4 v[108:111], v14, s[24:27], s46 offen offset:768
  buffer_load_dwordx4 v[112:115], v14, s[24:27], s46 offen offset:1024
  s_add_u32 s46, s46, 5120
  buffer_load_dwordx4 v[116:119], v14, s[24:27], s46 offen offset:0
  buffer_load_dwordx4 v[120:123], v14, s[24:27], s46 offen offset:256
  buffer_load_dwordx4 v[124:127], v14, s[24:27], s46 offen offset:512
  buffer_load_dwordx4 v[128:131], v14, s[24:27], s46 offen offset:768
  buffer_load_dwordx4 v[132:135], v14, s[24:27], s46 offen offset:1024
  s_add_u32 s46, s46, 5120
  buffer_load_dwordx4 v[136:139], v14, s[24:27], s46 offen offset:0
  buffer_load_dwordx4 v[140:143], v14, s[24:27], s46 offen offset:256
  buffer_load_dwordx4 v[144:147], v14, s[24:27], s46 offen offset:512
  buffer_load_dwordx4 v[148:151], v14, s[24:27], s46 offen offset:768
  buffer_load_dwordx4 v[152:155], v14, s[24:27], s46 offen offset:1024
  s_add_u32 s46, s46, 5120
  buffer_load_dwordx4 v[156:159], v14, s[24:27], s46 offen offset:0
  buffer_load_dwordx4 v[160:163], v14, s[24:27], s46 offen offset:256
  buffer_load_dwordx4 v[164:167], v14, s[24:27], s46 offen offset:512
  buffer_load_dwordx4 v[168:171], v14, s[24:27], s46 offen offset:768
  buffer_load_dwordx4 v[172:175], v14, s[24:27], s46 offen offset:1024
  s_add_u32 s46, s46, 5120
  v_mov_b32 v15, 0x3f803f80
  v_mov_b32 v176, 0
  v_mov_b32 v177, 0
  s_waitcnt vmcnt(35)
  v_dot2c_f32_bf16 v176, v16, v15
  v_dot2c_f32_bf16 v177, v16, v16
  v_dot2c_f32_bf16 v176, v17, v15
  v_dot2c_f32_bf16 v177, v17, v17
  v_dot2c_f32_bf16 v176, v18, v15
  v_dot2c_f32_bf16 v177, v18, v18
  v_dot2c_f32_bf16 v176, v19, v15
  v_dot2c_f32_bf16 v177, v19, v19
  v_dot2c_f32_bf16 v176, v20, v15
  v_dot2c_f32_bf16 v177, v20, v20
  v_dot2c_f32_bf16 v176, v21, v15
  v_dot2c_f32_bf16 v177, v21, v21
  v_dot2c_f32_bf16 v176, v22, v15
  v_dot2c_f32_bf16 v177, v22, v22
  v_dot2c_f32_bf16 v176, v23, v15
  v_dot2c_f32_bf16 v177, v23, v23
  v_dot2c_f32_bf16 v176, v24, v15
  v_dot2c_f32_bf16 v177, v24, v24
  v_dot2c_f32_bf16 v176, v25, v15
  v_dot2c_f32_bf16 v177, v25, v25
  v_dot2c_f32_bf16 v176, v26, v15
  v_dot2c_f32_bf16 v177, v26, v26
  v_dot2c_f32_bf16 v176, v27, v15
  v_dot2c_f32_bf16 v177, v27, v27
  v_dot2c_f32_bf16 v176, v28, v15
  v_dot2c_f32_bf16 v177, v28, v28
  v_dot2c_f32_bf16 v176, v29, v15
  v_dot2c_f32_bf16 v177, v29, v29
  v_dot2c_f32_bf16 v176, v30, v15
  v_dot2c_f32_bf16 v177, v30, v30
  v_dot2c_f32_bf16 v176, v31, v15
  v_dot2c_f32_bf16 v177, v31, v31
  v_dot2c_f32_bf16 v176, v32, v15
  v_dot2c_f32_bf16 v177, v32, v32
  v_dot2c_f32_bf16 v176, v33, v15
  v_dot2c_f32_bf16 v177, v33, v33
  v_dot2c_f32_bf16 v176, v34, v15
  v_dot2c_f32_bf16 v177, v34, v34
  v_dot2c_f32_bf16 v176, v35, v15
  v_dot2c_f32_bf16 v177, v35, v35
  v_mov_b32 v178, 0
  v_mov_b32 v179, 0
  s_waitcnt vmcnt(30)
  v_dot2c_f32_bf16 v178, v36, v15
  v_dot2c_f32_bf16 v179, v36, v36
  v_dot2c_f32_bf16 v178, v37, v15
  v_dot2c_f32_bf16 v179, v37, v37
  v_dot2c_f32_bf16 v178, v38, v15
  v_dot2c_f32_bf16 v179, v38, v38
  v_dot2c_f32_bf16 v178, v39, v15
  v_dot2c_f32_bf16 v179, v39, v39
  v_dot2c_f32_bf16 v178, v40, v15
  v_dot2c_f32_bf16 v179, v40, v40
  v_dot2c_f32_bf16 v178, v41, v15
  v_dot2c_f32_bf16 v179, v41, v41
  v_dot2c_f32_bf16 v178, v42, v15
  v_dot2c_f32_bf16 v179, v42, v42
  v_dot2c_f32_bf16 v178, v43, v15
  v_dot2c_f32_bf16 v179, v43, v43
  v_dot2c_f32_bf16 v178, v44, v15
  v_dot2c_f32_bf16 v179, v44, v44
  v_dot2c_f32_bf16 v178, v45, v15
  v_dot2c_f32_bf16 v179, v45, v45
  v_dot2c_f32_bf16 v178, v46, v15
  v_dot2c_f32_bf16 v179, v46, v46
  v_dot2c_f32_bf16 v178, v47, v15
  v_dot2c_f32_bf16 v179, v47, v47
  v_dot2c_f32_bf16 v178, v48, v15
  v_dot2c_f32_bf16 v179, v48, v48
  v_dot2c_f32_bf16 v178, v49, v15
  v_dot2c_f32_bf16 v179, v49, v49
  v_dot2c_f32_bf16 v178, v50, v15
  v_dot2c_f32_bf16 v179, v50, v50
  v_dot2c_f32_bf16 v178, v51, v15
  v_dot2c_f32_bf16 v179, v51, v51
  v_dot2c_f32_bf16 v178, v52, v15
  v_dot2c_f32_bf16 v179, v52, v52
  v_dot2c_f32_bf16 v178, v53, v15
  v_dot2c_f32_bf16 v179, v53, v53
  v_dot2c_f32_bf16 v178, v54, v15
  v_dot2c_f32_bf16 v179, v54, v54
  v_dot2c_f32_bf16 v178, v55, v15
  v_dot2c_f32_bf16 v179, v55, v55
  v_mov_b32 v180, 0
  v_mov_b32 v181, 0
  s_waitcnt vmcnt(25)
  v_dot2c_f32_bf16 v180, v56, v15
  v_dot2c_f32_bf16 v181, v56, v56
  v_dot2c_f32_bf16 v180, v57, v15
  v_dot2c_f32_bf16 v181, v57, v57
  v_dot2c_f32_bf16 v180, v58, v15
  v_dot2c_f32_bf16 v181, v58, v58
  v_dot2c_f32_bf16 v180, v59, v15
  v_dot2c_f32_bf16 v181, v59, v59
  v_dot2c_f32_bf16 v180, v60, v15
  v_dot2c_f32_bf16 v181, v60, v60
  v_dot2c_f32_bf16 v180, v61, v15
  v_dot2c_f32_bf16 v181, v61, v61
  v_dot2c_f32_bf16 v180, v62, v15
  v_dot2c_f32_bf16 v181, v62, v62
  v_dot2c_f32_bf16 v180, v63, v15
  v_dot2c_f32_bf16 v181, v63, v63
  v_dot2c_f32_bf16 v180, v64, v15
  v_dot2c_f32_bf16 v181, v64, v64
  v_dot2c_f32_bf16 v180, v65, v15
  v_dot2c_f32_bf16 v181, v65, v65
  v_dot2c_f32_bf16 v180, v66, v15
  v_dot2c_f32_bf16 v181, v66, v66
  v_dot2c_f32_bf16 v180, v67, v15
  v_dot2c_f32_bf16 v181, v67, v67
  v_dot2c_f32_bf16 v180, v68, v15
  v_dot2c_f32_bf16 v181, v68, v68
  v_dot2c_f32_bf16 v180, v69, v15
  v_dot2c_f32_bf16 v181, v69, v69
  v_dot2c_f32_bf16 v180, v70, v15
  v_dot2c_f32_bf16 v181, v70, v70
  v_dot2c_f32_bf16 v180, v71, v15
  v_dot2c_f32_bf16 v181, v71, v71
  v_dot2c_f32_bf16 v180, v72, v15
  v_dot2c_f32_bf16 v181, v72, v72
  v_dot2c_f32_bf16 v180, v73, v15
  v_dot2c_f32_bf16 v181, v73, v73
  v_dot2c_f32_bf16 v180, v74, v15
  v_dot2c_f32_bf16 v181, v74, v74
  v_dot2c_f32_bf16 v180, v75, v15
  v_dot2c_f32_bf16 v181, v75, v75
  v_mov_b32 v182, 0
  v_mov_b32 v183, 0
  s_waitcnt vmcnt(20)
  v_dot2c_f32_bf16 v182, v76, v15
  v_dot2c_f32_bf16 v183, v76, v76
  v_dot2c_f32_bf16 v182, v77, v15
  v_dot2c_f32_bf16 v183, v77, v77
  v_dot2c_f32_bf16 v182, v78, v15
  v_dot2c_f32_bf16 v183, v78, v78
  v_dot2c_f32_bf16 v182, v79, v15
  v_dot2c_f32_bf16 v183, v79, v79
  v_dot2c_f32_bf16 v182, v80, v15
  v_dot2c_f32_bf16 v183, v80, v80
  v_dot2c_f32_bf16 v182, v81, v15
  v_dot2c_f32_bf16 v183, v81, v81
  v_dot2c_f32_bf16 v182, v82, v15
  v_dot2c_f32_bf16 v183, v82, v82
  v_dot2c_f32_bf16 v182, v83, v15
  v_dot2c_f32_bf16 v183, v83, v83
  v_dot2c_f32_bf16 v182, v84, v15
  v_dot2c_f32_bf16 v183, v84, v84
  v_dot2c_f32_bf16 v182, v85, v15
  v_dot2c_f32_bf16 v183, v85, v85
  v_dot2c_f32_bf16 v182, v86, v15
  v_dot2c_f32_bf16 v183, v86, v86
  v_dot2c_f32_bf16 v182, v87, v15
  v_dot2c_f32_bf16 v183, v87, v87
  v_dot2c_f32_bf16 v182, v88, v15
  v_dot2c_f32_bf16 v183, v88, v88
  v_dot2c_f32_bf16 v182, v89, v15
  v_dot2c_f32_bf16 v183, v89, v89
  v_dot2c_f32_bf16 v182, v90, v15
  v_dot2c_f32_bf16 v183, v90, v90
  v_dot2c_f32_bf16 v182, v91, v15
  v_dot2c_f32_bf16 v183, v91, v91
  v_dot2c_f32_bf16 v182, v92, v15
  v_dot2c_f32_bf16 v183, v92, v92
  v_dot2c_f32_bf16 v182, v93, v15
  v_dot2c_f32_bf16 v183, v93, v93
  v_dot2c_f32_bf16 v182, v94, v15
  v_dot2c_f32_bf16 v183, v94, v94
  v_dot2c_f32_bf16 v182, v95, v15
  v_dot2c_f32_bf16 v183, v95, v95
  v_mov_b32 v184, 0
  v_mov_b32 v185, 0
  s_waitcnt vmcnt(15)
  v_dot2c_f32_bf16 v184, v96, v15
  v_dot2c_f32_bf16 v185, v96, v96
  v_dot2c_f32_bf16 v184, v97, v15
  v_dot2c_f32_bf16 v185, v97, v97
  v_dot2c_f32_bf16 v184, v98, v15
  v_dot2c_f32_bf16 v185, v98, v98
  v_dot2c_f32_bf16 v184, v99, v15
  v_dot2c_f32_bf16 v185, v99, v99
  v_dot2c_f32_bf16 v184, v100, v15
  v_dot2c_f32_bf16 v185, v100, v100
  v_dot2c_f32_bf16 v184, v101, v15
  v_dot2c_f32_bf16 v185, v101, v101
  v_dot2c_f32_bf16 v184, v102, v15
  v_dot2c_f32_bf16 v185, v102, v102
  v_dot2c_f32_bf16 v184, v103, v15
  v_dot2c_f32_bf16 v185, v103, v103
  v_dot2c_f32_bf16 v184, v104, v15
  v_dot2c_f32_bf16 v185, v104, v104
  v_dot2c_f32_bf16 v184, v105, v15
  v_dot2c_f32_bf16 v185, v105, v105
  v_dot2c_f32_bf16 v184, v106, v15
  v_dot2c_f32_bf16 v185, v106, v106
  v_dot2c_f32_bf16 v184, v107, v15
  v_dot2c_f32_bf16 v185, v107, v107
  v_dot2c_f32_bf16 v184, v108, v15
  v_dot2c_f32_bf16 v185, v108, v108
  v_dot2c_f32_bf16 v184, v109, v15
  v_dot2c_f32_bf16 v185, v109, v109
  v_dot2c_f32_bf16 v184, v110, v15
  v_dot2c_f32_bf16 v185, v110, v110
  v_dot2c_f32_bf16 v184, v111, v15
  v_dot2c_f32_bf16 v185, v111, v111
  v_dot2c_f32_bf16 v184, v112, v15
  v_dot2c_f32_bf16 v185, v112, v112
  v_dot2c_f32_bf16 v184, v113, v15
  v_dot2c_f32_bf16 v185, v113, v113
  v_dot2c_f32_bf16 v184, v114, v15
  v_dot2c_f32_bf16 v185, v114, v114
  v_dot2c_f32_bf16 v184, v115, v15
  v_dot2c_f32_bf16 v185, v115, v115
  v_mov_b32 v186, 0
  v_mov_b32 v187, 0
  s_waitcnt vmcnt(10)
  v_dot2c_f32_bf16 v186, v116, v15
  v_dot2c_f32_bf16 v187, v116, v116
  v_dot2c_f32_bf16 v186, v117, v15
  v_dot2c_f32_bf16 v187, v117, v117
  v_dot2c_f32_bf16 v186, v118, v15
  v_dot2c_f32_bf16 v187, v118, v118
  v_dot2c_f32_bf16 v186, v119, v15
  v_dot2c_f32_bf16 v187, v119, v119
  v_dot2c_f32_bf16 v186, v120, v15
  v_dot2c_f32_bf16 v187, v120, v120
  v_dot2c_f32_bf16 v186, v121, v15
  v_dot2c_f32_bf16 v187, v121, v121
  v_dot2c_f32_bf16 v186, v122, v15
  v_dot2c_f32_bf16 v187, v122, v122
  v_dot2c_f32_bf16 v186, v123, v15
  v_dot2c_f32_bf16 v187, v123, v123
  v_dot2c_f32_bf16 v186, v124, v15
  v_dot2c_f32_bf16 v187, v124, v124
  v_dot2c_f32_bf16 v186, v125, v15
  v_dot2c_f32_bf16 v187, v125, v125
  v_dot2c_f32_bf16 v186, v126, v15
  v_dot2c_f32_bf16 v187, v126, v126
  v_dot2c_f32_bf16 v186, v127, v15
  v_dot2c_f32_bf16 v187, v127, v127
  v_dot2c_f32_bf16 v186, v128, v15
  v_dot2c_f32_bf16 v187, v128, v128
  v_dot2c_f32_bf16 v186, v129, v15
  v_dot2c_f32_bf16 v187, v129, v129
  v_dot2c_f32_bf16 v186, v130, v15
  v_dot2c_f32_bf16 v187, v130, v130
  v_dot2c_f32_bf16 v186, v131, v15
  v_dot2c_f32_bf16 v187, v131, v131
  v_dot2c_f32_bf16 v186, v132, v15
  v_dot2c_f32_bf16 v187, v132, v132
  v_dot2c_f32_bf16 v186, v133, v15
  v_dot2c_f32_bf16 v187, v133, v133
  v_dot2c_f32_bf16 v186, v134, v15
  v_dot2c_f32_bf16 v187, v134, v134
  v_dot2c_f32_bf16 v186, v135, v15
  v_dot2c_f32_bf16 v187, v135, v135
  v_mov_b32 v188, 0
  v_mov_b32 v189, 0
  s_waitcnt vmcnt(5)
  v_dot2c_f32_bf16 v188, v136, v15
  v_dot2c_f32_bf16 v189, v136, v136
  v_dot2c_f32_bf16 v188, v137, v15
  v_dot2c_f32_bf16 v189, v137, v137
  v_dot2c_f32_bf16 v188, v138, v15
  v_dot2c_f32_bf16 v189, v138, v138
  v_dot2c_f32_bf16 v188, v139, v15
  v_dot2c_f32_bf16 v189, v139, v139
  v_dot2c_f32_bf16 v188, v140, v15
  v_dot2c_f32_bf16 v189, v140, v140
  v_dot2c_f32_bf16 v188, v141, v15
  v_dot2c_f32_bf16 v189, v141, v141
  v_dot2c_f32_bf16 v188, v142, v15
  v_dot2c_f32_bf16 v189, v142, v142
  v_dot2c_f32_bf16 v188, v143, v15
  v_dot2c_f32_bf16 v189, v143, v143
  v_dot2c_f32_bf16 v188, v144, v15
  v_dot2c_f32_bf16 v189, v144, v144
  v_dot2c_f32_bf16 v188, v145, v15
  v_dot2c_f32_bf16 v189, v145, v145
  v_dot2c_f32_bf16 v188, v146, v15
  v_dot2c_f32_bf16 v189, v146, v146
  v_dot2c_f32_bf16 v188, v147, v15
  v_dot2c_f32_bf16 v189, v147, v147
  v_dot2c_f32_bf16 v188, v148, v15
  v_dot2c_f32_bf16 v189, v148, v148
  v_dot2c_f32_bf16 v188, v149, v15
  v_dot2c_f32_bf16 v189, v149, v149
  v_dot2c_f32_bf16 v188, v150, v15
  v_dot2c_f32_bf16 v189, v150, v150
  v_dot2c_f32_bf16 v188, v151, v15
  v_dot2c_f32_bf16 v189, v151, v151
  v_dot2c_f32_bf16 v188, v152, v15
  v_dot2c_f32_bf16 v189, v152, v152
  v_dot2c_f32_bf16 v188, v153, v15
  v_dot2c_f32_bf16 v189, v153, v153
  v_dot2c_f32_bf16 v188, v154, v15
  v_dot2c_f32_bf16 v189, v154, v154
  v_dot2c_f32_bf16 v188, v155, v15
  v_dot2c_f32_bf16 v189, v155, v155
  v_mov_b32 v190, 0
  v_mov_b32_e64 v191, 0
  s_waitcnt vmcnt(0)
  v_dot2c_f32_bf16 v190, v156, v15
  v_dot2c_f32_bf16 v191, v156, v156
  v_dot2c_f32_bf16 v190, v157, v15
  v_dot2c_f32_bf16 v191, v157, v157
  v_dot2c_f32_bf16 v190, v158, v15
  v_dot2c_f32_bf16 v191, v158, v158
  v_dot2c_f32_bf16 v190, v159, v15
  v_dot2c_f32_bf16 v191, v159, v159
  v_dot2c_f32_bf16 v190, v160, v15
  v_dot2c_f32_bf16 v191, v160, v160
  v_dot2c_f32_bf16 v190, v161, v15
  v_dot2c_f32_bf16 v191, v161, v161
  v_dot2c_f32_bf16 v190, v162, v15
  v_dot2c_f32_bf16 v191, v162, v162
  v_dot2c_f32_bf16 v190, v163, v15
  v_dot2c_f32_bf16 v191, v163, v163
  v_dot2c_f32_bf16 v190, v164, v15
  v_dot2c_f32_bf16 v191, v164, v164
  v_dot2c_f32_bf16 v190, v165, v15
  v_dot2c_f32_bf16 v191, v165, v165
  v_dot2c_f32_bf16 v190, v166, v15
  v_dot2c_f32_bf16 v191, v166, v166
  v_dot2c_f32_bf16 v190, v167, v15
  v_dot2c_f32_bf16 v191, v167, v167
  v_dot2c_f32_bf16 v190, v168, v15
  v_dot2c_f32_bf16 v191, v168, v168
  v_dot2c_f32_bf16 v190, v169, v15
  v_dot2c_f32_bf16 v191, v169, v169
  v_dot2c_f32_bf16 v190, v170, v15
  v_dot2c_f32_bf16 v191, v170, v170
  v_dot2c_f32_bf16 v190, v171, v15
  v_dot2c_f32_bf16 v191, v171, v171
  v_dot2c_f32_bf16 v190, v172, v15
  v_dot2c_f32_bf16 v191, v172, v172
  v_dot2c_f32_bf16 v190, v173, v15
  v_dot2c_f32_bf16 v191, v173, v173
  v_dot2c_f32_bf16 v190, v174, v15
  v_dot2c_f32_bf16 v191, v174, v174
  v_dot2c_f32_bf16 v190, v175, v15
  v_dot2c_f32_bf16 v191, v175, v175
  v_add_f32_dpp v176, v176, v176 row_ror:8 row_mask:0xf bank_mask:0xf
  v_add_f32_dpp v177, v177, v177 row_ror:8 row_mask:0xf bank_mask:0xf
  v_add_f32_dpp v178, v178, v178 row_ror:8 row_mask:0xf bank_mask:0xf
  v_add_f32_dpp v179, v179, v179 row_ror:8 row_mask:0xf bank_mask:0xf
  v_add_f32_dpp v180, v180, v180 row_ror:8 row_mask:0xf bank_mask:0xf
  v_add_f32_dpp v181, v181, v181 row_ror:8 row_mask:0xf bank_mask:0xf
  v_add_f32_dpp v182, v182, v182 row_ror:8 row_mask:0xf bank_mask:0xf
  v_add_f32_dpp v183, v183, v183 row_ror:8 row_mask:0xf bank_mask:0xf
  v_add_f32_dpp v184, v184, v184 row_ror:8 row_mask:0xf bank_mask:0xf
  v_add_f32_dpp v185, v185, v185 row_ror:8 row_mask:0xf bank_mask:0xf
  v_add_f32_dpp v186, v186, v186 row_ror:8 row_mask:0xf bank_mask:0xf
  v_add_f32_dpp v187, v187, v187 row_ror:8 row_mask:0xf bank_mask:0xf
  v_add_f32_dpp v188, v188, v188 row_ror:8 row_mask:0xf bank_mask:0xf
  v_add_f32_dpp v189, v189, v189 row_ror:8 row_mask:0xf bank_mask:0xf
  v_add_f32_dpp v190, v190, v190 row_ror:8 row_mask:0xf bank_mask:0xf
  v_add_f32_dpp v191, v191, v191 row_ror:8 row_mask:0xf bank_mask:0xf
  v_add_f32_dpp v176, v176, v176 row_ror:4 row_mask:0xf bank_mask:0xf
  v_add_f32_dpp v177, v177, v177 row_ror:4 row_mask:0xf bank_mask:0xf
  v_add_f32_dpp v178, v178, v178 row_ror:4 row_mask:0xf bank_mask:0xf
  v_add_f32_dpp v179, v179, v179 row_ror:4 row_mask:0xf bank_mask:0xf
  v_add_f32_dpp v180, v180, v180 row_ror:4 row_mask:0xf bank_mask:0xf
  v_add_f32_dpp v181, v181, v181 row_ror:4 row_mask:0xf bank_mask:0xf
  v_add_f32_dpp v182, v182, v182 row_ror:4 row_mask:0xf bank_mask:0xf
  v_add_f32_dpp v183, v183, v183 row_ror:4 row_mask:0xf bank_mask:0xf
  v_add_f32_dpp v184, v184, v184 row_ror:4 row_mask:0xf bank_mask:0xf
  v_add_f32_dpp v185, v185, v185 row_ror:4 row_mask:0xf bank_mask:0xf
  v_add_f32_dpp v186, v186, v186 row_ror:4 row_mask:0xf bank_mask:0xf
  v_add_f32_dpp v187, v187, v187 row_ror:4 row_mask:0xf bank_mask:0xf
  v_add_f32_dpp v188, v188, v188 row_ror:4 row_mask:0xf bank_mask:0xf
  v_add_f32_dpp v189, v189, v189 row_ror:4 row_mask:0xf bank_mask:0xf
  v_add_f32_dpp v190, v190, v190 row_ror:4 row_mask:0xf bank_mask:0xf
  v_add_f32_dpp v191, v191, v191 row_ror:4 row_mask:0xf bank_mask:0xf
  v_add_f32_dpp v176, v176, v176 row_ror:2 row_mask:0xf bank_mask:0xf
  v_add_f32_dpp v177, v177, v177 row_ror:2 row_mask:0xf bank_mask:0xf
  v_add_f32_dpp v178, v178, v178 row_ror:2 row_mask:0xf bank_mask:0xf
  v_add_f32_dpp v179, v179, v179 row_ror:2 row_mask:0xf bank_mask:0xf
  v_add_f32_dpp v180, v180, v180 row_ror:2 row_mask:0xf bank_mask:0xf
  v_add_f32_dpp v181, v181, v181 row_ror:2 row_mask:0xf bank_mask:0xf
  v_add_f32_dpp v182, v182, v182 row_ror:2 row_mask:0xf bank_mask:0xf
  v_add_f32_dpp v183, v183, v183 row_ror:2 row_mask:0xf bank_mask:0xf
  v_add_f32_dpp v184, v184, v184 row_ror:2 row_mask:0xf bank_mask:0xf
  v_add_f32_dpp v185, v185, v185 row_ror:2 row_mask:0xf bank_mask:0xf
  v_add_f32_dpp v186, v186, v186 row_ror:2 row_mask:0xf bank_mask:0xf
  v_add_f32_dpp v187, v187, v187 row_ror:2 row_mask:0xf bank_mask:0xf
  v_add_f32_dpp v188, v188, v188 row_ror:2 row_mask:0xf bank_mask:0xf
  v_add_f32_dpp v189, v189, v189 row_ror:2 row_mask:0xf bank_mask:0xf
  v_add_f32_dpp v190, v190, v190 row_ror:2 row_mask:0xf bank_mask:0xf
  v_add_f32_dpp v191, v191, v191 row_ror:2 row_mask:0xf bank_mask:0xf
  v_add_f32_dpp v176, v176, v176 row_ror:1 row_mask:0xf bank_mask:0xf
  v_add_f32_dpp v177, v177, v177 row_ror:1 row_mask:0xf bank_mask:0xf
  v_add_f32_dpp v178, v178, v178 row_ror:1 row_mask:0xf bank_mask:0xf
  v_add_f32_dpp v179, v179, v179 row_ror:1 row_mask:0xf bank_mask:0xf
  v_add_f32_dpp v180, v180, v180 row_ror:1 row_mask:0xf bank_mask:0xf
  v_add_f32_dpp v181, v181, v181 row_ror:1 row_mask:0xf bank_mask:0xf
  v_add_f32_dpp v182, v182, v182 row_ror:1 row_mask:0xf bank_mask:0xf
  v_add_f32_dpp v183, v183, v183 row_ror:1 row_mask:0xf bank_mask:0xf
  v_add_f32_dpp v184, v184, v184 row_ror:1 row_mask:0xf bank_mask:0xf
  v_add_f32_dpp v185, v185, v185 row_ror:1 row_mask:0xf bank_mask:0xf
  v_add_f32_dpp v186, v186, v186 row_ror:1 row_mask:0xf bank_mask:0xf
  v_add_f32_dpp v187, v187, v187 row_ror:1 row_mask:0xf bank_mask:0xf
  v_add_f32_dpp v188, v188, v188 row_ror:1 row_mask:0xf bank_mask:0xf
  v_add_f32_dpp v189, v189, v189 row_ror:1 row_mask:0xf bank_mask:0xf
  v_add_f32_dpp v190, v190, v190 row_ror:1 row_mask:0xf bank_mask:0xf
  v_add_f32_dpp v191, v191, v191 row_ror:1 row_mask:0xf bank_mask:0xf
  v_lshrrev_b32 v1, 4, v255
  v_lshlrev_b32 v1, 4, v1
  s_lshl_b32 s46, s37, 7
  s_lshl_b32 s47, s22, 5
  s_add_u32 s46, s46, s47
  s_lshl_b32 s46, s46, 4
  s_add_u32 s46, s46, 14745600
  v_mul_f32 v16, 0xbacccccd, v176
  v_mul_f32 v177, 0x3acccccd, v177
  v_fma_f32 v177, -v16, v16, v177
  v_max_f32_e64 v177, 0, v177
  v_add_f32 v177, 0x3727c5ac, v177
  v_rsq_f32 v17, v177
  v_mov_b32 v19, s23
  v_mul_f32_e64 v18, v177, v17
  v_mul_f32 v20, 0xbacccccd, v178
  v_mul_f32 v179, 0x3acccccd, v179
  v_fma_f32 v179, -v20, v20, v179
  v_max_f32_e64 v179, 0, v179
  v_add_f32 v179, 0x3727c5ac, v179
  v_rsq_f32 v21, v179
  v_mov_b32 v23, s23
  v_mul_f32_e64 v22, v179, v21
  v_mul_f32 v24, 0xbacccccd, v180
  v_mul_f32 v181, 0x3acccccd, v181
  v_fma_f32 v181, -v24, v24, v181
  v_max_f32_e64 v181, 0, v181
  v_add_f32 v181, 0x3727c5ac, v181
  v_rsq_f32 v25, v181
  v_mov_b32 v27, s23
  v_mul_f32_e64 v26, v181, v25
  v_mul_f32 v28, 0xbacccccd, v182
  v_mul_f32 v183, 0x3acccccd, v183
  v_fma_f32 v183, -v28, v28, v183
  v_max_f32_e64 v183, 0, v183
  v_add_f32 v183, 0x3727c5ac, v183
  v_rsq_f32 v29, v183
  v_mov_b32 v31, s23
  v_mul_f32_e64 v30, v183, v29
  v_mul_f32 v32, 0xbacccccd, v184
  v_mul_f32 v185, 0x3acccccd, v185
  v_fma_f32 v185, -v32, v32, v185
  v_max_f32_e64 v185, 0, v185
  v_add_f32 v185, 0x3727c5ac, v185
  v_rsq_f32 v33, v185
  v_mov_b32 v35, s23
  v_mul_f32_e64 v34, v185, v33
  v_mul_f32 v36, 0xbacccccd, v186
  v_mul_f32 v187, 0x3acccccd, v187
  v_fma_f32 v187, -v36, v36, v187
  v_max_f32_e64 v187, 0, v187
  v_add_f32 v187, 0x3727c5ac, v187
  v_rsq_f32 v37, v187
  v_mov_b32 v39, s23
  v_mul_f32_e64 v38, v187, v37
  v_mul_f32 v40, 0xbacccccd, v188
  v_mul_f32 v189, 0x3acccccd, v189
  v_fma_f32 v189, -v40, v40, v189
  v_max_f32_e64 v189, 0, v189
  v_add_f32 v189, 0x3727c5ac, v189
  v_rsq_f32 v41, v189
  v_mov_b32 v43, s23
  v_mul_f32_e64 v42, v189, v41
  v_mul_f32 v44, 0xbacccccd, v190
  v_mul_f32 v191, 0x3acccccd, v191
  v_fma_f32 v191, -v44, v44, v191
  v_max_f32_e64 v191, 0, v191
  v_add_f32 v191, 0x3727c5ac, v191
  v_rsq_f32 v45, v191
  v_mov_b32 v47, s23
  v_mul_f32_e64 v46, v191, v45
  s_mov_b32 exec_lo, 0x00010001
  s_mov_b32 exec_hi, 0x00010001
  buffer_store_dwordx4 v[16:19], v1, s[32:35], s46 offen offset:0 sc1
  buffer_store_dwordx4 v[20:23], v1, s[32:35], s46 offen offset:64 sc1
  buffer_store_dwordx4 v[24:27], v1, s[32:35], s46 offen offset:128 sc1
  buffer_store_dwordx4 v[28:31], v1, s[32:35], s46 offen offset:192 sc1
  buffer_store_dwordx4 v[32:35], v1, s[32:35], s46 offen offset:256 sc1
  buffer_store_dwordx4 v[36:39], v1, s[32:35], s46 offen offset:320 sc1
  buffer_store_dwordx4 v[40:43], v1, s[32:35], s46 offen offset:384 sc1
  buffer_store_dwordx4 v[44:47], v1, s[32:35], s46 offen offset:448 sc1
  s_mov_b64 exec, -1
  s_and_b32 s46, s2, 7
  s_lshr_b32 s47, s2, 3
  s_lshr_b32 s80, s47, 3
  s_lshl_b32 s46, s46, 2
  s_add_u32 s80, s80, s46
  s_and_b32 s81, s47, 7
  s_lshr_b32 s89, s80, 1
  s_lshl_b32 s89, s89, 2
  s_mul_i32 s83, s81, 378880
  s_add_u32 s83, s83, 10485760
  s_mul_i32 s84, s80, 303104
  s_mul_i32 s85, s22, 12288
  s_add_u32 s85, s85, 49152
  s_mul_i32 s86, s22, 13312
  s_add_u32 s86, s86, 98304
  s_mul_i32 s46, s81, 7
  s_lshr_b32 s46, s46, 2
  s_and_b32 s47, s80, 3
  s_mul_i32 s47, s47, 7
  s_lshr_b32 s47, s47, 1
  s_add_u32 s46, s46, s47
  s_sub_u32 s47, s46, 14
  s_cmp_ge_u32 s46, 14
  s_cselect_b32 s46, s47, s46
  s_lshl_b32 s46, s46, 2
  s_add_u32 s46, s46, s22
  s_add_u32 s46, s46, 20
  s_lshl_b32 s4, s46, 10
  s_cmp_ge_u32 s46, 74
  s_cselect_b32 s4, 0x10000000, s4
  s_add_u32 s46, s46, 4
  s_sub_u32 s47, s46, 56
  s_cmp_ge_u32 s46, 76
  s_cselect_b32 s46, s47, s46
  s_lshl_b32 s5, s46, 10
  s_cmp_ge_u32 s46, 74
  s_cselect_b32 s5, 0x10000000, s5
  s_add_u32 s46, s46, 4
  s_sub_u32 s47, s46, 56
  s_cmp_ge_u32 s46, 76
  s_cselect_b32 s46, s47, s46
  s_lshl_b32 s6, s46, 10
  s_cmp_ge_u32 s46, 74
  s_cselect_b32 s6, 0x10000000, s6
  s_add_u32 s46, s46, 4
  s_sub_u32 s47, s46, 56
  s_cmp_ge_u32 s46, 76
  s_cselect_b32 s46, s47, s46
  s_lshl_b32 s7, s46, 10
  s_cmp_ge_u32 s46, 74
  s_cselect_b32 s7, 0x10000000, s7
  s_add_u32 s46, s46, 4
  s_sub_u32 s47, s46, 56
  s_cmp_ge_u32 s46, 76
  s_cselect_b32 s46, s47, s46
  s_lshl_b32 s8, s46, 10
  s_cmp_ge_u32 s46, 74
  s_cselect_b32 s8, 0x10000000, s8
  s_add_u32 s46, s46, 4
  s_sub_u32 s47, s46, 56
  s_cmp_ge_u32 s46, 76
  s_cselect_b32 s46, s47, s46
  s_lshl_b32 s9, s46, 10
  s_cmp_ge_u32 s46, 74
  s_cselect_b32 s9, 0x10000000, s9
  s_add_u32 s46, s46, 4
  s_sub_u32 s47, s46, 56
  s_cmp_ge_u32 s46, 76
  s_cselect_b32 s46, s47, s46
  s_lshl_b32 s10, s46, 10
  s_cmp_ge_u32 s46, 74
  s_cselect_b32 s10, 0x10000000, s10
  s_add_u32 s46, s46, 4
  s_sub_u32 s47, s46, 56
  s_cmp_ge_u32 s46, 76
  s_cselect_b32 s46, s47, s46
  s_lshl_b32 s11, s46, 10
  s_cmp_ge_u32 s46, 74
  s_cselect_b32 s11, 0x10000000, s11
  s_add_u32 s46, s46, 4
  s_sub_u32 s47, s46, 56
  s_cmp_ge_u32 s46, 76
  s_cselect_b32 s46, s47, s46
  s_lshl_b32 s12, s46, 10
  s_cmp_ge_u32 s46, 74
  s_cselect_b32 s12, 0x10000000, s12
  s_add_u32 s46, s46, 4
  s_sub_u32 s47, s46, 56
  s_cmp_ge_u32 s46, 76
  s_cselect_b32 s46, s47, s46
  s_lshl_b32 s13, s46, 10
  s_cmp_ge_u32 s46, 74
  s_cselect_b32 s13, 0x10000000, s13
  s_add_u32 s46, s46, 4
  s_sub_u32 s47, s46, 56
  s_cmp_ge_u32 s46, 76
  s_cselect_b32 s46, s47, s46
  s_lshl_b32 s14, s46, 10
  s_cmp_ge_u32 s46, 74
  s_cselect_b32 s14, 0x10000000, s14
  s_add_u32 s46, s46, 4
  s_sub_u32 s47, s46, 56
  s_cmp_ge_u32 s46, 76
  s_cselect_b32 s46, s47, s46
  s_lshl_b32 s15, s46, 10
  s_cmp_ge_u32 s46, 74
  s_cselect_b32 s15, 0x10000000, s15
  s_add_u32 s46, s46, 4
  s_sub_u32 s47, s46, 56
  s_cmp_ge_u32 s46, 76
  s_cselect_b32 s46, s47, s46
  s_lshl_b32 s18, s46, 10
  s_cmp_ge_u32 s46, 74
  s_cselect_b32 s18, 0x10000000, s18
  s_add_u32 s46, s46, 4
  s_sub_u32 s47, s46, 56
  s_cmp_ge_u32 s46, 76
  s_cselect_b32 s46, s47, s46
  s_lshl_b32 s19, s46, 10
  s_cmp_ge_u32 s46, 74
  s_cselect_b32 s19, 0x10000000, s19
  v_add_u32 v245, 4096, v241
  s_lshl_b32 s45, s2, 7
  s_add_u32 s45, s45, 15728640
  s_cmp_lg_u32 s22, 0
  s_cbranch_scc1 L_pf_nospin
  s_mov_b32 s47, 0
  v_mov_b32_e64 v251, 0
L_cspin_pf:
  buffer_load_dword v250, v251, s[76:79], 0 offen offset:4 sc1
  s_waitcnt vmcnt(0)
  v_readfirstlane_b32 s46, v250
  s_nop 3
  s_cmp_ge_u32 s46, 128
  s_cbranch_scc1 L_cok_pf
  s_sleep 40
  s_add_u32 s47, s47, 1
  s_cmp_lt_u32 s47, 200000
  s_cbranch_scc1 L_cspin_pf
L_cok_pf:
L_pf_nospin:
  s_barrier
  s_mov_b32 s47, 0
  v_mov_b32 v251, 0
L_nspin_pf:
  buffer_load_dword v250, v251, s[76:79], 0 offen sc1
  s_waitcnt vmcnt(0)
  v_readfirstlane_b32 s23, v250
  s_nop 3
  s_cmp_lg_u32 s23, 0
  s_cbranch_scc1 L_nok_pf
  s_sleep 8
  s_add_u32 s47, s47, 1
  s_cmp_lt_u32 s47, 200000
  s_cbranch_scc1 L_nspin_pf
L_nok_pf:
  s_mul_i32 s87, s4, 5
  s_add_u32 s87, s87, s83
  s_add_u32 m0, s85, 0
  s_add_u32 s88, s87, 0
  buffer_load_dwordx4 v241, s[32:35], s88 offen sc1 lds
  s_add_u32 m0, s85, 1024
  s_add_u32 s88, s87, 1024
  buffer_load_dwordx4 v241, s[32:35], s88 offen sc1 lds
  s_add_u32 m0, s85, 2048
  s_add_u32 s88, s87, 2048
  buffer_load_dwordx4 v241, s[32:35], s88 offen sc1 lds
  s_add_u32 m0, s85, 3072
  s_add_u32 s88, s87, 3072
  buffer_load_dwordx4 v241, s[32:35], s88 offen sc1 lds
  s_add_u32 m0, s85, 4096
  s_add_u32 s88, s87, 4096
  buffer_load_dwordx4 v241, s[32:35], s88 offen sc1 lds
  s_mul_i32 s87, s5, 5
  s_add_u32 s87, s87, s83
  s_add_u32 m0, s85, 5120
  s_add_u32 s88, s87, 0
  buffer_load_dwordx4 v241, s[32:35], s88 offen sc1 lds
  s_add_u32 m0, s85, 6144
  s_add_u32 s88, s87, 1024
  buffer_load_dwordx4 v241, s[32:35], s88 offen sc1 lds
  s_add_u32 m0, s85, 7168
  s_add_u32 s88, s87, 2048
  buffer_load_dwordx4 v241, s[32:35], s88 offen sc1 lds
  s_add_u32 m0, s85, 8192
  s_add_u32 s88, s87, 3072
  buffer_load_dwordx4 v241, s[32:35], s88 offen sc1 lds
  s_add_u32 m0, s85, 9216
  s_add_u32 s88, s87, 4096
  buffer_load_dwordx4 v241, s[32:35], s88 offen sc1 lds
  s_mul_i32 s87, s6, 5
  s_add_u32 s87, s87, s83
  s_add_u32 m0, s85, 10240
  s_add_u32 s88, s87, 0
  buffer_load_dwordx4 v241, s[32:35], s88 offen sc1 lds
  s_add_u32 m0, s85, 11264
  s_add_u32 s88, s87, 1024
  buffer_load_dwordx4 v241, s[32:35], s88 offen sc1 lds
  s_add_u32 m0, s86, 0
  s_add_u32 s88, s87, 2048
  buffer_load_dwordx4 v241, s[32:35], s88 offen sc1 lds
  s_add_u32 m0, s86, 1024
  s_add_u32 s88, s87, 3072
  buffer_load_dwordx4 v241, s[32:35], s88 offen sc1 lds
  s_add_u32 m0, s86, 2048
  s_add_u32 s88, s87, 4096
  buffer_load_dwordx4 v241, s[32:35], s88 offen sc1 lds
  s_mul_i32 s87, s7, 5
  s_add_u32 s87, s87, s83
  s_add_u32 m0, s86, 3072
  s_add_u32 s88, s87, 0
  buffer_load_dwordx4 v241, s[32:35], s88 offen sc1 lds
  s_add_u32 m0, s86, 4096
  s_add_u32 s88, s87, 1024
  buffer_load_dwordx4 v241, s[32:35], s88 offen sc1 lds
  s_add_u32 m0, s86, 5120
  s_add_u32 s88, s87, 2048
  buffer_load_dwordx4 v241, s[32:35], s88 offen sc1 lds
  s_add_u32 m0, s86, 6144
  s_add_u32 s88, s87, 3072
  buffer_load_dwordx4 v241, s[32:35], s88 offen sc1 lds
  s_add_u32 m0, s86, 7168
  s_add_u32 s88, s87, 4096
  buffer_load_dwordx4 v241, s[32:35], s88 offen sc1 lds
  s_mul_i32 s87, s8, 5
  s_add_u32 s87, s87, s83
  s_add_u32 m0, s86, 8192
  s_add_u32 s88, s87, 0
  buffer_load_dwordx4 v241, s[32:35], s88 offen sc1 lds
  s_add_u32 m0, s86, 9216
  s_add_u32 s88, s87, 1024
  buffer_load_dwordx4 v241, s[32:35], s88 offen sc1 lds
  s_add_u32 m0, s86, 10240
  s_add_u32 s88, s87, 2048
  buffer_load_dwordx4 v241, s[32:35], s88 offen sc1 lds
  s_add_u32 m0, s86, 11264
  s_add_u32 s88, s87, 3072
  buffer_load_dwordx4 v241, s[32:35], s88 offen sc1 lds
  s_add_u32 m0, s86, 12288
  s_add_u32 s88, s87, 4096
  buffer_load_dwordx4 v241, s[32:35], s88 offen sc1 lds
  v_lshlrev_b32 v2, 2, v255
  buffer_load_dword v243, v2, s[32:35], s45 offen sc1
  s_mul_i32 s87, s9, 5
  s_add_u32 s87, s87, s83
  buffer_load_dwordx4 a[0:3], v241, s[32:35], s87 offen offset:0 sc1
  buffer_load_dwordx4 a[4:7], v241, s[32:35], s87 offen offset:1024 sc1
  buffer_load_dwordx4 a[8:11], v241, s[32:35], s87 offen offset:2048 sc1
  buffer_load_dwordx4 a[12:15], v241, s[32:35], s87 offen offset:3072 sc1
  buffer_load_dwordx4 a[16:19], v245, s[32:35], s87 offen sc1
  s_mul_i32 s87, s10, 5
  s_add_u32 s87, s87, s83
  buffer_load_dwordx4 a[20:23], v241, s[32:35], s87 offen offset:0 sc1
  buffer_load_dwordx4 a[24:27], v241, s[32:35], s87 offen offset:1024 sc1
  buffer_load_dwordx4 a[28:31], v241, s[32:35], s87 offen offset:2048 sc1
  buffer_load_dwordx4 a[32:35], v241, s[32:35], s87 offen offset:3072 sc1
  buffer_load_dwordx4 a[36:39], v245, s[32:35], s87 offen sc1
  s_mul_i32 s87, s11, 5
  s_add_u32 s87, s87, s83
  buffer_load_dwordx4 a[40:43], v241, s[32:35], s87 offen offset:0 sc1
  buffer_load_dwordx4 a[44:47], v241, s[32:35], s87 offen offset:1024 sc1
  buffer_load_dwordx4 a[48:51], v241, s[32:35], s87 offen offset:2048 sc1
  buffer_load_dwordx4 a[52:55], v241, s[32:35], s87 offen offset:3072 sc1
  buffer_load_dwordx4 a[56:59], v245, s[32:35], s87 offen sc1
  s_mul_i32 s87, s12, 5
  s_add_u32 s87, s87, s83
  buffer_load_dwordx4 a[60:63], v241, s[32:35], s87 offen offset:0 sc1
  buffer_load_dwordx4 a[64:67], v241, s[32:35], s87 offen offset:1024 sc1
  buffer_load_dwordx4 a[68:71], v241, s[32:35], s87 offen offset:2048 sc1
  buffer_load_dwordx4 a[72:75], v241, s[32:35], s87 offen offset:3072 sc1
  buffer_load_dwordx4 a[76:79], v245, s[32:35], s87 offen sc1
  s_mul_i32 s87, s13, 5
  s_add_u32 s87, s87, s83
  buffer_load_dwordx4 a[80:83], v241, s[32:35], s87 offen offset:0 sc1
  buffer_load_dwordx4 a[84:87], v241, s[32:35], s87 offen offset:1024 sc1
  buffer_load_dwordx4 a[88:91], v241, s[32:35], s87 offen offset:2048 sc1
  buffer_load_dwordx4 a[92:95], v241, s[32:35], s87 offen offset:3072 sc1
  buffer_load_dwordx4 a[96:99], v245, s[32:35], s87 offen sc1
  s_mul_i32 s87, s14, 5
  s_add_u32 s87, s87, s83
  buffer_load_dwordx4 a[100:103], v241, s[32:35], s87 offen offset:0 sc1
  buffer_load_dwordx4 a[104:107], v241, s[32:35], s87 offen offset:1024 sc1
  buffer_load_dwordx4 a[108:111], v241, s[32:35], s87 offen offset:2048 sc1
  buffer_load_dwordx4 a[112:115], v241, s[32:35], s87 offen offset:3072 sc1
  buffer_load_dwordx4 a[116:119], v245, s[32:35], s87 offen sc1
  s_mul_i32 s87, s15, 5
  s_add_u32 s87, s87, s83
  buffer_load_dwordx4 a[120:123], v241, s[32:35], s87 offen offset:0 sc1
  buffer_load_dwordx4 a[124:127], v241, s[32:35], s87 offen offset:1024 sc1
  buffer_load_dwordx4 a[128:131], v241, s[32:35], s87 offen offset:2048 sc1
  buffer_load_dwordx4 a[132:135], v241, s[32:35], s87 offen offset:3072 sc1
  buffer_load_dwordx4 a[136:139], v245, s[32:35], s87 offen sc1
  s_mul_i32 s87, s18, 5
  s_add_u32 s87, s87, s83
  buffer_load_dwordx4 a[140:143], v241, s[32:35], s87 offen offset:0 sc1
  buffer_load_dwordx4 a[144:147], v241, s[32:35], s87 offen offset:1024 sc1
  buffer_load_dwordx4 a[148:151], v241, s[32:35], s87 offen offset:2048 sc1
  buffer_load_dwordx4 a[152:155], v241, s[32:35], s87 offen offset:3072 sc1
  buffer_load_dwordx4 a[156:159], v245, s[32:35], s87 offen sc1
  s_mul_i32 s87, s19, 5
  s_add_u32 s87, s87, s83
  buffer_load_dwordx4 a[160:163], v241, s[32:35], s87 offen offset:0 sc1
  buffer_load_dwordx4 a[164:167], v241, s[32:35], s87 offen offset:1024 sc1
  buffer_load_dwordx4 a[168:171], v241, s[32:35], s87 offen offset:2048 sc1
  buffer_load_dwordx4 a[172:175], v241, s[32:35], s87 offen offset:3072 sc1
  buffer_load_dwordx4 a[176:179], v245, s[32:35], s87 offen sc1
  s_mul_i32 s87, s22, 5120
  s_add_u32 s87, s87, s83
  s_add_u32 s87, s87, 0
  buffer_load_dwordx4 a[180:183], v241, s[32:35], s87 offen offset:0 sc1
  buffer_load_dwordx4 a[184:187], v241, s[32:35], s87 offen offset:1024 sc1
  buffer_load_dwordx4 a[188:191], v241, s[32:35], s87 offen offset:2048 sc1
  buffer_load_dwordx4 a[192:195], v241, s[32:35], s87 offen offset:3072 sc1
  buffer_load_dwordx4 a[196:199], v245, s[32:35], s87 offen sc1
  s_mul_i32 s87, s22, 5120
  s_add_u32 s87, s87, s83
  s_add_u32 s87, s87, 20480
  buffer_load_dwordx4 a[200:203], v241, s[32:35], s87 offen offset:0 sc1
  buffer_load_dwordx4 a[204:207], v241, s[32:35], s87 offen offset:1024 sc1
  buffer_load_dwordx4 a[208:211], v241, s[32:35], s87 offen offset:2048 sc1
  buffer_load_dwordx4 a[212:215], v241, s[32:35], s87 offen offset:3072 sc1
  buffer_load_dwordx4 a[216:219], v245, s[32:35], s87 offen sc1
  s_mul_i32 s87, s22, 5120
  s_add_u32 s87, s87, s83
  s_add_u32 s87, s87, 40960
  buffer_load_dwordx4 a[220:223], v241, s[32:35], s87 offen offset:0 sc1
  buffer_load_dwordx4 a[224:227], v241, s[32:35], s87 offen offset:1024 sc1
  buffer_load_dwordx4 a[228:231], v241, s[32:35], s87 offen offset:2048 sc1
  buffer_load_dwordx4 a[232:235], v241, s[32:35], s87 offen offset:3072 sc1
  buffer_load_dwordx4 a[236:239], v245, s[32:35], s87 offen sc1
  s_mov_b32 s100, 1
  s_waitcnt vmcnt(60)
  s_branch L_ph2
L_attn_0:
  v_lshlrev_b32 v241, 4, v255
  v_and_b32 v1, 15, v255
  v_lshrrev_b32 v2, 2, v1
  v_and_b32 v3, 3, v1
  v_lshrrev_b32 v4, 4, v255
  v_lshrrev_b32_e64 v5, 1, v2
  v_lshl_add_u32 v5, v4, 1, v5
  v_mul_u32_u24 v5, 1088, v5
  v_and_b32_e64 v2, 1, v2
  v_mul_u32_u24 v2, 480, v2
  v_lshlrev_b32_e64 v3, 3, v3
  v_add3_u32 v5, v5, v2, v3
  v_add_u32 v160, 18432, v5
  v_and_b32 v1, 15, v255
  v_lshrrev_b32 v4, 4, v255
  v_lshrrev_b32 v2, 1, v1
  v_xor_b32 v2, v2, v4
  v_lshlrev_b32_e64 v2, 4, v2
  v_lshl_add_u32 v2, v1, 7, v2
  v_add_u32 v161, 0, v2
  v_xor_b32 v2, 64, v2
  v_add_u32 v162, 0, v2
  v_and_b32 v1, 15, v255
  v_lshrrev_b32 v2, 4, v255
  v_lshlrev_b32 v3, 2, v2
  v_sub_u32 v3, v1, v3
  v_and_b32 v4, 1, v1
  v_mov_b32 v5, 0xf149f2ca
  v_cmp_eq_u32 s[64:65], 0, v4
  v_subrev_u32_e64 v6, 0, v3
  v_cmp_le_i32 s[66:67], 0, v6
  s_mov_b64 s[68:69], s[64:65]
  s_and_b64 s[70:71], s[68:69], s[66:67]
  s_andn2_b64 s[72:73], s[68:69], s[66:67]
  v_cndmask_b32_e64 v7, v5, 0, s[72:73]
  v_accvgpr_write_b32 a244, v7
  v_cndmask_b32_e64 v8, v5, 0, s[70:71]
  v_accvgpr_write_b32 a248, v8
  v_subrev_u32 v6, 1, v3
  v_cmp_le_i32 s[66:67], 0, v6
  s_andn2_b64 s[68:69], exec, s[64:65]
  s_and_b64 s[70:71], s[68:69], s[66:67]
  s_andn2_b64 s[72:73], s[68:69], s[66:67]
  v_cndmask_b32_e64 v7, v5, 0, s[72:73]
  v_accvgpr_write_b32 a245, v7
  v_cndmask_b32_e64 v8, v5, 0, s[70:71]
  v_accvgpr_write_b32 a249, v8
  v_subrev_u32 v6, 2, v3
  v_cmp_le_i32 s[66:67], 0, v6
  s_mov_b64 s[68:69], s[64:65]
  s_and_b64 s[70:71], s[68:69], s[66:67]
  s_andn2_b64 s[72:73], s[68:69], s[66:67]
  v_cndmask_b32_e64 v7, v5, 0, s[72:73]
  v_accvgpr_write_b32 a246, v7
  v_cndmask_b32_e64 v8, v5, 0, s[70:71]
  v_accvgpr_write_b32 a250, v8
  v_subrev_u32 v6, 3, v3
  v_cmp_le_i32 s[66:67], 0, v6
  s_andn2_b64 s[68:69], exec, s[64:65]
  s_and_b64 s[70:71], s[68:69], s[66:67]
  s_andn2_b64 s[72:73], s[68:69], s[66:67]
  v_cndmask_b32_e64 v7, v5, 0, s[72:73]
  v_accvgpr_write_b32 a247, v7
  v_cndmask_b32_e64 v8, v5, 0, s[70:71]
  v_accvgpr_write_b32 a251, v8
  v_sub_u32 v6, v3, v4
  v_mov_b32 v9, 0x0c0c0100
  v_mov_b32 v10, 0x01000c0c
  v_cndmask_b32_e64 v9, v10, v9, s[64:65]
  v_mov_b32 v10, 0x0c0c0302
  v_mov_b32 v11, 0x03020c0c
  v_cndmask_b32_e64 v10, v11, v10, s[64:65]
  v_mov_b32 v11, 0x0c0c0c0c
  v_cmp_le_i32 s[66:67], 0, v6
  s_nop 1
  v_cndmask_b32_e64 v12, v9, v11, s[66:67]
  v_accvgpr_write_b32 a252, v12
  v_cndmask_b32_e64 v13, v11, v9, s[66:67]
  v_accvgpr_write_b32 a254, v13
  v_cmp_le_i32 s[66:67], 2, v6
  s_nop 1
  v_cndmask_b32_e64 v12, v10, v11, s[66:67]
  v_accvgpr_write_b32 a253, v12
  v_cndmask_b32_e64 v13, v11, v10, s[66:67]
  v_accvgpr_write_b32 a255, v13
  s_cmp_lg_u32 s2, 0
  s_cbranch_scc1 L_nononce
  s_memrealtime s[96:97]
  s_waitcnt lgkmcnt(0)
  s_or_b32 s96, s96, 1
  v_mov_b32 v14, s96
  v_mov_b32 v15, 0
  buffer_store_dword v14, v15, s[76:79], 0 offen sc1
L_nononce:
  v_and_b32 v2, 7, v255
  v_lshlrev_b32 v7, 4, v2
  v_mov_b32 v8, 0x3f803f80
  v_mov_b32 v9, v8
  v_mov_b32 v10, v8
  v_mov_b32_e64 v11, v8
  ds_write_b128 v7, v[8:11]
  v_add_u32 v12, 53248, v7
  ds_write_b128 v12, v[8:11]
  v_add_u32 v13, 106496, v7
  ds_write_b128 v13, v[8:11]
  s_add_u32 s90, s93, 0
  v_add_u32 v166, s90, v163
  s_add_u32 s90, s93, 9216
  v_add_u32 v167, s90, v164
  s_add_u32 s90, s92, 0
  v_add_u32_e64 v168, s90, v163
  s_add_u32 s90, s92, 9216
  v_add_u32_e64 v169, s90, v164
  s_add_u32 s90, s92, 18432
  v_add_u32 v170, s90, v163
  v_add_u32 v171, 0, v165
  v_add_u32 v172, 6592, v165
  v_add_u32 v173, 28544, v165
  v_add_u32 v174, 35136, v165
  v_add_u32 v175, 61440, v165
  v_add_u32 v176, 68032, v165
  v_add_u32 v177, 89984, v165
  v_add_u32 v178, 96576, v165
  v_mov_b32 v232, 0
  v_mov_b32 v233, 0
  v_mov_b32 v234, 0
  v_mov_b32_e64 v235, 0
  s_nop 1
  v_mfma_f32_32x32x16_bf16 v[0:15], v[232:235], v[232:235], 0
  v_mfma_f32_32x32x16_bf16 v[16:31], v[232:235], v[232:235], 0
  v_mfma_f32_32x32x16_bf16 v[32:47], v[232:235], v[232:235], 0
  v_mfma_f32_32x32x16_bf16 v[48:63], v[232:235], v[232:235], 0
  v_mfma_f32_32x32x16_bf16 v[64:79], v[232:235], v[232:235], 0
  v_mfma_f32_32x32x16_bf16 v[80:95], v[232:235], v[232:235], 0
  v_mfma_f32_32x32x16_bf16 v[96:111], v[232:235], v[232:235], 0
  v_mfma_f32_32x32x16_bf16 v[112:127], v[232:235], v[232:235], 0
  v_mov_b32 v128, 0
  v_mov_b32 v129, 0
  v_mov_b32 v130, 0
  v_mov_b32 v131, 0
  v_mov_b32 v132, 0
  v_mov_b32 v133, 0
  v_mov_b32 v134, 0
  v_mov_b32 v135, 0
  v_mov_b32 v254, 0x3f803f80
  v_accvgpr_write_b32 a240, v254
  v_accvgpr_write_b32 a241, v254
  v_accvgpr_write_b32 a242, v254
  v_accvgpr_write_b32 a243, v254
  v_mov_b32 v249, 0
  s_lshl_b32 s39, s38, 7
  s_mul_i32 s40, s38, 245760
  s_mov_b32 s41, 53248
  s_add_u32 m0, s41, 0
  s_mov_b32 exec_lo, 0xffffff00
  buffer_load_dwordx4 v166, s[24:27], s39 offen offset:0 lds
  s_mov_b32 exec_lo, -1
  buffer_load_dwordx4 v167, s[24:27], s39 offen offset:1024 lds
  s_add_u32 m0, s41, 2048
  s_nop 0
  buffer_load_dwordx4 v168, s[24:27], s39 offen offset:0 lds
  buffer_load_dwordx4 v169, s[24:27], s39 offen offset:1024 lds
  buffer_load_dwordx4 v170, s[24:27], s39 offen offset:2048 lds
  s_add_u32 m0, s41, 18432
  s_nop 0
  buffer_load_dwordx4 v171, s[28:31], s40 offen offset:0 lds
  buffer_load_dwordx4 v172, s[28:31], s40 offen offset:1088 lds
  buffer_load_dwordx4 v173, s[28:31], s40 offen offset:2176 lds
  buffer_load_dwordx4 v174, s[28:31], s40 offen offset:3264 lds
  s_add_u32 m0, s41, 22784
  s_nop 0
  buffer_load_dwordx4 v175, s[28:31], s40 offen offset:0 lds
  buffer_load_dwordx4 v176, s[28:31], s40 offen offset:1088 lds
  buffer_load_dwordx4 v177, s[28:31], s40 offen offset:2176 lds
  buffer_load_dwordx4 v178, s[28:31], s40 offen offset:3264 lds
  s_add_u32 s38, s38, 1
  s_cmp_eq_u32 s38, 10
  s_cselect_b32 s38, 0, s38
  s_and_b32 s46, s2, 7
  s_lshr_b32 s47, s2, 3
  s_lshr_b32 s80, s47, 3
  s_lshl_b32 s46, s46, 2
  s_add_u32 s80, s80, s46
  s_and_b32 s81, s47, 7
  s_lshr_b32 s89, s80, 1
  s_lshl_b32 s89, s89, 2
  s_mul_i32 s83, s81, 378880
  s_add_u32 s83, s83, 10485760
  s_mul_i32 s84, s80, 303104
  s_mul_i32 s85, s22, 12288
  s_add_u32 s85, s85, 53248
  s_mul_i32 s86, s22, 13312
  s_add_u32 s86, s86, 106496
  s_mul_i32 s46, s81, 7
  s_lshr_b32 s46, s46, 2
  s_and_b32 s47, s80, 3
  s_mul_i32 s47, s47, 7
  s_lshr_b32 s47, s47, 1
  s_add_u32 s46, s46, s47
  s_sub_u32 s47, s46, 14
  s_cmp_ge_u32 s46, 14
  s_cselect_b32 s46, s47, s46
  s_lshl_b32 s46, s46, 2
  s_add_u32 s46, s46, s22
  s_add_u32 s46, s46, 20
  s_lshl_b32 s4, s46, 10
  s_cmp_ge_u32 s46, 74
  s_cselect_b32 s4, 0x10000000, s4
  s_add_u32 s46, s46, 4
  s_sub_u32 s47, s46, 56
  s_cmp_ge_u32 s46, 76
  s_cselect_b32 s46, s47, s46
  s_lshl_b32 s5, s46, 10
  s_cmp_ge_u32 s46, 74
  s_cselect_b32 s5, 0x10000000, s5
  s_add_u32 s46, s46, 4
  s_sub_u32 s47, s46, 56
  s_cmp_ge_u32 s46, 76
  s_cselect_b32 s46, s47, s46
  s_lshl_b32 s6, s46, 10
  s_cmp_ge_u32 s46, 74
  s_cselect_b32 s6, 0x10000000, s6
  s_add_u32 s46, s46, 4
  s_sub_u32 s47, s46, 56
  s_cmp_ge_u32 s46, 76
  s_cselect_b32 s46, s47, s46
  s_lshl_b32 s7, s46, 10
  s_cmp_ge_u32 s46, 74
  s_cselect_b32 s7, 0x10000000, s7
  s_add_u32 s46, s46, 4
  s_sub_u32 s47, s46, 56
  s_cmp_ge_u32 s46, 76
  s_cselect_b32 s46, s47, s46
  s_lshl_b32 s8, s46, 10
  s_cmp_ge_u32 s46, 74
  s_cselect_b32 s8, 0x10000000, s8
  s_add_u32 s46, s46, 4
  s_sub_u32 s47, s46, 56
  s_cmp_ge_u32 s46, 76
  s_cselect_b32 s46, s47, s46
  s_lshl_b32 s9, s46, 10
  s_cmp_ge_u32 s46, 74
  s_cselect_b32 s9, 0x10000000, s9
  s_add_u32 s46, s46, 4
  s_sub_u32 s47, s46, 56
  s_cmp_ge_u32 s46, 76
  s_cselect_b32 s46, s47, s46
  s_lshl_b32 s10, s46, 10
  s_cmp_ge_u32 s46, 74
  s_cselect_b32 s10, 0x10000000, s10
  s_add_u32 s46, s46, 4
  s_sub_u32 s47, s46, 56
  s_cmp_ge_u32 s46, 76
  s_cselect_b32 s46, s47, s46
  s_lshl_b32 s11, s46, 10
  s_cmp_ge_u32 s46, 74
  s_cselect_b32 s11, 0x10000000, s11
  s_add_u32 s46, s46, 4
  s_sub_u32 s47, s46, 56
  s_cmp_ge_u32 s46, 76
  s_cselect_b32 s46, s47, s46
  s_lshl_b32 s12, s46, 10
  s_cmp_ge_u32 s46, 74
  s_cselect_b32 s12, 0x10000000, s12
  s_add_u32 s46, s46, 4
  s_sub_u32 s47, s46, 56
  s_cmp_ge_u32 s46, 76
  s_cselect_b32 s46, s47, s46
  s_lshl_b32 s13, s46, 10
  s_cmp_ge_u32 s46, 74
  s_cselect_b32 s13, 0x10000000, s13
  s_add_u32 s46, s46, 4
  s_sub_u32 s47, s46, 56
  s_cmp_ge_u32 s46, 76
  s_cselect_b32 s46, s47, s46
  s_lshl_b32 s14, s46, 10
  s_cmp_ge_u32 s46, 74
  s_cselect_b32 s14, 0x10000000, s14
  s_add_u32 s46, s46, 4
  s_sub_u32 s47, s46, 56
  s_cmp_ge_u32 s46, 76
  s_cselect_b32 s46, s47, s46
  s_lshl_b32 s15, s46, 10
  s_cmp_ge_u32 s46, 74
  s_cselect_b32 s15, 0x10000000, s15
  s_add_u32 s46, s46, 4
  s_sub_u32 s47, s46, 56
  s_cmp_ge_u32 s46, 76
  s_cselect_b32 s46, s47, s46
  s_lshl_b32 s18, s46, 10
  s_cmp_ge_u32 s46, 74
  s_cselect_b32 s18, 0x10000000, s18
  s_add_u32 s46, s46, 4
  s_sub_u32 s47, s46, 56
  s_cmp_ge_u32 s46, 76
  s_cselect_b32 s46, s47, s46
  s_lshl_b32 s19, s46, 10
  s_cmp_ge_u32 s46, 74
  s_cselect_b32 s19, 0x10000000, s19
  v_add_u32 v245, 4096, v241
  s_lshl_b32 s45, s2, 7
  s_add_u32 s45, s45, 15728640
  s_lshl_b32 s39, s38, 7
  s_mul_i32 s40, s38, 245760
  s_mov_b32 s41, 106496
  s_mov_b32 s94, 53248
  s_mov_b32 s95, 4294860800
  s_mov_b32 s43, 0
  s_waitcnt vmcnt(13) lgkmcnt(0)
  s_barrier
  ds_read_b128 a[40:43], v161 offset:2048
  ds_read_b128 a[44:47], v161 offset:4096
  ds_read_b128 a[48:51], v161 offset:0
  ds_read_b64_tr_b16 a[0:1], v160 offset:0
  ds_read_b64_tr_b16 a[2:3], v160 offset:8704
  ds_read_b64_tr_b16 a[4:5], v160 offset:32
  ds_read_b64_tr_b16 a[6:7], v160 offset:8736
  ds_read_b64_tr_b16 a[8:9], v160 offset:64
  ds_read_b64_tr_b16 a[10:11], v160 offset:8768
  ds_read_b64_tr_b16 a[12:13], v160 offset:96
  ds_read_b64_tr_b16 a[14:15], v160 offset:8800
  ds_read_b64_tr_b16 a[16:17], v160 offset:128
  ds_read_b64_tr_b16 a[18:19], v160 offset:8832
  ds_read_b64_tr_b16 a[20:21], v160 offset:160
  ds_read_b64_tr_b16 a[22:23], v160 offset:8864
L_loop_attn_0:
  ds_read_b64_tr_b16 a[24:25], v160 offset:192
  s_waitcnt lgkmcnt(9)
  v_mfma_f32_16x16x32_bf16 v[0:3], a[0:3], a[40:43], v[0:3]
  ds_read_b64_tr_b16 a[26:27], v160 offset:8896
  v_mfma_f32_16x16x32_bf16 v[60:63], a[0:3], a[44:47], v[60:63]
  s_cmp_lg_u32 s43, 7
  s_cbranch_scc0 L_pp_attn_0
L_np_attn_0:
  v_mfma_f32_16x16x32_bf16 v[120:123], a[0:3], a[48:51], v[120:123]
  ds_read_b64_tr_b16 a[28:29], v160 offset:224
  v_mfma_f32_16x16x32_bf16 v[4:7], a[4:7], a[40:43], v[4:7]
  ds_read_b64_tr_b16 a[30:31], v160 offset:8928
  v_mfma_f32_16x16x32_bf16 v[64:67], a[4:7], a[44:47], v[64:67]
  s_add_u32 m0, s41, 0
  ds_read_b64_tr_b16 a[32:33], v160 offset:256
  s_waitcnt lgkmcnt(9)
  v_mfma_f32_16x16x32_bf16 v[8:11], a[8:11], a[40:43], v[8:11]
  ds_read_b64_tr_b16 a[34:35], v160 offset:8960
  v_mfma_f32_16x16x32_bf16 v[68:71], a[8:11], a[44:47], v[68:71]
  ds_read_b64_tr_b16 a[36:37], v160 offset:288
  v_mfma_f32_16x16x32_bf16 v[12:15], a[12:15], a[40:43], v[12:15]
  s_mov_b32 exec_lo, 0xffffff00
  buffer_load_dwordx4 v166, s[24:27], s39 offen offset:0 lds
  s_mov_b32 exec_lo, -1
  ds_read_b64_tr_b16 a[38:39], v160 offset:8992
  v_mfma_f32_16x16x32_bf16 v[72:75], a[12:15], a[44:47], v[72:75]
  ds_read_b64_tr_b16 a[0:1], v160 offset:320
  ds_read_b64_tr_b16 a[2:3], v160 offset:9024
  s_waitcnt lgkmcnt(10)
  v_mfma_f32_16x16x32_bf16 v[16:19], a[16:19], a[40:43], v[16:19]
  ds_read_b128 a[52:55], v162 offset:2048
  ds_read_b128 a[56:59], v162 offset:4096
  v_mfma_f32_16x16x32_bf16 v[76:79], a[16:19], a[44:47], v[76:79]
  ds_read_b128 a[60:63], v162 offset:0
  v_mfma_f32_16x16x32_bf16 v[132:135], a[16:19], a[48:51], v[132:135]
  buffer_load_dwordx4 v167, s[24:27], s39 offen offset:1024 lds
  s_add_u32 m0, s41, 2048
  ds_read_b64_tr_b16 a[4:5], v160 offset:352
  v_mfma_f32_16x16x32_bf16 v[20:23], a[20:23], a[40:43], v[20:23]
  ds_read_b64_tr_b16 a[6:7], v160 offset:9056
  v_mfma_f32_16x16x32_bf16 v[80:83], a[20:23], a[44:47], v[80:83]
  v_mfma_f32_16x16x32_bf16 v[124:127], a[20:23], a[48:51], v[124:127]
  buffer_load_dwordx4 v168, s[24:27], s39 offen offset:0 lds
  ds_read_b64_tr_b16 a[8:9], v160 offset:384
  s_waitcnt lgkmcnt(12)
  v_mfma_f32_16x16x32_bf16 v[24:27], a[24:27], a[40:43], v[24:27]
  ds_read_b64_tr_b16 a[10:11], v160 offset:9088
  v_mfma_f32_16x16x32_bf16 v[84:87], a[24:27], a[44:47], v[84:87]
  ds_read_b64_tr_b16 a[12:13], v160 offset:416
  v_mfma_f32_16x16x32_bf16 v[28:31], a[28:31], a[40:43], v[28:31]
  buffer_load_dwordx4 v169, s[24:27], s39 offen offset:1024 lds
  ds_read_b64_tr_b16 a[14:15], v160 offset:9120
  v_mfma_f32_16x16x32_bf16 v[88:91], a[28:31], a[44:47], v[88:91]
  ds_read_b64_tr_b16 a[16:17], v160 offset:448
  s_waitcnt lgkmcnt(12)
  v_mfma_f32_16x16x32_bf16 v[32:35], a[32:35], a[40:43], v[32:35]
  ds_read_b64_tr_b16 a[18:19], v160 offset:9152
  v_mfma_f32_16x16x32_bf16 v[92:95], a[32:35], a[44:47], v[92:95]
  ds_read_b64_tr_b16 a[20:21], v160 offset:17408
  v_mfma_f32_16x16x32_bf16 v[36:39], a[36:39], a[40:43], v[36:39]
  buffer_load_dwordx4 v170, s[24:27], s39 offen offset:2048 lds
  s_add_u32 m0, s41, 18432
  ds_read_b64_tr_b16 a[22:23], v160 offset:26112
  v_mfma_f32_16x16x32_bf16 v[96:99], a[36:39], a[44:47], v[96:99]
  ds_read_b64_tr_b16 a[24:25], v160 offset:17440
  s_waitcnt lgkmcnt(12)
  v_mfma_f32_16x16x32_bf16 v[40:43], a[40:43], a[0:3], v[40:43]
  ds_read_b64_tr_b16 a[26:27], v160 offset:26144
  v_mfma_f32_16x16x32_bf16 v[100:103], a[44:47], a[0:3], v[100:103]
  buffer_load_dwordx4 v171, s[28:31], s40 offen offset:0 lds
  v_mfma_f32_16x16x32_bf16 v[128:131], a[48:51], a[0:3], v[128:131]
  ds_read_b64_tr_b16 a[28:29], v160 offset:17472
  s_waitcnt lgkmcnt(9)
  v_mfma_f32_16x16x32_bf16 v[44:47], a[40:43], a[4:7], v[44:47]
  ds_read_b64_tr_b16 a[30:31], v160 offset:26176
  v_mfma_f32_16x16x32_bf16 v[104:107], a[44:47], a[4:7], v[104:107]
  buffer_load_dwordx4 v172, s[28:31], s40 offen offset:1088 lds
  ds_read_b64_tr_b16 a[32:33], v160 offset:17504
  v_mfma_f32_16x16x32_bf16 v[48:51], a[40:43], a[8:11], v[48:51]
  ds_read_b64_tr_b16 a[34:35], v160 offset:26208
  v_mfma_f32_16x16x32_bf16 v[108:111], a[44:47], a[8:11], v[108:111]
  ds_read_b64_tr_b16 a[36:37], v160 offset:17536
  s_waitcnt lgkmcnt(9)
  v_mfma_f32_16x16x32_bf16 v[52:55], a[40:43], a[12:15], v[52:55]
  ds_read_b64_tr_b16 a[38:39], v160 offset:26240
  v_mfma_f32_16x16x32_bf16 v[112:115], a[44:47], a[12:15], v[112:115]
  buffer_load_dwordx4 v173, s[28:31], s40 offen offset:2176 lds
  ds_read_b64_tr_b16 a[0:1], v160 offset:17568
  v_mfma_f32_16x16x32_bf16 v[56:59], a[40:43], a[16:19], v[56:59]
  ds_read_b64_tr_b16 a[2:3], v160 offset:26272
  v_mfma_f32_16x16x32_bf16 v[116:119], a[44:47], a[16:19], v[116:119]
  ds_read_b64_tr_b16 a[4:5], v160 offset:17600
  s_waitcnt lgkmcnt(9)
  v_mfma_f32_16x16x32_bf16 v[0:3], a[20:23], a[52:55], v[0:3]
  buffer_load_dwordx4 v174, s[28:31], s40 offen offset:3264 lds
  s_add_u32 m0, s41, 22784
  ds_read_b64_tr_b16 a[6:7], v160 offset:26304
  v_mfma_f32_16x16x32_bf16 v[60:63], a[20:23], a[56:59], v[60:63]
  v_mfma_f32_16x16x32_bf16 v[120:123], a[20:23], a[60:63], v[120:123]
  ds_read_b64_tr_b16 a[8:9], v160 offset:17632
  v_mfma_f32_16x16x32_bf16 v[4:7], a[24:27], a[52:55], v[4:7]
  buffer_load_dwordx4 v175, s[28:31], s40 offen offset:0 lds
  ds_read_b64_tr_b16 a[10:11], v160 offset:26336
  v_mfma_f32_16x16x32_bf16 v[64:67], a[24:27], a[56:59], v[64:67]
  ds_read_b64_tr_b16 a[12:13], v160 offset:17664
  s_waitcnt lgkmcnt(9)
  v_mfma_f32_16x16x32_bf16 v[8:11], a[28:31], a[52:55], v[8:11]
  ds_read_b64_tr_b16 a[14:15], v160 offset:26368
  v_mfma_f32_16x16x32_bf16 v[68:71], a[28:31], a[56:59], v[68:71]
  ds_read_b64_tr_b16 a[16:17], v160 offset:17696
  v_mfma_f32_16x16x32_bf16 v[12:15], a[32:35], a[52:55], v[12:15]
  buffer_load_dwordx4 v176, s[28:31], s40 offen offset:1088 lds
  ds_read_b64_tr_b16 a[18:19], v160 offset:26400
  v_mfma_f32_16x16x32_bf16 v[72:75], a[32:35], a[56:59], v[72:75]
  ds_read_b64_tr_b16 a[20:21], v160 offset:17728
  s_waitcnt lgkmcnt(9)
  v_mfma_f32_16x16x32_bf16 v[16:19], a[36:39], a[52:55], v[16:19]
  ds_read_b64_tr_b16 a[22:23], v160 offset:26432
  v_mfma_f32_16x16x32_bf16 v[76:79], a[36:39], a[56:59], v[76:79]
  buffer_load_dwordx4 v177, s[28:31], s40 offen offset:2176 lds
  v_mfma_f32_16x16x32_bf16 v[132:135], a[36:39], a[60:63], v[132:135]
  ds_read_b64_tr_b16 a[24:25], v160 offset:17760
  v_mfma_f32_16x16x32_bf16 v[20:23], a[0:3], a[52:55], v[20:23]
  ds_read_b64_tr_b16 a[26:27], v160 offset:26464
  v_mfma_f32_16x16x32_bf16 v[80:83], a[0:3], a[56:59], v[80:83]
  buffer_load_dwordx4 v178, s[28:31], s40 offen offset:3264 lds
  v_mfma_f32_16x16x32_bf16 v[124:127], a[0:3], a[60:63], v[124:127]
  ds_read_b64_tr_b16 a[28:29], v160 offset:17792
  s_waitcnt lgkmcnt(9)
  v_mfma_f32_16x16x32_bf16 v[24:27], a[4:7], a[52:55], v[24:27]
  ds_read_b64_tr_b16 a[30:31], v160 offset:26496
  v_mfma_f32_16x16x32_bf16 v[84:87], a[4:7], a[56:59], v[84:87]
  ds_read_b64_tr_b16 a[32:33], v160 offset:17824
  v_mfma_f32_16x16x32_bf16 v[28:31], a[8:11], a[52:55], v[28:31]
  ds_read_b64_tr_b16 a[34:35], v160 offset:26528
  v_mfma_f32_16x16x32_bf16 v[88:91], a[8:11], a[56:59], v[88:91]
  ds_read_b64_tr_b16 a[36:37], v160 offset:17856
  s_waitcnt lgkmcnt(9)
  v_mfma_f32_16x16x32_bf16 v[32:35], a[12:15], a[52:55], v[32:35]
  ds_read_b64_tr_b16 a[38:39], v160 offset:26560
  v_mfma_f32_16x16x32_bf16 v[92:95], a[12:15], a[56:59], v[92:95]
  v_mfma_f32_16x16x32_bf16 v[36:39], a[16:19], a[52:55], v[36:39]
  v_mfma_f32_16x16x32_bf16 v[96:99], a[16:19], a[56:59], v[96:99]
  s_waitcnt lgkmcnt(6)
  v_mfma_f32_16x16x32_bf16 v[40:43], a[52:55], a[20:23], v[40:43]
  v_mfma_f32_16x16x32_bf16 v[100:103], a[56:59], a[20:23], v[100:103]
  v_mfma_f32_16x16x32_bf16 v[128:131], a[60:63], a[20:23], v[128:131]
  s_waitcnt vmcnt(13) lgkmcnt(0)
  s_barrier
  v_mfma_f32_16x16x32_bf16 v[44:47], a[52:55], a[24:27], v[44:47]
  s_cmp_eq_u32 s41, 53248
  s_cselect_b32 s42, s95, s94
  v_add_u32 v160, s42, v160
  v_add_u32_e64 v161, s42, v161
  v_mfma_f32_16x16x32_bf16 v[104:107], a[56:59], a[24:27], v[104:107]
  v_add_u32_e64 v162, s42, v162
  ds_read_b128 a[40:43], v161 offset:2048
  ds_read_b128 a[44:47], v161 offset:4096
  ds_read_b128 a[48:51], v161 offset:0
  v_mfma_f32_16x16x32_bf16 v[48:51], a[52:55], a[28:31], v[48:51]
  ds_read_b64_tr_b16 a[0:1], v160 offset:0
  ds_read_b64_tr_b16 a[2:3], v160 offset:8704
  ds_read_b64_tr_b16 a[4:5], v160 offset:32
  ds_read_b64_tr_b16 a[6:7], v160 offset:8736
  v_mfma_f32_16x16x32_bf16 v[108:111], a[56:59], a[28:31], v[108:111]
  ds_read_b64_tr_b16 a[8:9], v160 offset:64
  ds_read_b64_tr_b16 a[10:11], v160 offset:8768
  ds_read_b64_tr_b16 a[12:13], v160 offset:96
  ds_read_b64_tr_b16 a[14:15], v160 offset:8800
  v_mfma_f32_16x16x32_bf16 v[52:55], a[52:55], a[32:35], v[52:55]
  ds_read_b64_tr_b16 a[16:17], v160 offset:128
  ds_read_b64_tr_b16 a[18:19], v160 offset:8832
  ds_read_b64_tr_b16 a[20:21], v160 offset:160
  ds_read_b64_tr_b16 a[22:23], v160 offset:8864
  v_mfma_f32_16x16x32_bf16 v[112:115], a[56:59], a[32:35], v[112:115]
  s_add_u32 s38, s38, 1
  s_cmp_eq_u32 s38, 10
  s_cselect_b32 s38, 0, s38
  s_lshl_b32 s39, s38, 7
  v_mfma_f32_16x16x32_bf16 v[56:59], a[52:55], a[36:39], v[56:59]
  s_mul_i32 s40, s38, 245760
  s_cmp_eq_u32 s41, 106496
  s_cselect_b32 s42, s95, s94
  s_add_u32 s41, s41, s42
  v_mfma_f32_16x16x32_bf16 v[116:119], a[56:59], a[36:39], v[116:119]
  s_add_u32 s43, s43, 1
  s_cmp_lt_u32 s43, 8
  s_cbranch_scc1 L_loop_attn_0
  v_readfirstlane_b32 s23, v252
  s_nop 3
  s_cmp_lg_u32 s23, 0
  s_cbranch_scc1 L_nok_attn_0
  s_mov_b32 s47, 0
  v_mov_b32_e64 v251, 0
L_nspin_attn_0:
  buffer_load_dword v250, v251, s[76:79], 0 offen sc1
  s_waitcnt vmcnt(0)
  v_readfirstlane_b32 s23, v250
  s_nop 3
  s_cmp_lg_u32 s23, 0
  s_cbranch_scc1 L_nok_attn_0
  s_sleep 8
  s_add_u32 s47, s47, 1
  s_cmp_lt_u32 s47, 200000
  s_cbranch_scc1 L_nspin_attn_0
L_nok_attn_0:
  v_readfirstlane_b32 s46, v253
  s_nop 3
  s_cmp_ge_u32 s46, 128
  s_cbranch_scc1 L_cok_p_attn_0
  s_mov_b32 s47, 0
  v_mov_b32_e64 v251, 0
L_cspin_p_attn_0:
  buffer_load_dword v250, v251, s[76:79], 0 offen offset:4 sc1
  s_waitcnt vmcnt(0)
  v_readfirstlane_b32 s46, v250
  s_nop 3
  s_cmp_ge_u32 s46, 128
  s_cbranch_scc1 L_cok_p_attn_0
  s_sleep 40
  s_add_u32 s47, s47, 1
  s_cmp_lt_u32 s47, 200000
  s_cbranch_scc1 L_cspin_p_attn_0
L_cok_p_attn_0:
  ds_read_b64_tr_b16 a[24:25], v160 offset:192
  s_waitcnt lgkmcnt(9)
  v_mfma_f32_16x16x32_bf16 v[0:3], a[0:3], a[40:43], v[0:3]
  ds_read_b64_tr_b16 a[26:27], v160 offset:8896
  v_mfma_f32_16x16x32_bf16 v[60:63], a[0:3], a[44:47], v[60:63]
  s_mul_i32 s87, s4, 5
  s_add_u32 s87, s87, s83
  s_add_u32 m0, s85, 0
  s_add_u32 s88, s87, 0
  buffer_load_dwordx4 v241, s[32:35], s88 offen sc1 lds
  v_mfma_f32_16x16x32_bf16 v[120:123], a[0:3], a[48:51], v[120:123]
  ds_read_b64_tr_b16 a[28:29], v160 offset:224
  v_mfma_f32_16x16x32_bf16 v[4:7], a[4:7], a[40:43], v[4:7]
  ds_read_b64_tr_b16 a[30:31], v160 offset:8928
  v_mfma_f32_16x16x32_bf16 v[64:67], a[4:7], a[44:47], v[64:67]
  ds_read_b64_tr_b16 a[32:33], v160 offset:256
  s_waitcnt lgkmcnt(9)
  v_mfma_f32_16x16x32_bf16 v[8:11], a[8:11], a[40:43], v[8:11]
  s_add_u32 m0, s85, 1024
  s_add_u32 s88, s87, 1024
  buffer_load_dwordx4 v241, s[32:35], s88 offen sc1 lds
  ds_read_b64_tr_b16 a[34:35], v160 offset:8960
  v_mfma_f32_16x16x32_bf16 v[68:71], a[8:11], a[44:47], v[68:71]
  ds_read_b64_tr_b16 a[36:37], v160 offset:288
  v_mfma_f32_16x16x32_bf16 v[12:15], a[12:15], a[40:43], v[12:15]
  ds_read_b64_tr_b16 a[38:39], v160 offset:8992
  v_mfma_f32_16x16x32_bf16 v[72:75], a[12:15], a[44:47], v[72:75]
  ds_read_b64_tr_b16 a[0:1], v160 offset:320
  ds_read_b64_tr_b16 a[2:3], v160 offset:9024
  s_waitcnt lgkmcnt(10)
  v_mfma_f32_16x16x32_bf16 v[16:19], a[16:19], a[40:43], v[16:19]
  s_add_u32 m0, s85, 2048
  s_add_u32 s88, s87, 2048
  buffer_load_dwordx4 v241, s[32:35], s88 offen sc1 lds
  ds_read_b128 a[52:55], v162 offset:2048
  ds_read_b128 a[56:59], v162 offset:4096
  v_mfma_f32_16x16x32_bf16 v[76:79], a[16:19], a[44:47], v[76:79]
  ds_read_b128 a[60:63], v162 offset:0
  v_mfma_f32_16x16x32_bf16 v[132:135], a[16:19], a[48:51], v[132:135]
  ds_read_b64_tr_b16 a[4:5], v160 offset:352
  v_mfma_f32_16x16x32_bf16 v[20:23], a[20:23], a[40:43], v[20:23]
  ds_read_b64_tr_b16 a[6:7], v160 offset:9056
  v_mfma_f32_16x16x32_bf16 v[80:83], a[20:23], a[44:47], v[80:83]
  s_add_u32 m0, s85, 3072
  s_add_u32 s88, s87, 3072
  buffer_load_dwordx4 v241, s[32:35], s88 offen sc1 lds
  v_mfma_f32_16x16x32_bf16 v[124:127], a[20:23], a[48:51], v[124:127]
  ds_read_b64_tr_b16 a[8:9], v160 offset:384
  s_waitcnt lgkmcnt(12)
  v_mfma_f32_16x16x32_bf16 v[24:27], a[24:27], a[40:43], v[24:27]
  ds_read_b64_tr_b16 a[10:11], v160 offset:9088
  v_mfma_f32_16x16x32_bf16 v[84:87], a[24:27], a[44:47], v[84:87]
  ds_read_b64_tr_b16 a[12:13], v160 offset:416
  v_mfma_f32_16x16x32_bf16 v[28:31], a[28:31], a[40:43], v[28:31]
  s_add_u32 m0, s85, 4096
  s_add_u32 s88, s87, 4096
  buffer_load_dwordx4 v241, s[32:35], s88 offen sc1 lds
  ds_read_b64_tr_b16 a[14:15], v160 offset:9120
  v_mfma_f32_16x16x32_bf16 v[88:91], a[28:31], a[44:47], v[88:91]
  ds_read_b64_tr_b16 a[16:17], v160 offset:448
  s_waitcnt lgkmcnt(12)
  v_mfma_f32_16x16x32_bf16 v[32:35], a[32:35], a[40:43], v[32:35]
  ds_read_b64_tr_b16 a[18:19], v160 offset:9152
  v_mfma_f32_16x16x32_bf16 v[92:95], a[32:35], a[44:47], v[92:95]
  ds_read_b64_tr_b16 a[20:21], v160 offset:17408
  v_mfma_f32_16x16x32_bf16 v[36:39], a[36:39], a[40:43], v[36:39]
  s_mul_i32 s87, s5, 5
  s_add_u32 s87, s87, s83
  s_add_u32 m0, s85, 5120
  s_add_u32 s88, s87, 0
  buffer_load_dwordx4 v241, s[32:35], s88 offen sc1 lds
  ds_read_b64_tr_b16 a[22:23], v160 offset:26112
  v_mfma_f32_16x16x32_bf16 v[96:99], a[36:39], a[44:47], v[96:99]
  ds_read_b64_tr_b16 a[24:25], v160 offset:17440
  s_waitcnt lgkmcnt(12)
  v_mfma_f32_16x16x32_bf16 v[40:43], a[40:43], a[0:3], v[40:43]
  ds_read_b64_tr_b16 a[26:27], v160 offset:26144
  v_mfma_f32_16x16x32_bf16 v[100:103], a[44:47], a[0:3], v[100:103]
  v_mfma_f32_16x16x32_bf16 v[128:131], a[48:51], a[0:3], v[128:131]
  ds_read_b64_tr_b16 a[28:29], v160 offset:17472
  s_waitcnt lgkmcnt(9)
  v_mfma_f32_16x16x32_bf16 v[44:47], a[40:43], a[4:7], v[44:47]
  s_add_u32 m0, s85, 6144
  s_add_u32 s88, s87, 1024
  buffer_load_dwordx4 v241, s[32:35], s88 offen sc1 lds
  ds_read_b64_tr_b16 a[30:31], v160 offset:26176
  v_mfma_f32_16x16x32_bf16 v[104:107], a[44:47], a[4:7], v[104:107]
  ds_read_b64_tr_b16 a[32:33], v160 offset:17504
  v_mfma_f32_16x16x32_bf16 v[48:51], a[40:43], a[8:11], v[48:51]
  ds_read_b64_tr_b16 a[34:35], v160 offset:26208
  v_mfma_f32_16x16x32_bf16 v[108:111], a[44:47], a[8:11], v[108:111]
  ds_read_b64_tr_b16 a[36:37], v160 offset:17536
  s_waitcnt lgkmcnt(9)
  v_mfma_f32_16x16x32_bf16 v[52:55], a[40:43], a[12:15], v[52:55]
  s_add_u32 m0, s85, 7168
  s_add_u32 s88, s87, 2048
  buffer_load_dwordx4 v241, s[32:35], s88 offen sc1 lds
  ds_read_b64_tr_b16 a[38:39], v160 offset:26240
  v_mfma_f32_16x16x32_bf16 v[112:115], a[44:47], a[12:15], v[112:115]
  ds_read_b64_tr_b16 a[0:1], v160 offset:17568
  v_mfma_f32_16x16x32_bf16 v[56:59], a[40:43], a[16:19], v[56:59]
  ds_read_b64_tr_b16 a[2:3], v160 offset:26272
  v_mfma_f32_16x16x32_bf16 v[116:119], a[44:47], a[16:19], v[116:119]
  ds_read_b64_tr_b16 a[4:5], v160 offset:17600
  s_waitcnt lgkmcnt(9)
  v_mfma_f32_16x16x32_bf16 v[0:3], a[20:23], a[52:55], v[0:3]
  s_add_u32 m0, s85, 8192
  s_add_u32 s88, s87, 3072
  buffer_load_dwordx4 v241, s[32:35], s88 offen sc1 lds
  ds_read_b64_tr_b16 a[6:7], v160 offset:26304
  v_mfma_f32_16x16x32_bf16 v[60:63], a[20:23], a[56:59], v[60:63]
  v_mfma_f32_16x16x32_bf16 v[120:123], a[20:23], a[60:63], v[120:123]
  ds_read_b64_tr_b16 a[8:9], v160 offset:17632
  v_mfma_f32_16x16x32_bf16 v[4:7], a[24:27], a[52:55], v[4:7]
  ds_read_b64_tr_b16 a[10:11], v160 offset:26336
  v_mfma_f32_16x16x32_bf16 v[64:67], a[24:27], a[56:59], v[64:67]
  s_add_u32 m0, s85, 9216
  s_add_u32 s88, s87, 4096
  buffer_load_dwordx4 v241, s[32:35], s88 offen sc1 lds
  ds_read_b64_tr_b16 a[12:13], v160 offset:17664
  s_waitcnt lgkmcnt(9)
  v_mfma_f32_16x16x32_bf16 v[8:11], a[28:31], a[52:55], v[8:11]
  ds_read_b64_tr_b16 a[14:15], v160 offset:26368
  v_mfma_f32_16x16x32_bf16 v[68:71], a[28:31], a[56:59], v[68:71]
  ds_read_b64_tr_b16 a[16:17], v160 offset:17696
  v_mfma_f32_16x16x32_bf16 v[12:15], a[32:35], a[52:55], v[12:15]
  ds_read_b64_tr_b16 a[18:19], v160 offset:26400
  v_mfma_f32_16x16x32_bf16 v[72:75], a[32:35], a[56:59], v[72:75]
  s_mul_i32 s87, s6, 5
  s_add_u32 s87, s87, s83
  s_add_u32 m0, s85, 10240
  s_add_u32 s88, s87, 0
  buffer_load_dwordx4 v241, s[32:35], s88 offen sc1 lds
  ds_read_b64_tr_b16 a[20:21], v160 offset:17728
  s_waitcnt lgkmcnt(9)
  v_mfma_f32_16x16x32_bf16 v[16:19], a[36:39], a[52:55], v[16:19]
  ds_read_b64_tr_b16 a[22:23], v160 offset:26432
  v_mfma_f32_16x16x32_bf16 v[76:79], a[36:39], a[56:59], v[76:79]
  v_mfma_f32_16x16x32_bf16 v[132:135], a[36:39], a[60:63], v[132:135]
  ds_read_b64_tr_b16 a[24:25], v160 offset:17760
  v_mfma_f32_16x16x32_bf16 v[20:23], a[0:3], a[52:55], v[20:23]
  s_add_u32 m0, s85, 11264
  s_add_u32 s88, s87, 1024
  buffer_load_dwordx4 v241, s[32:35], s88 offen sc1 lds
  ds_read_b64_tr_b16 a[26:27], v160 offset:26464
  v_mfma_f32_16x16x32_bf16 v[80:83], a[0:3], a[56:59], v[80:83]
  v_mfma_f32_16x16x32_bf16 v[124:127], a[0:3], a[60:63], v[124:127]
  ds_read_b64_tr_b16 a[28:29], v160 offset:17792
  s_waitcnt lgkmcnt(9)
  v_mfma_f32_16x16x32_bf16 v[24:27], a[4:7], a[52:55], v[24:27]
  ds_read_b64_tr_b16 a[30:31], v160 offset:26496
  v_mfma_f32_16x16x32_bf16 v[84:87], a[4:7], a[56:59], v[84:87]
  ds_read_b64_tr_b16 a[32:33], v160 offset:17824
  v_mfma_f32_16x16x32_bf16 v[28:31], a[8:11], a[52:55], v[28:31]
  ds_read_b64_tr_b16 a[34:35], v160 offset:26528
  v_mfma_f32_16x16x32_bf16 v[88:91], a[8:11], a[56:59], v[88:91]
  ds_read_b64_tr_b16 a[36:37], v160 offset:17856
  s_waitcnt lgkmcnt(9)
  v_mfma_f32_16x16x32_bf16 v[32:35], a[12:15], a[52:55], v[32:35]
  ds_read_b64_tr_b16 a[38:39], v160 offset:26560
  v_mfma_f32_16x16x32_bf16 v[92:95], a[12:15], a[56:59], v[92:95]
  v_mfma_f32_16x16x32_bf16 v[36:39], a[16:19], a[52:55], v[36:39]
  v_mfma_f32_16x16x32_bf16 v[96:99], a[16:19], a[56:59], v[96:99]
  s_waitcnt lgkmcnt(6)
  v_mfma_f32_16x16x32_bf16 v[40:43], a[52:55], a[20:23], v[40:43]
  v_mfma_f32_16x16x32_bf16 v[100:103], a[56:59], a[20:23], v[100:103]
  v_mfma_f32_16x16x32_bf16 v[128:131], a[60:63], a[20:23], v[128:131]
  s_waitcnt vmcnt(12) lgkmcnt(0)
  s_barrier
  v_mfma_f32_16x16x32_bf16 v[44:47], a[52:55], a[24:27], v[44:47]
  s_cmp_eq_u32 s41, 53248
  s_cselect_b32 s42, s95, s94
  v_add_u32_e64 v160, s42, v160
  v_mfma_f32_16x16x32_bf16 v[104:107], a[56:59], a[24:27], v[104:107]
  v_add_u32 v161, s42, v161
  v_add_u32 v162, s42, v162
  ds_read_b128 a[40:43], v161 offset:2048
  v_mfma_f32_16x16x32_bf16 v[48:51], a[52:55], a[28:31], v[48:51]
  ds_read_b128 a[44:47], v161 offset:4096
  ds_read_b128 a[48:51], v161 offset:0
  ds_read_b64_tr_b16 a[0:1], v160 offset:0
  v_mfma_f32_16x16x32_bf16 v[108:111], a[56:59], a[28:31], v[108:111]
  ds_read_b64_tr_b16 a[2:3], v160 offset:8704
  ds_read_b64_tr_b16 a[4:5], v160 offset:32
  ds_read_b64_tr_b16 a[6:7], v160 offset:8736
  v_mfma_f32_16x16x32_bf16 v[52:55], a[52:55], a[32:35], v[52:55]
  ds_read_b64_tr_b16 a[8:9], v160 offset:64
  ds_read_b64_tr_b16 a[10:11], v160 offset:8768
  ds_read_b64_tr_b16 a[12:13], v160 offset:96
  v_mfma_f32_16x16x32_bf16 v[112:115], a[56:59], a[32:35], v[112:115]
  ds_read_b64_tr_b16 a[14:15], v160 offset:8800
  ds_read_b64_tr_b16 a[16:17], v160 offset:128
  ds_read_b64_tr_b16 a[18:19], v160 offset:8832
  v_mfma_f32_16x16x32_bf16 v[56:59], a[52:55], a[36:39], v[56:59]
  ds_read_b64_tr_b16 a[20:21], v160 offset:160
  ds_read_b64_tr_b16 a[22:23], v160 offset:8864
  v_mfma_f32_16x16x32_bf16 v[116:119], a[56:59], a[36:39], v[116:119]
  v_and_b32 v251, 15, v255
  v_lshlrev_b32 v251, 4, v251
  s_lshl_b32 s74, s36, 7
  s_sub_u32 s101, s74, 16
  s_cmp_eq_u32 s36, 0
  s_cselect_b32 s101, 0, s101
  s_add_u32 s74, s74, 0
  s_add_u32 s75, s74, 16
  ds_read_b64_tr_b16 a[24:25], v160 offset:192
  s_waitcnt lgkmcnt(9)
  v_mfma_f32_16x16x32_bf16 v[0:3], a[0:3], a[40:43], v[0:3]
  ds_read_b64_tr_b16 a[26:27], v160 offset:8896
  v_mfma_f32_16x16x32_bf16 v[60:63], a[0:3], a[44:47], v[60:63]
  s_lshl_b32 s88, s74, 4
  s_add_u32 s88, s88, 14745600
  buffer_load_dwordx4 v[180:183], v251, s[32:35], s88 offen sc1
  v_mfma_f32_16x16x32_bf16 v[120:123], a[0:3], a[48:51], v[120:123]
  ds_read_b64_tr_b16 a[28:29], v160 offset:224
  v_mfma_f32_16x16x32_bf16 v[4:7], a[4:7], a[40:43], v[4:7]
  ds_read_b64_tr_b16 a[30:31], v160 offset:8928
  v_mfma_f32_16x16x32_bf16 v[64:67], a[4:7], a[44:47], v[64:67]
  s_lshl_b32 s88, s75, 4
  s_add_u32 s88, s88, 14745600
  buffer_load_dwordx4 v[184:187], v251, s[32:35], s88 offen sc1
  ds_read_b64_tr_b16 a[32:33], v160 offset:256
  s_waitcnt lgkmcnt(9)
  v_mfma_f32_16x16x32_bf16 v[8:11], a[8:11], a[40:43], v[8:11]
  ds_read_b64_tr_b16 a[34:35], v160 offset:8960
  v_mfma_f32_16x16x32_bf16 v[68:71], a[8:11], a[44:47], v[68:71]
  ds_read_b64_tr_b16 a[36:37], v160 offset:288
  v_mfma_f32_16x16x32_bf16 v[12:15], a[12:15], a[40:43], v[12:15]
  s_lshl_b32 s88, s101, 4
  s_add_u32 s88, s88, 14745600
  buffer_load_dwordx4 v[188:191], v251, s[32:35], s88 offen sc1
  ds_read_b64_tr_b16 a[38:39], v160 offset:8992
  v_mfma_f32_16x16x32_bf16 v[72:75], a[12:15], a[44:47], v[72:75]
  ds_read_b64_tr_b16 a[0:1], v160 offset:320
  ds_read_b64_tr_b16 a[2:3], v160 offset:9024
  s_waitcnt lgkmcnt(10)
  v_mfma_f32_16x16x32_bf16 v[16:19], a[16:19], a[40:43], v[16:19]
  ds_read_b128 a[52:55], v162 offset:2048
  ds_read_b128 a[56:59], v162 offset:4096
  v_mfma_f32_16x16x32_bf16 v[76:79], a[16:19], a[44:47], v[76:79]
  s_mul_i32 s87, s6, 5
  s_add_u32 s87, s87, s83
  s_add_u32 m0, s86, 0
  s_add_u32 s88, s87, 2048
  buffer_load_dwordx4 v241, s[32:35], s88 offen sc1 lds
  ds_read_b128 a[60:63], v162 offset:0
  v_mfma_f32_16x16x32_bf16 v[132:135], a[16:19], a[48:51], v[132:135]
  ds_read_b64_tr_b16 a[4:5], v160 offset:352
  v_mfma_f32_16x16x32_bf16 v[20:23], a[20:23], a[40:43], v[20:23]
  ds_read_b64_tr_b16 a[6:7], v160 offset:9056
  v_mfma_f32_16x16x32_bf16 v[80:83], a[20:23], a[44:47], v[80:83]
  s_add_u32 m0, s86, 1024
  s_add_u32 s88, s87, 3072
  buffer_load_dwordx4 v241, s[32:35], s88 offen sc1 lds
  v_mfma_f32_16x16x32_bf16 v[124:127], a[20:23], a[48:51], v[124:127]
  ds_read_b64_tr_b16 a[8:9], v160 offset:384
  s_waitcnt lgkmcnt(12)
  v_mfma_f32_16x16x32_bf16 v[24:27], a[24:27], a[40:43], v[24:27]
  ds_read_b64_tr_b16 a[10:11], v160 offset:9088
  v_mfma_f32_16x16x32_bf16 v[84:87], a[24:27], a[44:47], v[84:87]
  s_add_u32 m0, s86, 2048
  s_add_u32 s88, s87, 4096
  buffer_load_dwordx4 v241, s[32:35], s88 offen sc1 lds
  ds_read_b64_tr_b16 a[12:13], v160 offset:416
  v_mfma_f32_16x16x32_bf16 v[28:31], a[28:31], a[40:43], v[28:31]
  ds_read_b64_tr_b16 a[14:15], v160 offset:9120
  v_mfma_f32_16x16x32_bf16 v[88:91], a[28:31], a[44:47], v[88:91]
  ds_read_b64_tr_b16 a[16:17], v160 offset:448
  s_waitcnt lgkmcnt(12)
  v_mfma_f32_16x16x32_bf16 v[32:35], a[32:35], a[40:43], v[32:35]
  s_mul_i32 s87, s7, 5
  s_add_u32 s87, s87, s83
  s_add_u32 m0, s86, 3072
  s_add_u32 s88, s87, 0
  buffer_load_dwordx4 v241, s[32:35], s88 offen sc1 lds
  ds_read_b64_tr_b16 a[18:19], v160 offset:9152
  v_mfma_f32_16x16x32_bf16 v[92:95], a[32:35], a[44:47], v[92:95]
  ds_read_b64_tr_b16 a[20:21], v160 offset:17408
  v_mfma_f32_16x16x32_bf16 v[36:39], a[36:39], a[40:43], v[36:39]
  ds_read_b64_tr_b16 a[22:23], v160 offset:26112
  v_mfma_f32_16x16x32_bf16 v[96:99], a[36:39], a[44:47], v[96:99]
  s_add_u32 m0, s86, 4096
  s_add_u32 s88, s87, 1024
  buffer_load_dwordx4 v241, s[32:35], s88 offen sc1 lds
  ds_read_b64_tr_b16 a[24:25], v160 offset:17440
  s_waitcnt lgkmcnt(12)
  v_mfma_f32_16x16x32_bf16 v[40:43], a[40:43], a[0:3], v[40:43]
  ds_read_b64_tr_b16 a[26:27], v160 offset:26144
  v_mfma_f32_16x16x32_bf16 v[100:103], a[44:47], a[0:3], v[100:103]
  v_mfma_f32_16x16x32_bf16 v[128:131], a[48:51], a[0:3], v[128:131]
  ds_read_b64_tr_b16 a[28:29], v160 offset:17472
  s_waitcnt lgkmcnt(9)
  v_mfma_f32_16x16x32_bf16 v[44:47], a[40:43], a[4:7], v[44:47]
  s_add_u32 m0, s86, 5120
  s_add_u32 s88, s87, 2048
  buffer_load_dwordx4 v241, s[32:35], s88 offen sc1 lds
  ds_read_b64_tr_b16 a[30:31], v160 offset:26176
  v_mfma_f32_16x16x32_bf16 v[104:107], a[44:47], a[4:7], v[104:107]
  ds_read_b64_tr_b16 a[32:33], v160 offset:17504
  v_mfma_f32_16x16x32_bf16 v[48:51], a[40:43], a[8:11], v[48:51]
  ds_read_b64_tr_b16 a[34:35], v160 offset:26208
  v_mfma_f32_16x16x32_bf16 v[108:111], a[44:47], a[8:11], v[108:111]
  s_add_u32 m0, s86, 6144
  s_add_u32 s88, s87, 3072
  buffer_load_dwordx4 v241, s[32:35], s88 offen sc1 lds
  ds_read_b64_tr_b16 a[36:37], v160 offset:17536
  s_waitcnt lgkmcnt(9)
  v_mfma_f32_16x16x32_bf16 v[52:55], a[40:43], a[12:15], v[52:55]
  ds_read_b64_tr_b16 a[38:39], v160 offset:26240
  v_mfma_f32_16x16x32_bf16 v[112:115], a[44:47], a[12:15], v[112:115]
  ds_read_b64_tr_b16 a[0:1], v160 offset:17568
  v_mfma_f32_16x16x32_bf16 v[56:59], a[40:43], a[16:19], v[56:59]
  s_add_u32 m0, s86, 7168
  s_add_u32 s88, s87, 4096
  buffer_load_dwordx4 v241, s[32:35], s88 offen sc1 lds
  ds_read_b64_tr_b16 a[2:3], v160 offset:26272
  v_mfma_f32_16x16x32_bf16 v[116:119], a[44:47], a[16:19], v[116:119]
  ds_read_b64_tr_b16 a[4:5], v160 offset:17600
  s_waitcnt lgkmcnt(9)
  v_mfma_f32_16x16x32_bf16 v[0:3], a[20:23], a[52:55], v[0:3]
  ds_read_b64_tr_b16 a[6:7], v160 offset:26304
  v_mfma_f32_16x16x32_bf16 v[60:63], a[20:23], a[56:59], v[60:63]
  s_mul_i32 s87, s8, 5
  s_add_u32 s87, s87, s83
  s_add_u32 m0, s86, 8192
  s_add_u32 s88, s87, 0
  buffer_load_dwordx4 v241, s[32:35], s88 offen sc1 lds
  v_mfma_f32_16x16x32_bf16 v[120:123], a[20:23], a[60:63], v[120:123]
  ds_read_b64_tr_b16 a[8:9], v160 offset:17632
  v_mfma_f32_16x16x32_bf16 v[4:7], a[24:27], a[52:55], v[4:7]
  ds_read_b64_tr_b16 a[10:11], v160 offset:26336
  v_mfma_f32_16x16x32_bf16 v[64:67], a[24:27], a[56:59], v[64:67]
  s_add_u32 m0, s86, 9216
  s_add_u32 s88, s87, 1024
  buffer_load_dwordx4 v241, s[32:35], s88 offen sc1 lds
  ds_read_b64_tr_b16 a[12:13], v160 offset:17664
  s_waitcnt lgkmcnt(9)
  v_mfma_f32_16x16x32_bf16 v[8:11], a[28:31], a[52:55], v[8:11]
  ds_read_b64_tr_b16 a[14:15], v160 offset:26368
  v_mfma_f32_16x16x32_bf16 v[68:71], a[28:31], a[56:59], v[68:71]
  ds_read_b64_tr_b16 a[16:17], v160 offset:17696
  v_mfma_f32_16x16x32_bf16 v[12:15], a[32:35], a[52:55], v[12:15]
  s_add_u32 m0, s86, 10240
  s_add_u32 s88, s87, 2048
  buffer_load_dwordx4 v241, s[32:35], s88 offen sc1 lds
  ds_read_b64_tr_b16 a[18:19], v160 offset:26400
  v_mfma_f32_16x16x32_bf16 v[72:75], a[32:35], a[56:59], v[72:75]
  ds_read_b64_tr_b16 a[20:21], v160 offset:17728
  s_waitcnt lgkmcnt(9)
  v_mfma_f32_16x16x32_bf16 v[16:19], a[36:39], a[52:55], v[16:19]
  ds_read_b64_tr_b16 a[22:23], v160 offset:26432
  v_mfma_f32_16x16x32_bf16 v[76:79], a[36:39], a[56:59], v[76:79]
  s_add_u32 m0, s86, 11264
  s_add_u32 s88, s87, 3072
  buffer_load_dwordx4 v241, s[32:35], s88 offen sc1 lds
  v_mfma_f32_16x16x32_bf16 v[132:135], a[36:39], a[60:63], v[132:135]
  ds_read_b64_tr_b16 a[24:25], v160 offset:17760
  v_mfma_f32_16x16x32_bf16 v[20:23], a[0:3], a[52:55], v[20:23]
  ds_read_b64_tr_b16 a[26:27], v160 offset:26464
  v_mfma_f32_16x16x32_bf16 v[80:83], a[0:3], a[56:59], v[80:83]
  s_add_u32 m0, s86, 12288
  s_add_u32 s88, s87, 4096
  buffer_load_dwordx4 v241, s[32:35], s88 offen sc1 lds
  v_mfma_f32_16x16x32_bf16 v[124:127], a[0:3], a[60:63], v[124:127]
  ds_read_b64_tr_b16 a[28:29], v160 offset:17792
  s_waitcnt lgkmcnt(9)
  v_mfma_f32_16x16x32_bf16 v[24:27], a[4:7], a[52:55], v[24:27]
  ds_read_b64_tr_b16 a[30:31], v160 offset:26496
  v_mfma_f32_16x16x32_bf16 v[84:87], a[4:7], a[56:59], v[84:87]
  ds_read_b64_tr_b16 a[32:33], v160 offset:17824
  v_mfma_f32_16x16x32_bf16 v[28:31], a[8:11], a[52:55], v[28:31]
  ds_read_b64_tr_b16 a[34:35], v160 offset:26528
  v_mfma_f32_16x16x32_bf16 v[88:91], a[8:11], a[56:59], v[88:91]
  ds_read_b64_tr_b16 a[36:37], v160 offset:17856
  s_waitcnt lgkmcnt(9)
  v_mfma_f32_16x16x32_bf16 v[32:35], a[12:15], a[52:55], v[32:35]
  ds_read_b64_tr_b16 a[38:39], v160 offset:26560
  v_mfma_f32_16x16x32_bf16 v[92:95], a[12:15], a[56:59], v[92:95]
  v_mfma_f32_16x16x32_bf16 v[36:39], a[16:19], a[52:55], v[36:39]
  v_mfma_f32_16x16x32_bf16 v[96:99], a[16:19], a[56:59], v[96:99]
  s_waitcnt lgkmcnt(6)
  v_mfma_f32_16x16x32_bf16 v[40:43], a[52:55], a[20:23], v[40:43]
  v_mfma_f32_16x16x32_bf16 v[100:103], a[56:59], a[20:23], v[100:103]
  v_mfma_f32_16x16x32_bf16 v[128:131], a[60:63], a[20:23], v[128:131]
  s_waitcnt lgkmcnt(0)
  s_barrier
  v_mfma_f32_16x16x32_bf16 v[44:47], a[52:55], a[24:27], v[44:47]
  v_mfma_f32_16x16x32_bf16 v[104:107], a[56:59], a[24:27], v[104:107]
  v_mfma_f32_16x16x32_bf16 v[48:51], a[52:55], a[28:31], v[48:51]
  v_mfma_f32_16x16x32_bf16 v[108:111], a[56:59], a[28:31], v[108:111]
  v_mfma_f32_16x16x32_bf16 v[52:55], a[52:55], a[32:35], v[52:55]
  v_mfma_f32_16x16x32_bf16 v[112:115], a[56:59], a[32:35], v[112:115]
  v_mfma_f32_16x16x32_bf16 v[56:59], a[52:55], a[36:39], v[56:59]
  v_mfma_f32_16x16x32_bf16 v[116:119], a[56:59], a[36:39], v[116:119]
  s_branch L_ep_attn
L_pp_attn_0:
  buffer_load_dwordx2 v[252:253], v249, s[76:79], 0 offen sc1
  s_branch L_np_attn_0
L_attn_1:
  v_lshlrev_b32 v241, 4, v255
  v_and_b32 v1, 15, v255
  v_lshrrev_b32 v2, 2, v1
  v_and_b32 v3, 3, v1
  v_lshrrev_b32 v4, 4, v255
  v_lshrrev_b32 v5, 1, v2
  v_lshl_add_u32 v5, v4, 1, v5
  v_mul_u32_u24 v5, 1088, v5
  v_and_b32_e64 v2, 1, v2
  v_mul_u32_u24 v2, 480, v2
  v_lshlrev_b32_e64 v3, 3, v3
  v_add3_u32 v5, v5, v2, v3
  v_add_u32 v160, 18432, v5
  v_and_b32 v1, 15, v255
  v_lshrrev_b32 v4, 4, v255
  v_lshrrev_b32 v2, 1, v1
  v_xor_b32 v2, v2, v4
  v_lshlrev_b32_e64 v2, 4, v2
  v_lshl_add_u32 v2, v1, 7, v2
  v_add_u32 v161, 0, v2
  v_xor_b32 v2, 64, v2
  v_add_u32 v162, 0, v2
  v_and_b32 v1, 15, v255
  v_lshrrev_b32 v2, 4, v255
  v_lshlrev_b32 v3, 2, v2
  v_sub_u32 v3, v1, v3
  v_and_b32 v4, 1, v1
  v_mov_b32 v5, 0xf149f2ca
  v_cmp_eq_u32 s[64:65], 0, v4
  v_subrev_u32_e64 v6, 0, v3
  v_cmp_le_i32 s[66:67], 0, v6
  s_mov_b64 s[68:69], s[64:65]
  s_and_b64 s[70:71], s[68:69], s[66:67]
  s_andn2_b64 s[72:73], s[68:69], s[66:67]
  v_cndmask_b32_e64 v7, v5, 0, s[72:73]
  v_accvgpr_write_b32 a244, v7
  v_cndmask_b32_e64 v8, v5, 0, s[70:71]
  v_accvgpr_write_b32 a248, v8
  v_subrev_u32 v6, 1, v3
  v_cmp_le_i32 s[66:67], 0, v6
  s_andn2_b64 s[68:69], exec, s[64:65]
  s_and_b64 s[70:71], s[68:69], s[66:67]
  s_andn2_b64 s[72:73], s[68:69], s[66:67]
  v_cndmask_b32_e64 v7, v5, 0, s[72:73]
  v_accvgpr_write_b32 a245, v7
  v_cndmask_b32_e64 v8, v5, 0, s[70:71]
  v_accvgpr_write_b32 a249, v8
  v_subrev_u32 v6, 2, v3
  v_cmp_le_i32 s[66:67], 0, v6
  s_mov_b64 s[68:69], s[64:65]
  s_and_b64 s[70:71], s[68:69], s[66:67]
  s_andn2_b64 s[72:73], s[68:69], s[66:67]
  v_cndmask_b32_e64 v7, v5, 0, s[72:73]
  v_accvgpr_write_b32 a246, v7
  v_cndmask_b32_e64 v8, v5, 0, s[70:71]
  v_accvgpr_write_b32 a250, v8
  v_subrev_u32 v6, 3, v3
  v_cmp_le_i32 s[66:67], 0, v6
  s_andn2_b64 s[68:69], exec, s[64:65]
  s_and_b64 s[70:71], s[68:69], s[66:67]
  s_andn2_b64 s[72:73], s[68:69], s[66:67]
  v_cndmask_b32_e64 v7, v5, 0, s[72:73]
  v_accvgpr_write_b32 a247, v7
  v_cndmask_b32_e64 v8, v5, 0, s[70:71]
  v_accvgpr_write_b32 a251, v8
  v_sub_u32 v6, v3, v4
  v_mov_b32 v9, 0x0c0c0100
  v_mov_b32 v10, 0x01000c0c
  v_cndmask_b32_e64 v9, v10, v9, s[64:65]
  v_mov_b32 v10, 0x0c0c0302
  v_mov_b32 v11, 0x03020c0c
  v_cndmask_b32_e64 v10, v11, v10, s[64:65]
  v_mov_b32 v11, 0x0c0c0c0c
  v_cmp_le_i32 s[66:67], 0, v6
  s_nop 1
  v_cndmask_b32_e64 v12, v9, v11, s[66:67]
  v_accvgpr_write_b32 a252, v12
  v_cndmask_b32_e64 v13, v11, v9, s[66:67]
  v_accvgpr_write_b32 a254, v13
  v_cmp_le_i32 s[66:67], 2, v6
  s_nop 1
  v_cndmask_b32_e64 v12, v10, v11, s[66:67]
  v_accvgpr_write_b32 a253, v12
  v_cndmask_b32_e64 v13, v11, v10, s[66:67]
  v_accvgpr_write_b32 a255, v13
  s_add_u32 s90, s92, 30720
  v_add_u32_e64 v166, s90, v164
  s_add_u32 s90, s92, 39936
  v_add_u32_e64 v167, s90, v163
  s_add_u32 s90, s92, 49152
  v_add_u32_e64 v168, s90, v164
  s_add_u32 s90, s92, 58368
  v_add_u32_e64 v169, s90, v163
  s_add_u32 s90, s92, 71680
  v_add_u32_e64 v170, s90, v164
  v_add_u32 v171, 15360, v165
  v_add_u32 v172, 21952, v165
  v_add_u32 v173, 43904, v165
  v_add_u32 v174, 50496, v165
  v_add_u32 v175, 76800, v165
  v_add_u32 v176, 83392, v165
  v_add_u32 v177, 105344, v165
  v_add_u32 v178, 111936, v165
  v_mov_b32 v232, 0
  v_mov_b32 v233, 0
  v_mov_b32 v234, 0
  v_mov_b32_e64 v235, 0
  s_nop 1
  v_mfma_f32_32x32x16_bf16 v[0:15], v[232:235], v[232:235], 0
  v_mfma_f32_32x32x16_bf16 v[16:31], v[232:235], v[232:235], 0
  v_mfma_f32_32x32x16_bf16 v[32:47], v[232:235], v[232:235], 0
  v_mfma_f32_32x32x16_bf16 v[48:63], v[232:235], v[232:235], 0
  v_mfma_f32_32x32x16_bf16 v[64:79], v[232:235], v[232:235], 0
  v_mfma_f32_32x32x16_bf16 v[80:95], v[232:235], v[232:235], 0
  v_mfma_f32_32x32x16_bf16 v[96:111], v[232:235], v[232:235], 0
  v_mfma_f32_32x32x16_bf16 v[112:127], v[232:235], v[232:235], 0
  v_mov_b32 v128, 0
  v_mov_b32 v129, 0
  v_mov_b32 v130, 0
  v_mov_b32 v131, 0
  v_mov_b32 v132, 0
  v_mov_b32 v133, 0
  v_mov_b32 v134, 0
  v_mov_b32 v135, 0
  v_mov_b32 v254, 0x3f803f80
  v_accvgpr_write_b32 a240, v254
  v_accvgpr_write_b32 a241, v254
  v_accvgpr_write_b32 a242, v254
  v_accvgpr_write_b32 a243, v254
  v_mov_b32 v249, 0
  s_lshl_b32 s39, s38, 7
  s_mul_i32 s40, s38, 245760
  s_mov_b32 s41, 53248
  s_add_u32 m0, s41, 5120
  s_nop 0
  buffer_load_dwordx4 v166, s[24:27], s39 offen offset:0 lds
  buffer_load_dwordx4 v167, s[24:27], s39 offen offset:1024 lds
  buffer_load_dwordx4 v168, s[24:27], s39 offen offset:2048 lds
  buffer_load_dwordx4 v169, s[24:27], s39 offen offset:3072 lds
  s_add_u32 m0, s41, 9216
  s_nop 0
  buffer_load_dwordx4 v170, s[24:27], s39 offen offset:0 lds
  s_add_u32 m0, s41, 27136
  s_nop 0
  buffer_load_dwordx4 v171, s[28:31], s40 offen offset:0 lds
  buffer_load_dwordx4 v172, s[28:31], s40 offen offset:1088 lds
  buffer_load_dwordx4 v173, s[28:31], s40 offen offset:2176 lds
  buffer_load_dwordx4 v174, s[28:31], s40 offen offset:3264 lds
  s_add_u32 m0, s41, 31488
  s_nop 0
  buffer_load_dwordx4 v175, s[28:31], s40 offen offset:0 lds
  buffer_load_dwordx4 v176, s[28:31], s40 offen offset:1088 lds
  buffer_load_dwordx4 v177, s[28:31], s40 offen offset:2176 lds
  buffer_load_dwordx4 v178, s[28:31], s40 offen offset:3264 lds
  s_add_u32 s38, s38, 1
  s_cmp_eq_u32 s38, 10
  s_cselect_b32 s38, 0, s38
  s_and_b32 s46, s2, 7
  s_lshr_b32 s47, s2, 3
  s_lshr_b32 s80, s47, 3
  s_lshl_b32 s46, s46, 2
  s_add_u32 s80, s80, s46
  s_and_b32 s81, s47, 7
  s_lshr_b32 s89, s80, 1
  s_lshl_b32 s89, s89, 2
  s_mul_i32 s83, s81, 378880
  s_add_u32 s83, s83, 10485760
  s_mul_i32 s84, s80, 303104
  s_mul_i32 s85, s22, 12288
  s_add_u32 s85, s85, 53248
  s_mul_i32 s86, s22, 13312
  s_add_u32 s86, s86, 106496
  s_mul_i32 s46, s81, 7
  s_lshr_b32 s46, s46, 2
  s_and_b32 s47, s80, 3
  s_mul_i32 s47, s47, 7
  s_lshr_b32 s47, s47, 1
  s_add_u32 s46, s46, s47
  s_sub_u32 s47, s46, 14
  s_cmp_ge_u32 s46, 14
  s_cselect_b32 s46, s47, s46
  s_lshl_b32 s46, s46, 2
  s_add_u32 s46, s46, s22
  s_add_u32 s46, s46, 20
  s_lshl_b32 s4, s46, 10
  s_cmp_ge_u32 s46, 74
  s_cselect_b32 s4, 0x10000000, s4
  s_add_u32 s46, s46, 4
  s_sub_u32 s47, s46, 56
  s_cmp_ge_u32 s46, 76
  s_cselect_b32 s46, s47, s46
  s_lshl_b32 s5, s46, 10
  s_cmp_ge_u32 s46, 74
  s_cselect_b32 s5, 0x10000000, s5
  s_add_u32 s46, s46, 4
  s_sub_u32 s47, s46, 56
  s_cmp_ge_u32 s46, 76
  s_cselect_b32 s46, s47, s46
  s_lshl_b32 s6, s46, 10
  s_cmp_ge_u32 s46, 74
  s_cselect_b32 s6, 0x10000000, s6
  s_add_u32 s46, s46, 4
  s_sub_u32 s47, s46, 56
  s_cmp_ge_u32 s46, 76
  s_cselect_b32 s46, s47, s46
  s_lshl_b32 s7, s46, 10
  s_cmp_ge_u32 s46, 74
  s_cselect_b32 s7, 0x10000000, s7
  s_add_u32 s46, s46, 4
  s_sub_u32 s47, s46, 56
  s_cmp_ge_u32 s46, 76
  s_cselect_b32 s46, s47, s46
  s_lshl_b32 s8, s46, 10
  s_cmp_ge_u32 s46, 74
  s_cselect_b32 s8, 0x10000000, s8
  s_add_u32 s46, s46, 4
  s_sub_u32 s47, s46, 56
  s_cmp_ge_u32 s46, 76
  s_cselect_b32 s46, s47, s46
  s_lshl_b32 s9, s46, 10
  s_cmp_ge_u32 s46, 74
  s_cselect_b32 s9, 0x10000000, s9
  s_add_u32 s46, s46, 4
  s_sub_u32 s47, s46, 56
  s_cmp_ge_u32 s46, 76
  s_cselect_b32 s46, s47, s46
  s_lshl_b32 s10, s46, 10
  s_cmp_ge_u32 s46, 74
  s_cselect_b32 s10, 0x10000000, s10
  s_add_u32 s46, s46, 4
  s_sub_u32 s47, s46, 56
  s_cmp_ge_u32 s46, 76
  s_cselect_b32 s46, s47, s46
  s_lshl_b32 s11, s46, 10
  s_cmp_ge_u32 s46, 74
  s_cselect_b32 s11, 0x10000000, s11
  s_add_u32 s46, s46, 4
  s_sub_u32 s47, s46, 56
  s_cmp_ge_u32 s46, 76
  s_cselect_b32 s46, s47, s46
  s_lshl_b32 s12, s46, 10
  s_cmp_ge_u32 s46, 74
  s_cselect_b32 s12, 0x10000000, s12
  s_add_u32 s46, s46, 4
  s_sub_u32 s47, s46, 56
  s_cmp_ge_u32 s46, 76
  s_cselect_b32 s46, s47, s46
  s_lshl_b32 s13, s46, 10
  s_cmp_ge_u32 s46, 74
  s_cselect_b32 s13, 0x10000000, s13
  s_add_u32 s46, s46, 4
  s_sub_u32 s47, s46, 56
  s_cmp_ge_u32 s46, 76
  s_cselect_b32 s46, s47, s46
  s_lshl_b32 s14, s46, 10
  s_cmp_ge_u32 s46, 74
  s_cselect_b32 s14, 0x10000000, s14
  s_add_u32 s46, s46, 4
  s_sub_u32 s47, s46, 56
  s_cmp_ge_u32 s46, 76
  s_cselect_b32 s46, s47, s46
  s_lshl_b32 s15, s46, 10
  s_cmp_ge_u32 s46, 74
  s_cselect_b32 s15, 0x10000000, s15
  s_add_u32 s46, s46, 4
  s_sub_u32 s47, s46, 56
  s_cmp_ge_u32 s46, 76
  s_cselect_b32 s46, s47, s46
  s_lshl_b32 s18, s46, 10
  s_cmp_ge_u32 s46, 74
  s_cselect_b32 s18, 0x10000000, s18
  s_add_u32 s46, s46, 4
  s_sub_u32 s47, s46, 56
  s_cmp_ge_u32 s46, 76
  s_cselect_b32 s46, s47, s46
  s_lshl_b32 s19, s46, 10
  s_cmp_ge_u32 s46, 74
  s_cselect_b32 s19, 0x10000000, s19
  v_add_u32 v245, 4096, v241
  s_lshl_b32 s45, s2, 7
  s_add_u32 s45, s45, 15728640
  s_lshl_b32 s39, s38, 7
  s_mul_i32 s40, s38, 245760
  s_mov_b32 s41, 106496
  s_mov_b32 s94, 53248
  s_mov_b32 s95, 4294860800
  s_mov_b32 s43, 0
  s_waitcnt vmcnt(13) lgkmcnt(0)
  s_barrier
  ds_read_b128 a[40:43], v161 offset:6144
  ds_read_b128 a[44:47], v161 offset:8192
  ds_read_b128 a[48:51], v161 offset:0
  ds_read_b64_tr_b16 a[0:1], v160 offset:0
  ds_read_b64_tr_b16 a[2:3], v160 offset:8704
  ds_read_b64_tr_b16 a[4:5], v160 offset:32
  ds_read_b64_tr_b16 a[6:7], v160 offset:8736
  ds_read_b64_tr_b16 a[8:9], v160 offset:64
  ds_read_b64_tr_b16 a[10:11], v160 offset:8768
  ds_read_b64_tr_b16 a[12:13], v160 offset:96
  ds_read_b64_tr_b16 a[14:15], v160 offset:8800
  ds_read_b64_tr_b16 a[16:17], v160 offset:128
  ds_read_b64_tr_b16 a[18:19], v160 offset:8832
  ds_read_b64_tr_b16 a[20:21], v160 offset:160
  ds_read_b64_tr_b16 a[22:23], v160 offset:8864
L_loop_attn_1:
  ds_read_b64_tr_b16 a[24:25], v160 offset:192
  s_waitcnt lgkmcnt(9)
  v_mfma_f32_16x16x32_bf16 v[0:3], a[0:3], a[40:43], v[0:3]
  ds_read_b64_tr_b16 a[26:27], v160 offset:8896
  v_mfma_f32_16x16x32_bf16 v[60:63], a[0:3], a[44:47], v[60:63]
  ds_read_b64_tr_b16 a[28:29], v160 offset:224
  v_mfma_f32_16x16x32_bf16 v[4:7], a[4:7], a[40:43], v[4:7]
  s_cmp_lg_u32 s43, 7
  s_cbranch_scc0 L_pp_attn_1
L_np_attn_1:
  ds_read_b64_tr_b16 a[30:31], v160 offset:8928
  v_mfma_f32_16x16x32_bf16 v[64:67], a[4:7], a[44:47], v[64:67]
  v_mfma_f32_16x16x32_bf16 v[120:123], a[4:7], a[48:51], v[120:123]
  ds_read_b64_tr_b16 a[32:33], v160 offset:256
  s_waitcnt lgkmcnt(9)
  v_mfma_f32_16x16x32_bf16 v[8:11], a[8:11], a[40:43], v[8:11]
  s_add_u32 m0, s41, 5120
  ds_read_b64_tr_b16 a[34:35], v160 offset:8960
  v_mfma_f32_16x16x32_bf16 v[68:71], a[8:11], a[44:47], v[68:71]
  ds_read_b64_tr_b16 a[36:37], v160 offset:288
  v_mfma_f32_16x16x32_bf16 v[12:15], a[12:15], a[40:43], v[12:15]
  ds_read_b64_tr_b16 a[38:39], v160 offset:8992
  v_mfma_f32_16x16x32_bf16 v[72:75], a[12:15], a[44:47], v[72:75]
  buffer_load_dwordx4 v166, s[24:27], s39 offen offset:0 lds
  ds_read_b64_tr_b16 a[0:1], v160 offset:320
  ds_read_b64_tr_b16 a[2:3], v160 offset:9024
  ds_read_b128 a[52:55], v162 offset:6144
  s_waitcnt lgkmcnt(11)
  v_mfma_f32_16x16x32_bf16 v[16:19], a[16:19], a[40:43], v[16:19]
  ds_read_b128 a[56:59], v162 offset:8192
  ds_read_b128 a[60:63], v162 offset:0
  v_mfma_f32_16x16x32_bf16 v[76:79], a[16:19], a[44:47], v[76:79]
  ds_read_b64_tr_b16 a[4:5], v160 offset:352
  v_mfma_f32_16x16x32_bf16 v[20:23], a[20:23], a[40:43], v[20:23]
  buffer_load_dwordx4 v167, s[24:27], s39 offen offset:1024 lds
  ds_read_b64_tr_b16 a[6:7], v160 offset:9056
  v_mfma_f32_16x16x32_bf16 v[80:83], a[20:23], a[44:47], v[80:83]
  ds_read_b64_tr_b16 a[8:9], v160 offset:384
  s_waitcnt lgkmcnt(12)
  v_mfma_f32_16x16x32_bf16 v[24:27], a[24:27], a[40:43], v[24:27]
  ds_read_b64_tr_b16 a[10:11], v160 offset:9088
  v_mfma_f32_16x16x32_bf16 v[84:87], a[24:27], a[44:47], v[84:87]
  buffer_load_dwordx4 v168, s[24:27], s39 offen offset:2048 lds
  v_mfma_f32_16x16x32_bf16 v[124:127], a[24:27], a[48:51], v[124:127]
  ds_read_b64_tr_b16 a[12:13], v160 offset:416
  v_mfma_f32_16x16x32_bf16 v[28:31], a[28:31], a[40:43], v[28:31]
  ds_read_b64_tr_b16 a[14:15], v160 offset:9120
  v_mfma_f32_16x16x32_bf16 v[88:91], a[28:31], a[44:47], v[88:91]
  ds_read_b64_tr_b16 a[16:17], v160 offset:448
  s_waitcnt lgkmcnt(12)
  v_mfma_f32_16x16x32_bf16 v[32:35], a[32:35], a[40:43], v[32:35]
  buffer_load_dwordx4 v169, s[24:27], s39 offen offset:3072 lds
  s_add_u32 m0, s41, 9216
  ds_read_b64_tr_b16 a[18:19], v160 offset:9152
  v_mfma_f32_16x16x32_bf16 v[92:95], a[32:35], a[44:47], v[92:95]
  ds_read_b64_tr_b16 a[20:21], v160 offset:17408
  v_mfma_f32_16x16x32_bf16 v[36:39], a[36:39], a[40:43], v[36:39]
  ds_read_b64_tr_b16 a[22:23], v160 offset:26112
  v_mfma_f32_16x16x32_bf16 v[96:99], a[36:39], a[44:47], v[96:99]
  buffer_load_dwordx4 v170, s[24:27], s39 offen offset:0 lds
  s_add_u32 m0, s41, 27136
  v_mfma_f32_16x16x32_bf16 v[132:135], a[36:39], a[48:51], v[132:135]
  ds_read_b64_tr_b16 a[24:25], v160 offset:17440
  s_waitcnt lgkmcnt(12)
  v_mfma_f32_16x16x32_bf16 v[40:43], a[40:43], a[0:3], v[40:43]
  ds_read_b64_tr_b16 a[26:27], v160 offset:26144
  v_mfma_f32_16x16x32_bf16 v[100:103], a[44:47], a[0:3], v[100:103]
  buffer_load_dwordx4 v171, s[28:31], s40 offen offset:0 lds
  ds_read_b64_tr_b16 a[28:29], v160 offset:17472
  s_waitcnt lgkmcnt(9)
  v_mfma_f32_16x16x32_bf16 v[44:47], a[40:43], a[4:7], v[44:47]
  ds_read_b64_tr_b16 a[30:31], v160 offset:26176
  v_mfma_f32_16x16x32_bf16 v[104:107], a[44:47], a[4:7], v[104:107]
  v_mfma_f32_16x16x32_bf16 v[128:131], a[48:51], a[4:7], v[128:131]
  buffer_load_dwordx4 v172, s[28:31], s40 offen offset:1088 lds
  ds_read_b64_tr_b16 a[32:33], v160 offset:17504
  v_mfma_f32_16x16x32_bf16 v[48:51], a[40:43], a[8:11], v[48:51]
  ds_read_b64_tr_b16 a[34:35], v160 offset:26208
  v_mfma_f32_16x16x32_bf16 v[108:111], a[44:47], a[8:11], v[108:111]
  ds_read_b64_tr_b16 a[36:37], v160 offset:17536
  s_waitcnt lgkmcnt(9)
  v_mfma_f32_16x16x32_bf16 v[52:55], a[40:43], a[12:15], v[52:55]
  buffer_load_dwordx4 v173, s[28:31], s40 offen offset:2176 lds
  ds_read_b64_tr_b16 a[38:39], v160 offset:26240
  v_mfma_f32_16x16x32_bf16 v[112:115], a[44:47], a[12:15], v[112:115]
  ds_read_b64_tr_b16 a[0:1], v160 offset:17568
  v_mfma_f32_16x16x32_bf16 v[56:59], a[40:43], a[16:19], v[56:59]
  ds_read_b64_tr_b16 a[2:3], v160 offset:26272
  v_mfma_f32_16x16x32_bf16 v[116:119], a[44:47], a[16:19], v[116:119]
  ds_read_b64_tr_b16 a[4:5], v160 offset:17600
  s_waitcnt lgkmcnt(9)
  v_mfma_f32_16x16x32_bf16 v[0:3], a[20:23], a[52:55], v[0:3]
  buffer_load_dwordx4 v174, s[28:31], s40 offen offset:3264 lds
  s_add_u32 m0, s41, 31488
  ds_read_b64_tr_b16 a[6:7], v160 offset:26304
  v_mfma_f32_16x16x32_bf16 v[60:63], a[20:23], a[56:59], v[60:63]
  ds_read_b64_tr_b16 a[8:9], v160 offset:17632
  v_mfma_f32_16x16x32_bf16 v[4:7], a[24:27], a[52:55], v[4:7]
  ds_read_b64_tr_b16 a[10:11], v160 offset:26336
  v_mfma_f32_16x16x32_bf16 v[64:67], a[24:27], a[56:59], v[64:67]
  buffer_load_dwordx4 v175, s[28:31], s40 offen offset:0 lds
  v_mfma_f32_16x16x32_bf16 v[120:123], a[24:27], a[60:63], v[120:123]
  ds_read_b64_tr_b16 a[12:13], v160 offset:17664
  s_waitcnt lgkmcnt(9)
  v_mfma_f32_16x16x32_bf16 v[8:11], a[28:31], a[52:55], v[8:11]
  ds_read_b64_tr_b16 a[14:15], v160 offset:26368
  v_mfma_f32_16x16x32_bf16 v[68:71], a[28:31], a[56:59], v[68:71]
  buffer_load_dwordx4 v176, s[28:31], s40 offen offset:1088 lds
  ds_read_b64_tr_b16 a[16:17], v160 offset:17696
  v_mfma_f32_16x16x32_bf16 v[12:15], a[32:35], a[52:55], v[12:15]
  ds_read_b64_tr_b16 a[18:19], v160 offset:26400
  v_mfma_f32_16x16x32_bf16 v[72:75], a[32:35], a[56:59], v[72:75]
  ds_read_b64_tr_b16 a[20:21], v160 offset:17728
  s_waitcnt lgkmcnt(9)
  v_mfma_f32_16x16x32_bf16 v[16:19], a[36:39], a[52:55], v[16:19]
  buffer_load_dwordx4 v177, s[28:31], s40 offen offset:2176 lds
  ds_read_b64_tr_b16 a[22:23], v160 offset:26432
  v_mfma_f32_16x16x32_bf16 v[76:79], a[36:39], a[56:59], v[76:79]
  ds_read_b64_tr_b16 a[24:25], v160 offset:17760
  v_mfma_f32_16x16x32_bf16 v[20:23], a[0:3], a[52:55], v[20:23]
  ds_read_b64_tr_b16 a[26:27], v160 offset:26464
  v_mfma_f32_16x16x32_bf16 v[80:83], a[0:3], a[56:59], v[80:83]
  buffer_load_dwordx4 v178, s[28:31], s40 offen offset:3264 lds
  ds_read_b64_tr_b16 a[28:29], v160 offset:17792
  s_waitcnt lgkmcnt(9)
  v_mfma_f32_16x16x32_bf16 v[24:27], a[4:7], a[52:55], v[24:27]
  ds_read_b64_tr_b16 a[30:31], v160 offset:26496
  v_mfma_f32_16x16x32_bf16 v[84:87], a[4:7], a[56:59], v[84:87]
  v_mfma_f32_16x16x32_bf16 v[124:127], a[4:7], a[60:63], v[124:127]
  ds_read_b64_tr_b16 a[32:33], v160 offset:17824
  v_mfma_f32_16x16x32_bf16 v[28:31], a[8:11], a[52:55], v[28:31]
  ds_read_b64_tr_b16 a[34:35], v160 offset:26528
  v_mfma_f32_16x16x32_bf16 v[88:91], a[8:11], a[56:59], v[88:91]
  ds_read_b64_tr_b16 a[36:37], v160 offset:17856
  s_waitcnt lgkmcnt(9)
  v_mfma_f32_16x16x32_bf16 v[32:35], a[12:15], a[52:55], v[32:35]
  ds_read_b64_tr_b16 a[38:39], v160 offset:26560
  v_mfma_f32_16x16x32_bf16 v[92:95], a[12:15], a[56:59], v[92:95]
  v_mfma_f32_16x16x32_bf16 v[36:39], a[16:19], a[52:55], v[36:39]
  v_mfma_f32_16x16x32_bf16 v[96:99], a[16:19], a[56:59], v[96:99]
  v_mfma_f32_16x16x32_bf16 v[132:135], a[16:19], a[60:63], v[132:135]
  s_waitcnt lgkmcnt(6)
  v_mfma_f32_16x16x32_bf16 v[40:43], a[52:55], a[20:23], v[40:43]
  v_mfma_f32_16x16x32_bf16 v[100:103], a[56:59], a[20:23], v[100:103]
  s_waitcnt vmcnt(13) lgkmcnt(0)
  s_barrier
  v_mfma_f32_16x16x32_bf16 v[44:47], a[52:55], a[24:27], v[44:47]
  s_cmp_eq_u32 s41, 53248
  s_cselect_b32 s42, s95, s94
  v_add_u32 v160, s42, v160
  v_add_u32 v161, s42, v161
  v_mfma_f32_16x16x32_bf16 v[104:107], a[56:59], a[24:27], v[104:107]
  v_add_u32_e64 v162, s42, v162
  ds_read_b128 a[40:43], v161 offset:6144
  ds_read_b128 a[44:47], v161 offset:8192
  ds_read_b128 a[48:51], v161 offset:0
  v_mfma_f32_16x16x32_bf16 v[128:131], a[60:63], a[24:27], v[128:131]
  ds_read_b64_tr_b16 a[0:1], v160 offset:0
  ds_read_b64_tr_b16 a[2:3], v160 offset:8704
  ds_read_b64_tr_b16 a[4:5], v160 offset:32
  ds_read_b64_tr_b16 a[6:7], v160 offset:8736
  v_mfma_f32_16x16x32_bf16 v[48:51], a[52:55], a[28:31], v[48:51]
  ds_read_b64_tr_b16 a[8:9], v160 offset:64
  ds_read_b64_tr_b16 a[10:11], v160 offset:8768
  ds_read_b64_tr_b16 a[12:13], v160 offset:96
  ds_read_b64_tr_b16 a[14:15], v160 offset:8800
  v_mfma_f32_16x16x32_bf16 v[108:111], a[56:59], a[28:31], v[108:111]
  ds_read_b64_tr_b16 a[16:17], v160 offset:128
  ds_read_b64_tr_b16 a[18:19], v160 offset:8832
  ds_read_b64_tr_b16 a[20:21], v160 offset:160
  ds_read_b64_tr_b16 a[22:23], v160 offset:8864
  v_mfma_f32_16x16x32_bf16 v[52:55], a[52:55], a[32:35], v[52:55]
  s_add_u32 s38, s38, 1
  s_cmp_eq_u32 s38, 10
  s_cselect_b32 s38, 0, s38
  s_lshl_b32 s39, s38, 7
  v_mfma_f32_16x16x32_bf16 v[112:115], a[56:59], a[32:35], v[112:115]
  s_mul_i32 s40, s38, 245760
  s_cmp_eq_u32 s41, 106496
  s_cselect_b32 s42, s95, s94
  s_add_u32 s41, s41, s42
  v_mfma_f32_16x16x32_bf16 v[56:59], a[52:55], a[36:39], v[56:59]
  s_add_u32 s43, s43, 1
  s_cmp_lt_u32 s43, 8
  v_mfma_f32_16x16x32_bf16 v[116:119], a[56:59], a[36:39], v[116:119]
  s_cbranch_scc1 L_loop_attn_1
  v_readfirstlane_b32 s23, v252
  s_nop 3
  s_cmp_lg_u32 s23, 0
  s_cbranch_scc1 L_nok_attn_1
  s_mov_b32 s47, 0
  v_mov_b32_e64 v251, 0
L_nspin_attn_1:
  buffer_load_dword v250, v251, s[76:79], 0 offen sc1
  s_waitcnt vmcnt(0)
  v_readfirstlane_b32 s23, v250
  s_nop 3
  s_cmp_lg_u32 s23, 0
  s_cbranch_scc1 L_nok_attn_1
  s_sleep 8
  s_add_u32 s47, s47, 1
  s_cmp_lt_u32 s47, 200000
  s_cbranch_scc1 L_nspin_attn_1
L_nok_attn_1:
  v_readfirstlane_b32 s46, v253
  s_nop 3
  s_cmp_ge_u32 s46, 128
  s_cbranch_scc1 L_cok_p_attn_1
  s_mov_b32 s47, 0
  v_mov_b32_e64 v251, 0
L_cspin_p_attn_1:
  buffer_load_dword v250, v251, s[76:79], 0 offen offset:4 sc1
  s_waitcnt vmcnt(0)
  v_readfirstlane_b32 s46, v250
  s_nop 3
  s_cmp_ge_u32 s46, 128
  s_cbranch_scc1 L_cok_p_attn_1
  s_sleep 40
  s_add_u32 s47, s47, 1
  s_cmp_lt_u32 s47, 200000
  s_cbranch_scc1 L_cspin_p_attn_1
L_cok_p_attn_1:
  ds_read_b64_tr_b16 a[24:25], v160 offset:192
  s_waitcnt lgkmcnt(9)
  v_mfma_f32_16x16x32_bf16 v[0:3], a[0:3], a[40:43], v[0:3]
  ds_read_b64_tr_b16 a[26:27], v160 offset:8896
  v_mfma_f32_16x16x32_bf16 v[60:63], a[0:3], a[44:47], v[60:63]
  ds_read_b64_tr_b16 a[28:29], v160 offset:224
  v_mfma_f32_16x16x32_bf16 v[4:7], a[4:7], a[40:43], v[4:7]
  s_mul_i32 s87, s4, 5
  s_add_u32 s87, s87, s83
  s_add_u32 m0, s85, 0
  s_add_u32 s88, s87, 0
  buffer_load_dwordx4 v241, s[32:35], s88 offen sc1 lds
  ds_read_b64_tr_b16 a[30:31], v160 offset:8928
  v_mfma_f32_16x16x32_bf16 v[64:67], a[4:7], a[44:47], v[64:67]
  v_mfma_f32_16x16x32_bf16 v[120:123], a[4:7], a[48:51], v[120:123]
  ds_read_b64_tr_b16 a[32:33], v160 offset:256
  s_waitcnt lgkmcnt(9)
  v_mfma_f32_16x16x32_bf16 v[8:11], a[8:11], a[40:43], v[8:11]
  ds_read_b64_tr_b16 a[34:35], v160 offset:8960
  v_mfma_f32_16x16x32_bf16 v[68:71], a[8:11], a[44:47], v[68:71]
  s_add_u32 m0, s85, 1024
  s_add_u32 s88, s87, 1024
  buffer_load_dwordx4 v241, s[32:35], s88 offen sc1 lds
  ds_read_b64_tr_b16 a[36:37], v160 offset:288
  v_mfma_f32_16x16x32_bf16 v[12:15], a[12:15], a[40:43], v[12:15]
  ds_read_b64_tr_b16 a[38:39], v160 offset:8992
  v_mfma_f32_16x16x32_bf16 v[72:75], a[12:15], a[44:47], v[72:75]
  ds_read_b64_tr_b16 a[0:1], v160 offset:320
  ds_read_b64_tr_b16 a[2:3], v160 offset:9024
  ds_read_b128 a[52:55], v162 offset:6144
  s_waitcnt lgkmcnt(11)
  v_mfma_f32_16x16x32_bf16 v[16:19], a[16:19], a[40:43], v[16:19]
  ds_read_b128 a[56:59], v162 offset:8192
  ds_read_b128 a[60:63], v162 offset:0
  v_mfma_f32_16x16x32_bf16 v[76:79], a[16:19], a[44:47], v[76:79]
  s_add_u32 m0, s85, 2048
  s_add_u32 s88, s87, 2048
  buffer_load_dwordx4 v241, s[32:35], s88 offen sc1 lds
  ds_read_b64_tr_b16 a[4:5], v160 offset:352
  v_mfma_f32_16x16x32_bf16 v[20:23], a[20:23], a[40:43], v[20:23]
  ds_read_b64_tr_b16 a[6:7], v160 offset:9056
  v_mfma_f32_16x16x32_bf16 v[80:83], a[20:23], a[44:47], v[80:83]
  ds_read_b64_tr_b16 a[8:9], v160 offset:384
  s_waitcnt lgkmcnt(12)
  v_mfma_f32_16x16x32_bf16 v[24:27], a[24:27], a[40:43], v[24:27]
  ds_read_b64_tr_b16 a[10:11], v160 offset:9088
  v_mfma_f32_16x16x32_bf16 v[84:87], a[24:27], a[44:47], v[84:87]
  s_add_u32 m0, s85, 3072
  s_add_u32 s88, s87, 3072
  buffer_load_dwordx4 v241, s[32:35], s88 offen sc1 lds
  v_mfma_f32_16x16x32_bf16 v[124:127], a[24:27], a[48:51], v[124:127]
  ds_read_b64_tr_b16 a[12:13], v160 offset:416
  v_mfma_f32_16x16x32_bf16 v[28:31], a[28:31], a[40:43], v[28:31]
  ds_read_b64_tr_b16 a[14:15], v160 offset:9120
  v_mfma_f32_16x16x32_bf16 v[88:91], a[28:31], a[44:47], v[88:91]
  ds_read_b64_tr_b16 a[16:17], v160 offset:448
  s_waitcnt lgkmcnt(12)
  v_mfma_f32_16x16x32_bf16 v[32:35], a[32:35], a[40:43], v[32:35]
  s_add_u32 m0, s85, 4096
  s_add_u32 s88, s87, 4096
  buffer_load_dwordx4 v241, s[32:35], s88 offen sc1 lds
  ds_read_b64_tr_b16 a[18:19], v160 offset:9152
  v_mfma_f32_16x16x32_bf16 v[92:95], a[32:35], a[44:47], v[92:95]
  ds_read_b64_tr_b16 a[20:21], v160 offset:17408
  v_mfma_f32_16x16x32_bf16 v[36:39], a[36:39], a[40:43], v[36:39]
  ds_read_b64_tr_b16 a[22:23], v160 offset:26112
  v_mfma_f32_16x16x32_bf16 v[96:99], a[36:39], a[44:47], v[96:99]
  v_mfma_f32_16x16x32_bf16 v[132:135], a[36:39], a[48:51], v[132:135]
  s_mul_i32 s87, s5, 5
  s_add_u32 s87, s87, s83
  s_add_u32 m0, s85, 5120
  s_add_u32 s88, s87, 0
  buffer_load_dwordx4 v241, s[32:35], s88 offen sc1 lds
  ds_read_b64_tr_b16 a[24:25], v160 offset:17440
  s_waitcnt lgkmcnt(12)
  v_mfma_f32_16x16x32_bf16 v[40:43], a[40:43], a[0:3], v[40:43]
  ds_read_b64_tr_b16 a[26:27], v160 offset:26144
  v_mfma_f32_16x16x32_bf16 v[100:103], a[44:47], a[0:3], v[100:103]
  ds_read_b64_tr_b16 a[28:29], v160 offset:17472
  s_waitcnt lgkmcnt(9)
  v_mfma_f32_16x16x32_bf16 v[44:47], a[40:43], a[4:7], v[44:47]
  ds_read_b64_tr_b16 a[30:31], v160 offset:26176
  v_mfma_f32_16x16x32_bf16 v[104:107], a[44:47], a[4:7], v[104:107]
  s_add_u32 m0, s85, 6144
  s_add_u32 s88, s87, 1024
  buffer_load_dwordx4 v241, s[32:35], s88 offen sc1 lds
  v_mfma_f32_16x16x32_bf16 v[128:131], a[48:51], a[4:7], v[128:131]
  ds_read_b64_tr_b16 a[32:33], v160 offset:17504
  v_mfma_f32_16x16x32_bf16 v[48:51], a[40:43], a[8:11], v[48:51]
  ds_read_b64_tr_b16 a[34:35], v160 offset:26208
  v_mfma_f32_16x16x32_bf16 v[108:111], a[44:47], a[8:11], v[108:111]
  ds_read_b64_tr_b16 a[36:37], v160 offset:17536
  s_waitcnt lgkmcnt(9)
  v_mfma_f32_16x16x32_bf16 v[52:55], a[40:43], a[12:15], v[52:55]
  s_add_u32 m0, s85, 7168
  s_add_u32 s88, s87, 2048
  buffer_load_dwordx4 v241, s[32:35], s88 offen sc1 lds
  ds_read_b64_tr_b16 a[38:39], v160 offset:26240
  v_mfma_f32_16x16x32_bf16 v[112:115], a[44:47], a[12:15], v[112:115]
  ds_read_b64_tr_b16 a[0:1], v160 offset:17568
  v_mfma_f32_16x16x32_bf16 v[56:59], a[40:43], a[16:19], v[56:59]
  ds_read_b64_tr_b16 a[2:3], v160 offset:26272
  v_mfma_f32_16x16x32_bf16 v[116:119], a[44:47], a[16:19], v[116:119]
  ds_read_b64_tr_b16 a[4:5], v160 offset:17600
  s_waitcnt lgkmcnt(9)
  v_mfma_f32_16x16x32_bf16 v[0:3], a[20:23], a[52:55], v[0:3]
  s_add_u32 m0, s85, 8192
  s_add_u32 s88, s87, 3072
  buffer_load_dwordx4 v241, s[32:35], s88 offen sc1 lds
  ds_read_b64_tr_b16 a[6:7], v160 offset:26304
  v_mfma_f32_16x16x32_bf16 v[60:63], a[20:23], a[56:59], v[60:63]
  ds_read_b64_tr_b16 a[8:9], v160 offset:17632
  v_mfma_f32_16x16x32_bf16 v[4:7], a[24:27], a[52:55], v[4:7]
  ds_read_b64_tr_b16 a[10:11], v160 offset:26336
  v_mfma_f32_16x16x32_bf16 v[64:67], a[24:27], a[56:59], v[64:67]
  v_mfma_f32_16x16x32_bf16 v[120:123], a[24:27], a[60:63], v[120:123]
  s_add_u32 m0, s85, 9216
  s_add_u32 s88, s87, 4096
  buffer_load_dwordx4 v241, s[32:35], s88 offen sc1 lds
  ds_read_b64_tr_b16 a[12:13], v160 offset:17664
  s_waitcnt lgkmcnt(9)
  v_mfma_f32_16x16x32_bf16 v[8:11], a[28:31], a[52:55], v[8:11]
  ds_read_b64_tr_b16 a[14:15], v160 offset:26368
  v_mfma_f32_16x16x32_bf16 v[68:71], a[28:31], a[56:59], v[68:71]
  ds_read_b64_tr_b16 a[16:17], v160 offset:17696
  v_mfma_f32_16x16x32_bf16 v[12:15], a[32:35], a[52:55], v[12:15]
  ds_read_b64_tr_b16 a[18:19], v160 offset:26400
  v_mfma_f32_16x16x32_bf16 v[72:75], a[32:35], a[56:59], v[72:75]
  s_mul_i32 s87, s6, 5
  s_add_u32 s87, s87, s83
  s_add_u32 m0, s85, 10240
  s_add_u32 s88, s87, 0
  buffer_load_dwordx4 v241, s[32:35], s88 offen sc1 lds
  ds_read_b64_tr_b16 a[20:21], v160 offset:17728
  s_waitcnt lgkmcnt(9)
  v_mfma_f32_16x16x32_bf16 v[16:19], a[36:39], a[52:55], v[16:19]
  ds_read_b64_tr_b16 a[22:23], v160 offset:26432
  v_mfma_f32_16x16x32_bf16 v[76:79], a[36:39], a[56:59], v[76:79]
  ds_read_b64_tr_b16 a[24:25], v160 offset:17760
  v_mfma_f32_16x16x32_bf16 v[20:23], a[0:3], a[52:55], v[20:23]
  ds_read_b64_tr_b16 a[26:27], v160 offset:26464
  v_mfma_f32_16x16x32_bf16 v[80:83], a[0:3], a[56:59], v[80:83]
  s_add_u32 m0, s85, 11264
  s_add_u32 s88, s87, 1024
  buffer_load_dwordx4 v241, s[32:35], s88 offen sc1 lds
  ds_read_b64_tr_b16 a[28:29], v160 offset:17792
  s_waitcnt lgkmcnt(9)
  v_mfma_f32_16x16x32_bf16 v[24:27], a[4:7], a[52:55], v[24:27]
  ds_read_b64_tr_b16 a[30:31], v160 offset:26496
  v_mfma_f32_16x16x32_bf16 v[84:87], a[4:7], a[56:59], v[84:87]
  v_mfma_f32_16x16x32_bf16 v[124:127], a[4:7], a[60:63], v[124:127]
  ds_read_b64_tr_b16 a[32:33], v160 offset:17824
  v_mfma_f32_16x16x32_bf16 v[28:31], a[8:11], a[52:55], v[28:31]
  ds_read_b64_tr_b16 a[34:35], v160 offset:26528
  v_mfma_f32_16x16x32_bf16 v[88:91], a[8:11], a[56:59], v[88:91]
  ds_read_b64_tr_b16 a[36:37], v160 offset:17856
  s_waitcnt lgkmcnt(9)
  v_mfma_f32_16x16x32_bf16 v[32:35], a[12:15], a[52:55], v[32:35]
  ds_read_b64_tr_b16 a[38:39], v160 offset:26560
  v_mfma_f32_16x16x32_bf16 v[92:95], a[12:15], a[56:59], v[92:95]
  v_mfma_f32_16x16x32_bf16 v[36:39], a[16:19], a[52:55], v[36:39]
  v_mfma_f32_16x16x32_bf16 v[96:99], a[16:19], a[56:59], v[96:99]
  v_mfma_f32_16x16x32_bf16 v[132:135], a[16:19], a[60:63], v[132:135]
  s_waitcnt lgkmcnt(6)
  v_mfma_f32_16x16x32_bf16 v[40:43], a[52:55], a[20:23], v[40:43]
  v_mfma_f32_16x16x32_bf16 v[100:103], a[56:59], a[20:23], v[100:103]
  s_waitcnt vmcnt(12) lgkmcnt(0)
  s_barrier
  v_mfma_f32_16x16x32_bf16 v[44:47], a[52:55], a[24:27], v[44:47]
  s_cmp_eq_u32 s41, 53248
  s_cselect_b32 s42, s95, s94
  v_add_u32_e64 v160, s42, v160
  v_mfma_f32_16x16x32_bf16 v[104:107], a[56:59], a[24:27], v[104:107]
  v_add_u32 v161, s42, v161
  v_add_u32 v162, s42, v162
  ds_read_b128 a[40:43], v161 offset:6144
  v_mfma_f32_16x16x32_bf16 v[128:131], a[60:63], a[24:27], v[128:131]
  ds_read_b128 a[44:47], v161 offset:8192
  ds_read_b128 a[48:51], v161 offset:0
  ds_read_b64_tr_b16 a[0:1], v160 offset:0
  v_mfma_f32_16x16x32_bf16 v[48:51], a[52:55], a[28:31], v[48:51]
  ds_read_b64_tr_b16 a[2:3], v160 offset:8704
  ds_read_b64_tr_b16 a[4:5], v160 offset:32
  ds_read_b64_tr_b16 a[6:7], v160 offset:8736
  v_mfma_f32_16x16x32_bf16 v[108:111], a[56:59], a[28:31], v[108:111]
  ds_read_b64_tr_b16 a[8:9], v160 offset:64
  ds_read_b64_tr_b16 a[10:11], v160 offset:8768
  ds_read_b64_tr_b16 a[12:13], v160 offset:96
  v_mfma_f32_16x16x32_bf16 v[52:55], a[52:55], a[32:35], v[52:55]
  ds_read_b64_tr_b16 a[14:15], v160 offset:8800
  ds_read_b64_tr_b16 a[16:17], v160 offset:128
  ds_read_b64_tr_b16 a[18:19], v160 offset:8832
  v_mfma_f32_16x16x32_bf16 v[112:115], a[56:59], a[32:35], v[112:115]
  ds_read_b64_tr_b16 a[20:21], v160 offset:160
  ds_read_b64_tr_b16 a[22:23], v160 offset:8864
  v_mfma_f32_16x16x32_bf16 v[56:59], a[52:55], a[36:39], v[56:59]
  v_mfma_f32_16x16x32_bf16 v[116:119], a[56:59], a[36:39], v[116:119]
  v_and_b32 v251, 15, v255
  v_lshlrev_b32 v251, 4, v251
  s_lshl_b32 s74, s36, 7
  s_sub_u32 s101, s74, 16
  s_cmp_eq_u32 s36, 0
  s_cselect_b32 s101, 0, s101
  s_add_u32 s74, s74, 32
  s_add_u32 s75, s74, 16
  ds_read_b64_tr_b16 a[24:25], v160 offset:192
  s_waitcnt lgkmcnt(9)
  v_mfma_f32_16x16x32_bf16 v[0:3], a[0:3], a[40:43], v[0:3]
  ds_read_b64_tr_b16 a[26:27], v160 offset:8896
  v_mfma_f32_16x16x32_bf16 v[60:63], a[0:3], a[44:47], v[60:63]
  ds_read_b64_tr_b16 a[28:29], v160 offset:224
  v_mfma_f32_16x16x32_bf16 v[4:7], a[4:7], a[40:43], v[4:7]
  s_lshl_b32 s88, s74, 4
  s_add_u32 s88, s88, 14745600
  buffer_load_dwordx4 v[180:183], v251, s[32:35], s88 offen sc1
  ds_read_b64_tr_b16 a[30:31], v160 offset:8928
  v_mfma_f32_16x16x32_bf16 v[64:67], a[4:7], a[44:47], v[64:67]
  v_mfma_f32_16x16x32_bf16 v[120:123], a[4:7], a[48:51], v[120:123]
  ds_read_b64_tr_b16 a[32:33], v160 offset:256
  s_waitcnt lgkmcnt(9)
  v_mfma_f32_16x16x32_bf16 v[8:11], a[8:11], a[40:43], v[8:11]
  s_lshl_b32 s88, s75, 4
  s_add_u32 s88, s88, 14745600
  buffer_load_dwordx4 v[184:187], v251, s[32:35], s88 offen sc1
  ds_read_b64_tr_b16 a[34:35], v160 offset:8960
  v_mfma_f32_16x16x32_bf16 v[68:71], a[8:11], a[44:47], v[68:71]
  ds_read_b64_tr_b16 a[36:37], v160 offset:288
  v_mfma_f32_16x16x32_bf16 v[12:15], a[12:15], a[40:43], v[12:15]
  ds_read_b64_tr_b16 a[38:39], v160 offset:8992
  v_mfma_f32_16x16x32_bf16 v[72:75], a[12:15], a[44:47], v[72:75]
  s_lshl_b32 s88, s101, 4
  s_add_u32 s88, s88, 14745600
  buffer_load_dwordx4 v[188:191], v251, s[32:35], s88 offen sc1
  ds_read_b64_tr_b16 a[0:1], v160 offset:320
  ds_read_b64_tr_b16 a[2:3], v160 offset:9024
  ds_read_b128 a[52:55], v162 offset:6144
  s_waitcnt lgkmcnt(11)
  v_mfma_f32_16x16x32_bf16 v[16:19], a[16:19], a[40:43], v[16:19]
  ds_read_b128 a[56:59], v162 offset:8192
  ds_read_b128 a[60:63], v162 offset:0
  v_mfma_f32_16x16x32_bf16 v[76:79], a[16:19], a[44:47], v[76:79]
  ds_read_b64_tr_b16 a[4:5], v160 offset:352
  v_mfma_f32_16x16x32_bf16 v[20:23], a[20:23], a[40:43], v[20:23]
  s_mul_i32 s87, s6, 5
  s_add_u32 s87, s87, s83
  s_add_u32 m0, s86, 0
  s_add_u32 s88, s87, 2048
  buffer_load_dwordx4 v241, s[32:35], s88 offen sc1 lds
  ds_read_b64_tr_b16 a[6:7], v160 offset:9056
  v_mfma_f32_16x16x32_bf16 v[80:83], a[20:23], a[44:47], v[80:83]
  ds_read_b64_tr_b16 a[8:9], v160 offset:384
  s_waitcnt lgkmcnt(12)
  v_mfma_f32_16x16x32_bf16 v[24:27], a[24:27], a[40:43], v[24:27]
  ds_read_b64_tr_b16 a[10:11], v160 offset:9088
  v_mfma_f32_16x16x32_bf16 v[84:87], a[24:27], a[44:47], v[84:87]
  s_add_u32 m0, s86, 1024
  s_add_u32 s88, s87, 3072
  buffer_load_dwordx4 v241, s[32:35], s88 offen sc1 lds
  v_mfma_f32_16x16x32_bf16 v[124:127], a[24:27], a[48:51], v[124:127]
  ds_read_b64_tr_b16 a[12:13], v160 offset:416
  v_mfma_f32_16x16x32_bf16 v[28:31], a[28:31], a[40:43], v[28:31]
  ds_read_b64_tr_b16 a[14:15], v160 offset:9120
  v_mfma_f32_16x16x32_bf16 v[88:91], a[28:31], a[44:47], v[88:91]
  s_add_u32 m0, s86, 2048
  s_add_u32 s88, s87, 4096
  buffer_load_dwordx4 v241, s[32:35], s88 offen sc1 lds
  ds_read_b64_tr_b16 a[16:17], v160 offset:448
  s_waitcnt lgkmcnt(12)
  v_mfma_f32_16x16x32_bf16 v[32:35], a[32:35], a[40:43], v[32:35]
  ds_read_b64_tr_b16 a[18:19], v160 offset:9152
  v_mfma_f32_16x16x32_bf16 v[92:95], a[32:35], a[44:47], v[92:95]
  ds_read_b64_tr_b16 a[20:21], v160 offset:17408
  v_mfma_f32_16x16x32_bf16 v[36:39], a[36:39], a[40:43], v[36:39]
  s_mul_i32 s87, s7, 5
  s_add_u32 s87, s87, s83
  s_add_u32 m0, s86, 3072
  s_add_u32 s88, s87, 0
  buffer_load_dwordx4 v241, s[32:35], s88 offen sc1 lds
  ds_read_b64_tr_b16 a[22:23], v160 offset:26112
  v_mfma_f32_16x16x32_bf16 v[96:99], a[36:39], a[44:47], v[96:99]
  v_mfma_f32_16x16x32_bf16 v[132:135], a[36:39], a[48:51], v[132:135]
  ds_read_b64_tr_b16 a[24:25], v160 offset:17440
  s_waitcnt lgkmcnt(12)
  v_mfma_f32_16x16x32_bf16 v[40:43], a[40:43], a[0:3], v[40:43]
  s_add_u32 m0, s86, 4096
  s_add_u32 s88, s87, 1024
  buffer_load_dwordx4 v241, s[32:35], s88 offen sc1 lds
  ds_read_b64_tr_b16 a[26:27], v160 offset:26144
  v_mfma_f32_16x16x32_bf16 v[100:103], a[44:47], a[0:3], v[100:103]
  ds_read_b64_tr_b16 a[28:29], v160 offset:17472
  s_waitcnt lgkmcnt(9)
  v_mfma_f32_16x16x32_bf16 v[44:47], a[40:43], a[4:7], v[44:47]
  ds_read_b64_tr_b16 a[30:31], v160 offset:26176
  v_mfma_f32_16x16x32_bf16 v[104:107], a[44:47], a[4:7], v[104:107]
  s_add_u32 m0, s86, 5120
  s_add_u32 s88, s87, 2048
  buffer_load_dwordx4 v241, s[32:35], s88 offen sc1 lds
  v_mfma_f32_16x16x32_bf16 v[128:131], a[48:51], a[4:7], v[128:131]
  ds_read_b64_tr_b16 a[32:33], v160 offset:17504
  v_mfma_f32_16x16x32_bf16 v[48:51], a[40:43], a[8:11], v[48:51]
  ds_read_b64_tr_b16 a[34:35], v160 offset:26208
  v_mfma_f32_16x16x32_bf16 v[108:111], a[44:47], a[8:11], v[108:111]
  s_add_u32 m0, s86, 6144
  s_add_u32 s88, s87, 3072
  buffer_load_dwordx4 v241, s[32:35], s88 offen sc1 lds
  ds_read_b64_tr_b16 a[36:37], v160 offset:17536
  s_waitcnt lgkmcnt(9)
  v_mfma_f32_16x16x32_bf16 v[52:55], a[40:43], a[12:15], v[52:55]
  ds_read_b64_tr_b16 a[38:39], v160 offset:26240
  v_mfma_f32_16x16x32_bf16 v[112:115], a[44:47], a[12:15], v[112:115]
  ds_read_b64_tr_b16 a[0:1], v160 offset:17568
  v_mfma_f32_16x16x32_bf16 v[56:59], a[40:43], a[16:19], v[56:59]
  s_add_u32 m0, s86, 7168
  s_add_u32 s88, s87, 4096
  buffer_load_dwordx4 v241, s[32:35], s88 offen sc1 lds
  ds_read_b64_tr_b16 a[2:3], v160 offset:26272
  v_mfma_f32_16x16x32_bf16 v[116:119], a[44:47], a[16:19], v[116:119]
  ds_read_b64_tr_b16 a[4:5], v160 offset:17600
  s_waitcnt lgkmcnt(9)
  v_mfma_f32_16x16x32_bf16 v[0:3], a[20:23], a[52:55], v[0:3]
  ds_read_b64_tr_b16 a[6:7], v160 offset:26304
  v_mfma_f32_16x16x32_bf16 v[60:63], a[20:23], a[56:59], v[60:63]
  s_mul_i32 s87, s8, 5
  s_add_u32 s87, s87, s83
  s_add_u32 m0, s86, 8192
  s_add_u32 s88, s87, 0
  buffer_load_dwordx4 v241, s[32:35], s88 offen sc1 lds
  ds_read_b64_tr_b16 a[8:9], v160 offset:17632
  v_mfma_f32_16x16x32_bf16 v[4:7], a[24:27], a[52:55], v[4:7]
  ds_read_b64_tr_b16 a[10:11], v160 offset:26336
  v_mfma_f32_16x16x32_bf16 v[64:67], a[24:27], a[56:59], v[64:67]
  v_mfma_f32_16x16x32_bf16 v[120:123], a[24:27], a[60:63], v[120:123]
  s_add_u32 m0, s86, 9216
  s_add_u32 s88, s87, 1024
  buffer_load_dwordx4 v241, s[32:35], s88 offen sc1 lds
  ds_read_b64_tr_b16 a[12:13], v160 offset:17664
  s_waitcnt lgkmcnt(9)
  v_mfma_f32_16x16x32_bf16 v[8:11], a[28:31], a[52:55], v[8:11]
  ds_read_b64_tr_b16 a[14:15], v160 offset:26368
  v_mfma_f32_16x16x32_bf16 v[68:71], a[28:31], a[56:59], v[68:71]
  ds_read_b64_tr_b16 a[16:17], v160 offset:17696
  v_mfma_f32_16x16x32_bf16 v[12:15], a[32:35], a[52:55], v[12:15]
  s_add_u32 m0, s86, 10240
  s_add_u32 s88, s87, 2048
  buffer_load_dwordx4 v241, s[32:35], s88 offen sc1 lds
  ds_read_b64_tr_b16 a[18:19], v160 offset:26400
  v_mfma_f32_16x16x32_bf16 v[72:75], a[32:35], a[56:59], v[72:75]
  ds_read_b64_tr_b16 a[20:21], v160 offset:17728
  s_waitcnt lgkmcnt(9)
  v_mfma_f32_16x16x32_bf16 v[16:19], a[36:39], a[52:55], v[16:19]
  ds_read_b64_tr_b16 a[22:23], v160 offset:26432
  v_mfma_f32_16x16x32_bf16 v[76:79], a[36:39], a[56:59], v[76:79]
  s_add_u32 m0, s86, 11264
  s_add_u32 s88, s87, 3072
  buffer_load_dwordx4 v241, s[32:35], s88 offen sc1 lds
  ds_read_b64_tr_b16 a[24:25], v160 offset:17760
  v_mfma_f32_16x16x32_bf16 v[20:23], a[0:3], a[52:55], v[20:23]
  ds_read_b64_tr_b16 a[26:27], v160 offset:26464
  v_mfma_f32_16x16x32_bf16 v[80:83], a[0:3], a[56:59], v[80:83]
  ds_read_b64_tr_b16 a[28:29], v160 offset:17792
  s_waitcnt lgkmcnt(9)
  v_mfma_f32_16x16x32_bf16 v[24:27], a[4:7], a[52:55], v[24:27]
  s_add_u32 m0, s86, 12288
  s_add_u32 s88, s87, 4096
  buffer_load_dwordx4 v241, s[32:35], s88 offen sc1 lds
  ds_read_b64_tr_b16 a[30:31], v160 offset:26496
  v_mfma_f32_16x16x32_bf16 v[84:87], a[4:7], a[56:59], v[84:87]
  v_mfma_f32_16x16x32_bf16 v[124:127], a[4:7], a[60:63], v[124:127]
  ds_read_b64_tr_b16 a[32:33], v160 offset:17824
  v_mfma_f32_16x16x32_bf16 v[28:31], a[8:11], a[52:55], v[28:31]
  ds_read_b64_tr_b16 a[34:35], v160 offset:26528
  v_mfma_f32_16x16x32_bf16 v[88:91], a[8:11], a[56:59], v[88:91]
  ds_read_b64_tr_b16 a[36:37], v160 offset:17856
  s_waitcnt lgkmcnt(9)
  v_mfma_f32_16x16x32_bf16 v[32:35], a[12:15], a[52:55], v[32:35]
  ds_read_b64_tr_b16 a[38:39], v160 offset:26560
  v_mfma_f32_16x16x32_bf16 v[92:95], a[12:15], a[56:59], v[92:95]
  v_mfma_f32_16x16x32_bf16 v[36:39], a[16:19], a[52:55], v[36:39]
  v_mfma_f32_16x16x32_bf16 v[96:99], a[16:19], a[56:59], v[96:99]
  v_mfma_f32_16x16x32_bf16 v[132:135], a[16:19], a[60:63], v[132:135]
  s_waitcnt lgkmcnt(6)
  v_mfma_f32_16x16x32_bf16 v[40:43], a[52:55], a[20:23], v[40:43]
  v_mfma_f32_16x16x32_bf16 v[100:103], a[56:59], a[20:23], v[100:103]
  s_waitcnt lgkmcnt(0)
  s_barrier
  v_mfma_f32_16x16x32_bf16 v[44:47], a[52:55], a[24:27], v[44:47]
  v_mfma_f32_16x16x32_bf16 v[104:107], a[56:59], a[24:27], v[104:107]
  v_mfma_f32_16x16x32_bf16 v[128:131], a[60:63], a[24:27], v[128:131]
  v_mfma_f32_16x16x32_bf16 v[48:51], a[52:55], a[28:31], v[48:51]
  v_mfma_f32_16x16x32_bf16 v[108:111], a[56:59], a[28:31], v[108:111]
  v_mfma_f32_16x16x32_bf16 v[52:55], a[52:55], a[32:35], v[52:55]
  v_mfma_f32_16x16x32_bf16 v[112:115], a[56:59], a[32:35], v[112:115]
  v_mfma_f32_16x16x32_bf16 v[56:59], a[52:55], a[36:39], v[56:59]
  v_mfma_f32_16x16x32_bf16 v[116:119], a[56:59], a[36:39], v[116:119]
  s_branch L_ep_attn
L_pp_attn_1:
  buffer_load_dwordx2 v[252:253], v249, s[76:79], 0 offen sc1
  s_branch L_np_attn_1
L_attn_2:
  v_lshlrev_b32 v241, 4, v255
  v_and_b32 v1, 15, v255
  v_lshrrev_b32 v2, 2, v1
  v_and_b32 v3, 3, v1
  v_lshrrev_b32 v4, 4, v255
  v_lshrrev_b32 v5, 1, v2
  v_lshl_add_u32 v5, v4, 1, v5
  v_mul_u32_u24 v5, 1088, v5
  v_and_b32_e64 v2, 1, v2
  v_mul_u32_u24 v2, 480, v2
  v_lshlrev_b32_e64 v3, 3, v3
  v_add3_u32 v5, v5, v2, v3
  v_add_u32 v160, 18432, v5
  v_and_b32 v1, 15, v255
  v_lshrrev_b32 v4, 4, v255
  v_lshrrev_b32 v2, 1, v1
  v_xor_b32 v2, v2, v4
  v_lshlrev_b32_e64 v2, 4, v2
  v_lshl_add_u32 v2, v1, 7, v2
  v_add_u32 v161, 0, v2
  v_xor_b32 v2, 64, v2
  v_add_u32 v162, 0, v2
  v_and_b32 v1, 15, v255
  v_lshrrev_b32 v2, 4, v255
  v_lshlrev_b32 v3, 2, v2
  v_sub_u32 v3, v1, v3
  v_and_b32 v4, 1, v1
  v_mov_b32 v5, 0xf149f2ca
  v_cmp_eq_u32 s[64:65], 0, v4
  v_subrev_u32_e64 v6, 0, v3
  v_cmp_le_i32 s[66:67], 0, v6
  s_mov_b64 s[68:69], s[64:65]
  s_and_b64 s[70:71], s[68:69], s[66:67]
  s_andn2_b64 s[72:73], s[68:69], s[66:67]
  v_cndmask_b32_e64 v7, v5, 0, s[72:73]
  v_accvgpr_write_b32 a244, v7
  v_cndmask_b32_e64 v8, v5, 0, s[70:71]
  v_accvgpr_write_b32 a248, v8
  v_subrev_u32 v6, 1, v3
  v_cmp_le_i32 s[66:67], 0, v6
  s_andn2_b64 s[68:69], exec, s[64:65]
  s_and_b64 s[70:71], s[68:69], s[66:67]
  s_andn2_b64 s[72:73], s[68:69], s[66:67]
  v_cndmask_b32_e64 v7, v5, 0, s[72:73]
  v_accvgpr_write_b32 a245, v7
  v_cndmask_b32_e64 v8, v5, 0, s[70:71]
  v_accvgpr_write_b32 a249, v8
  v_subrev_u32 v6, 2, v3
  v_cmp_le_i32 s[66:67], 0, v6
  s_mov_b64 s[68:69], s[64:65]
  s_and_b64 s[70:71], s[68:69], s[66:67]
  s_andn2_b64 s[72:73], s[68:69], s[66:67]
  v_cndmask_b32_e64 v7, v5, 0, s[72:73]
  v_accvgpr_write_b32 a246, v7
  v_cndmask_b32_e64 v8, v5, 0, s[70:71]
  v_accvgpr_write_b32 a250, v8
  v_subrev_u32 v6, 3, v3
  v_cmp_le_i32 s[66:67], 0, v6
  s_andn2_b64 s[68:69], exec, s[64:65]
  s_and_b64 s[70:71], s[68:69], s[66:67]
  s_andn2_b64 s[72:73], s[68:69], s[66:67]
  v_cndmask_b32_e64 v7, v5, 0, s[72:73]
  v_accvgpr_write_b32 a247, v7
  v_cndmask_b32_e64 v8, v5, 0, s[70:71]
  v_accvgpr_write_b32 a251, v8
  v_sub_u32 v6, v3, v4
  v_mov_b32 v9, 0x0c0c0100
  v_mov_b32 v10, 0x01000c0c
  v_cndmask_b32_e64 v9, v10, v9, s[64:65]
  v_mov_b32 v10, 0x0c0c0302
  v_mov_b32 v11, 0x03020c0c
  v_cndmask_b32_e64 v10, v11, v10, s[64:65]
  v_mov_b32 v11, 0x0c0c0c0c
  v_cmp_le_i32 s[66:67], 0, v6
  s_nop 1
  v_cndmask_b32_e64 v12, v9, v11, s[66:67]
  v_accvgpr_write_b32 a252, v12
  v_cndmask_b32_e64 v13, v11, v9, s[66:67]
  v_accvgpr_write_b32 a254, v13
  v_cmp_le_i32 s[66:67], 2, v6
  s_nop 1
  v_cndmask_b32_e64 v12, v10, v11, s[66:67]
  v_accvgpr_write_b32 a253, v12
  v_cndmask_b32_e64 v13, v11, v10, s[66:67]
  v_accvgpr_write_b32 a255, v13
  s_add_u32 s90, s92, 81920
  v_add_u32_e64 v166, s90, v163
  s_add_u32 s90, s92, 91136
  v_add_u32_e64 v167, s90, v164
  s_add_u32 s90, s92, 100352
  v_add_u32_e64 v168, s90, v163
  s_add_u32 s90, s92, 109568
  v_add_u32_e64 v169, s90, v164
  v_add_u32 v170, 122880, v165
  v_add_u32 v171, 129472, v165
  v_add_u32 v172, 151424, v165
  v_add_u32 v173, 158016, v165
  v_add_u32 v174, 184320, v165
  v_add_u32 v175, 190912, v165
  v_add_u32 v176, 212864, v165
  v_add_u32 v177, 219456, v165
  v_mov_b32 v232, 0
  v_mov_b32 v233, 0
  v_mov_b32 v234, 0
  v_mov_b32_e64 v235, 0
  s_nop 1
  v_mfma_f32_32x32x16_bf16 v[0:15], v[232:235], v[232:235], 0
  v_mfma_f32_32x32x16_bf16 v[16:31], v[232:235], v[232:235], 0
  v_mfma_f32_32x32x16_bf16 v[32:47], v[232:235], v[232:235], 0
  v_mfma_f32_32x32x16_bf16 v[48:63], v[232:235], v[232:235], 0
  v_mfma_f32_32x32x16_bf16 v[64:79], v[232:235], v[232:235], 0
  v_mfma_f32_32x32x16_bf16 v[80:95], v[232:235], v[232:235], 0
  v_mfma_f32_32x32x16_bf16 v[96:111], v[232:235], v[232:235], 0
  v_mfma_f32_32x32x16_bf16 v[112:127], v[232:235], v[232:235], 0
  v_mov_b32 v128, 0
  v_mov_b32 v129, 0
  v_mov_b32 v130, 0
  v_mov_b32 v131, 0
  v_mov_b32 v132, 0
  v_mov_b32 v133, 0
  v_mov_b32 v134, 0
  v_mov_b32 v135, 0
  v_mov_b32 v254, 0x3f803f80
  v_accvgpr_write_b32 a240, v254
  v_accvgpr_write_b32 a241, v254
  v_accvgpr_write_b32 a242, v254
  v_accvgpr_write_b32 a243, v254
  v_mov_b32 v249, 0
  s_lshl_b32 s39, s38, 7
  s_mul_i32 s40, s38, 245760
  s_mov_b32 s41, 53248
  s_add_u32 m0, s41, 10240
  s_nop 0
  buffer_load_dwordx4 v166, s[24:27], s39 offen offset:0 lds
  buffer_load_dwordx4 v167, s[24:27], s39 offen offset:1024 lds
  buffer_load_dwordx4 v168, s[24:27], s39 offen offset:2048 lds
  buffer_load_dwordx4 v169, s[24:27], s39 offen offset:3072 lds
  s_add_u32 m0, s41, 35840
  s_nop 0
  buffer_load_dwordx4 v170, s[28:31], s40 offen offset:0 lds
  buffer_load_dwordx4 v171, s[28:31], s40 offen offset:1088 lds
  buffer_load_dwordx4 v172, s[28:31], s40 offen offset:2176 lds
  buffer_load_dwordx4 v173, s[28:31], s40 offen offset:3264 lds
  s_add_u32 m0, s41, 40192
  s_nop 0
  buffer_load_dwordx4 v174, s[28:31], s40 offen offset:0 lds
  buffer_load_dwordx4 v175, s[28:31], s40 offen offset:1088 lds
  buffer_load_dwordx4 v176, s[28:31], s40 offen offset:2176 lds
  buffer_load_dwordx4 v177, s[28:31], s40 offen offset:3264 lds
  s_add_u32 s38, s38, 1
  s_cmp_eq_u32 s38, 10
  s_cselect_b32 s38, 0, s38
  s_and_b32 s46, s2, 7
  s_lshr_b32 s47, s2, 3
  s_lshr_b32 s80, s47, 3
  s_lshl_b32 s46, s46, 2
  s_add_u32 s80, s80, s46
  s_and_b32 s81, s47, 7
  s_lshr_b32 s89, s80, 1
  s_lshl_b32 s89, s89, 2
  s_mul_i32 s83, s81, 378880
  s_add_u32 s83, s83, 10485760
  s_mul_i32 s84, s80, 303104
  s_mul_i32 s85, s22, 12288
  s_add_u32 s85, s85, 53248
  s_mul_i32 s86, s22, 13312
  s_add_u32 s86, s86, 106496
  s_mul_i32 s46, s81, 7
  s_lshr_b32 s46, s46, 2
  s_and_b32 s47, s80, 3
  s_mul_i32 s47, s47, 7
  s_lshr_b32 s47, s47, 1
  s_add_u32 s46, s46, s47
  s_sub_u32 s47, s46, 14
  s_cmp_ge_u32 s46, 14
  s_cselect_b32 s46, s47, s46
  s_lshl_b32 s46, s46, 2
  s_add_u32 s46, s46, s22
  s_add_u32 s46, s46, 20
  s_lshl_b32 s4, s46, 10
  s_cmp_ge_u32 s46, 74
  s_cselect_b32 s4, 0x10000000, s4
  s_add_u32 s46, s46, 4
  s_sub_u32 s47, s46, 56
  s_cmp_ge_u32 s46, 76
  s_cselect_b32 s46, s47, s46
  s_lshl_b32 s5, s46, 10
  s_cmp_ge_u32 s46, 74
  s_cselect_b32 s5, 0x10000000, s5
  s_add_u32 s46, s46, 4
  s_sub_u32 s47, s46, 56
  s_cmp_ge_u32 s46, 76
  s_cselect_b32 s46, s47, s46
  s_lshl_b32 s6, s46, 10
  s_cmp_ge_u32 s46, 74
  s_cselect_b32 s6, 0x10000000, s6
  s_add_u32 s46, s46, 4
  s_sub_u32 s47, s46, 56
  s_cmp_ge_u32 s46, 76
  s_cselect_b32 s46, s47, s46
  s_lshl_b32 s7, s46, 10
  s_cmp_ge_u32 s46, 74
  s_cselect_b32 s7, 0x10000000, s7
  s_add_u32 s46, s46, 4
  s_sub_u32 s47, s46, 56
  s_cmp_ge_u32 s46, 76
  s_cselect_b32 s46, s47, s46
  s_lshl_b32 s8, s46, 10
  s_cmp_ge_u32 s46, 74
  s_cselect_b32 s8, 0x10000000, s8
  s_add_u32 s46, s46, 4
  s_sub_u32 s47, s46, 56
  s_cmp_ge_u32 s46, 76
  s_cselect_b32 s46, s47, s46
  s_lshl_b32 s9, s46, 10
  s_cmp_ge_u32 s46, 74
  s_cselect_b32 s9, 0x10000000, s9
  s_add_u32 s46, s46, 4
  s_sub_u32 s47, s46, 56
  s_cmp_ge_u32 s46, 76
  s_cselect_b32 s46, s47, s46
  s_lshl_b32 s10, s46, 10
  s_cmp_ge_u32 s46, 74
  s_cselect_b32 s10, 0x10000000, s10
  s_add_u32 s46, s46, 4
  s_sub_u32 s47, s46, 56
  s_cmp_ge_u32 s46, 76
  s_cselect_b32 s46, s47, s46
  s_lshl_b32 s11, s46, 10
  s_cmp_ge_u32 s46, 74
  s_cselect_b32 s11, 0x10000000, s11
  s_add_u32 s46, s46, 4
  s_sub_u32 s47, s46, 56
  s_cmp_ge_u32 s46, 76
  s_cselect_b32 s46, s47, s46
  s_lshl_b32 s12, s46, 10
  s_cmp_ge_u32 s46, 74
  s_cselect_b32 s12, 0x10000000, s12
  s_add_u32 s46, s46, 4
  s_sub_u32 s47, s46, 56
  s_cmp_ge_u32 s46, 76
  s_cselect_b32 s46, s47, s46
  s_lshl_b32 s13, s46, 10
  s_cmp_ge_u32 s46, 74
  s_cselect_b32 s13, 0x10000000, s13
  s_add_u32 s46, s46, 4
  s_sub_u32 s47, s46, 56
  s_cmp_ge_u32 s46, 76
  s_cselect_b32 s46, s47, s46
  s_lshl_b32 s14, s46, 10
  s_cmp_ge_u32 s46, 74
  s_cselect_b32 s14, 0x10000000, s14
  s_add_u32 s46, s46, 4
  s_sub_u32 s47, s46, 56
  s_cmp_ge_u32 s46, 76
  s_cselect_b32 s46, s47, s46
  s_lshl_b32 s15, s46, 10
  s_cmp_ge_u32 s46, 74
  s_cselect_b32 s15, 0x10000000, s15
  s_add_u32 s46, s46, 4
  s_sub_u32 s47, s46, 56
  s_cmp_ge_u32 s46, 76
  s_cselect_b32 s46, s47, s46
  s_lshl_b32 s18, s46, 10
  s_cmp_ge_u32 s46, 74
  s_cselect_b32 s18, 0x10000000, s18
  s_add_u32 s46, s46, 4
  s_sub_u32 s47, s46, 56
  s_cmp_ge_u32 s46, 76
  s_cselect_b32 s46, s47, s46
  s_lshl_b32 s19, s46, 10
  s_cmp_ge_u32 s46, 74
  s_cselect_b32 s19, 0x10000000, s19
  v_add_u32 v245, 4096, v241
  s_lshl_b32 s45, s2, 7
  s_add_u32 s45, s45, 15728640
  s_lshl_b32 s39, s38, 7
  s_mul_i32 s40, s38, 245760
  s_mov_b32 s41, 106496
  s_mov_b32 s94, 53248
  s_mov_b32 s95, 4294860800
  s_mov_b32 s43, 0
  s_waitcnt vmcnt(12) lgkmcnt(0)
  s_barrier
  ds_read_b128 a[40:43], v161 offset:10240
  ds_read_b128 a[44:47], v161 offset:12288
  ds_read_b128 a[48:51], v161 offset:0
  ds_read_b64_tr_b16 a[0:1], v160 offset:0
  ds_read_b64_tr_b16 a[2:3], v160 offset:8704
  ds_read_b64_tr_b16 a[4:5], v160 offset:32
  ds_read_b64_tr_b16 a[6:7], v160 offset:8736
  ds_read_b64_tr_b16 a[8:9], v160 offset:64
  ds_read_b64_tr_b16 a[10:11], v160 offset:8768
  ds_read_b64_tr_b16 a[12:13], v160 offset:96
  ds_read_b64_tr_b16 a[14:15], v160 offset:8800
  ds_read_b64_tr_b16 a[16:17], v160 offset:128
  ds_read_b64_tr_b16 a[18:19], v160 offset:8832
  ds_read_b64_tr_b16 a[20:21], v160 offset:160
  ds_read_b64_tr_b16 a[22:23], v160 offset:8864
L_loop_attn_2:
  ds_read_b64_tr_b16 a[24:25], v160 offset:192
  s_waitcnt lgkmcnt(9)
  v_mfma_f32_16x16x32_bf16 v[0:3], a[0:3], a[40:43], v[0:3]
  ds_read_b64_tr_b16 a[26:27], v160 offset:8896
  v_mfma_f32_16x16x32_bf16 v[60:63], a[0:3], a[44:47], v[60:63]
  ds_read_b64_tr_b16 a[28:29], v160 offset:224
  v_mfma_f32_16x16x32_bf16 v[4:7], a[4:7], a[40:43], v[4:7]
  ds_read_b64_tr_b16 a[30:31], v160 offset:8928
  v_mfma_f32_16x16x32_bf16 v[64:67], a[4:7], a[44:47], v[64:67]
  s_cmp_lg_u32 s43, 7
  s_cbranch_scc0 L_pp_attn_2
L_np_attn_2:
  ds_read_b64_tr_b16 a[32:33], v160 offset:256
  s_waitcnt lgkmcnt(9)
  v_mfma_f32_16x16x32_bf16 v[8:11], a[8:11], a[40:43], v[8:11]
  ds_read_b64_tr_b16 a[34:35], v160 offset:8960
  v_mfma_f32_16x16x32_bf16 v[68:71], a[8:11], a[44:47], v[68:71]
  v_mfma_f32_16x16x32_bf16 v[120:123], a[8:11], a[48:51], v[120:123]
  s_add_u32 m0, s41, 10240
  ds_read_b64_tr_b16 a[36:37], v160 offset:288
  v_mfma_f32_16x16x32_bf16 v[12:15], a[12:15], a[40:43], v[12:15]
  ds_read_b64_tr_b16 a[38:39], v160 offset:8992
  v_mfma_f32_16x16x32_bf16 v[72:75], a[12:15], a[44:47], v[72:75]
  ds_read_b64_tr_b16 a[0:1], v160 offset:320
  ds_read_b64_tr_b16 a[2:3], v160 offset:9024
  ds_read_b128 a[52:55], v162 offset:10240
  s_waitcnt lgkmcnt(11)
  v_mfma_f32_16x16x32_bf16 v[16:19], a[16:19], a[40:43], v[16:19]
  buffer_load_dwordx4 v166, s[24:27], s39 offen offset:0 lds
  ds_read_b128 a[56:59], v162 offset:12288
  ds_read_b128 a[60:63], v162 offset:0
  v_mfma_f32_16x16x32_bf16 v[76:79], a[16:19], a[44:47], v[76:79]
  ds_read_b64_tr_b16 a[4:5], v160 offset:352
  v_mfma_f32_16x16x32_bf16 v[20:23], a[20:23], a[40:43], v[20:23]
  ds_read_b64_tr_b16 a[6:7], v160 offset:9056
  v_mfma_f32_16x16x32_bf16 v[80:83], a[20:23], a[44:47], v[80:83]
  buffer_load_dwordx4 v167, s[24:27], s39 offen offset:1024 lds
  ds_read_b64_tr_b16 a[8:9], v160 offset:384
  s_waitcnt lgkmcnt(12)
  v_mfma_f32_16x16x32_bf16 v[24:27], a[24:27], a[40:43], v[24:27]
  ds_read_b64_tr_b16 a[10:11], v160 offset:9088
  v_mfma_f32_16x16x32_bf16 v[84:87], a[24:27], a[44:47], v[84:87]
  ds_read_b64_tr_b16 a[12:13], v160 offset:416
  v_mfma_f32_16x16x32_bf16 v[28:31], a[28:31], a[40:43], v[28:31]
  ds_read_b64_tr_b16 a[14:15], v160 offset:9120
  v_mfma_f32_16x16x32_bf16 v[88:91], a[28:31], a[44:47], v[88:91]
  buffer_load_dwordx4 v168, s[24:27], s39 offen offset:2048 lds
  v_mfma_f32_16x16x32_bf16 v[124:127], a[28:31], a[48:51], v[124:127]
  ds_read_b64_tr_b16 a[16:17], v160 offset:448
  s_waitcnt lgkmcnt(12)
  v_mfma_f32_16x16x32_bf16 v[32:35], a[32:35], a[40:43], v[32:35]
  ds_read_b64_tr_b16 a[18:19], v160 offset:9152
  v_mfma_f32_16x16x32_bf16 v[92:95], a[32:35], a[44:47], v[92:95]
  buffer_load_dwordx4 v169, s[24:27], s39 offen offset:3072 lds
  s_add_u32 m0, s41, 35840
  ds_read_b64_tr_b16 a[20:21], v160 offset:17408
  v_mfma_f32_16x16x32_bf16 v[36:39], a[36:39], a[40:43], v[36:39]
  ds_read_b64_tr_b16 a[22:23], v160 offset:26112
  v_mfma_f32_16x16x32_bf16 v[96:99], a[36:39], a[44:47], v[96:99]
  ds_read_b64_tr_b16 a[24:25], v160 offset:17440
  s_waitcnt lgkmcnt(12)
  v_mfma_f32_16x16x32_bf16 v[40:43], a[40:43], a[0:3], v[40:43]
  buffer_load_dwordx4 v170, s[28:31], s40 offen offset:0 lds
  ds_read_b64_tr_b16 a[26:27], v160 offset:26144
  v_mfma_f32_16x16x32_bf16 v[100:103], a[44:47], a[0:3], v[100:103]
  ds_read_b64_tr_b16 a[28:29], v160 offset:17472
  s_waitcnt lgkmcnt(9)
  v_mfma_f32_16x16x32_bf16 v[44:47], a[40:43], a[4:7], v[44:47]
  ds_read_b64_tr_b16 a[30:31], v160 offset:26176
  v_mfma_f32_16x16x32_bf16 v[104:107], a[44:47], a[4:7], v[104:107]
  ds_read_b64_tr_b16 a[32:33], v160 offset:17504
  v_mfma_f32_16x16x32_bf16 v[48:51], a[40:43], a[8:11], v[48:51]
  buffer_load_dwordx4 v171, s[28:31], s40 offen offset:1088 lds
  ds_read_b64_tr_b16 a[34:35], v160 offset:26208
  v_mfma_f32_16x16x32_bf16 v[108:111], a[44:47], a[8:11], v[108:111]
  v_mfma_f32_16x16x32_bf16 v[128:131], a[48:51], a[8:11], v[128:131]
  ds_read_b64_tr_b16 a[36:37], v160 offset:17536
  s_waitcnt lgkmcnt(9)
  v_mfma_f32_16x16x32_bf16 v[52:55], a[40:43], a[12:15], v[52:55]
  buffer_load_dwordx4 v172, s[28:31], s40 offen offset:2176 lds
  ds_read_b64_tr_b16 a[38:39], v160 offset:26240
  v_mfma_f32_16x16x32_bf16 v[112:115], a[44:47], a[12:15], v[112:115]
  ds_read_b64_tr_b16 a[0:1], v160 offset:17568
  v_mfma_f32_16x16x32_bf16 v[56:59], a[40:43], a[16:19], v[56:59]
  ds_read_b64_tr_b16 a[2:3], v160 offset:26272
  v_mfma_f32_16x16x32_bf16 v[116:119], a[44:47], a[16:19], v[116:119]
  buffer_load_dwordx4 v173, s[28:31], s40 offen offset:3264 lds
  s_add_u32 m0, s41, 40192
  v_mfma_f32_16x16x32_bf16 v[132:135], a[48:51], a[16:19], v[132:135]
  ds_read_b64_tr_b16 a[4:5], v160 offset:17600
  s_waitcnt lgkmcnt(9)
  v_mfma_f32_16x16x32_bf16 v[0:3], a[20:23], a[52:55], v[0:3]
  ds_read_b64_tr_b16 a[6:7], v160 offset:26304
  v_mfma_f32_16x16x32_bf16 v[60:63], a[20:23], a[56:59], v[60:63]
  buffer_load_dwordx4 v174, s[28:31], s40 offen offset:0 lds
  ds_read_b64_tr_b16 a[8:9], v160 offset:17632
  v_mfma_f32_16x16x32_bf16 v[4:7], a[24:27], a[52:55], v[4:7]
  ds_read_b64_tr_b16 a[10:11], v160 offset:26336
  v_mfma_f32_16x16x32_bf16 v[64:67], a[24:27], a[56:59], v[64:67]
  ds_read_b64_tr_b16 a[12:13], v160 offset:17664
  s_waitcnt lgkmcnt(9)
  v_mfma_f32_16x16x32_bf16 v[8:11], a[28:31], a[52:55], v[8:11]
  ds_read_b64_tr_b16 a[14:15], v160 offset:26368
  v_mfma_f32_16x16x32_bf16 v[68:71], a[28:31], a[56:59], v[68:71]
  buffer_load_dwordx4 v175, s[28:31], s40 offen offset:1088 lds
  v_mfma_f32_16x16x32_bf16 v[120:123], a[28:31], a[60:63], v[120:123]
  ds_read_b64_tr_b16 a[16:17], v160 offset:17696
  v_mfma_f32_16x16x32_bf16 v[12:15], a[32:35], a[52:55], v[12:15]
  ds_read_b64_tr_b16 a[18:19], v160 offset:26400
  v_mfma_f32_16x16x32_bf16 v[72:75], a[32:35], a[56:59], v[72:75]
  buffer_load_dwordx4 v176, s[28:31], s40 offen offset:2176 lds
  ds_read_b64_tr_b16 a[20:21], v160 offset:17728
  s_waitcnt lgkmcnt(9)
  v_mfma_f32_16x16x32_bf16 v[16:19], a[36:39], a[52:55], v[16:19]
  ds_read_b64_tr_b16 a[22:23], v160 offset:26432
  v_mfma_f32_16x16x32_bf16 v[76:79], a[36:39], a[56:59], v[76:79]
  ds_read_b64_tr_b16 a[24:25], v160 offset:17760
  v_mfma_f32_16x16x32_bf16 v[20:23], a[0:3], a[52:55], v[20:23]
  buffer_load_dwordx4 v177, s[28:31], s40 offen offset:3264 lds
  ds_read_b64_tr_b16 a[26:27], v160 offset:26464
  v_mfma_f32_16x16x32_bf16 v[80:83], a[0:3], a[56:59], v[80:83]
  ds_read_b64_tr_b16 a[28:29], v160 offset:17792
  s_waitcnt lgkmcnt(9)
  v_mfma_f32_16x16x32_bf16 v[24:27], a[4:7], a[52:55], v[24:27]
  ds_read_b64_tr_b16 a[30:31], v160 offset:26496
  v_mfma_f32_16x16x32_bf16 v[84:87], a[4:7], a[56:59], v[84:87]
  ds_read_b64_tr_b16 a[32:33], v160 offset:17824
  v_mfma_f32_16x16x32_bf16 v[28:31], a[8:11], a[52:55], v[28:31]
  ds_read_b64_tr_b16 a[34:35], v160 offset:26528
  v_mfma_f32_16x16x32_bf16 v[88:91], a[8:11], a[56:59], v[88:91]
  v_mfma_f32_16x16x32_bf16 v[124:127], a[8:11], a[60:63], v[124:127]
  ds_read_b64_tr_b16 a[36:37], v160 offset:17856
  s_waitcnt lgkmcnt(9)
  v_mfma_f32_16x16x32_bf16 v[32:35], a[12:15], a[52:55], v[32:35]
  ds_read_b64_tr_b16 a[38:39], v160 offset:26560
  v_mfma_f32_16x16x32_bf16 v[92:95], a[12:15], a[56:59], v[92:95]
  v_mfma_f32_16x16x32_bf16 v[36:39], a[16:19], a[52:55], v[36:39]
  v_mfma_f32_16x16x32_bf16 v[96:99], a[16:19], a[56:59], v[96:99]
  s_waitcnt lgkmcnt(6)
  v_mfma_f32_16x16x32_bf16 v[40:43], a[52:55], a[20:23], v[40:43]
  v_mfma_f32_16x16x32_bf16 v[100:103], a[56:59], a[20:23], v[100:103]
  s_waitcnt vmcnt(12) lgkmcnt(0)
  s_barrier
  v_mfma_f32_16x16x32_bf16 v[44:47], a[52:55], a[24:27], v[44:47]
  s_cmp_eq_u32 s41, 53248
  s_cselect_b32 s42, s95, s94
  v_add_u32 v160, s42, v160
  v_mfma_f32_16x16x32_bf16 v[104:107], a[56:59], a[24:27], v[104:107]
  v_add_u32 v161, s42, v161
  v_add_u32 v162, s42, v162
  ds_read_b128 a[40:43], v161 offset:10240
  v_mfma_f32_16x16x32_bf16 v[48:51], a[52:55], a[28:31], v[48:51]
  ds_read_b128 a[44:47], v161 offset:12288
  ds_read_b128 a[48:51], v161 offset:0
  ds_read_b64_tr_b16 a[0:1], v160 offset:0
  v_mfma_f32_16x16x32_bf16 v[108:111], a[56:59], a[28:31], v[108:111]
  ds_read_b64_tr_b16 a[2:3], v160 offset:8704
  ds_read_b64_tr_b16 a[4:5], v160 offset:32
  ds_read_b64_tr_b16 a[6:7], v160 offset:8736
  v_mfma_f32_16x16x32_bf16 v[128:131], a[60:63], a[28:31], v[128:131]
  ds_read_b64_tr_b16 a[8:9], v160 offset:64
  ds_read_b64_tr_b16 a[10:11], v160 offset:8768
  ds_read_b64_tr_b16 a[12:13], v160 offset:96
  v_mfma_f32_16x16x32_bf16 v[52:55], a[52:55], a[32:35], v[52:55]
  ds_read_b64_tr_b16 a[14:15], v160 offset:8800
  ds_read_b64_tr_b16 a[16:17], v160 offset:128
  ds_read_b64_tr_b16 a[18:19], v160 offset:8832
  v_mfma_f32_16x16x32_bf16 v[112:115], a[56:59], a[32:35], v[112:115]
  ds_read_b64_tr_b16 a[20:21], v160 offset:160
  ds_read_b64_tr_b16 a[22:23], v160 offset:8864
  s_add_u32 s38, s38, 1
  v_mfma_f32_16x16x32_bf16 v[56:59], a[52:55], a[36:39], v[56:59]
  s_cmp_eq_u32 s38, 10
  s_cselect_b32 s38, 0, s38
  s_lshl_b32 s39, s38, 7
  v_mfma_f32_16x16x32_bf16 v[116:119], a[56:59], a[36:39], v[116:119]
  s_mul_i32 s40, s38, 245760
  s_cmp_eq_u32 s41, 106496
  s_cselect_b32 s42, s95, s94
  v_mfma_f32_16x16x32_bf16 v[132:135], a[60:63], a[36:39], v[132:135]
  s_add_u32 s41, s41, s42
  s_add_u32 s43, s43, 1
  s_cmp_lt_u32 s43, 8
  s_cbranch_scc1 L_loop_attn_2
  v_readfirstlane_b32 s23, v252
  s_nop 3
  s_cmp_lg_u32 s23, 0
  s_cbranch_scc1 L_nok_attn_2
  s_mov_b32 s47, 0
  v_mov_b32_e64 v251, 0
L_nspin_attn_2:
  buffer_load_dword v250, v251, s[76:79], 0 offen sc1
  s_waitcnt vmcnt(0)
  v_readfirstlane_b32 s23, v250
  s_nop 3
  s_cmp_lg_u32 s23, 0
  s_cbranch_scc1 L_nok_attn_2
  s_sleep 8
  s_add_u32 s47, s47, 1
  s_cmp_lt_u32 s47, 200000
  s_cbranch_scc1 L_nspin_attn_2
L_nok_attn_2:
  v_readfirstlane_b32 s46, v253
  s_nop 3
  s_cmp_ge_u32 s46, 128
  s_cbranch_scc1 L_cok_p_attn_2
  s_mov_b32 s47, 0
  v_mov_b32_e64 v251, 0
L_cspin_p_attn_2:
  buffer_load_dword v250, v251, s[76:79], 0 offen offset:4 sc1
  s_waitcnt vmcnt(0)
  v_readfirstlane_b32 s46, v250
  s_nop 3
  s_cmp_ge_u32 s46, 128
  s_cbranch_scc1 L_cok_p_attn_2
  s_sleep 40
  s_add_u32 s47, s47, 1
  s_cmp_lt_u32 s47, 200000
  s_cbranch_scc1 L_cspin_p_attn_2
L_cok_p_attn_2:
  ds_read_b64_tr_b16 a[24:25], v160 offset:192
  s_waitcnt lgkmcnt(9)
  v_mfma_f32_16x16x32_bf16 v[0:3], a[0:3], a[40:43], v[0:3]
  ds_read_b64_tr_b16 a[26:27], v160 offset:8896
  v_mfma_f32_16x16x32_bf16 v[60:63], a[0:3], a[44:47], v[60:63]
  ds_read_b64_tr_b16 a[28:29], v160 offset:224
  v_mfma_f32_16x16x32_bf16 v[4:7], a[4:7], a[40:43], v[4:7]
  ds_read_b64_tr_b16 a[30:31], v160 offset:8928
  v_mfma_f32_16x16x32_bf16 v[64:67], a[4:7], a[44:47], v[64:67]
  s_mul_i32 s87, s4, 5
  s_add_u32 s87, s87, s83
  s_add_u32 m0, s85, 0
  s_add_u32 s88, s87, 0
  buffer_load_dwordx4 v241, s[32:35], s88 offen sc1 lds
  ds_read_b64_tr_b16 a[32:33], v160 offset:256
  s_waitcnt lgkmcnt(9)
  v_mfma_f32_16x16x32_bf16 v[8:11], a[8:11], a[40:43], v[8:11]
  ds_read_b64_tr_b16 a[34:35], v160 offset:8960
  v_mfma_f32_16x16x32_bf16 v[68:71], a[8:11], a[44:47], v[68:71]
  v_mfma_f32_16x16x32_bf16 v[120:123], a[8:11], a[48:51], v[120:123]
  s_add_u32 m0, s85, 1024
  s_add_u32 s88, s87, 1024
  buffer_load_dwordx4 v241, s[32:35], s88 offen sc1 lds
  ds_read_b64_tr_b16 a[36:37], v160 offset:288
  v_mfma_f32_16x16x32_bf16 v[12:15], a[12:15], a[40:43], v[12:15]
  ds_read_b64_tr_b16 a[38:39], v160 offset:8992
  v_mfma_f32_16x16x32_bf16 v[72:75], a[12:15], a[44:47], v[72:75]
  ds_read_b64_tr_b16 a[0:1], v160 offset:320
  ds_read_b64_tr_b16 a[2:3], v160 offset:9024
  ds_read_b128 a[52:55], v162 offset:10240
  s_waitcnt lgkmcnt(11)
  v_mfma_f32_16x16x32_bf16 v[16:19], a[16:19], a[40:43], v[16:19]
  ds_read_b128 a[56:59], v162 offset:12288
  ds_read_b128 a[60:63], v162 offset:0
  v_mfma_f32_16x16x32_bf16 v[76:79], a[16:19], a[44:47], v[76:79]
  s_add_u32 m0, s85, 2048
  s_add_u32 s88, s87, 2048
  buffer_load_dwordx4 v241, s[32:35], s88 offen sc1 lds
  ds_read_b64_tr_b16 a[4:5], v160 offset:352
  v_mfma_f32_16x16x32_bf16 v[20:23], a[20:23], a[40:43], v[20:23]
  ds_read_b64_tr_b16 a[6:7], v160 offset:9056
  v_mfma_f32_16x16x32_bf16 v[80:83], a[20:23], a[44:47], v[80:83]
  ds_read_b64_tr_b16 a[8:9], v160 offset:384
  s_waitcnt lgkmcnt(12)
  v_mfma_f32_16x16x32_bf16 v[24:27], a[24:27], a[40:43], v[24:27]
  ds_read_b64_tr_b16 a[10:11], v160 offset:9088
  v_mfma_f32_16x16x32_bf16 v[84:87], a[24:27], a[44:47], v[84:87]
  s_add_u32 m0, s85, 3072
  s_add_u32 s88, s87, 3072
  buffer_load_dwordx4 v241, s[32:35], s88 offen sc1 lds
  ds_read_b64_tr_b16 a[12:13], v160 offset:416
  v_mfma_f32_16x16x32_bf16 v[28:31], a[28:31], a[40:43], v[28:31]
  ds_read_b64_tr_b16 a[14:15], v160 offset:9120
  v_mfma_f32_16x16x32_bf16 v[88:91], a[28:31], a[44:47], v[88:91]
  v_mfma_f32_16x16x32_bf16 v[124:127], a[28:31], a[48:51], v[124:127]
  ds_read_b64_tr_b16 a[16:17], v160 offset:448
  s_waitcnt lgkmcnt(12)
  v_mfma_f32_16x16x32_bf16 v[32:35], a[32:35], a[40:43], v[32:35]
  s_add_u32 m0, s85, 4096
  s_add_u32 s88, s87, 4096
  buffer_load_dwordx4 v241, s[32:35], s88 offen sc1 lds
  ds_read_b64_tr_b16 a[18:19], v160 offset:9152
  v_mfma_f32_16x16x32_bf16 v[92:95], a[32:35], a[44:47], v[92:95]
  ds_read_b64_tr_b16 a[20:21], v160 offset:17408
  v_mfma_f32_16x16x32_bf16 v[36:39], a[36:39], a[40:43], v[36:39]
  ds_read_b64_tr_b16 a[22:23], v160 offset:26112
  v_mfma_f32_16x16x32_bf16 v[96:99], a[36:39], a[44:47], v[96:99]
  ds_read_b64_tr_b16 a[24:25], v160 offset:17440
  s_waitcnt lgkmcnt(12)
  v_mfma_f32_16x16x32_bf16 v[40:43], a[40:43], a[0:3], v[40:43]
  s_mul_i32 s87, s5, 5
  s_add_u32 s87, s87, s83
  s_add_u32 m0, s85, 5120
  s_add_u32 s88, s87, 0
  buffer_load_dwordx4 v241, s[32:35], s88 offen sc1 lds
  ds_read_b64_tr_b16 a[26:27], v160 offset:26144
  v_mfma_f32_16x16x32_bf16 v[100:103], a[44:47], a[0:3], v[100:103]
  ds_read_b64_tr_b16 a[28:29], v160 offset:17472
  s_waitcnt lgkmcnt(9)
  v_mfma_f32_16x16x32_bf16 v[44:47], a[40:43], a[4:7], v[44:47]
  ds_read_b64_tr_b16 a[30:31], v160 offset:26176
  v_mfma_f32_16x16x32_bf16 v[104:107], a[44:47], a[4:7], v[104:107]
  ds_read_b64_tr_b16 a[32:33], v160 offset:17504
  v_mfma_f32_16x16x32_bf16 v[48:51], a[40:43], a[8:11], v[48:51]
  s_add_u32 m0, s85, 6144
  s_add_u32 s88, s87, 1024
  buffer_load_dwordx4 v241, s[32:35], s88 offen sc1 lds
  ds_read_b64_tr_b16 a[34:35], v160 offset:26208
  v_mfma_f32_16x16x32_bf16 v[108:111], a[44:47], a[8:11], v[108:111]
  v_mfma_f32_16x16x32_bf16 v[128:131], a[48:51], a[8:11], v[128:131]
  ds_read_b64_tr_b16 a[36:37], v160 offset:17536
  s_waitcnt lgkmcnt(9)
  v_mfma_f32_16x16x32_bf16 v[52:55], a[40:43], a[12:15], v[52:55]
  s_add_u32 m0, s85, 7168
  s_add_u32 s88, s87, 2048
  buffer_load_dwordx4 v241, s[32:35], s88 offen sc1 lds
  ds_read_b64_tr_b16 a[38:39], v160 offset:26240
  v_mfma_f32_16x16x32_bf16 v[112:115], a[44:47], a[12:15], v[112:115]
  ds_read_b64_tr_b16 a[0:1], v160 offset:17568
  v_mfma_f32_16x16x32_bf16 v[56:59], a[40:43], a[16:19], v[56:59]
  ds_read_b64_tr_b16 a[2:3], v160 offset:26272
  v_mfma_f32_16x16x32_bf16 v[116:119], a[44:47], a[16:19], v[116:119]
  v_mfma_f32_16x16x32_bf16 v[132:135], a[48:51], a[16:19], v[132:135]
  s_add_u32 m0, s85, 8192
  s_add_u32 s88, s87, 3072
  buffer_load_dwordx4 v241, s[32:35], s88 offen sc1 lds
  ds_read_b64_tr_b16 a[4:5], v160 offset:17600
  s_waitcnt lgkmcnt(9)
  v_mfma_f32_16x16x32_bf16 v[0:3], a[20:23], a[52:55], v[0:3]
  ds_read_b64_tr_b16 a[6:7], v160 offset:26304
  v_mfma_f32_16x16x32_bf16 v[60:63], a[20:23], a[56:59], v[60:63]
  ds_read_b64_tr_b16 a[8:9], v160 offset:17632
  v_mfma_f32_16x16x32_bf16 v[4:7], a[24:27], a[52:55], v[4:7]
  ds_read_b64_tr_b16 a[10:11], v160 offset:26336
  v_mfma_f32_16x16x32_bf16 v[64:67], a[24:27], a[56:59], v[64:67]
  s_add_u32 m0, s85, 9216
  s_add_u32 s88, s87, 4096
  buffer_load_dwordx4 v241, s[32:35], s88 offen sc1 lds
  ds_read_b64_tr_b16 a[12:13], v160 offset:17664
  s_waitcnt lgkmcnt(9)
  v_mfma_f32_16x16x32_bf16 v[8:11], a[28:31], a[52:55], v[8:11]
  ds_read_b64_tr_b16 a[14:15], v160 offset:26368
  v_mfma_f32_16x16x32_bf16 v[68:71], a[28:31], a[56:59], v[68:71]
  v_mfma_f32_16x16x32_bf16 v[120:123], a[28:31], a[60:63], v[120:123]
  ds_read_b64_tr_b16 a[16:17], v160 offset:17696
  v_mfma_f32_16x16x32_bf16 v[12:15], a[32:35], a[52:55], v[12:15]
  s_mul_i32 s87, s6, 5
  s_add_u32 s87, s87, s83
  s_add_u32 m0, s85, 10240
  s_add_u32 s88, s87, 0
  buffer_load_dwordx4 v241, s[32:35], s88 offen sc1 lds
  ds_read_b64_tr_b16 a[18:19], v160 offset:26400
  v_mfma_f32_16x16x32_bf16 v[72:75], a[32:35], a[56:59], v[72:75]
  ds_read_b64_tr_b16 a[20:21], v160 offset:17728
  s_waitcnt lgkmcnt(9)
  v_mfma_f32_16x16x32_bf16 v[16:19], a[36:39], a[52:55], v[16:19]
  ds_read_b64_tr_b16 a[22:23], v160 offset:26432
  v_mfma_f32_16x16x32_bf16 v[76:79], a[36:39], a[56:59], v[76:79]
  ds_read_b64_tr_b16 a[24:25], v160 offset:17760
  v_mfma_f32_16x16x32_bf16 v[20:23], a[0:3], a[52:55], v[20:23]
  s_add_u32 m0, s85, 11264
  s_add_u32 s88, s87, 1024
  buffer_load_dwordx4 v241, s[32:35], s88 offen sc1 lds
  ds_read_b64_tr_b16 a[26:27], v160 offset:26464
  v_mfma_f32_16x16x32_bf16 v[80:83], a[0:3], a[56:59], v[80:83]
  ds_read_b64_tr_b16 a[28:29], v160 offset:17792
  s_waitcnt lgkmcnt(9)
  v_mfma_f32_16x16x32_bf16 v[24:27], a[4:7], a[52:55], v[24:27]
  ds_read_b64_tr_b16 a[30:31], v160 offset:26496
  v_mfma_f32_16x16x32_bf16 v[84:87], a[4:7], a[56:59], v[84:87]
  ds_read_b64_tr_b16 a[32:33], v160 offset:17824
  v_mfma_f32_16x16x32_bf16 v[28:31], a[8:11], a[52:55], v[28:31]
  ds_read_b64_tr_b16 a[34:35], v160 offset:26528
  v_mfma_f32_16x16x32_bf16 v[88:91], a[8:11], a[56:59], v[88:91]
  v_mfma_f32_16x16x32_bf16 v[124:127], a[8:11], a[60:63], v[124:127]
  ds_read_b64_tr_b16 a[36:37], v160 offset:17856
  s_waitcnt lgkmcnt(9)
  v_mfma_f32_16x16x32_bf16 v[32:35], a[12:15], a[52:55], v[32:35]
  ds_read_b64_tr_b16 a[38:39], v160 offset:26560
  v_mfma_f32_16x16x32_bf16 v[92:95], a[12:15], a[56:59], v[92:95]
  v_mfma_f32_16x16x32_bf16 v[36:39], a[16:19], a[52:55], v[36:39]
  v_mfma_f32_16x16x32_bf16 v[96:99], a[16:19], a[56:59], v[96:99]
  s_waitcnt lgkmcnt(6)
  v_mfma_f32_16x16x32_bf16 v[40:43], a[52:55], a[20:23], v[40:43]
  v_mfma_f32_16x16x32_bf16 v[100:103], a[56:59], a[20:23], v[100:103]
  s_waitcnt vmcnt(12) lgkmcnt(0)
  s_barrier
  v_mfma_f32_16x16x32_bf16 v[44:47], a[52:55], a[24:27], v[44:47]
  s_cmp_eq_u32 s41, 53248
  s_cselect_b32 s42, s95, s94
  v_mfma_f32_16x16x32_bf16 v[104:107], a[56:59], a[24:27], v[104:107]
  v_add_u32 v160, s42, v160
  v_add_u32 v161, s42, v161
  v_mfma_f32_16x16x32_bf16 v[48:51], a[52:55], a[28:31], v[48:51]
  v_add_u32_e64 v162, s42, v162
  ds_read_b128 a[40:43], v161 offset:10240
  v_mfma_f32_16x16x32_bf16 v[108:111], a[56:59], a[28:31], v[108:111]
  ds_read_b128 a[44:47], v161 offset:12288
  ds_read_b128 a[48:51], v161 offset:0
  v_mfma_f32_16x16x32_bf16 v[128:131], a[60:63], a[28:31], v[128:131]
  ds_read_b64_tr_b16 a[0:1], v160 offset:0
  ds_read_b64_tr_b16 a[2:3], v160 offset:8704
  v_mfma_f32_16x16x32_bf16 v[52:55], a[52:55], a[32:35], v[52:55]
  ds_read_b64_tr_b16 a[4:5], v160 offset:32
  ds_read_b64_tr_b16 a[6:7], v160 offset:8736
  v_mfma_f32_16x16x32_bf16 v[112:115], a[56:59], a[32:35], v[112:115]
  ds_read_b64_tr_b16 a[8:9], v160 offset:64
  ds_read_b64_tr_b16 a[10:11], v160 offset:8768
  v_mfma_f32_16x16x32_bf16 v[56:59], a[52:55], a[36:39], v[56:59]
  ds_read_b64_tr_b16 a[12:13], v160 offset:96
  ds_read_b64_tr_b16 a[14:15], v160 offset:8800
  v_mfma_f32_16x16x32_bf16 v[116:119], a[56:59], a[36:39], v[116:119]
  ds_read_b64_tr_b16 a[16:17], v160 offset:128
  ds_read_b64_tr_b16 a[18:19], v160 offset:8832
  v_mfma_f32_16x16x32_bf16 v[132:135], a[60:63], a[36:39], v[132:135]
  ds_read_b64_tr_b16 a[20:21], v160 offset:160
  ds_read_b64_tr_b16 a[22:23], v160 offset:8864
  v_and_b32 v251, 15, v255
  v_lshlrev_b32 v251, 4, v251
  s_lshl_b32 s74, s36, 7
  s_sub_u32 s101, s74, 16
  s_cmp_eq_u32 s36, 0
  s_cselect_b32 s101, 0, s101
  s_add_u32 s74, s74, 64
  s_add_u32 s75, s74, 16
  ds_read_b64_tr_b16 a[24:25], v160 offset:192
  s_waitcnt lgkmcnt(9)
  v_mfma_f32_16x16x32_bf16 v[0:3], a[0:3], a[40:43], v[0:3]
  ds_read_b64_tr_b16 a[26:27], v160 offset:8896
  v_mfma_f32_16x16x32_bf16 v[60:63], a[0:3], a[44:47], v[60:63]
  ds_read_b64_tr_b16 a[28:29], v160 offset:224
  v_mfma_f32_16x16x32_bf16 v[4:7], a[4:7], a[40:43], v[4:7]
  ds_read_b64_tr_b16 a[30:31], v160 offset:8928
  v_mfma_f32_16x16x32_bf16 v[64:67], a[4:7], a[44:47], v[64:67]
  s_lshl_b32 s88, s74, 4
  s_add_u32 s88, s88, 14745600
  buffer_load_dwordx4 v[180:183], v251, s[32:35], s88 offen sc1
  ds_read_b64_tr_b16 a[32:33], v160 offset:256
  s_waitcnt lgkmcnt(9)
  v_mfma_f32_16x16x32_bf16 v[8:11], a[8:11], a[40:43], v[8:11]
  ds_read_b64_tr_b16 a[34:35], v160 offset:8960
  v_mfma_f32_16x16x32_bf16 v[68:71], a[8:11], a[44:47], v[68:71]
  s_lshl_b32 s88, s75, 4
  s_add_u32 s88, s88, 14745600
  buffer_load_dwordx4 v[184:187], v251, s[32:35], s88 offen sc1
  v_mfma_f32_16x16x32_bf16 v[120:123], a[8:11], a[48:51], v[120:123]
  ds_read_b64_tr_b16 a[36:37], v160 offset:288
  v_mfma_f32_16x16x32_bf16 v[12:15], a[12:15], a[40:43], v[12:15]
  ds_read_b64_tr_b16 a[38:39], v160 offset:8992
  v_mfma_f32_16x16x32_bf16 v[72:75], a[12:15], a[44:47], v[72:75]
  s_lshl_b32 s88, s101, 4
  s_add_u32 s88, s88, 14745600
  buffer_load_dwordx4 v[188:191], v251, s[32:35], s88 offen sc1
  ds_read_b64_tr_b16 a[0:1], v160 offset:320
  ds_read_b64_tr_b16 a[2:3], v160 offset:9024
  ds_read_b128 a[52:55], v162 offset:10240
  s_waitcnt lgkmcnt(11)
  v_mfma_f32_16x16x32_bf16 v[16:19], a[16:19], a[40:43], v[16:19]
  ds_read_b128 a[56:59], v162 offset:12288
  ds_read_b128 a[60:63], v162 offset:0
  v_mfma_f32_16x16x32_bf16 v[76:79], a[16:19], a[44:47], v[76:79]
  ds_read_b64_tr_b16 a[4:5], v160 offset:352
  v_mfma_f32_16x16x32_bf16 v[20:23], a[20:23], a[40:43], v[20:23]
  s_mul_i32 s87, s6, 5
  s_add_u32 s87, s87, s83
  s_add_u32 m0, s86, 0
  s_add_u32 s88, s87, 2048
  buffer_load_dwordx4 v241, s[32:35], s88 offen sc1 lds
  ds_read_b64_tr_b16 a[6:7], v160 offset:9056
  v_mfma_f32_16x16x32_bf16 v[80:83], a[20:23], a[44:47], v[80:83]
  ds_read_b64_tr_b16 a[8:9], v160 offset:384
  s_waitcnt lgkmcnt(12)
  v_mfma_f32_16x16x32_bf16 v[24:27], a[24:27], a[40:43], v[24:27]
  ds_read_b64_tr_b16 a[10:11], v160 offset:9088
  v_mfma_f32_16x16x32_bf16 v[84:87], a[24:27], a[44:47], v[84:87]
  s_add_u32 m0, s86, 1024
  s_add_u32 s88, s87, 3072
  buffer_load_dwordx4 v241, s[32:35], s88 offen sc1 lds
  ds_read_b64_tr_b16 a[12:13], v160 offset:416
  v_mfma_f32_16x16x32_bf16 v[28:31], a[28:31], a[40:43], v[28:31]
  ds_read_b64_tr_b16 a[14:15], v160 offset:9120
  v_mfma_f32_16x16x32_bf16 v[88:91], a[28:31], a[44:47], v[88:91]
  v_mfma_f32_16x16x32_bf16 v[124:127], a[28:31], a[48:51], v[124:127]
  s_add_u32 m0, s86, 2048
  s_add_u32 s88, s87, 4096
  buffer_load_dwordx4 v241, s[32:35], s88 offen sc1 lds
  ds_read_b64_tr_b16 a[16:17], v160 offset:448
  s_waitcnt lgkmcnt(12)
  v_mfma_f32_16x16x32_bf16 v[32:35], a[32:35], a[40:43], v[32:35]
  ds_read_b64_tr_b16 a[18:19], v160 offset:9152
  v_mfma_f32_16x16x32_bf16 v[92:95], a[32:35], a[44:47], v[92:95]
  ds_read_b64_tr_b16 a[20:21], v160 offset:17408
  v_mfma_f32_16x16x32_bf16 v[36:39], a[36:39], a[40:43], v[36:39]
  s_mul_i32 s87, s7, 5
  s_add_u32 s87, s87, s83
  s_add_u32 m0, s86, 3072
  s_add_u32 s88, s87, 0
  buffer_load_dwordx4 v241, s[32:35], s88 offen sc1 lds
  ds_read_b64_tr_b16 a[22:23], v160 offset:26112
  v_mfma_f32_16x16x32_bf16 v[96:99], a[36:39], a[44:47], v[96:99]
  ds_read_b64_tr_b16 a[24:25], v160 offset:17440
  s_waitcnt lgkmcnt(12)
  v_mfma_f32_16x16x32_bf16 v[40:43], a[40:43], a[0:3], v[40:43]
  ds_read_b64_tr_b16 a[26:27], v160 offset:26144
  v_mfma_f32_16x16x32_bf16 v[100:103], a[44:47], a[0:3], v[100:103]
  s_add_u32 m0, s86, 4096
  s_add_u32 s88, s87, 1024
  buffer_load_dwordx4 v241, s[32:35], s88 offen sc1 lds
  ds_read_b64_tr_b16 a[28:29], v160 offset:17472
  s_waitcnt lgkmcnt(9)
  v_mfma_f32_16x16x32_bf16 v[44:47], a[40:43], a[4:7], v[44:47]
  ds_read_b64_tr_b16 a[30:31], v160 offset:26176
  v_mfma_f32_16x16x32_bf16 v[104:107], a[44:47], a[4:7], v[104:107]
  ds_read_b64_tr_b16 a[32:33], v160 offset:17504
  v_mfma_f32_16x16x32_bf16 v[48:51], a[40:43], a[8:11], v[48:51]
  s_add_u32 m0, s86, 5120
  s_add_u32 s88, s87, 2048
  buffer_load_dwordx4 v241, s[32:35], s88 offen sc1 lds
  ds_read_b64_tr_b16 a[34:35], v160 offset:26208
  v_mfma_f32_16x16x32_bf16 v[108:111], a[44:47], a[8:11], v[108:111]
  v_mfma_f32_16x16x32_bf16 v[128:131], a[48:51], a[8:11], v[128:131]
  s_add_u32 m0, s86, 6144
  s_add_u32 s88, s87, 3072
  buffer_load_dwordx4 v241, s[32:35], s88 offen sc1 lds
  ds_read_b64_tr_b16 a[36:37], v160 offset:17536
  s_waitcnt lgkmcnt(9)
  v_mfma_f32_16x16x32_bf16 v[52:55], a[40:43], a[12:15], v[52:55]
  ds_read_b64_tr_b16 a[38:39], v160 offset:26240
  v_mfma_f32_16x16x32_bf16 v[112:115], a[44:47], a[12:15], v[112:115]
  ds_read_b64_tr_b16 a[0:1], v160 offset:17568
  v_mfma_f32_16x16x32_bf16 v[56:59], a[40:43], a[16:19], v[56:59]
  s_add_u32 m0, s86, 7168
  s_add_u32 s88, s87, 4096
  buffer_load_dwordx4 v241, s[32:35], s88 offen sc1 lds
  ds_read_b64_tr_b16 a[2:3], v160 offset:26272
  v_mfma_f32_16x16x32_bf16 v[116:119], a[44:47], a[16:19], v[116:119]
  v_mfma_f32_16x16x32_bf16 v[132:135], a[48:51], a[16:19], v[132:135]
  ds_read_b64_tr_b16 a[4:5], v160 offset:17600
  s_waitcnt lgkmcnt(9)
  v_mfma_f32_16x16x32_bf16 v[0:3], a[20:23], a[52:55], v[0:3]
  s_mul_i32 s87, s8, 5
  s_add_u32 s87, s87, s83
  s_add_u32 m0, s86, 8192
  s_add_u32 s88, s87, 0
  buffer_load_dwordx4 v241, s[32:35], s88 offen sc1 lds
  ds_read_b64_tr_b16 a[6:7], v160 offset:26304
  v_mfma_f32_16x16x32_bf16 v[60:63], a[20:23], a[56:59], v[60:63]
  ds_read_b64_tr_b16 a[8:9], v160 offset:17632
  v_mfma_f32_16x16x32_bf16 v[4:7], a[24:27], a[52:55], v[4:7]
  ds_read_b64_tr_b16 a[10:11], v160 offset:26336
  v_mfma_f32_16x16x32_bf16 v[64:67], a[24:27], a[56:59], v[64:67]
  s_add_u32 m0, s86, 9216
  s_add_u32 s88, s87, 1024
  buffer_load_dwordx4 v241, s[32:35], s88 offen sc1 lds
  ds_read_b64_tr_b16 a[12:13], v160 offset:17664
  s_waitcnt lgkmcnt(9)
  v_mfma_f32_16x16x32_bf16 v[8:11], a[28:31], a[52:55], v[8:11]
  ds_read_b64_tr_b16 a[14:15], v160 offset:26368
  v_mfma_f32_16x16x32_bf16 v[68:71], a[28:31], a[56:59], v[68:71]
  v_mfma_f32_16x16x32_bf16 v[120:123], a[28:31], a[60:63], v[120:123]
  s_add_u32 m0, s86, 10240
  s_add_u32 s88, s87, 2048
  buffer_load_dwordx4 v241, s[32:35], s88 offen sc1 lds
  ds_read_b64_tr_b16 a[16:17], v160 offset:17696
  v_mfma_f32_16x16x32_bf16 v[12:15], a[32:35], a[52:55], v[12:15]
  ds_read_b64_tr_b16 a[18:19], v160 offset:26400
  v_mfma_f32_16x16x32_bf16 v[72:75], a[32:35], a[56:59], v[72:75]
  ds_read_b64_tr_b16 a[20:21], v160 offset:17728
  s_waitcnt lgkmcnt(9)
  v_mfma_f32_16x16x32_bf16 v[16:19], a[36:39], a[52:55], v[16:19]
  s_add_u32 m0, s86, 11264
  s_add_u32 s88, s87, 3072
  buffer_load_dwordx4 v241, s[32:35], s88 offen sc1 lds
  ds_read_b64_tr_b16 a[22:23], v160 offset:26432
  v_mfma_f32_16x16x32_bf16 v[76:79], a[36:39], a[56:59], v[76:79]
  ds_read_b64_tr_b16 a[24:25], v160 offset:17760
  v_mfma_f32_16x16x32_bf16 v[20:23], a[0:3], a[52:55], v[20:23]
  ds_read_b64_tr_b16 a[26:27], v160 offset:26464
  v_mfma_f32_16x16x32_bf16 v[80:83], a[0:3], a[56:59], v[80:83]
  s_add_u32 m0, s86, 12288
  s_add_u32 s88, s87, 4096
  buffer_load_dwordx4 v241, s[32:35], s88 offen sc1 lds
  ds_read_b64_tr_b16 a[28:29], v160 offset:17792
  s_waitcnt lgkmcnt(9)
  v_mfma_f32_16x16x32_bf16 v[24:27], a[4:7], a[52:55], v[24:27]
  ds_read_b64_tr_b16 a[30:31], v160 offset:26496
  v_mfma_f32_16x16x32_bf16 v[84:87], a[4:7], a[56:59], v[84:87]
  ds_read_b64_tr_b16 a[32:33], v160 offset:17824
  v_mfma_f32_16x16x32_bf16 v[28:31], a[8:11], a[52:55], v[28:31]
  ds_read_b64_tr_b16 a[34:35], v160 offset:26528
  v_mfma_f32_16x16x32_bf16 v[88:91], a[8:11], a[56:59], v[88:91]
  v_mfma_f32_16x16x32_bf16 v[124:127], a[8:11], a[60:63], v[124:127]
  ds_read_b64_tr_b16 a[36:37], v160 offset:17856
  s_waitcnt lgkmcnt(9)
  v_mfma_f32_16x16x32_bf16 v[32:35], a[12:15], a[52:55], v[32:35]
  ds_read_b64_tr_b16 a[38:39], v160 offset:26560
  v_mfma_f32_16x16x32_bf16 v[92:95], a[12:15], a[56:59], v[92:95]
  v_mfma_f32_16x16x32_bf16 v[36:39], a[16:19], a[52:55], v[36:39]
  v_mfma_f32_16x16x32_bf16 v[96:99], a[16:19], a[56:59], v[96:99]
  s_waitcnt lgkmcnt(6)
  v_mfma_f32_16x16x32_bf16 v[40:43], a[52:55], a[20:23], v[40:43]
  v_mfma_f32_16x16x32_bf16 v[100:103], a[56:59], a[20:23], v[100:103]
  s_waitcnt lgkmcnt(0)
  s_barrier
  v_mfma_f32_16x16x32_bf16 v[44:47], a[52:55], a[24:27], v[44:47]
  v_mfma_f32_16x16x32_bf16 v[104:107], a[56:59], a[24:27], v[104:107]
  v_mfma_f32_16x16x32_bf16 v[48:51], a[52:55], a[28:31], v[48:51]
  v_mfma_f32_16x16x32_bf16 v[108:111], a[56:59], a[28:31], v[108:111]
  v_mfma_f32_16x16x32_bf16 v[128:131], a[60:63], a[28:31], v[128:131]
  v_mfma_f32_16x16x32_bf16 v[52:55], a[52:55], a[32:35], v[52:55]
  v_mfma_f32_16x16x32_bf16 v[112:115], a[56:59], a[32:35], v[112:115]
  v_mfma_f32_16x16x32_bf16 v[56:59], a[52:55], a[36:39], v[56:59]
  v_mfma_f32_16x16x32_bf16 v[116:119], a[56:59], a[36:39], v[116:119]
  v_mfma_f32_16x16x32_bf16 v[132:135], a[60:63], a[36:39], v[132:135]
  s_branch L_ep_attn
L_pp_attn_2:
  buffer_load_dwordx2 v[252:253], v249, s[76:79], 0 offen sc1
  s_branch L_np_attn_2
L_attn_3:
  v_lshlrev_b32 v241, 4, v255
  v_and_b32 v1, 15, v255
  v_lshrrev_b32 v2, 2, v1
  v_and_b32 v3, 3, v1
  v_lshrrev_b32 v4, 4, v255
  v_lshrrev_b32 v5, 1, v2
  v_lshl_add_u32 v5, v4, 1, v5
  v_mul_u32_u24 v5, 1088, v5
  v_and_b32_e64 v2, 1, v2
  v_mul_u32_u24 v2, 480, v2
  v_lshlrev_b32_e64 v3, 3, v3
  v_add3_u32 v5, v5, v2, v3
  v_add_u32 v160, 18432, v5
  v_and_b32 v1, 15, v255
  v_lshrrev_b32 v4, 4, v255
  v_lshrrev_b32 v2, 1, v1
  v_xor_b32 v2, v2, v4
  v_lshlrev_b32_e64 v2, 4, v2
  v_lshl_add_u32 v2, v1, 7, v2
  v_add_u32 v161, 0, v2
  v_xor_b32 v2, 64, v2
  v_add_u32 v162, 0, v2
  v_and_b32 v1, 15, v255
  v_lshrrev_b32 v2, 4, v255
  v_lshlrev_b32 v3, 2, v2
  v_sub_u32 v3, v1, v3
  v_and_b32 v4, 1, v1
  v_mov_b32 v5, 0xf149f2ca
  v_cmp_eq_u32 s[64:65], 0, v4
  v_subrev_u32_e64 v6, 0, v3
  v_cmp_le_i32 s[66:67], 0, v6
  s_mov_b64 s[68:69], s[64:65]
  s_and_b64 s[70:71], s[68:69], s[66:67]
  s_andn2_b64 s[72:73], s[68:69], s[66:67]
  v_cndmask_b32_e64 v7, v5, 0, s[72:73]
  v_accvgpr_write_b32 a244, v7
  v_cndmask_b32_e64 v8, v5, 0, s[70:71]
  v_accvgpr_write_b32 a248, v8
  v_subrev_u32 v6, 1, v3
  v_cmp_le_i32 s[66:67], 0, v6
  s_andn2_b64 s[68:69], exec, s[64:65]
  s_and_b64 s[70:71], s[68:69], s[66:67]
  s_andn2_b64 s[72:73], s[68:69], s[66:67]
  v_cndmask_b32_e64 v7, v5, 0, s[72:73]
  v_accvgpr_write_b32 a245, v7
  v_cndmask_b32_e64 v8, v5, 0, s[70:71]
  v_accvgpr_write_b32 a249, v8
  v_subrev_u32 v6, 2, v3
  v_cmp_le_i32 s[66:67], 0, v6
  s_mov_b64 s[68:69], s[64:65]
  s_and_b64 s[70:71], s[68:69], s[66:67]
  s_andn2_b64 s[72:73], s[68:69], s[66:67]
  v_cndmask_b32_e64 v7, v5, 0, s[72:73]
  v_accvgpr_write_b32 a246, v7
  v_cndmask_b32_e64 v8, v5, 0, s[70:71]
  v_accvgpr_write_b32 a250, v8
  v_subrev_u32 v6, 3, v3
  v_cmp_le_i32 s[66:67], 0, v6
  s_andn2_b64 s[68:69], exec, s[64:65]
  s_and_b64 s[70:71], s[68:69], s[66:67]
  s_andn2_b64 s[72:73], s[68:69], s[66:67]
  v_cndmask_b32_e64 v7, v5, 0, s[72:73]
  v_accvgpr_write_b32 a247, v7
  v_cndmask_b32_e64 v8, v5, 0, s[70:71]
  v_accvgpr_write_b32 a251, v8
  v_sub_u32 v6, v3, v4
  v_mov_b32 v9, 0x0c0c0100
  v_mov_b32 v10, 0x01000c0c
  v_cndmask_b32_e64 v9, v10, v9, s[64:65]
  v_mov_b32 v10, 0x0c0c0302
  v_mov_b32 v11, 0x03020c0c
  v_cndmask_b32_e64 v10, v11, v10, s[64:65]
  v_mov_b32 v11, 0x0c0c0c0c
  v_cmp_le_i32 s[66:67], 0, v6
  s_nop 1
  v_cndmask_b32_e64 v12, v9, v11, s[66:67]
  v_accvgpr_write_b32 a252, v12
  v_cndmask_b32_e64 v13, v11, v9, s[66:67]
  v_accvgpr_write_b32 a254, v13
  v_cmp_le_i32 s[66:67], 2, v6
  s_nop 1
  v_cndmask_b32_e64 v12, v10, v11, s[66:67]
  v_accvgpr_write_b32 a253, v12
  v_cndmask_b32_e64 v13, v11, v10, s[66:67]
  v_accvgpr_write_b32 a255, v13
  s_add_u32 s90, s92, 122880
  v_add_u32_e64 v166, s90, v163
  s_add_u32 s90, s92, 132096
  v_add_u32_e64 v167, s90, v164
  s_add_u32 s90, s92, 141312
  v_add_u32_e64 v168, s90, v163
  s_add_u32 s90, s92, 150528
  v_add_u32_e64 v169, s90, v164
  v_add_u32 v170, 138240, v165
  v_add_u32 v171, 144832, v165
  v_add_u32 v172, 166784, v165
  v_add_u32 v173, 173376, v165
  v_add_u32 v174, 199680, v165
  v_add_u32 v175, 206272, v165
  v_add_u32 v176, 228224, v165
  v_add_u32 v177, 234816, v165
  v_mov_b32 v232, 0
  v_mov_b32 v233, 0
  v_mov_b32 v234, 0
  v_mov_b32_e64 v235, 0
  s_nop 1
  v_mfma_f32_32x32x16_bf16 v[0:15], v[232:235], v[232:235], 0
  v_mfma_f32_32x32x16_bf16 v[16:31], v[232:235], v[232:235], 0
  v_mfma_f32_32x32x16_bf16 v[32:47], v[232:235], v[232:235], 0
  v_mfma_f32_32x32x16_bf16 v[48:63], v[232:235], v[232:235], 0
  v_mfma_f32_32x32x16_bf16 v[64:79], v[232:235], v[232:235], 0
  v_mfma_f32_32x32x16_bf16 v[80:95], v[232:235], v[232:235], 0
  v_mfma_f32_32x32x16_bf16 v[96:111], v[232:235], v[232:235], 0
  v_mfma_f32_32x32x16_bf16 v[112:127], v[232:235], v[232:235], 0
  v_mov_b32 v128, 0
  v_mov_b32 v129, 0
  v_mov_b32 v130, 0
  v_mov_b32 v131, 0
  v_mov_b32 v132, 0
  v_mov_b32 v133, 0
  v_mov_b32 v134, 0
  v_mov_b32 v135, 0
  v_mov_b32 v254, 0x3f803f80
  v_accvgpr_write_b32 a240, v254
  v_accvgpr_write_b32 a241, v254
  v_accvgpr_write_b32 a242, v254
  v_accvgpr_write_b32 a243, v254
  v_mov_b32 v249, 0
  s_lshl_b32 s39, s38, 7
  s_mul_i32 s40, s38, 245760
  s_mov_b32 s41, 53248
  s_add_u32 m0, s41, 14336
  s_nop 0
  buffer_load_dwordx4 v166, s[24:27], s39 offen offset:0 lds
  buffer_load_dwordx4 v167, s[24:27], s39 offen offset:1024 lds
  buffer_load_dwordx4 v168, s[24:27], s39 offen offset:2048 lds
  buffer_load_dwordx4 v169, s[24:27], s39 offen offset:3072 lds
  s_add_u32 m0, s41, 44544
  s_nop 0
  buffer_load_dwordx4 v170, s[28:31], s40 offen offset:0 lds
  buffer_load_dwordx4 v171, s[28:31], s40 offen offset:1088 lds
  buffer_load_dwordx4 v172, s[28:31], s40 offen offset:2176 lds
  buffer_load_dwordx4 v173, s[28:31], s40 offen offset:3264 lds
  s_add_u32 m0, s41, 48896
  s_nop 0
  buffer_load_dwordx4 v174, s[28:31], s40 offen offset:0 lds
  buffer_load_dwordx4 v175, s[28:31], s40 offen offset:1088 lds
  buffer_load_dwordx4 v176, s[28:31], s40 offen offset:2176 lds
  buffer_load_dwordx4 v177, s[28:31], s40 offen offset:3264 lds
  s_add_u32 s38, s38, 1
  s_cmp_eq_u32 s38, 10
  s_cselect_b32 s38, 0, s38
  s_and_b32 s46, s2, 7
  s_lshr_b32 s47, s2, 3
  s_lshr_b32 s80, s47, 3
  s_lshl_b32 s46, s46, 2
  s_add_u32 s80, s80, s46
  s_and_b32 s81, s47, 7
  s_lshr_b32 s89, s80, 1
  s_lshl_b32 s89, s89, 2
  s_mul_i32 s83, s81, 378880
  s_add_u32 s83, s83, 10485760
  s_mul_i32 s84, s80, 303104
  s_mul_i32 s85, s22, 12288
  s_add_u32 s85, s85, 53248
  s_mul_i32 s86, s22, 13312
  s_add_u32 s86, s86, 106496
  s_mul_i32 s46, s81, 7
  s_lshr_b32 s46, s46, 2
  s_and_b32 s47, s80, 3
  s_mul_i32 s47, s47, 7
  s_lshr_b32 s47, s47, 1
  s_add_u32 s46, s46, s47
  s_sub_u32 s47, s46, 14
  s_cmp_ge_u32 s46, 14
  s_cselect_b32 s46, s47, s46
  s_lshl_b32 s46, s46, 2
  s_add_u32 s46, s46, s22
  s_add_u32 s46, s46, 20
  s_lshl_b32 s4, s46, 10
  s_cmp_ge_u32 s46, 74
  s_cselect_b32 s4, 0x10000000, s4
  s_add_u32 s46, s46, 4
  s_sub_u32 s47, s46, 56
  s_cmp_ge_u32 s46, 76
  s_cselect_b32 s46, s47, s46
  s_lshl_b32 s5, s46, 10
  s_cmp_ge_u32 s46, 74
  s_cselect_b32 s5, 0x10000000, s5
  s_add_u32 s46, s46, 4
  s_sub_u32 s47, s46, 56
  s_cmp_ge_u32 s46, 76
  s_cselect_b32 s46, s47, s46
  s_lshl_b32 s6, s46, 10
  s_cmp_ge_u32 s46, 74
  s_cselect_b32 s6, 0x10000000, s6
  s_add_u32 s46, s46, 4
  s_sub_u32 s47, s46, 56
  s_cmp_ge_u32 s46, 76
  s_cselect_b32 s46, s47, s46
  s_lshl_b32 s7, s46, 10
  s_cmp_ge_u32 s46, 74
  s_cselect_b32 s7, 0x10000000, s7
  s_add_u32 s46, s46, 4
  s_sub_u32 s47, s46, 56
  s_cmp_ge_u32 s46, 76
  s_cselect_b32 s46, s47, s46
  s_lshl_b32 s8, s46, 10
  s_cmp_ge_u32 s46, 74
  s_cselect_b32 s8, 0x10000000, s8
  s_add_u32 s46, s46, 4
  s_sub_u32 s47, s46, 56
  s_cmp_ge_u32 s46, 76
  s_cselect_b32 s46, s47, s46
  s_lshl_b32 s9, s46, 10
  s_cmp_ge_u32 s46, 74
  s_cselect_b32 s9, 0x10000000, s9
  s_add_u32 s46, s46, 4
  s_sub_u32 s47, s46, 56
  s_cmp_ge_u32 s46, 76
  s_cselect_b32 s46, s47, s46
  s_lshl_b32 s10, s46, 10
  s_cmp_ge_u32 s46, 74
  s_cselect_b32 s10, 0x10000000, s10
  s_add_u32 s46, s46, 4
  s_sub_u32 s47, s46, 56
  s_cmp_ge_u32 s46, 76
  s_cselect_b32 s46, s47, s46
  s_lshl_b32 s11, s46, 10
  s_cmp_ge_u32 s46, 74
  s_cselect_b32 s11, 0x10000000, s11
  s_add_u32 s46, s46, 4
  s_sub_u32 s47, s46, 56
  s_cmp_ge_u32 s46, 76
  s_cselect_b32 s46, s47, s46
  s_lshl_b32 s12, s46, 10
  s_cmp_ge_u32 s46, 74
  s_cselect_b32 s12, 0x10000000, s12
  s_add_u32 s46, s46, 4
  s_sub_u32 s47, s46, 56
  s_cmp_ge_u32 s46, 76
  s_cselect_b32 s46, s47, s46
  s_lshl_b32 s13, s46, 10
  s_cmp_ge_u32 s46, 74
  s_cselect_b32 s13, 0x10000000, s13
  s_add_u32 s46, s46, 4
  s_sub_u32 s47, s46, 56
  s_cmp_ge_u32 s46, 76
  s_cselect_b32 s46, s47, s46
  s_lshl_b32 s14, s46, 10
  s_cmp_ge_u32 s46, 74
  s_cselect_b32 s14, 0x10000000, s14
  s_add_u32 s46, s46, 4
  s_sub_u32 s47, s46, 56
  s_cmp_ge_u32 s46, 76
  s_cselect_b32 s46, s47, s46
  s_lshl_b32 s15, s46, 10
  s_cmp_ge_u32 s46, 74
  s_cselect_b32 s15, 0x10000000, s15
  s_add_u32 s46, s46, 4
  s_sub_u32 s47, s46, 56
  s_cmp_ge_u32 s46, 76
  s_cselect_b32 s46, s47, s46
  s_lshl_b32 s18, s46, 10
  s_cmp_ge_u32 s46, 74
  s_cselect_b32 s18, 0x10000000, s18
  s_add_u32 s46, s46, 4
  s_sub_u32 s47, s46, 56
  s_cmp_ge_u32 s46, 76
  s_cselect_b32 s46, s47, s46
  s_lshl_b32 s19, s46, 10
  s_cmp_ge_u32 s46, 74
  s_cselect_b32 s19, 0x10000000, s19
  v_add_u32 v245, 4096, v241
  s_lshl_b32 s45, s2, 7
  s_add_u32 s45, s45, 15728640
  s_lshl_b32 s39, s38, 7
  s_mul_i32 s40, s38, 245760
  s_mov_b32 s41, 106496
  s_mov_b32 s94, 53248
  s_mov_b32 s95, 4294860800
  s_mov_b32 s43, 0
  s_waitcnt vmcnt(12) lgkmcnt(0)
  s_barrier
  ds_read_b128 a[40:43], v161 offset:14336
  ds_read_b128 a[44:47], v161 offset:16384
  ds_read_b128 a[48:51], v161 offset:0
  ds_read_b64_tr_b16 a[0:1], v160 offset:0
  ds_read_b64_tr_b16 a[2:3], v160 offset:8704
  ds_read_b64_tr_b16 a[4:5], v160 offset:32
  ds_read_b64_tr_b16 a[6:7], v160 offset:8736
  ds_read_b64_tr_b16 a[8:9], v160 offset:64
  ds_read_b64_tr_b16 a[10:11], v160 offset:8768
  ds_read_b64_tr_b16 a[12:13], v160 offset:96
  ds_read_b64_tr_b16 a[14:15], v160 offset:8800
  ds_read_b64_tr_b16 a[16:17], v160 offset:128
  ds_read_b64_tr_b16 a[18:19], v160 offset:8832
  ds_read_b64_tr_b16 a[20:21], v160 offset:160
  ds_read_b64_tr_b16 a[22:23], v160 offset:8864
L_loop_attn_3:
  ds_read_b64_tr_b16 a[24:25], v160 offset:192
  s_waitcnt lgkmcnt(9)
  v_mfma_f32_16x16x32_bf16 v[0:3], a[0:3], a[40:43], v[0:3]
  ds_read_b64_tr_b16 a[26:27], v160 offset:8896
  v_mfma_f32_16x16x32_bf16 v[60:63], a[0:3], a[44:47], v[60:63]
  ds_read_b64_tr_b16 a[28:29], v160 offset:224
  v_mfma_f32_16x16x32_bf16 v[4:7], a[4:7], a[40:43], v[4:7]
  ds_read_b64_tr_b16 a[30:31], v160 offset:8928
  v_mfma_f32_16x16x32_bf16 v[64:67], a[4:7], a[44:47], v[64:67]
  ds_read_b64_tr_b16 a[32:33], v160 offset:256
  s_waitcnt lgkmcnt(9)
  v_mfma_f32_16x16x32_bf16 v[8:11], a[8:11], a[40:43], v[8:11]
  s_cmp_lg_u32 s43, 7
  s_cbranch_scc0 L_pp_attn_3
L_np_attn_3:
  ds_read_b64_tr_b16 a[34:35], v160 offset:8960
  v_mfma_f32_16x16x32_bf16 v[68:71], a[8:11], a[44:47], v[68:71]
  ds_read_b64_tr_b16 a[36:37], v160 offset:288
  v_mfma_f32_16x16x32_bf16 v[12:15], a[12:15], a[40:43], v[12:15]
  ds_read_b64_tr_b16 a[38:39], v160 offset:8992
  v_mfma_f32_16x16x32_bf16 v[72:75], a[12:15], a[44:47], v[72:75]
  s_add_u32 m0, s41, 14336
  v_mfma_f32_16x16x32_bf16 v[120:123], a[12:15], a[48:51], v[120:123]
  ds_read_b64_tr_b16 a[0:1], v160 offset:320
  ds_read_b64_tr_b16 a[2:3], v160 offset:9024
  ds_read_b128 a[52:55], v162 offset:14336
  s_waitcnt lgkmcnt(11)
  v_mfma_f32_16x16x32_bf16 v[16:19], a[16:19], a[40:43], v[16:19]
  ds_read_b128 a[56:59], v162 offset:16384
  ds_read_b128 a[60:63], v162 offset:0
  v_mfma_f32_16x16x32_bf16 v[76:79], a[16:19], a[44:47], v[76:79]
  buffer_load_dwordx4 v166, s[24:27], s39 offen offset:0 lds
  ds_read_b64_tr_b16 a[4:5], v160 offset:352
  v_mfma_f32_16x16x32_bf16 v[20:23], a[20:23], a[40:43], v[20:23]
  ds_read_b64_tr_b16 a[6:7], v160 offset:9056
  v_mfma_f32_16x16x32_bf16 v[80:83], a[20:23], a[44:47], v[80:83]
  ds_read_b64_tr_b16 a[8:9], v160 offset:384
  s_waitcnt lgkmcnt(12)
  v_mfma_f32_16x16x32_bf16 v[24:27], a[24:27], a[40:43], v[24:27]
  buffer_load_dwordx4 v167, s[24:27], s39 offen offset:1024 lds
  ds_read_b64_tr_b16 a[10:11], v160 offset:9088
  v_mfma_f32_16x16x32_bf16 v[84:87], a[24:27], a[44:47], v[84:87]
  ds_read_b64_tr_b16 a[12:13], v160 offset:416
  v_mfma_f32_16x16x32_bf16 v[28:31], a[28:31], a[40:43], v[28:31]
  ds_read_b64_tr_b16 a[14:15], v160 offset:9120
  v_mfma_f32_16x16x32_bf16 v[88:91], a[28:31], a[44:47], v[88:91]
  buffer_load_dwordx4 v168, s[24:27], s39 offen offset:2048 lds
  ds_read_b64_tr_b16 a[16:17], v160 offset:448
  s_waitcnt lgkmcnt(12)
  v_mfma_f32_16x16x32_bf16 v[32:35], a[32:35], a[40:43], v[32:35]
  ds_read_b64_tr_b16 a[18:19], v160 offset:9152
  v_mfma_f32_16x16x32_bf16 v[92:95], a[32:35], a[44:47], v[92:95]
  v_mfma_f32_16x16x32_bf16 v[124:127], a[32:35], a[48:51], v[124:127]
  buffer_load_dwordx4 v169, s[24:27], s39 offen offset:3072 lds
  s_add_u32 m0, s41, 44544
  ds_read_b64_tr_b16 a[20:21], v160 offset:17408
  v_mfma_f32_16x16x32_bf16 v[36:39], a[36:39], a[40:43], v[36:39]
  ds_read_b64_tr_b16 a[22:23], v160 offset:26112
  v_mfma_f32_16x16x32_bf16 v[96:99], a[36:39], a[44:47], v[96:99]
  ds_read_b64_tr_b16 a[24:25], v160 offset:17440
  s_waitcnt lgkmcnt(12)
  v_mfma_f32_16x16x32_bf16 v[40:43], a[40:43], a[0:3], v[40:43]
  buffer_load_dwordx4 v170, s[28:31], s40 offen offset:0 lds
  ds_read_b64_tr_b16 a[26:27], v160 offset:26144
  v_mfma_f32_16x16x32_bf16 v[100:103], a[44:47], a[0:3], v[100:103]
  ds_read_b64_tr_b16 a[28:29], v160 offset:17472
  s_waitcnt lgkmcnt(9)
  v_mfma_f32_16x16x32_bf16 v[44:47], a[40:43], a[4:7], v[44:47]
  ds_read_b64_tr_b16 a[30:31], v160 offset:26176
  v_mfma_f32_16x16x32_bf16 v[104:107], a[44:47], a[4:7], v[104:107]
  ds_read_b64_tr_b16 a[32:33], v160 offset:17504
  v_mfma_f32_16x16x32_bf16 v[48:51], a[40:43], a[8:11], v[48:51]
  buffer_load_dwordx4 v171, s[28:31], s40 offen offset:1088 lds
  ds_read_b64_tr_b16 a[34:35], v160 offset:26208
  v_mfma_f32_16x16x32_bf16 v[108:111], a[44:47], a[8:11], v[108:111]
  ds_read_b64_tr_b16 a[36:37], v160 offset:17536
  s_waitcnt lgkmcnt(9)
  v_mfma_f32_16x16x32_bf16 v[52:55], a[40:43], a[12:15], v[52:55]
  ds_read_b64_tr_b16 a[38:39], v160 offset:26240
  v_mfma_f32_16x16x32_bf16 v[112:115], a[44:47], a[12:15], v[112:115]
  buffer_load_dwordx4 v172, s[28:31], s40 offen offset:2176 lds
  v_mfma_f32_16x16x32_bf16 v[128:131], a[48:51], a[12:15], v[128:131]
  ds_read_b64_tr_b16 a[0:1], v160 offset:17568
  v_mfma_f32_16x16x32_bf16 v[56:59], a[40:43], a[16:19], v[56:59]
  ds_read_b64_tr_b16 a[2:3], v160 offset:26272
  v_mfma_f32_16x16x32_bf16 v[116:119], a[44:47], a[16:19], v[116:119]
  buffer_load_dwordx4 v173, s[28:31], s40 offen offset:3264 lds
  s_add_u32 m0, s41, 48896
  ds_read_b64_tr_b16 a[4:5], v160 offset:17600
  s_waitcnt lgkmcnt(9)
  v_mfma_f32_16x16x32_bf16 v[0:3], a[20:23], a[52:55], v[0:3]
  ds_read_b64_tr_b16 a[6:7], v160 offset:26304
  v_mfma_f32_16x16x32_bf16 v[60:63], a[20:23], a[56:59], v[60:63]
  ds_read_b64_tr_b16 a[8:9], v160 offset:17632
  v_mfma_f32_16x16x32_bf16 v[4:7], a[24:27], a[52:55], v[4:7]
  buffer_load_dwordx4 v174, s[28:31], s40 offen offset:0 lds
  ds_read_b64_tr_b16 a[10:11], v160 offset:26336
  v_mfma_f32_16x16x32_bf16 v[64:67], a[24:27], a[56:59], v[64:67]
  ds_read_b64_tr_b16 a[12:13], v160 offset:17664
  s_waitcnt lgkmcnt(9)
  v_mfma_f32_16x16x32_bf16 v[8:11], a[28:31], a[52:55], v[8:11]
  ds_read_b64_tr_b16 a[14:15], v160 offset:26368
  v_mfma_f32_16x16x32_bf16 v[68:71], a[28:31], a[56:59], v[68:71]
  buffer_load_dwordx4 v175, s[28:31], s40 offen offset:1088 lds
  ds_read_b64_tr_b16 a[16:17], v160 offset:17696
  v_mfma_f32_16x16x32_bf16 v[12:15], a[32:35], a[52:55], v[12:15]
  ds_read_b64_tr_b16 a[18:19], v160 offset:26400
  v_mfma_f32_16x16x32_bf16 v[72:75], a[32:35], a[56:59], v[72:75]
  v_mfma_f32_16x16x32_bf16 v[120:123], a[32:35], a[60:63], v[120:123]
  buffer_load_dwordx4 v176, s[28:31], s40 offen offset:2176 lds
  ds_read_b64_tr_b16 a[20:21], v160 offset:17728
  s_waitcnt lgkmcnt(9)
  v_mfma_f32_16x16x32_bf16 v[16:19], a[36:39], a[52:55], v[16:19]
  ds_read_b64_tr_b16 a[22:23], v160 offset:26432
  v_mfma_f32_16x16x32_bf16 v[76:79], a[36:39], a[56:59], v[76:79]
  ds_read_b64_tr_b16 a[24:25], v160 offset:17760
  v_mfma_f32_16x16x32_bf16 v[20:23], a[0:3], a[52:55], v[20:23]
  buffer_load_dwordx4 v177, s[28:31], s40 offen offset:3264 lds
  ds_read_b64_tr_b16 a[26:27], v160 offset:26464
  v_mfma_f32_16x16x32_bf16 v[80:83], a[0:3], a[56:59], v[80:83]
  ds_read_b64_tr_b16 a[28:29], v160 offset:17792
  s_waitcnt lgkmcnt(9)
  v_mfma_f32_16x16x32_bf16 v[24:27], a[4:7], a[52:55], v[24:27]
  ds_read_b64_tr_b16 a[30:31], v160 offset:26496
  v_mfma_f32_16x16x32_bf16 v[84:87], a[4:7], a[56:59], v[84:87]
  ds_read_b64_tr_b16 a[32:33], v160 offset:17824
  v_mfma_f32_16x16x32_bf16 v[28:31], a[8:11], a[52:55], v[28:31]
  ds_read_b64_tr_b16 a[34:35], v160 offset:26528
  v_mfma_f32_16x16x32_bf16 v[88:91], a[8:11], a[56:59], v[88:91]
  ds_read_b64_tr_b16 a[36:37], v160 offset:17856
  s_waitcnt lgkmcnt(9)
  v_mfma_f32_16x16x32_bf16 v[32:35], a[12:15], a[52:55], v[32:35]
  ds_read_b64_tr_b16 a[38:39], v160 offset:26560
  v_mfma_f32_16x16x32_bf16 v[92:95], a[12:15], a[56:59], v[92:95]
  v_mfma_f32_16x16x32_bf16 v[124:127], a[12:15], a[60:63], v[124:127]
  v_mfma_f32_16x16x32_bf16 v[36:39], a[16:19], a[52:55], v[36:39]
  v_mfma_f32_16x16x32_bf16 v[96:99], a[16:19], a[56:59], v[96:99]
  s_waitcnt lgkmcnt(6)
  v_mfma_f32_16x16x32_bf16 v[40:43], a[52:55], a[20:23], v[40:43]
  v_mfma_f32_16x16x32_bf16 v[100:103], a[56:59], a[20:23], v[100:103]
  s_waitcnt vmcnt(12) lgkmcnt(0)
  s_barrier
  v_mfma_f32_16x16x32_bf16 v[44:47], a[52:55], a[24:27], v[44:47]
  s_cmp_eq_u32 s41, 53248
  s_cselect_b32 s42, s95, s94
  v_add_u32 v160, s42, v160
  v_add_u32_e64 v161, s42, v161
  v_mfma_f32_16x16x32_bf16 v[104:107], a[56:59], a[24:27], v[104:107]
  v_add_u32_e64 v162, s42, v162
  ds_read_b128 a[40:43], v161 offset:14336
  ds_read_b128 a[44:47], v161 offset:16384
  ds_read_b128 a[48:51], v161 offset:0
  v_mfma_f32_16x16x32_bf16 v[48:51], a[52:55], a[28:31], v[48:51]
  ds_read_b64_tr_b16 a[0:1], v160 offset:0
  ds_read_b64_tr_b16 a[2:3], v160 offset:8704
  ds_read_b64_tr_b16 a[4:5], v160 offset:32
  ds_read_b64_tr_b16 a[6:7], v160 offset:8736
  v_mfma_f32_16x16x32_bf16 v[108:111], a[56:59], a[28:31], v[108:111]
  ds_read_b64_tr_b16 a[8:9], v160 offset:64
  ds_read_b64_tr_b16 a[10:11], v160 offset:8768
  ds_read_b64_tr_b16 a[12:13], v160 offset:96
  ds_read_b64_tr_b16 a[14:15], v160 offset:8800
  v_mfma_f32_16x16x32_bf16 v[52:55], a[52:55], a[32:35], v[52:55]
  ds_read_b64_tr_b16 a[16:17], v160 offset:128
  ds_read_b64_tr_b16 a[18:19], v160 offset:8832
  ds_read_b64_tr_b16 a[20:21], v160 offset:160
  ds_read_b64_tr_b16 a[22:23], v160 offset:8864
  v_mfma_f32_16x16x32_bf16 v[112:115], a[56:59], a[32:35], v[112:115]
  s_add_u32 s38, s38, 1
  s_cmp_eq_u32 s38, 10
  s_cselect_b32 s38, 0, s38
  s_lshl_b32 s39, s38, 7
  v_mfma_f32_16x16x32_bf16 v[128:131], a[60:63], a[32:35], v[128:131]
  s_mul_i32 s40, s38, 245760
  s_cmp_eq_u32 s41, 106496
  s_cselect_b32 s42, s95, s94
  s_add_u32 s41, s41, s42
  v_mfma_f32_16x16x32_bf16 v[56:59], a[52:55], a[36:39], v[56:59]
  s_add_u32 s43, s43, 1
  s_cmp_lt_u32 s43, 8
  v_mfma_f32_16x16x32_bf16 v[116:119], a[56:59], a[36:39], v[116:119]
  s_cbranch_scc1 L_loop_attn_3
  v_readfirstlane_b32 s23, v252
  s_nop 3
  s_cmp_lg_u32 s23, 0
  s_cbranch_scc1 L_nok_attn_3
  s_mov_b32 s47, 0
  v_mov_b32_e64 v251, 0
L_nspin_attn_3:
  buffer_load_dword v250, v251, s[76:79], 0 offen sc1
  s_waitcnt vmcnt(0)
  v_readfirstlane_b32 s23, v250
  s_nop 3
  s_cmp_lg_u32 s23, 0
  s_cbranch_scc1 L_nok_attn_3
  s_sleep 8
  s_add_u32 s47, s47, 1
  s_cmp_lt_u32 s47, 200000
  s_cbranch_scc1 L_nspin_attn_3
L_nok_attn_3:
  v_readfirstlane_b32 s46, v253
  s_nop 3
  s_cmp_ge_u32 s46, 128
  s_cbranch_scc1 L_cok_p_attn_3
  s_mov_b32 s47, 0
  v_mov_b32_e64 v251, 0
L_cspin_p_attn_3:
  buffer_load_dword v250, v251, s[76:79], 0 offen offset:4 sc1
  s_waitcnt vmcnt(0)
  v_readfirstlane_b32 s46, v250
  s_nop 3
  s_cmp_ge_u32 s46, 128
  s_cbranch_scc1 L_cok_p_attn_3
  s_sleep 40
  s_add_u32 s47, s47, 1
  s_cmp_lt_u32 s47, 200000
  s_cbranch_scc1 L_cspin_p_attn_3
L_cok_p_attn_3:
  ds_read_b64_tr_b16 a[24:25], v160 offset:192
  s_waitcnt lgkmcnt(9)
  v_mfma_f32_16x16x32_bf16 v[0:3], a[0:3], a[40:43], v[0:3]
  ds_read_b64_tr_b16 a[26:27], v160 offset:8896
  v_mfma_f32_16x16x32_bf16 v[60:63], a[0:3], a[44:47], v[60:63]
  ds_read_b64_tr_b16 a[28:29], v160 offset:224
  v_mfma_f32_16x16x32_bf16 v[4:7], a[4:7], a[40:43], v[4:7]
  ds_read_b64_tr_b16 a[30:31], v160 offset:8928
  v_mfma_f32_16x16x32_bf16 v[64:67], a[4:7], a[44:47], v[64:67]
  ds_read_b64_tr_b16 a[32:33], v160 offset:256
  s_waitcnt lgkmcnt(9)
  v_mfma_f32_16x16x32_bf16 v[8:11], a[8:11], a[40:43], v[8:11]
  s_mul_i32 s87, s4, 5
  s_add_u32 s87, s87, s83
  s_add_u32 m0, s85, 0
  s_add_u32 s88, s87, 0
  buffer_load_dwordx4 v241, s[32:35], s88 offen sc1 lds
  ds_read_b64_tr_b16 a[34:35], v160 offset:8960
  v_mfma_f32_16x16x32_bf16 v[68:71], a[8:11], a[44:47], v[68:71]
  ds_read_b64_tr_b16 a[36:37], v160 offset:288
  v_mfma_f32_16x16x32_bf16 v[12:15], a[12:15], a[40:43], v[12:15]
  ds_read_b64_tr_b16 a[38:39], v160 offset:8992
  v_mfma_f32_16x16x32_bf16 v[72:75], a[12:15], a[44:47], v[72:75]
  s_add_u32 m0, s85, 1024
  s_add_u32 s88, s87, 1024
  buffer_load_dwordx4 v241, s[32:35], s88 offen sc1 lds
  v_mfma_f32_16x16x32_bf16 v[120:123], a[12:15], a[48:51], v[120:123]
  ds_read_b64_tr_b16 a[0:1], v160 offset:320
  ds_read_b64_tr_b16 a[2:3], v160 offset:9024
  ds_read_b128 a[52:55], v162 offset:14336
  s_waitcnt lgkmcnt(11)
  v_mfma_f32_16x16x32_bf16 v[16:19], a[16:19], a[40:43], v[16:19]
  ds_read_b128 a[56:59], v162 offset:16384
  ds_read_b128 a[60:63], v162 offset:0
  v_mfma_f32_16x16x32_bf16 v[76:79], a[16:19], a[44:47], v[76:79]
  ds_read_b64_tr_b16 a[4:5], v160 offset:352
  v_mfma_f32_16x16x32_bf16 v[20:23], a[20:23], a[40:43], v[20:23]
  s_add_u32 m0, s85, 2048
  s_add_u32 s88, s87, 2048
  buffer_load_dwordx4 v241, s[32:35], s88 offen sc1 lds
  ds_read_b64_tr_b16 a[6:7], v160 offset:9056
  v_mfma_f32_16x16x32_bf16 v[80:83], a[20:23], a[44:47], v[80:83]
  ds_read_b64_tr_b16 a[8:9], v160 offset:384
  s_waitcnt lgkmcnt(12)
  v_mfma_f32_16x16x32_bf16 v[24:27], a[24:27], a[40:43], v[24:27]
  ds_read_b64_tr_b16 a[10:11], v160 offset:9088
  v_mfma_f32_16x16x32_bf16 v[84:87], a[24:27], a[44:47], v[84:87]
  ds_read_b64_tr_b16 a[12:13], v160 offset:416
  v_mfma_f32_16x16x32_bf16 v[28:31], a[28:31], a[40:43], v[28:31]
  s_add_u32 m0, s85, 3072
  s_add_u32 s88, s87, 3072
  buffer_load_dwordx4 v241, s[32:35], s88 offen sc1 lds
  ds_read_b64_tr_b16 a[14:15], v160 offset:9120
  v_mfma_f32_16x16x32_bf16 v[88:91], a[28:31], a[44:47], v[88:91]
  ds_read_b64_tr_b16 a[16:17], v160 offset:448
  s_waitcnt lgkmcnt(12)
  v_mfma_f32_16x16x32_bf16 v[32:35], a[32:35], a[40:43], v[32:35]
  ds_read_b64_tr_b16 a[18:19], v160 offset:9152
  v_mfma_f32_16x16x32_bf16 v[92:95], a[32:35], a[44:47], v[92:95]
  s_add_u32 m0, s85, 4096
  s_add_u32 s88, s87, 4096
  buffer_load_dwordx4 v241, s[32:35], s88 offen sc1 lds
  v_mfma_f32_16x16x32_bf16 v[124:127], a[32:35], a[48:51], v[124:127]
  ds_read_b64_tr_b16 a[20:21], v160 offset:17408
  v_mfma_f32_16x16x32_bf16 v[36:39], a[36:39], a[40:43], v[36:39]
  ds_read_b64_tr_b16 a[22:23], v160 offset:26112
  v_mfma_f32_16x16x32_bf16 v[96:99], a[36:39], a[44:47], v[96:99]
  ds_read_b64_tr_b16 a[24:25], v160 offset:17440
  s_waitcnt lgkmcnt(12)
  v_mfma_f32_16x16x32_bf16 v[40:43], a[40:43], a[0:3], v[40:43]
  s_mul_i32 s87, s5, 5
  s_add_u32 s87, s87, s83
  s_add_u32 m0, s85, 5120
  s_add_u32 s88, s87, 0
  buffer_load_dwordx4 v241, s[32:35], s88 offen sc1 lds
  ds_read_b64_tr_b16 a[26:27], v160 offset:26144
  v_mfma_f32_16x16x32_bf16 v[100:103], a[44:47], a[0:3], v[100:103]
  ds_read_b64_tr_b16 a[28:29], v160 offset:17472
  s_waitcnt lgkmcnt(9)
  v_mfma_f32_16x16x32_bf16 v[44:47], a[40:43], a[4:7], v[44:47]
  ds_read_b64_tr_b16 a[30:31], v160 offset:26176
  v_mfma_f32_16x16x32_bf16 v[104:107], a[44:47], a[4:7], v[104:107]
  ds_read_b64_tr_b16 a[32:33], v160 offset:17504
  v_mfma_f32_16x16x32_bf16 v[48:51], a[40:43], a[8:11], v[48:51]
  s_add_u32 m0, s85, 6144
  s_add_u32 s88, s87, 1024
  buffer_load_dwordx4 v241, s[32:35], s88 offen sc1 lds
  ds_read_b64_tr_b16 a[34:35], v160 offset:26208
  v_mfma_f32_16x16x32_bf16 v[108:111], a[44:47], a[8:11], v[108:111]
  ds_read_b64_tr_b16 a[36:37], v160 offset:17536
  s_waitcnt lgkmcnt(9)
  v_mfma_f32_16x16x32_bf16 v[52:55], a[40:43], a[12:15], v[52:55]
  ds_read_b64_tr_b16 a[38:39], v160 offset:26240
  v_mfma_f32_16x16x32_bf16 v[112:115], a[44:47], a[12:15], v[112:115]
  s_add_u32 m0, s85, 7168
  s_add_u32 s88, s87, 2048
  buffer_load_dwordx4 v241, s[32:35], s88 offen sc1 lds
  v_mfma_f32_16x16x32_bf16 v[128:131], a[48:51], a[12:15], v[128:131]
  ds_read_b64_tr_b16 a[0:1], v160 offset:17568
  v_mfma_f32_16x16x32_bf16 v[56:59], a[40:43], a[16:19], v[56:59]
  ds_read_b64_tr_b16 a[2:3], v160 offset:26272
  v_mfma_f32_16x16x32_bf16 v[116:119], a[44:47], a[16:19], v[116:119]
  ds_read_b64_tr_b16 a[4:5], v160 offset:17600
  s_waitcnt lgkmcnt(9)
  v_mfma_f32_16x16x32_bf16 v[0:3], a[20:23], a[52:55], v[0:3]
  s_add_u32 m0, s85, 8192
  s_add_u32 s88, s87, 3072
  buffer_load_dwordx4 v241, s[32:35], s88 offen sc1 lds
  ds_read_b64_tr_b16 a[6:7], v160 offset:26304
  v_mfma_f32_16x16x32_bf16 v[60:63], a[20:23], a[56:59], v[60:63]
  ds_read_b64_tr_b16 a[8:9], v160 offset:17632
  v_mfma_f32_16x16x32_bf16 v[4:7], a[24:27], a[52:55], v[4:7]
  ds_read_b64_tr_b16 a[10:11], v160 offset:26336
  v_mfma_f32_16x16x32_bf16 v[64:67], a[24:27], a[56:59], v[64:67]
  ds_read_b64_tr_b16 a[12:13], v160 offset:17664
  s_waitcnt lgkmcnt(9)
  v_mfma_f32_16x16x32_bf16 v[8:11], a[28:31], a[52:55], v[8:11]
  s_add_u32 m0, s85, 9216
  s_add_u32 s88, s87, 4096
  buffer_load_dwordx4 v241, s[32:35], s88 offen sc1 lds
  ds_read_b64_tr_b16 a[14:15], v160 offset:26368
  v_mfma_f32_16x16x32_bf16 v[68:71], a[28:31], a[56:59], v[68:71]
  ds_read_b64_tr_b16 a[16:17], v160 offset:17696
  v_mfma_f32_16x16x32_bf16 v[12:15], a[32:35], a[52:55], v[12:15]
  ds_read_b64_tr_b16 a[18:19], v160 offset:26400
  v_mfma_f32_16x16x32_bf16 v[72:75], a[32:35], a[56:59], v[72:75]
  s_mul_i32 s87, s6, 5
  s_add_u32 s87, s87, s83
  s_add_u32 m0, s85, 10240
  s_add_u32 s88, s87, 0
  buffer_load_dwordx4 v241, s[32:35], s88 offen sc1 lds
  v_mfma_f32_16x16x32_bf16 v[120:123], a[32:35], a[60:63], v[120:123]
  ds_read_b64_tr_b16 a[20:21], v160 offset:17728
  s_waitcnt lgkmcnt(9)
  v_mfma_f32_16x16x32_bf16 v[16:19], a[36:39], a[52:55], v[16:19]
  ds_read_b64_tr_b16 a[22:23], v160 offset:26432
  v_mfma_f32_16x16x32_bf16 v[76:79], a[36:39], a[56:59], v[76:79]
  ds_read_b64_tr_b16 a[24:25], v160 offset:17760
  v_mfma_f32_16x16x32_bf16 v[20:23], a[0:3], a[52:55], v[20:23]
  s_add_u32 m0, s85, 11264
  s_add_u32 s88, s87, 1024
  buffer_load_dwordx4 v241, s[32:35], s88 offen sc1 lds
  ds_read_b64_tr_b16 a[26:27], v160 offset:26464
  v_mfma_f32_16x16x32_bf16 v[80:83], a[0:3], a[56:59], v[80:83]
  ds_read_b64_tr_b16 a[28:29], v160 offset:17792
  s_waitcnt lgkmcnt(9)
  v_mfma_f32_16x16x32_bf16 v[24:27], a[4:7], a[52:55], v[24:27]
  ds_read_b64_tr_b16 a[30:31], v160 offset:26496
  v_mfma_f32_16x16x32_bf16 v[84:87], a[4:7], a[56:59], v[84:87]
  ds_read_b64_tr_b16 a[32:33], v160 offset:17824
  v_mfma_f32_16x16x32_bf16 v[28:31], a[8:11], a[52:55], v[28:31]
  ds_read_b64_tr_b16 a[34:35], v160 offset:26528
  v_mfma_f32_16x16x32_bf16 v[88:91], a[8:11], a[56:59], v[88:91]
  ds_read_b64_tr_b16 a[36:37], v160 offset:17856
  s_waitcnt lgkmcnt(9)
  v_mfma_f32_16x16x32_bf16 v[32:35], a[12:15], a[52:55], v[32:35]
  ds_read_b64_tr_b16 a[38:39], v160 offset:26560
  v_mfma_f32_16x16x32_bf16 v[92:95], a[12:15], a[56:59], v[92:95]
  v_mfma_f32_16x16x32_bf16 v[124:127], a[12:15], a[60:63], v[124:127]
  v_mfma_f32_16x16x32_bf16 v[36:39], a[16:19], a[52:55], v[36:39]
  v_mfma_f32_16x16x32_bf16 v[96:99], a[16:19], a[56:59], v[96:99]
  s_waitcnt lgkmcnt(6)
  v_mfma_f32_16x16x32_bf16 v[40:43], a[52:55], a[20:23], v[40:43]
  v_mfma_f32_16x16x32_bf16 v[100:103], a[56:59], a[20:23], v[100:103]
  s_waitcnt vmcnt(12) lgkmcnt(0)
  s_barrier
  v_mfma_f32_16x16x32_bf16 v[44:47], a[52:55], a[24:27], v[44:47]
  s_cmp_eq_u32 s41, 53248
  s_cselect_b32 s42, s95, s94
  v_add_u32_e64 v160, s42, v160
  v_mfma_f32_16x16x32_bf16 v[104:107], a[56:59], a[24:27], v[104:107]
  v_add_u32 v161, s42, v161
  v_add_u32 v162, s42, v162
  ds_read_b128 a[40:43], v161 offset:14336
  v_mfma_f32_16x16x32_bf16 v[48:51], a[52:55], a[28:31], v[48:51]
  ds_read_b128 a[44:47], v161 offset:16384
  ds_read_b128 a[48:51], v161 offset:0
  ds_read_b64_tr_b16 a[0:1], v160 offset:0
  v_mfma_f32_16x16x32_bf16 v[108:111], a[56:59], a[28:31], v[108:111]
  ds_read_b64_tr_b16 a[2:3], v160 offset:8704
  ds_read_b64_tr_b16 a[4:5], v160 offset:32
  ds_read_b64_tr_b16 a[6:7], v160 offset:8736
  v_mfma_f32_16x16x32_bf16 v[52:55], a[52:55], a[32:35], v[52:55]
  ds_read_b64_tr_b16 a[8:9], v160 offset:64
  ds_read_b64_tr_b16 a[10:11], v160 offset:8768
  ds_read_b64_tr_b16 a[12:13], v160 offset:96
  v_mfma_f32_16x16x32_bf16 v[112:115], a[56:59], a[32:35], v[112:115]
  ds_read_b64_tr_b16 a[14:15], v160 offset:8800
  ds_read_b64_tr_b16 a[16:17], v160 offset:128
  ds_read_b64_tr_b16 a[18:19], v160 offset:8832
  v_mfma_f32_16x16x32_bf16 v[128:131], a[60:63], a[32:35], v[128:131]
  ds_read_b64_tr_b16 a[20:21], v160 offset:160
  ds_read_b64_tr_b16 a[22:23], v160 offset:8864
  v_mfma_f32_16x16x32_bf16 v[56:59], a[52:55], a[36:39], v[56:59]
  v_mfma_f32_16x16x32_bf16 v[116:119], a[56:59], a[36:39], v[116:119]
  v_and_b32 v251, 15, v255
  v_lshlrev_b32 v251, 4, v251
  s_lshl_b32 s74, s36, 7
  s_sub_u32 s101, s74, 16
  s_cmp_eq_u32 s36, 0
  s_cselect_b32 s101, 0, s101
  s_add_u32 s74, s74, 96
  s_add_u32 s75, s74, 16
  ds_read_b64_tr_b16 a[24:25], v160 offset:192
  s_waitcnt lgkmcnt(9)
  v_mfma_f32_16x16x32_bf16 v[0:3], a[0:3], a[40:43], v[0:3]
  ds_read_b64_tr_b16 a[26:27], v160 offset:8896
  v_mfma_f32_16x16x32_bf16 v[60:63], a[0:3], a[44:47], v[60:63]
  ds_read_b64_tr_b16 a[28:29], v160 offset:224
  v_mfma_f32_16x16x32_bf16 v[4:7], a[4:7], a[40:43], v[4:7]
  ds_read_b64_tr_b16 a[30:31], v160 offset:8928
  v_mfma_f32_16x16x32_bf16 v[64:67], a[4:7], a[44:47], v[64:67]
  ds_read_b64_tr_b16 a[32:33], v160 offset:256
  s_waitcnt lgkmcnt(9)
  v_mfma_f32_16x16x32_bf16 v[8:11], a[8:11], a[40:43], v[8:11]
  s_lshl_b32 s88, s74, 4
  s_add_u32 s88, s88, 14745600
  buffer_load_dwordx4 v[180:183], v251, s[32:35], s88 offen sc1
  ds_read_b64_tr_b16 a[34:35], v160 offset:8960
  v_mfma_f32_16x16x32_bf16 v[68:71], a[8:11], a[44:47], v[68:71]
  ds_read_b64_tr_b16 a[36:37], v160 offset:288
  v_mfma_f32_16x16x32_bf16 v[12:15], a[12:15], a[40:43], v[12:15]
  s_lshl_b32 s88, s75, 4
  s_add_u32 s88, s88, 14745600
  buffer_load_dwordx4 v[184:187], v251, s[32:35], s88 offen sc1
  ds_read_b64_tr_b16 a[38:39], v160 offset:8992
  v_mfma_f32_16x16x32_bf16 v[72:75], a[12:15], a[44:47], v[72:75]
  v_mfma_f32_16x16x32_bf16 v[120:123], a[12:15], a[48:51], v[120:123]
  ds_read_b64_tr_b16 a[0:1], v160 offset:320
  ds_read_b64_tr_b16 a[2:3], v160 offset:9024
  ds_read_b128 a[52:55], v162 offset:14336
  s_waitcnt lgkmcnt(11)
  v_mfma_f32_16x16x32_bf16 v[16:19], a[16:19], a[40:43], v[16:19]
  s_lshl_b32 s88, s101, 4
  s_add_u32 s88, s88, 14745600
  buffer_load_dwordx4 v[188:191], v251, s[32:35], s88 offen sc1
  ds_read_b128 a[56:59], v162 offset:16384
  ds_read_b128 a[60:63], v162 offset:0
  v_mfma_f32_16x16x32_bf16 v[76:79], a[16:19], a[44:47], v[76:79]
  ds_read_b64_tr_b16 a[4:5], v160 offset:352
  v_mfma_f32_16x16x32_bf16 v[20:23], a[20:23], a[40:43], v[20:23]
  ds_read_b64_tr_b16 a[6:7], v160 offset:9056
  v_mfma_f32_16x16x32_bf16 v[80:83], a[20:23], a[44:47], v[80:83]
  s_mul_i32 s87, s6, 5
  s_add_u32 s87, s87, s83
  s_add_u32 m0, s86, 0
  s_add_u32 s88, s87, 2048
  buffer_load_dwordx4 v241, s[32:35], s88 offen sc1 lds
  ds_read_b64_tr_b16 a[8:9], v160 offset:384
  s_waitcnt lgkmcnt(12)
  v_mfma_f32_16x16x32_bf16 v[24:27], a[24:27], a[40:43], v[24:27]
  ds_read_b64_tr_b16 a[10:11], v160 offset:9088
  v_mfma_f32_16x16x32_bf16 v[84:87], a[24:27], a[44:47], v[84:87]
  ds_read_b64_tr_b16 a[12:13], v160 offset:416
  v_mfma_f32_16x16x32_bf16 v[28:31], a[28:31], a[40:43], v[28:31]
  s_add_u32 m0, s86, 1024
  s_add_u32 s88, s87, 3072
  buffer_load_dwordx4 v241, s[32:35], s88 offen sc1 lds
  ds_read_b64_tr_b16 a[14:15], v160 offset:9120
  v_mfma_f32_16x16x32_bf16 v[88:91], a[28:31], a[44:47], v[88:91]
  ds_read_b64_tr_b16 a[16:17], v160 offset:448
  s_waitcnt lgkmcnt(12)
  v_mfma_f32_16x16x32_bf16 v[32:35], a[32:35], a[40:43], v[32:35]
  s_add_u32 m0, s86, 2048
  s_add_u32 s88, s87, 4096
  buffer_load_dwordx4 v241, s[32:35], s88 offen sc1 lds
  ds_read_b64_tr_b16 a[18:19], v160 offset:9152
  v_mfma_f32_16x16x32_bf16 v[92:95], a[32:35], a[44:47], v[92:95]
  v_mfma_f32_16x16x32_bf16 v[124:127], a[32:35], a[48:51], v[124:127]
  ds_read_b64_tr_b16 a[20:21], v160 offset:17408
  v_mfma_f32_16x16x32_bf16 v[36:39], a[36:39], a[40:43], v[36:39]
  s_mul_i32 s87, s7, 5
  s_add_u32 s87, s87, s83
  s_add_u32 m0, s86, 3072
  s_add_u32 s88, s87, 0
  buffer_load_dwordx4 v241, s[32:35], s88 offen sc1 lds
  ds_read_b64_tr_b16 a[22:23], v160 offset:26112
  v_mfma_f32_16x16x32_bf16 v[96:99], a[36:39], a[44:47], v[96:99]
  ds_read_b64_tr_b16 a[24:25], v160 offset:17440
  s_waitcnt lgkmcnt(12)
  v_mfma_f32_16x16x32_bf16 v[40:43], a[40:43], a[0:3], v[40:43]
  ds_read_b64_tr_b16 a[26:27], v160 offset:26144
  v_mfma_f32_16x16x32_bf16 v[100:103], a[44:47], a[0:3], v[100:103]
  s_add_u32 m0, s86, 4096
  s_add_u32 s88, s87, 1024
  buffer_load_dwordx4 v241, s[32:35], s88 offen sc1 lds
  ds_read_b64_tr_b16 a[28:29], v160 offset:17472
  s_waitcnt lgkmcnt(9)
  v_mfma_f32_16x16x32_bf16 v[44:47], a[40:43], a[4:7], v[44:47]
  ds_read_b64_tr_b16 a[30:31], v160 offset:26176
  v_mfma_f32_16x16x32_bf16 v[104:107], a[44:47], a[4:7], v[104:107]
  ds_read_b64_tr_b16 a[32:33], v160 offset:17504
  v_mfma_f32_16x16x32_bf16 v[48:51], a[40:43], a[8:11], v[48:51]
  s_add_u32 m0, s86, 5120
  s_add_u32 s88, s87, 2048
  buffer_load_dwordx4 v241, s[32:35], s88 offen sc1 lds
  ds_read_b64_tr_b16 a[34:35], v160 offset:26208
  v_mfma_f32_16x16x32_bf16 v[108:111], a[44:47], a[8:11], v[108:111]
  ds_read_b64_tr_b16 a[36:37], v160 offset:17536
  s_waitcnt lgkmcnt(9)
  v_mfma_f32_16x16x32_bf16 v[52:55], a[40:43], a[12:15], v[52:55]
  s_add_u32 m0, s86, 6144
  s_add_u32 s88, s87, 3072
  buffer_load_dwordx4 v241, s[32:35], s88 offen sc1 lds
  ds_read_b64_tr_b16 a[38:39], v160 offset:26240
  v_mfma_f32_16x16x32_bf16 v[112:115], a[44:47], a[12:15], v[112:115]
  v_mfma_f32_16x16x32_bf16 v[128:131], a[48:51], a[12:15], v[128:131]
  ds_read_b64_tr_b16 a[0:1], v160 offset:17568
  v_mfma_f32_16x16x32_bf16 v[56:59], a[40:43], a[16:19], v[56:59]
  s_add_u32 m0, s86, 7168
  s_add_u32 s88, s87, 4096
  buffer_load_dwordx4 v241, s[32:35], s88 offen sc1 lds
  ds_read_b64_tr_b16 a[2:3], v160 offset:26272
  v_mfma_f32_16x16x32_bf16 v[116:119], a[44:47], a[16:19], v[116:119]
  ds_read_b64_tr_b16 a[4:5], v160 offset:17600
  s_waitcnt lgkmcnt(9)
  v_mfma_f32_16x16x32_bf16 v[0:3], a[20:23], a[52:55], v[0:3]
  ds_read_b64_tr_b16 a[6:7], v160 offset:26304
  v_mfma_f32_16x16x32_bf16 v[60:63], a[20:23], a[56:59], v[60:63]
  s_mul_i32 s87, s8, 5
  s_add_u32 s87, s87, s83
  s_add_u32 m0, s86, 8192
  s_add_u32 s88, s87, 0
  buffer_load_dwordx4 v241, s[32:35], s88 offen sc1 lds
  ds_read_b64_tr_b16 a[8:9], v160 offset:17632
  v_mfma_f32_16x16x32_bf16 v[4:7], a[24:27], a[52:55], v[4:7]
  ds_read_b64_tr_b16 a[10:11], v160 offset:26336
  v_mfma_f32_16x16x32_bf16 v[64:67], a[24:27], a[56:59], v[64:67]
  ds_read_b64_tr_b16 a[12:13], v160 offset:17664
  s_waitcnt lgkmcnt(9)
  v_mfma_f32_16x16x32_bf16 v[8:11], a[28:31], a[52:55], v[8:11]
  s_add_u32 m0, s86, 9216
  s_add_u32 s88, s87, 1024
  buffer_load_dwordx4 v241, s[32:35], s88 offen sc1 lds
  ds_read_b64_tr_b16 a[14:15], v160 offset:26368
  v_mfma_f32_16x16x32_bf16 v[68:71], a[28:31], a[56:59], v[68:71]
  ds_read_b64_tr_b16 a[16:17], v160 offset:17696
  v_mfma_f32_16x16x32_bf16 v[12:15], a[32:35], a[52:55], v[12:15]
  s_add_u32 m0, s86, 10240
  s_add_u32 s88, s87, 2048
  buffer_load_dwordx4 v241, s[32:35], s88 offen sc1 lds
  ds_read_b64_tr_b16 a[18:19], v160 offset:26400
  v_mfma_f32_16x16x32_bf16 v[72:75], a[32:35], a[56:59], v[72:75]
  v_mfma_f32_16x16x32_bf16 v[120:123], a[32:35], a[60:63], v[120:123]
  ds_read_b64_tr_b16 a[20:21], v160 offset:17728
  s_waitcnt lgkmcnt(9)
  v_mfma_f32_16x16x32_bf16 v[16:19], a[36:39], a[52:55], v[16:19]
  s_add_u32 m0, s86, 11264
  s_add_u32 s88, s87, 3072
  buffer_load_dwordx4 v241, s[32:35], s88 offen sc1 lds
  ds_read_b64_tr_b16 a[22:23], v160 offset:26432
  v_mfma_f32_16x16x32_bf16 v[76:79], a[36:39], a[56:59], v[76:79]
  ds_read_b64_tr_b16 a[24:25], v160 offset:17760
  v_mfma_f32_16x16x32_bf16 v[20:23], a[0:3], a[52:55], v[20:23]
  ds_read_b64_tr_b16 a[26:27], v160 offset:26464
  v_mfma_f32_16x16x32_bf16 v[80:83], a[0:3], a[56:59], v[80:83]
  s_add_u32 m0, s86, 12288
  s_add_u32 s88, s87, 4096
  buffer_load_dwordx4 v241, s[32:35], s88 offen sc1 lds
  ds_read_b64_tr_b16 a[28:29], v160 offset:17792
  s_waitcnt lgkmcnt(9)
  v_mfma_f32_16x16x32_bf16 v[24:27], a[4:7], a[52:55], v[24:27]
  ds_read_b64_tr_b16 a[30:31], v160 offset:26496
  v_mfma_f32_16x16x32_bf16 v[84:87], a[4:7], a[56:59], v[84:87]
  ds_read_b64_tr_b16 a[32:33], v160 offset:17824
  v_mfma_f32_16x16x32_bf16 v[28:31], a[8:11], a[52:55], v[28:31]
  ds_read_b64_tr_b16 a[34:35], v160 offset:26528
  v_mfma_f32_16x16x32_bf16 v[88:91], a[8:11], a[56:59], v[88:91]
  ds_read_b64_tr_b16 a[36:37], v160 offset:17856
  s_waitcnt lgkmcnt(9)
  v_mfma_f32_16x16x32_bf16 v[32:35], a[12:15], a[52:55], v[32:35]
  ds_read_b64_tr_b16 a[38:39], v160 offset:26560
  v_mfma_f32_16x16x32_bf16 v[92:95], a[12:15], a[56:59], v[92:95]
  v_mfma_f32_16x16x32_bf16 v[124:127], a[12:15], a[60:63], v[124:127]
  v_mfma_f32_16x16x32_bf16 v[36:39], a[16:19], a[52:55], v[36:39]
  v_mfma_f32_16x16x32_bf16 v[96:99], a[16:19], a[56:59], v[96:99]
  s_waitcnt lgkmcnt(6)
  v_mfma_f32_16x16x32_bf16 v[40:43], a[52:55], a[20:23], v[40:43]
  v_mfma_f32_16x16x32_bf16 v[100:103], a[56:59], a[20:23], v[100:103]
  s_waitcnt lgkmcnt(0)
  s_barrier
  v_mfma_f32_16x16x32_bf16 v[44:47], a[52:55], a[24:27], v[44:47]
  v_mfma_f32_16x16x32_bf16 v[104:107], a[56:59], a[24:27], v[104:107]
  v_mfma_f32_16x16x32_bf16 v[48:51], a[52:55], a[28:31], v[48:51]
  v_mfma_f32_16x16x32_bf16 v[108:111], a[56:59], a[28:31], v[108:111]
  v_mfma_f32_16x16x32_bf16 v[52:55], a[52:55], a[32:35], v[52:55]
  v_mfma_f32_16x16x32_bf16 v[112:115], a[56:59], a[32:35], v[112:115]
  v_mfma_f32_16x16x32_bf16 v[128:131], a[60:63], a[32:35], v[128:131]
  v_mfma_f32_16x16x32_bf16 v[56:59], a[52:55], a[36:39], v[56:59]
  v_mfma_f32_16x16x32_bf16 v[116:119], a[56:59], a[36:39], v[116:119]
  s_branch L_ep_attn
L_pp_attn_3:
  buffer_load_dwordx2 v[252:253], v249, s[76:79], 0 offen sc1
  s_branch L_np_attn_3
L_ep_attn:
  s_nop 7
  s_nop 1
  v_and_b32 v253, 15, v255
  v_lshlrev_b32 v253, 2, v253
  v_lshrrev_b32_e64 v252, 4, v255
  s_lshl_b32 s46, s22, 7
  s_mul_i32 s87, s9, 5
  s_add_u32 s87, s87, s83
  buffer_load_dwordx4 a[0:3], v241, s[32:35], s87 offen offset:0 sc1
  s_lshl_b32 s47, s22, 6
  v_add_u32 v176, s46, v253
  v_add_u32 v179, s47, v253
  s_waitcnt vmcnt(13)
  s_mov_b32 s43, 0
L_stc_attn:
  s_mov_b64 s[66:67], exec
  v_cmp_eq_u32 vcc, s23, v183
  s_nop 1
  s_and_b64 s[66:67], s[66:67], vcc
  v_cmp_eq_u32 vcc, s23, v187
  s_nop 1
  s_and_b64 s[66:67], s[66:67], vcc
  v_cmp_eq_u32 vcc, s23, v191
  s_nop 1
  s_and_b64 s[66:67], s[66:67], vcc
  s_cmp_eq_u64 s[66:67], exec
  s_cbranch_scc1 L_stok_attn
  s_add_u32 s43, s43, 1
  s_cmp_gt_u32 s43, 200000
  s_cbranch_scc1 L_stok_attn
  s_sleep 8
  s_lshl_b32 s88, s74, 4
  s_add_u32 s88, s88, 14745600
  buffer_load_dwordx4 v[180:183], v251, s[32:35], s88 offen sc1
  s_lshl_b32 s88, s75, 4
  s_add_u32 s88, s88, 14745600
  buffer_load_dwordx4 v[184:187], v251, s[32:35], s88 offen sc1
  s_lshl_b32 s88, s101, 4
  s_add_u32 s88, s88, 14745600
  buffer_load_dwordx4 v[188:191], v251, s[32:35], s88 offen sc1
  s_waitcnt vmcnt(0)
  s_branch L_stc_attn
L_stok_attn:
  v_mov_b32 v240, v180
  v_mov_b32 v244, v181
  v_mov_b32 v248, v182
  ds_write_b32 v176, v180 offset:1088
  ds_write_b32 v176, v181 offset:2112
  v_mov_b32 v242, v184
  v_mov_b32 v246, v185
  v_mov_b32_e64 v249, v186
  ds_write_b32 v176, v184 offset:1152
  ds_write_b32 v176, v185 offset:2176
  v_mov_b32 v152, v188
  v_mov_b32 v154, v189
  ds_write_b32 v253, v188 offset:1024
  ds_write_b32 v253, v189 offset:2048
  v_cmp_le_u32 s[66:67], 1, v252
  s_nop 1
  v_cndmask_b32_e64 v160, 0, -1, s[66:67]
  v_cmp_le_u32 s[66:67], 2, v252
  s_nop 1
  v_cndmask_b32_e64 v161, 0, -1, s[66:67]
  v_cmp_le_u32 s[66:67], 3, v252
  s_nop 1
  v_cndmask_b32_e64 v162, 0, -1, s[66:67]
  v_not_b32 v163, v160
  v_not_b32 v164, v161
  v_not_b32 v165, v162
  v_lshlrev_b32 v252, 4, v252
  v_add_u32 v177, s46, v252
  v_add_u32_e64 v178, s47, v252
  s_mov_b32 exec_lo, 0x00010001
  s_mov_b32 exec_hi, 0x00010001
  ds_write_b128 v178, v[120:123] offset:0
  ds_write_b128 v178, v[124:127] offset:320
  s_cmp_gt_u32 s22, 1
  s_cbranch_scc1 L_e3a
  s_mul_i32 s48, s22, 320
  v_add_u32_e64 v167, s48, v252
  ds_write_b128 v167, v[132:135] offset:256
L_e3a:
  s_mov_b32 exec_lo, 0x0000ffff
  s_mov_b32 exec_hi, 0
  ds_write_b32 v179, v128 offset:640
  s_cmp_lg_u32 s22, 2
  s_cbranch_scc1 L_e3b
  ds_write_b32 v253, v132 offset:896
L_e3b:
  s_mov_b64 exec, -1
  buffer_load_dwordx4 a[4:7], v241, s[32:35], s87 offen offset:1024 sc1
  v_lshlrev_b32 v251, 3, v255
  s_lshl_b32 s48, s22, 9
  v_add_u32_e64 v250, s48, v251
  s_mul_i32 s48, s22, 5120
  v_add_u32_e64 v254, s48, v251
  s_waitcnt lgkmcnt(0)
  s_barrier
  ds_read_b128 v[200:203], v252 offset:0
  ds_read_b128 v[204:207], v252 offset:64
  ds_read_b128 v[208:211], v252 offset:128
  ds_read_b128 v[212:215], v252 offset:192
  buffer_load_dwordx4 a[8:11], v241, s[32:35], s87 offen offset:2048 sc1
  ds_read_b128 v[216:219], v252 offset:256
  ds_read_b128 v[220:223], v252 offset:320
  ds_read_b128 v[224:227], v252 offset:384
  ds_read_b128 v[228:231], v252 offset:448
  ds_read_b128 v[232:235], v252 offset:512
  ds_read_b128 v[236:239], v252 offset:576
  ds_read_b128 v[156:159], v178 offset:320
  s_waitcnt lgkmcnt(10)
  v_pk_fma_f32 v[0:1], v[200:201], v[240:241], v[0:1] op_sel_hi:[1,0,1]
  v_pk_fma_f32 v[2:3], v[202:203], v[240:241], v[2:3] op_sel_hi:[1,0,1]
  v_cvt_pk_bf16_f32 v0, v0, v1
  buffer_load_dwordx4 a[12:15], v241, s[32:35], s87 offen offset:3072 sc1
  v_cvt_pk_bf16_f32 v1, v2, v3
  v_pk_fma_f32 v[60:61], v[200:201], v[242:243], v[60:61] op_sel_hi:[1,0,1]
  v_pk_fma_f32 v[62:63], v[202:203], v[242:243], v[62:63] op_sel_hi:[1,0,1]
  v_cvt_pk_bf16_f32 v60, v60, v61
  v_cvt_pk_bf16_f32 v61, v62, v63
  s_waitcnt lgkmcnt(9)
  v_pk_fma_f32 v[4:5], v[204:205], v[240:241], v[4:5] op_sel_hi:[1,0,1]
  v_pk_fma_f32 v[6:7], v[206:207], v[240:241], v[6:7] op_sel_hi:[1,0,1]
  v_cvt_pk_bf16_f32 v166, v4, v5
  v_cvt_pk_bf16_f32 v167, v6, v7
  buffer_load_dwordx4 a[16:19], v245, s[32:35], s87 offen sc1
  v_and_b32 v4, v166, v160
  v_and_b32 v5, v167, v160
  v_and_b32 v2, v166, v163
  v_and_b32 v3, v167, v163
  v_pk_fma_f32 v[64:65], v[204:205], v[242:243], v[64:65] op_sel_hi:[1,0,1]
  v_pk_fma_f32 v[66:67], v[206:207], v[242:243], v[66:67] op_sel_hi:[1,0,1]
  v_cvt_pk_bf16_f32 v166, v64, v65
  v_cvt_pk_bf16_f32 v167, v66, v67
  v_and_b32 v64, v166, v160
  v_and_b32 v65, v167, v160
  s_mul_i32 s87, s10, 5
  s_add_u32 s87, s87, s83
  buffer_load_dwordx4 a[20:23], v241, s[32:35], s87 offen offset:0 sc1
  v_and_b32 v62, v166, v163
  v_and_b32_e64 v63, v167, v163
  s_waitcnt lgkmcnt(8)
  v_pk_fma_f32 v[8:9], v[208:209], v[240:241], v[8:9] op_sel_hi:[1,0,1]
  v_pk_fma_f32 v[10:11], v[210:211], v[240:241], v[10:11] op_sel_hi:[1,0,1]
  v_cvt_pk_bf16_f32 v166, v8, v9
  v_cvt_pk_bf16_f32 v167, v10, v11
  v_and_b32 v8, v166, v161
  v_and_b32 v9, v167, v161
  v_and_b32_e64 v6, v166, v164
  buffer_load_dwordx4 a[24:27], v241, s[32:35], s87 offen offset:1024 sc1
  v_and_b32_e64 v7, v167, v164
  v_pk_fma_f32 v[68:69], v[208:209], v[242:243], v[68:69] op_sel_hi:[1,0,1]
  v_pk_fma_f32 v[70:71], v[210:211], v[242:243], v[70:71] op_sel_hi:[1,0,1]
  v_cvt_pk_bf16_f32 v166, v68, v69
  v_cvt_pk_bf16_f32 v167, v70, v71
  v_and_b32 v68, v166, v161
  v_and_b32 v69, v167, v161
  v_and_b32 v66, v166, v164
  v_and_b32 v67, v167, v164
  buffer_load_dwordx4 a[28:31], v241, s[32:35], s87 offen offset:2048 sc1
  s_waitcnt lgkmcnt(7)
  v_pk_fma_f32 v[12:13], v[212:213], v[240:241], v[12:13] op_sel_hi:[1,0,1]
  v_pk_fma_f32 v[14:15], v[214:215], v[240:241], v[14:15] op_sel_hi:[1,0,1]
  v_cvt_pk_bf16_f32 v166, v12, v13
  v_cvt_pk_bf16_f32 v167, v14, v15
  v_and_b32 v12, v166, v162
  v_and_b32 v13, v167, v162
  v_and_b32 v10, v166, v165
  v_and_b32_e64 v11, v167, v165
  v_pk_fma_f32 v[72:73], v[212:213], v[242:243], v[72:73] op_sel_hi:[1,0,1]
  v_pk_fma_f32 v[74:75], v[214:215], v[242:243], v[74:75] op_sel_hi:[1,0,1]
  buffer_load_dwordx4 a[32:35], v241, s[32:35], s87 offen offset:3072 sc1
  v_cvt_pk_bf16_f32 v166, v72, v73
  v_cvt_pk_bf16_f32 v167, v74, v75
  v_and_b32 v72, v166, v162
  v_and_b32 v73, v167, v162
  v_and_b32 v70, v166, v165
  v_and_b32_e64 v71, v167, v165
  s_waitcnt lgkmcnt(6)
  v_pk_fma_f32 v[16:17], v[216:217], v[240:241], v[16:17] op_sel_hi:[1,0,1]
  v_pk_fma_f32 v[18:19], v[218:219], v[240:241], v[18:19] op_sel_hi:[1,0,1]
  v_cvt_pk_bf16_f32 v14, v16, v17
  buffer_load_dwordx4 a[36:39], v245, s[32:35], s87 offen sc1
  v_cvt_pk_bf16_f32 v15, v18, v19
  v_pk_fma_f32 v[76:77], v[216:217], v[242:243], v[76:77] op_sel_hi:[1,0,1]
  v_pk_fma_f32 v[78:79], v[218:219], v[242:243], v[78:79] op_sel_hi:[1,0,1]
  v_cvt_pk_bf16_f32 v74, v76, v77
  v_cvt_pk_bf16_f32 v75, v78, v79
  ds_read_b128 v[136:139], v177 offset:1088
  ds_read_b128 v[144:147], v177 offset:2112
  ds_read_b128 v[140:143], v177 offset:1152
  ds_read_b128 v[148:151], v177 offset:2176
  ds_read_b128 v[168:171], v252 offset:1024
  s_mul_i32 s87, s11, 5
  s_add_u32 s87, s87, s83
  buffer_load_dwordx4 a[40:43], v241, s[32:35], s87 offen offset:0 sc1
  ds_read_b128 v[172:175], v252 offset:2048
  s_waitcnt lgkmcnt(11)
  s_nop 0
  v_pk_fma_f32 v[20:21], v[220:221], v[240:241], v[20:21] op_sel_hi:[1,0,1]
  v_pk_fma_f32 v[22:23], v[222:223], v[240:241], v[22:23] op_sel_hi:[1,0,1]
  v_pk_mul_f32 v[20:21], v[20:21], v[244:245] op_sel_hi:[1,0]
  v_pk_mul_f32 v[22:23], v[22:23], v[244:245] op_sel_hi:[1,0]
  v_cvt_pk_bf16_f32 v180, v20, v21
  v_cvt_pk_bf16_f32 v181, v22, v23
  v_pk_fma_f32 v[80:81], v[220:221], v[242:243], v[80:81] op_sel_hi:[1,0,1]
  v_pk_fma_f32 v[82:83], v[222:223], v[242:243], v[82:83] op_sel_hi:[1,0,1]
  buffer_load_dwordx4 a[44:47], v241, s[32:35], s87 offen offset:1024 sc1
  v_pk_mul_f32 v[80:81], v[80:81], v[246:247] op_sel_hi:[1,0]
  v_pk_mul_f32 v[82:83], v[82:83], v[246:247] op_sel_hi:[1,0]
  v_cvt_pk_bf16_f32 v190, v80, v81
  v_cvt_pk_bf16_f32 v191, v82, v83
  ds_write_b64 v254, v[190:191] offset:9216
  ds_read_b32 v16, v253 offset:640
  ds_read_b32 v18, v253 offset:704
  ds_read_b32 v76, v253 offset:768
  ds_read_b32 v78, v253 offset:832
  buffer_load_dwordx4 a[48:51], v241, s[32:35], s87 offen offset:2048 sc1
  ds_read_b32 v20, v253 offset:896
  ds_read_b32 v22, v179 offset:640
  s_waitcnt lgkmcnt(15)
  s_nop 0
  v_pk_fma_f32 v[24:25], v[224:225], v[240:241], v[24:25] op_sel_hi:[1,0,1]
  v_pk_fma_f32 v[26:27], v[226:227], v[240:241], v[26:27] op_sel_hi:[1,0,1]
  v_pk_mul_f32 v[24:25], v[24:25], v[244:245] op_sel_hi:[1,0]
  v_pk_mul_f32 v[26:27], v[26:27], v[244:245] op_sel_hi:[1,0]
  v_cvt_pk_bf16_f32 v182, v24, v25
  v_cvt_pk_bf16_f32 v183, v26, v27
  v_pk_fma_f32 v[84:85], v[224:225], v[242:243], v[84:85] op_sel_hi:[1,0,1]
  v_pk_fma_f32 v[86:87], v[226:227], v[242:243], v[86:87] op_sel_hi:[1,0,1]
  buffer_load_dwordx4 a[52:55], v241, s[32:35], s87 offen offset:3072 sc1
  v_pk_mul_f32 v[84:85], v[84:85], v[246:247] op_sel_hi:[1,0]
  v_pk_mul_f32 v[86:87], v[86:87], v[246:247] op_sel_hi:[1,0]
  v_cvt_pk_bf16_f32 v192, v84, v85
  v_cvt_pk_bf16_f32 v193, v86, v87
  ds_write_b64 v254, v[192:193] offset:9728
  v_pk_fma_f32 v[28:29], v[228:229], v[240:241], v[28:29] op_sel_hi:[1,0,1]
  v_pk_fma_f32 v[30:31], v[230:231], v[240:241], v[30:31] op_sel_hi:[1,0,1]
  v_pk_mul_f32 v[28:29], v[28:29], v[244:245] op_sel_hi:[1,0]
  v_pk_mul_f32 v[30:31], v[30:31], v[244:245] op_sel_hi:[1,0]
  buffer_load_dwordx4 a[56:59], v245, s[32:35], s87 offen sc1
  v_cvt_pk_bf16_f32 v184, v28, v29
  v_cvt_pk_bf16_f32 v185, v30, v31
  v_pk_fma_f32 v[88:89], v[228:229], v[242:243], v[88:89] op_sel_hi:[1,0,1]
  v_pk_fma_f32 v[90:91], v[230:231], v[242:243], v[90:91] op_sel_hi:[1,0,1]
  v_pk_mul_f32 v[88:89], v[88:89], v[246:247] op_sel_hi:[1,0]
  v_pk_mul_f32 v[90:91], v[90:91], v[246:247] op_sel_hi:[1,0]
  v_cvt_pk_bf16_f32 v194, v88, v89
  v_cvt_pk_bf16_f32 v195, v90, v91
  ds_write_b64 v254, v[194:195] offset:10240
  v_pk_fma_f32 v[32:33], v[232:233], v[240:241], v[32:33] op_sel_hi:[1,0,1]
  s_mul_i32 s87, s12, 5
  s_add_u32 s87, s87, s83
  buffer_load_dwordx4 a[60:63], v241, s[32:35], s87 offen offset:0 sc1
  v_pk_fma_f32 v[34:35], v[234:235], v[240:241], v[34:35] op_sel_hi:[1,0,1]
  v_pk_mul_f32 v[32:33], v[32:33], v[244:245] op_sel_hi:[1,0]
  v_pk_mul_f32 v[34:35], v[34:35], v[244:245] op_sel_hi:[1,0]
  v_cvt_pk_bf16_f32 v186, v32, v33
  v_cvt_pk_bf16_f32 v187, v34, v35
  v_pk_fma_f32 v[92:93], v[232:233], v[242:243], v[92:93] op_sel_hi:[1,0,1]
  v_pk_fma_f32 v[94:95], v[234:235], v[242:243], v[94:95] op_sel_hi:[1,0,1]
  v_pk_mul_f32 v[92:93], v[92:93], v[246:247] op_sel_hi:[1,0]
  v_pk_mul_f32 v[94:95], v[94:95], v[246:247] op_sel_hi:[1,0]
  buffer_load_dwordx4 a[64:67], v241, s[32:35], s87 offen offset:1024 sc1
  v_cvt_pk_bf16_f32 v196, v92, v93
  v_cvt_pk_bf16_f32 v197, v94, v95
  ds_write_b64 v254, v[196:197] offset:10752
  s_waitcnt lgkmcnt(15)
  s_nop 0
  v_pk_fma_f32 v[36:37], v[236:237], v[240:241], v[36:37] op_sel_hi:[1,0,1]
  v_pk_fma_f32 v[38:39], v[238:239], v[240:241], v[38:39] op_sel_hi:[1,0,1]
  v_pk_mul_f32 v[36:37], v[36:37], v[244:245] op_sel_hi:[1,0]
  v_pk_mul_f32 v[38:39], v[38:39], v[244:245] op_sel_hi:[1,0]
  v_cvt_pk_bf16_f32 v188, v36, v37
  v_cvt_pk_bf16_f32 v189, v38, v39
  buffer_load_dwordx4 a[68:71], v241, s[32:35], s87 offen offset:2048 sc1
  v_pk_fma_f32 v[96:97], v[236:237], v[242:243], v[96:97] op_sel_hi:[1,0,1]
  v_pk_fma_f32 v[98:99], v[238:239], v[242:243], v[98:99] op_sel_hi:[1,0,1]
  v_pk_mul_f32 v[96:97], v[96:97], v[246:247] op_sel_hi:[1,0]
  v_pk_mul_f32 v[98:99], v[98:99], v[246:247] op_sel_hi:[1,0]
  v_cvt_pk_bf16_f32 v198, v96, v97
  v_cvt_pk_bf16_f32 v199, v98, v99
  ds_write_b64 v254, v[198:199] offset:11264
  v_pk_fma_f32 v[124:125], v[156:157], v[152:153], v[124:125] op_sel_hi:[1,0,1]
  v_pk_fma_f32 v[126:127], v[158:159], v[152:153], v[126:127] op_sel_hi:[1,0,1]
  v_pk_mul_f32 v[124:125], v[124:125], v[154:155] op_sel_hi:[1,0]
  buffer_load_dwordx4 a[72:75], v241, s[32:35], s87 offen offset:3072 sc1
  v_pk_mul_f32 v[126:127], v[126:127], v[154:155] op_sel_hi:[1,0]
  v_cvt_pk_bf16_f32 v124, v124, v125
  v_cvt_pk_bf16_f32 v125, v126, v127
  ds_write_b64 v250, v[124:125] offset:4096
  s_cmp_lg_u32 s22, 1
  s_cbranch_scc1 L_e3k
  v_pk_fma_f32 v[132:133], v[236:237], v[152:153], v[132:133] op_sel_hi:[1,0,1]
  v_pk_fma_f32 v[134:135], v[238:239], v[152:153], v[134:135] op_sel_hi:[1,0,1]
  v_pk_mul_f32 v[132:133], v[132:133], v[154:155] op_sel_hi:[1,0]
  v_pk_mul_f32 v[134:135], v[134:135], v[154:155] op_sel_hi:[1,0]
  v_cvt_pk_bf16_f32 v132, v132, v133
  v_cvt_pk_bf16_f32 v133, v134, v135
  ds_write_b64 v251, v[132:133] offset:6144
L_e3k:
  s_waitcnt lgkmcnt(10)
  v_pk_fma_f32 v[40:41], v[136:137], v[16:17], v[40:41] op_sel_hi:[1,0,1]
  v_pk_mul_f32 v[40:41], v[40:41], v[144:145]
  v_pk_fma_f32 v[42:43], v[138:139], v[16:17], v[42:43] op_sel_hi:[1,0,1]
  v_pk_mul_f32 v[42:43], v[42:43], v[146:147]
  buffer_load_dwordx4 a[76:79], v245, s[32:35], s87 offen sc1
  s_nop 0
  v_cvt_pk_bf16_f32 v212, v40, v41
  v_cvt_pk_bf16_f32 v213, v42, v43
  v_pk_fma_f32 v[100:101], v[140:141], v[16:17], v[100:101] op_sel_hi:[1,0,1]
  v_pk_mul_f32 v[100:101], v[100:101], v[148:149]
  v_pk_fma_f32 v[102:103], v[142:143], v[16:17], v[102:103] op_sel_hi:[1,0,1]
  v_pk_mul_f32 v[102:103], v[102:103], v[150:151]
  v_cvt_pk_bf16_f32 v214, v100, v101
  v_cvt_pk_bf16_f32 v215, v102, v103
  ds_write_b64 v254, v[214:215] offset:11776
  s_waitcnt lgkmcnt(10)
  v_pk_fma_f32 v[44:45], v[136:137], v[18:19], v[44:45] op_sel_hi:[1,0,1]
  s_mul_i32 s87, s13, 5
  s_add_u32 s87, s87, s83
  buffer_load_dwordx4 a[80:83], v241, s[32:35], s87 offen offset:0 sc1
  s_nop 0
  v_pk_mul_f32 v[44:45], v[44:45], v[144:145]
  v_pk_fma_f32 v[46:47], v[138:139], v[18:19], v[46:47] op_sel_hi:[1,0,1]
  v_pk_mul_f32 v[46:47], v[46:47], v[146:147]
  v_cvt_pk_bf16_f32 v218, v44, v45
  v_cvt_pk_bf16_f32 v219, v46, v47
  v_pk_fma_f32 v[104:105], v[140:141], v[18:19], v[104:105] op_sel_hi:[1,0,1]
  v_pk_mul_f32 v[104:105], v[104:105], v[148:149]
  v_pk_fma_f32 v[106:107], v[142:143], v[18:19], v[106:107] op_sel_hi:[1,0,1]
  v_pk_mul_f32 v[106:107], v[106:107], v[150:151]
  buffer_load_dwordx4 a[84:87], v241, s[32:35], s87 offen offset:1024 sc1
  v_cvt_pk_bf16_f32 v220, v104, v105
  v_cvt_pk_bf16_f32 v221, v106, v107
  ds_write_b64 v254, v[220:221] offset:12288
  s_waitcnt lgkmcnt(10)
  s_nop 0
  v_pk_fma_f32 v[48:49], v[136:137], v[76:77], v[48:49] op_sel_hi:[1,0,1]
  v_pk_mul_f32 v[48:49], v[48:49], v[144:145]
  v_pk_fma_f32 v[50:51], v[138:139], v[76:77], v[50:51] op_sel_hi:[1,0,1]
  v_pk_mul_f32 v[50:51], v[50:51], v[146:147]
  v_cvt_pk_bf16_f32 v224, v48, v49
  v_cvt_pk_bf16_f32 v225, v50, v51
  buffer_load_dwordx4 a[88:91], v241, s[32:35], s87 offen offset:2048 sc1
  v_pk_fma_f32 v[108:109], v[140:141], v[76:77], v[108:109] op_sel_hi:[1,0,1]
  v_pk_mul_f32 v[108:109], v[108:109], v[148:149]
  v_pk_fma_f32 v[110:111], v[142:143], v[76:77], v[110:111] op_sel_hi:[1,0,1]
  v_pk_mul_f32 v[110:111], v[110:111], v[150:151]
  v_cvt_pk_bf16_f32 v226, v108, v109
  v_cvt_pk_bf16_f32 v227, v110, v111
  ds_write_b64 v254, v[226:227] offset:12800
  s_waitcnt lgkmcnt(10)
  v_pk_fma_f32 v[52:53], v[136:137], v[78:79], v[52:53] op_sel_hi:[1,0,1]
  v_pk_mul_f32 v[52:53], v[52:53], v[144:145]
  v_pk_fma_f32 v[54:55], v[138:139], v[78:79], v[54:55] op_sel_hi:[1,0,1]
  buffer_load_dwordx4 a[92:95], v241, s[32:35], s87 offen offset:3072 sc1
  s_nop 0
  v_pk_mul_f32 v[54:55], v[54:55], v[146:147]
  v_cvt_pk_bf16_f32 v230, v52, v53
  v_cvt_pk_bf16_f32 v231, v54, v55
  v_pk_fma_f32 v[112:113], v[140:141], v[78:79], v[112:113] op_sel_hi:[1,0,1]
  v_pk_mul_f32 v[112:113], v[112:113], v[148:149]
  v_pk_fma_f32 v[114:115], v[142:143], v[78:79], v[114:115] op_sel_hi:[1,0,1]
  v_pk_mul_f32 v[114:115], v[114:115], v[150:151]
  v_cvt_pk_bf16_f32 v232, v112, v113
  v_cvt_pk_bf16_f32 v233, v114, v115
  buffer_load_dwordx4 a[96:99], v245, s[32:35], s87 offen sc1
  ds_write_b64 v254, v[232:233] offset:13312
  s_waitcnt lgkmcnt(10)
  s_nop 0
  v_pk_fma_f32 v[56:57], v[136:137], v[20:21], v[56:57] op_sel_hi:[1,0,1]
  v_pk_mul_f32 v[56:57], v[56:57], v[144:145]
  v_pk_fma_f32 v[58:59], v[138:139], v[20:21], v[58:59] op_sel_hi:[1,0,1]
  v_pk_mul_f32 v[58:59], v[58:59], v[146:147]
  v_cvt_pk_bf16_f32 v236, v56, v57
  v_cvt_pk_bf16_f32 v237, v58, v59
  v_pk_fma_f32 v[116:117], v[140:141], v[20:21], v[116:117] op_sel_hi:[1,0,1]
  v_pk_mul_f32 v[116:117], v[116:117], v[148:149]
  v_pk_fma_f32 v[118:119], v[142:143], v[20:21], v[118:119] op_sel_hi:[1,0,1]
  s_mul_i32 s87, s14, 5
  s_add_u32 s87, s87, s83
  buffer_load_dwordx4 a[100:103], v241, s[32:35], s87 offen offset:0 sc1
  v_pk_mul_f32 v[118:119], v[118:119], v[150:151]
  v_cvt_pk_bf16_f32 v238, v116, v117
  v_cvt_pk_bf16_f32 v239, v118, v119
  ds_write_b64 v254, v[238:239] offset:13824
  s_waitcnt lgkmcnt(10)
  v_pk_fma_f32 v[128:129], v[168:169], v[22:23], v[128:129] op_sel_hi:[1,0,1]
  v_pk_mul_f32 v[128:129], v[128:129], v[172:173]
  v_pk_fma_f32 v[130:131], v[170:171], v[22:23], v[130:131] op_sel_hi:[1,0,1]
  v_pk_mul_f32 v[130:131], v[130:131], v[174:175]
  v_cvt_pk_bf16_f32 v128, v128, v129
  buffer_load_dwordx4 a[104:107], v241, s[32:35], s87 offen offset:1024 sc1
  v_cvt_pk_bf16_f32 v129, v130, v131
  ds_write_b64 v250, v[128:129] offset:6656
  s_cmp_lg_u32 s22, 2
  s_cbranch_scc1 L_e3v
  s_nop 0
  v_pk_fma_f32 v[132:133], v[168:169], v[20:21], v[132:133] op_sel_hi:[1,0,1]
  v_pk_mul_f32 v[132:133], v[132:133], v[172:173]
  v_pk_fma_f32 v[134:135], v[170:171], v[20:21], v[134:135] op_sel_hi:[1,0,1]
  v_pk_mul_f32 v[134:135], v[134:135], v[174:175]
  v_cvt_pk_bf16_f32 v132, v132, v133
  v_cvt_pk_bf16_f32 v133, v134, v135
  s_nop 1
  ds_write_b64 v251, v[132:133] offset:8704
L_e3v:
  s_nop 0
  v_accvgpr_read_b32 v20, a244
  v_accvgpr_read_b32 v24, a248
  v_accvgpr_read_b32 v32, a252
  v_accvgpr_read_b32 v21, a245
  v_accvgpr_read_b32 v25, a249
  v_accvgpr_read_b32 v33, a253
  buffer_load_dwordx4 a[108:111], v241, s[32:35], s87 offen offset:2048 sc1
  v_accvgpr_read_b32 v22, a246
  v_accvgpr_read_b32 v26, a250
  v_accvgpr_read_b32 v34, a254
  v_accvgpr_read_b32 v23, a247
  v_accvgpr_read_b32 v27, a251
  v_accvgpr_read_b32 v35, a255
  s_or_b32 s48, s22, s36
  s_cmp_eq_u32 s48, 0
  s_cselect_b32 s66, -1, 0
  s_cselect_b32 s67, -1, 0
  v_mov_b32 v36, 0xf149f2ca
  v_cndmask_b32_e64 v28, v20, v36, s[66:67]
  buffer_load_dwordx4 a[112:115], v241, s[32:35], s87 offen offset:3072 sc1
  v_cndmask_b32_e64 v29, v21, v36, s[66:67]
  v_cndmask_b32_e64 v30, v22, v36, s[66:67]
  v_cndmask_b32_e64 v31, v23, v36, s[66:67]
  v_mul_f32 v37, 0x3ea52b5c, v244
  v_mul_f32 v38, 0x3ea52b5c, v246
  s_mov_b32 s58, 0xffff
  s_mov_b32 s59, 0
  s_mov_b32 s60, -1
  s_mov_b32 s61, 0
  buffer_load_dwordx4 a[116:119], v245, s[32:35], s87 offen sc1
  s_mov_b32 s62, -1
  s_mov_b32 s63, 0xffff
  v_mfma_f32_16x16x32_bf16 v[80:83], v[180:183], v[60:63], v[20:23]
  v_mfma_f32_16x16x32_bf16 v[96:99], v[190:193], v[60:63], v[24:27]
  v_mfma_f32_16x16x32_bf16 v[84:87], v[182:185], v[64:67], v[20:23]
  v_mfma_f32_16x16x32_bf16 v[100:103], v[192:195], v[64:67], v[24:27]
  v_mfma_f32_16x16x32_bf16 v[88:91], v[184:187], v[68:71], v[20:23]
  v_mfma_f32_16x16x32_bf16 v[104:107], v[194:197], v[68:71], v[24:27]
  v_mfma_f32_16x16x32_bf16 v[92:95], v[186:189], v[72:75], v[20:23]
  v_mfma_f32_16x16x32_bf16 v[108:111], v[196:199], v[72:75], v[24:27]
  s_mul_i32 s87, s15, 5
  s_add_u32 s87, s87, s83
  buffer_load_dwordx4 a[120:123], v241, s[32:35], s87 offen offset:0 sc1
  v_max3_f32 v48, v80, v81, v96
  v_max3_f32 v49, v82, v83, v98
  v_max_f32 v48, v48, v97
  v_max_f32 v49, v49, v99
  v_max_f32_e64 v56, v48, v49
  v_max3_f32 v50, v84, v85, v100
  v_max3_f32 v51, v86, v87, v102
  v_max_f32 v50, v50, v101
  v_max_f32 v51, v51, v103
  buffer_load_dwordx4 a[124:127], v241, s[32:35], s87 offen offset:1024 sc1
  v_max_f32_e64 v57, v50, v51
  v_max3_f32 v52, v88, v89, v104
  v_max3_f32 v53, v90, v91, v106
  v_max_f32 v52, v52, v105
  v_max_f32 v53, v53, v107
  v_max_f32_e64 v58, v52, v53
  v_max3_f32 v54, v92, v93, v108
  v_max3_f32 v55, v94, v95, v110
  v_max_f32_e64 v54, v54, v109
  buffer_load_dwordx4 a[128:131], v241, s[32:35], s87 offen offset:2048 sc1
  v_max_f32 v55, v55, v111
  v_max_f32 v59, v54, v55
  v_permlane32_swap_b32 v56, v57
  s_nop 0
  v_permlane32_swap_b32 v58, v59
  v_max_f32 v56, v56, v57
  v_max_f32 v58, v58, v59
  s_nop 1
  v_permlane16_swap_b32 v56, v58
  v_max_f32 v56, v56, v58
  v_mov_b32_e64 v58, v56
  s_nop 1
  v_permlane16_swap_b32 v56, v58
  buffer_load_dwordx4 a[132:135], v241, s[32:35], s87 offen offset:3072 sc1
  v_mov_b32 v57, v56
  v_mov_b32 v59, v58
  s_nop 0
  v_permlane32_swap_b32 v56, v57
  v_permlane32_swap_b32 v58, v59
  v_mul_f32 v56, v56, v38
  v_mul_f32 v57, v57, v38
  v_mul_f32 v58, v58, v38
  v_mul_f32_e64 v59, v59, v38
  v_fma_f32 v48, v48, v38, -v56
  buffer_load_dwordx4 a[136:139], v245, s[32:35], s87 offen sc1
  v_fma_f32 v49, v49, v38, -v56
  v_fma_f32 v50, v50, v38, -v57
  v_fma_f32 v51, v51, v38, -v57
  v_fma_f32 v52, v52, v38, -v58
  v_fma_f32 v53, v53, v38, -v58
  v_fma_f32 v54, v54, v38, -v59
  v_fma_f32 v55, v55, v38, -v59
  v_exp_f32 v48, v48
  v_exp_f32 v49, v49
  v_exp_f32_e64 v50, v50
  s_mul_i32 s87, s18, 5
  s_add_u32 s87, s87, s83
  buffer_load_dwordx4 a[140:143], v241, s[32:35], s87 offen offset:0 sc1
  v_exp_f32 v51, v51
  v_exp_f32 v52, v52
  v_exp_f32 v53, v53
  v_exp_f32 v54, v54
  v_exp_f32_e64 v55, v55
  v_cvt_pk_bf16_f32 v48, v48, v49
  v_cvt_pk_bf16_f32 v50, v50, v51
  v_cvt_pk_bf16_f32 v52, v52, v53
  v_cvt_pk_bf16_f32 v54, v54, v55
  buffer_load_dwordx4 a[144:147], v241, s[32:35], s87 offen offset:1024 sc1
  v_perm_b32 v112, v48, v48, v32
  v_perm_b32 v113, v48, v48, v33
  v_perm_b32 v114, v48, v48, v34
  v_perm_b32 v115, v48, v48, v35
  v_perm_b32 v116, v50, v50, v32
  v_perm_b32 v117, v50, v50, v33
  v_perm_b32 v118, v50, v50, v34
  v_perm_b32 v119, v50, v50, v35
  v_perm_b32 v120, v52, v52, v32
  buffer_load_dwordx4 a[148:151], v241, s[32:35], s87 offen offset:2048 sc1
  v_perm_b32 v121, v52, v52, v33
  v_perm_b32 v122, v52, v52, v34
  v_perm_b32 v123, v52, v52, v35
  v_perm_b32 v124, v54, v54, v32
  v_perm_b32 v125, v54, v54, v33
  v_perm_b32 v126, v54, v54, v34
  v_perm_b32 v127, v54, v54, v35
  v_mfma_f32_16x16x32_bf16 v[128:131], a[240:243], v[112:115], 0
  v_mfma_f32_16x16x32_bf16 v[132:135], a[240:243], v[116:119], 0
  v_mfma_f32_16x16x32_bf16 v[40:43], a[240:243], v[120:123], 0
  buffer_load_dwordx4 a[152:155], v241, s[32:35], s87 offen offset:3072 sc1
  v_mfma_f32_16x16x32_bf16 v[44:47], a[240:243], v[124:127], 0
  v_mfma_f32_16x16x32_bf16 v[80:83], v[212:215], v[112:115], 0
  v_mfma_f32_16x16x32_bf16 v[84:87], v[218:221], v[112:115], 0
  v_mfma_f32_16x16x32_bf16 v[88:91], v[218:221], v[116:119], 0
  v_mfma_f32_16x16x32_bf16 v[92:95], v[224:227], v[116:119], 0
  v_mfma_f32_16x16x32_bf16 v[96:99], v[224:227], v[120:123], 0
  v_mfma_f32_16x16x32_bf16 v[100:103], v[230:233], v[120:123], 0
  v_mfma_f32_16x16x32_bf16 v[104:107], v[230:233], v[124:127], 0
  v_mfma_f32_16x16x32_bf16 v[108:111], v[236:239], v[124:127], 0
  buffer_load_dwordx4 a[156:159], v245, s[32:35], s87 offen sc1
  v_rcp_f32 v128, v128
  v_rcp_f32 v132, v132
  v_rcp_f32 v40, v40
  v_rcp_f32 v44, v44
  v_mul_f32 v128, v128, v249
  v_mul_f32 v132, v132, v249
  v_mul_f32 v40, v40, v249
  v_mul_f32 v44, v44, v249
  v_cndmask_b32_e64 v60, v132, v128, s[58:59]
  v_cndmask_b32_e64 v62, v40, v132, s[60:61]
  s_mul_i32 s87, s19, 5
  s_add_u32 s87, s87, s83
  buffer_load_dwordx4 a[160:163], v241, s[32:35], s87 offen offset:0 sc1
  v_cndmask_b32_e64 v64, v44, v40, s[62:63]
  v_cndmask_b32_e64 v88, v88, v84, s[58:59]
  v_cndmask_b32_e64 v89, v89, v85, s[58:59]
  v_cndmask_b32_e64 v90, v90, v86, s[58:59]
  v_cndmask_b32_e64 v91, v91, v87, s[58:59]
  v_cndmask_b32_e64 v96, v96, v92, s[60:61]
  v_cndmask_b32_e64 v97, v97, v93, s[60:61]
  v_cndmask_b32_e64 v98, v98, v94, s[60:61]
  v_cndmask_b32_e64 v99, v99, v95, s[60:61]
  buffer_load_dwordx4 a[164:167], v241, s[32:35], s87 offen offset:1024 sc1
  v_cndmask_b32_e64 v104, v104, v100, s[62:63]
  v_cndmask_b32_e64 v105, v105, v101, s[62:63]
  v_cndmask_b32_e64 v106, v106, v102, s[62:63]
  v_cndmask_b32_e64 v107, v107, v103, s[62:63]
  v_pk_mul_f32 v[80:81], v[80:81], v[128:129] op_sel_hi:[1,0]
  v_pk_mul_f32 v[82:83], v[82:83], v[128:129] op_sel_hi:[1,0]
  v_cvt_pk_bf16_f32 v112, v80, v81
  v_cvt_pk_bf16_f32 v113, v82, v83
  v_pk_mul_f32 v[88:89], v[88:89], v[60:61] op_sel_hi:[1,0]
  buffer_load_dwordx4 a[168:171], v241, s[32:35], s87 offen offset:2048 sc1
  v_pk_mul_f32 v[90:91], v[90:91], v[60:61] op_sel_hi:[1,0]
  v_cvt_pk_bf16_f32 v114, v88, v89
  v_cvt_pk_bf16_f32 v115, v90, v91
  v_pk_mul_f32 v[96:97], v[96:97], v[62:63] op_sel_hi:[1,0]
  v_pk_mul_f32 v[98:99], v[98:99], v[62:63] op_sel_hi:[1,0]
  v_cvt_pk_bf16_f32 v116, v96, v97
  v_cvt_pk_bf16_f32 v117, v98, v99
  v_pk_mul_f32 v[104:105], v[104:105], v[64:65] op_sel_hi:[1,0]
  v_pk_mul_f32 v[106:107], v[106:107], v[64:65] op_sel_hi:[1,0]
  v_cvt_pk_bf16_f32 v118, v104, v105
  buffer_load_dwordx4 a[172:175], v241, s[32:35], s87 offen offset:3072 sc1
  v_cvt_pk_bf16_f32 v119, v106, v107
  v_pk_mul_f32 v[108:109], v[108:109], v[44:45] op_sel_hi:[1,0]
  v_pk_mul_f32 v[110:111], v[110:111], v[44:45] op_sel_hi:[1,0]
  v_cvt_pk_bf16_f32 v120, v108, v109
  v_cvt_pk_bf16_f32 v121, v110, v111
  s_lshl_b32 s46, s36, 1
  s_lshr_b32 s47, s22, 1
  s_add_u32 s46, s46, s47
  s_mul_i32 s46, s46, 303104
  buffer_load_dwordx4 a[176:179], v245, s[32:35], s87 offen sc1
  s_and_b32 s47, s22, 1
  s_lshl_b32 s47, s47, 11
  s_add_u32 s46, s46, s47
  s_add_u32 s46, s46, 1024
  s_lshr_b32 s47, s37, 1
  s_mul_i32 s47, s47, 5
  s_and_b32 s48, s37, 1
  s_lshl_b32 s49, s48, 1
  s_add_u32 s49, s49, s47
  s_lshl_b32 s49, s49, 12
  s_mul_i32 s87, s22, 5120
  s_add_u32 s87, s87, s83
  s_add_u32 s87, s87, 0
  buffer_load_dwordx4 a[180:183], v241, s[32:35], s87 offen offset:0 sc1
  s_add_u32 s49, s49, s46
  buffer_store_dwordx4 v[112:115], v241, s[32:35], s49 offen sc1
  s_add_u32 s49, s49, 4096
  buffer_store_dwordx4 v[116:119], v241, s[32:35], s49 offen sc1
  s_add_u32 s47, s47, 4
  s_lshl_b32 s47, s47, 12
  s_add_u32 s47, s47, s46
  s_lshl_b32 s48, s48, 3
  s_add_u32 s47, s47, s48
  buffer_load_dwordx4 a[184:187], v241, s[32:35], s87 offen offset:1024 sc1
  buffer_store_dwordx2 v[120:121], v241, s[32:35], s47 offen sc1
  s_waitcnt lgkmcnt(0)
  s_barrier
  ds_read_b64 v[200:201], v254 offset:4096
  ds_read_b64 v[210:211], v254 offset:6656
  ds_read_b64 v[202:203], v254 offset:4608
  ds_read_b64 v[216:217], v254 offset:7168
  ds_read_b64 v[204:205], v254 offset:5120
  ds_read_b64 v[222:223], v254 offset:7680
  ds_read_b64 v[206:207], v254 offset:5632
  ds_read_b64 v[228:229], v254 offset:8192
  buffer_load_dwordx4 a[188:191], v241, s[32:35], s87 offen offset:2048 sc1
  ds_read_b64 v[208:209], v254 offset:6144
  ds_read_b64 v[234:235], v254 offset:8704
  s_waitcnt lgkmcnt(7)
  v_mfma_f32_16x16x32_bf16 v[80:83], v[200:203], v[0:3], v[28:31]
  v_mfma_f32_16x16x32_bf16 v[96:99], v[180:183], v[0:3], v[24:27]
  s_waitcnt lgkmcnt(5)
  v_mfma_f32_16x16x32_bf16 v[84:87], v[202:205], v[4:7], v[28:31]
  v_mfma_f32_16x16x32_bf16 v[100:103], v[182:185], v[4:7], v[24:27]
  s_waitcnt lgkmcnt(3)
  v_mfma_f32_16x16x32_bf16 v[88:91], v[204:207], v[8:11], v[28:31]
  v_mfma_f32_16x16x32_bf16 v[104:107], v[184:187], v[8:11], v[24:27]
  s_waitcnt lgkmcnt(1)
  v_mfma_f32_16x16x32_bf16 v[92:95], v[206:209], v[12:15], v[28:31]
  v_mfma_f32_16x16x32_bf16 v[108:111], v[186:189], v[12:15], v[24:27]
  buffer_load_dwordx4 a[192:195], v241, s[32:35], s87 offen offset:3072 sc1
  v_max3_f32 v48, v80, v81, v96
  v_max3_f32 v49, v82, v83, v98
  v_max_f32 v48, v48, v97
  v_max_f32 v49, v49, v99
  v_max_f32_e64 v56, v48, v49
  v_max3_f32 v50, v84, v85, v100
  v_max3_f32 v51, v86, v87, v102
  v_max_f32 v50, v50, v101
  v_max_f32 v51, v51, v103
  buffer_load_dwordx4 a[196:199], v245, s[32:35], s87 offen sc1
  v_max_f32_e64 v57, v50, v51
  v_max3_f32 v52, v88, v89, v104
  v_max3_f32 v53, v90, v91, v106
  v_max_f32 v52, v52, v105
  v_max_f32 v53, v53, v107
  v_max_f32_e64 v58, v52, v53
  v_max3_f32 v54, v92, v93, v108
  v_max3_f32 v55, v94, v95, v110
  v_max_f32 v54, v54, v109
  v_max_f32 v55, v55, v111
  s_mul_i32 s87, s22, 5120
  s_add_u32 s87, s87, s83
  s_add_u32 s87, s87, 20480
  buffer_load_dwordx4 a[200:203], v241, s[32:35], s87 offen offset:0 sc1
  v_max_f32 v59, v54, v55
  v_permlane32_swap_b32 v56, v57
  s_nop 0
  v_permlane32_swap_b32 v58, v59
  v_max_f32 v56, v56, v57
  v_max_f32 v58, v58, v59
  s_nop 1
  v_permlane16_swap_b32 v56, v58
  v_max_f32 v56, v56, v58
  v_mov_b32_e64 v58, v56
  s_nop 1
  v_permlane16_swap_b32 v56, v58
  buffer_load_dwordx4 a[204:207], v241, s[32:35], s87 offen offset:1024 sc1
  v_mov_b32 v57, v56
  v_mov_b32 v59, v58
  s_nop 0
  v_permlane32_swap_b32 v56, v57
  v_permlane32_swap_b32 v58, v59
  v_mul_f32 v56, v56, v37
  v_mul_f32 v57, v57, v37
  v_mul_f32 v58, v58, v37
  v_mul_f32_e64 v59, v59, v37
  v_fma_f32 v48, v48, v37, -v56
  buffer_load_dwordx4 a[208:211], v241, s[32:35], s87 offen offset:2048 sc1
  v_fma_f32 v49, v49, v37, -v56
  v_fma_f32 v50, v50, v37, -v57
  v_fma_f32 v51, v51, v37, -v57
  v_fma_f32 v52, v52, v37, -v58
  v_fma_f32 v53, v53, v37, -v58
  v_fma_f32 v54, v54, v37, -v59
  v_fma_f32 v55, v55, v37, -v59
  v_exp_f32 v48, v48
  v_exp_f32 v49, v49
  v_exp_f32_e64 v50, v50
  buffer_load_dwordx4 a[212:215], v241, s[32:35], s87 offen offset:3072 sc1
  v_exp_f32 v51, v51
  v_exp_f32 v52, v52
  v_exp_f32 v53, v53
  v_exp_f32 v54, v54
  v_exp_f32_e64 v55, v55
  v_cvt_pk_bf16_f32 v48, v48, v49
  v_cvt_pk_bf16_f32 v50, v50, v51
  v_cvt_pk_bf16_f32 v52, v52, v53
  v_cvt_pk_bf16_f32 v54, v54, v55
  buffer_load_dwordx4 a[216:219], v245, s[32:35], s87 offen sc1
  v_perm_b32 v112, v48, v48, v32
  v_perm_b32 v113, v48, v48, v33
  v_perm_b32 v114, v48, v48, v34
  v_perm_b32 v115, v48, v48, v35
  v_perm_b32 v116, v50, v50, v32
  v_lshlrev_b32_e64 v243, 2, v255
  buffer_load_dword v243, v243, s[32:35], s45 offen sc1
  v_perm_b32 v117, v50, v50, v33
  v_perm_b32 v118, v50, v50, v34
  v_perm_b32 v119, v50, v50, v35
  s_mul_i32 s87, s22, 5120
  s_add_u32 s87, s87, s83
  s_add_u32 s87, s87, 40960
  buffer_load_dwordx4 a[220:223], v241, s[32:35], s87 offen offset:0 sc1
  s_nop 0
  v_perm_b32 v120, v52, v52, v32
  v_perm_b32 v121, v52, v52, v33
  v_perm_b32 v122, v52, v52, v34
  v_perm_b32 v123, v52, v52, v35
  v_perm_b32 v124, v54, v54, v32
  v_perm_b32 v125, v54, v54, v33
  v_perm_b32 v126, v54, v54, v34
  v_perm_b32 v127, v54, v54, v35
  v_mfma_f32_16x16x32_bf16 v[128:131], a[240:243], v[112:115], 0
  buffer_load_dwordx4 a[224:227], v241, s[32:35], s87 offen offset:1024 sc1
  v_mfma_f32_16x16x32_bf16 v[132:135], a[240:243], v[116:119], 0
  v_mfma_f32_16x16x32_bf16 v[40:43], a[240:243], v[120:123], 0
  v_mfma_f32_16x16x32_bf16 v[44:47], a[240:243], v[124:127], 0
  v_mfma_f32_16x16x32_bf16 v[80:83], v[210:213], v[112:115], 0
  v_mfma_f32_16x16x32_bf16 v[84:87], v[216:219], v[112:115], 0
  v_mfma_f32_16x16x32_bf16 v[88:91], v[216:219], v[116:119], 0
  v_mfma_f32_16x16x32_bf16 v[92:95], v[222:225], v[116:119], 0
  v_mfma_f32_16x16x32_bf16 v[96:99], v[222:225], v[120:123], 0
  v_mfma_f32_16x16x32_bf16 v[100:103], v[228:231], v[120:123], 0
  buffer_load_dwordx4 a[228:231], v241, s[32:35], s87 offen offset:2048 sc1
  v_mfma_f32_16x16x32_bf16 v[104:107], v[228:231], v[124:127], 0
  s_waitcnt lgkmcnt(0)
  v_mfma_f32_16x16x32_bf16 v[108:111], v[234:237], v[124:127], 0
  v_rcp_f32 v128, v128
  v_rcp_f32 v132, v132
  v_rcp_f32 v40, v40
  v_rcp_f32 v44, v44
  v_mul_f32 v128, v128, v248
  v_mul_f32 v132, v132, v248
  v_mul_f32 v40, v40, v248
  v_mul_f32_e64 v44, v44, v248
  buffer_load_dwordx4 a[232:235], v241, s[32:35], s87 offen offset:3072 sc1
  v_cndmask_b32_e64 v60, v132, v128, s[58:59]
  v_cndmask_b32_e64 v62, v40, v132, s[60:61]
  v_cndmask_b32_e64 v64, v44, v40, s[62:63]
  v_cndmask_b32_e64 v88, v88, v84, s[58:59]
  v_cndmask_b32_e64 v89, v89, v85, s[58:59]
  v_cndmask_b32_e64 v90, v90, v86, s[58:59]
  v_cndmask_b32_e64 v91, v91, v87, s[58:59]
  v_cndmask_b32_e64 v96, v96, v92, s[60:61]
  v_cndmask_b32_e64 v97, v97, v93, s[60:61]
  buffer_load_dwordx4 a[236:239], v245, s[32:35], s87 offen sc1
  v_cndmask_b32_e64 v98, v98, v94, s[60:61]
  v_cndmask_b32_e64 v99, v99, v95, s[60:61]
  v_cndmask_b32_e64 v104, v104, v100, s[62:63]
  v_cndmask_b32_e64 v105, v105, v101, s[62:63]
  v_cndmask_b32_e64 v106, v106, v102, s[62:63]
  v_cndmask_b32_e64 v107, v107, v103, s[62:63]
  v_pk_mul_f32 v[80:81], v[80:81], v[128:129] op_sel_hi:[1,0]
  v_pk_mul_f32 v[82:83], v[82:83], v[128:129] op_sel_hi:[1,0]
  v_cvt_pk_bf16_f32 v112, v80, v81
  v_cvt_pk_bf16_f32 v113, v82, v83
  v_pk_mul_f32 v[88:89], v[88:89], v[60:61] op_sel_hi:[1,0]
  v_pk_mul_f32 v[90:91], v[90:91], v[60:61] op_sel_hi:[1,0]
  v_cvt_pk_bf16_f32 v114, v88, v89
  v_cvt_pk_bf16_f32 v115, v90, v91
  v_pk_mul_f32 v[96:97], v[96:97], v[62:63] op_sel_hi:[1,0]
  v_pk_mul_f32 v[98:99], v[98:99], v[62:63] op_sel_hi:[1,0]
  v_cvt_pk_bf16_f32 v116, v96, v97
  v_cvt_pk_bf16_f32 v117, v98, v99
  v_pk_mul_f32 v[104:105], v[104:105], v[64:65] op_sel_hi:[1,0]
  v_pk_mul_f32 v[106:107], v[106:107], v[64:65] op_sel_hi:[1,0]
  v_cvt_pk_bf16_f32 v118, v104, v105
  v_cvt_pk_bf16_f32 v119, v106, v107
  v_pk_mul_f32 v[108:109], v[108:109], v[44:45] op_sel_hi:[1,0]
  v_pk_mul_f32 v[110:111], v[110:111], v[44:45] op_sel_hi:[1,0]
  v_cvt_pk_bf16_f32 v120, v108, v109
  v_cvt_pk_bf16_f32 v121, v110, v111
  s_lshl_b32 s46, s36, 1
  s_lshr_b32 s47, s22, 1
  s_add_u32 s46, s46, s47
  s_mul_i32 s46, s46, 303104
  s_and_b32 s47, s22, 1
  s_lshl_b32 s47, s47, 11
  s_add_u32 s46, s46, s47
  s_add_u32 s46, s46, 0
  s_lshr_b32 s47, s37, 1
  s_mul_i32 s47, s47, 5
  s_and_b32 s48, s37, 1
  s_lshl_b32 s49, s48, 1
  s_add_u32 s49, s49, s47
  s_lshl_b32 s49, s49, 12
  s_add_u32 s49, s49, s46
  buffer_store_dwordx4 v[112:115], v241, s[32:35], s49 offen sc1
  s_add_u32 s49, s49, 4096
  buffer_store_dwordx4 v[116:119], v241, s[32:35], s49 offen sc1
  s_add_u32 s47, s47, 4
  s_lshl_b32 s47, s47, 12
  s_add_u32 s47, s47, s46
  s_lshl_b32 s48, s48, 3
  s_add_u32 s47, s47, s48
  buffer_store_dwordx2 v[120:121], v241, s[32:35], s47 offen sc1
  s_mov_b32 s100, 0
  s_add_u32 s46, s22, 0
  s_and_b32 s46, s46, 3
  s_lshl_b32 s46, s46, 10
  v_add_u32 v244, s46, v241
  s_add_u32 s46, s22, 1
  s_and_b32 s46, s46, 3
  s_lshl_b32 s46, s46, 10
  v_add_u32 v246, s46, v241
  s_add_u32 s46, s22, 2
  s_and_b32 s46, s46, 3
  s_lshl_b32 s46, s46, 10
  v_add_u32 v248, s46, v241
  s_add_u32 s46, s22, 3
  s_and_b32 s46, s46, 3
  s_lshl_b32 s46, s46, 10
  v_add_u32_e64 v249, s46, v241
  s_waitcnt vmcnt(8)
  v_cmp_eq_u32 vcc, s23, v243
  s_nop 3
  s_and_b32 s46, vcc_lo, 0x7f
  s_cmp_eq_u32 s46, 0x7f
  s_cbranch_scc1 L_att_fast
  s_mov_b32 s47, 0
  v_lshlrev_b32_e64 v251, 2, v255
L_spin_attf:
  buffer_load_dword v250, v251, s[32:35], s45 offen sc1
  s_waitcnt vmcnt(0)
  v_cmp_eq_u32 vcc, s23, v250
  s_nop 3
  s_and_b32 s46, vcc_lo, 0x7f
  s_cmp_eq_u32 s46, 0x7f
  s_cbranch_scc1 L_ok_attf
  s_sleep 8
  s_add_u32 s47, s47, 1
  s_cmp_lt_u32 s47, 200000
  s_cbranch_scc1 L_spin_attf
L_ok_attf:
L_att_fast:
  s_lshl_b32 s90, s4, 2
  s_add_u32 s90, s90, s84
  buffer_load_dwordx4 v[80:83], v244, s[32:35], s90 offen sc1
  buffer_load_dwordx4 v[84:87], v246, s[32:35], s90 offen sc1
  buffer_load_dwordx4 v[88:91], v248, s[32:35], s90 offen sc1
  buffer_load_dwordx4 v[92:95], v249, s[32:35], s90 offen sc1
  s_lshl_b32 s90, s5, 2
  s_add_u32 s90, s90, s84
  buffer_load_dwordx4 v[96:99], v244, s[32:35], s90 offen sc1
  buffer_load_dwordx4 v[100:103], v246, s[32:35], s90 offen sc1
  buffer_load_dwordx4 v[104:107], v248, s[32:35], s90 offen sc1
  buffer_load_dwordx4 v[108:111], v249, s[32:35], s90 offen sc1
  s_lshl_b32 s90, s6, 2
  s_add_u32 s90, s90, s84
  buffer_load_dwordx4 v[112:115], v244, s[32:35], s90 offen sc1
  buffer_load_dwordx4 v[116:119], v246, s[32:35], s90 offen sc1
  buffer_load_dwordx4 v[120:123], v248, s[32:35], s90 offen sc1
  buffer_load_dwordx4 v[124:127], v249, s[32:35], s90 offen sc1
  s_lshl_b32 s90, s7, 2
  s_add_u32 s90, s90, s84
  buffer_load_dwordx4 v[128:131], v244, s[32:35], s90 offen sc1
  buffer_load_dwordx4 v[132:135], v246, s[32:35], s90 offen sc1
  buffer_load_dwordx4 v[136:139], v248, s[32:35], s90 offen sc1
  buffer_load_dwordx4 v[140:143], v249, s[32:35], s90 offen sc1
  s_lshl_b32 s90, s8, 2
  s_add_u32 s90, s90, s84
  buffer_load_dwordx4 v[144:147], v244, s[32:35], s90 offen sc1
  buffer_load_dwordx4 v[148:151], v246, s[32:35], s90 offen sc1
  buffer_load_dwordx4 v[152:155], v248, s[32:35], s90 offen sc1
  buffer_load_dwordx4 v[156:159], v249, s[32:35], s90 offen sc1
  s_lshl_b32 s90, s9, 2
  s_add_u32 s90, s90, s84
  buffer_load_dwordx4 v[160:163], v244, s[32:35], s90 offen sc1
  buffer_load_dwordx4 v[164:167], v246, s[32:35], s90 offen sc1
  buffer_load_dwordx4 v[168:171], v248, s[32:35], s90 offen sc1
  buffer_load_dwordx4 v[172:175], v249, s[32:35], s90 offen sc1
  s_branch L_ph2_main_A
L_ffn_0:
  v_lshlrev_b32 v241, 4, v255
  s_lshl_b32 s46, s22, 6
  v_add_u32_e64 v1, s46, v255
  v_mul_u32_u24 v2, 3277, v1
  v_lshrrev_b32 v2, 16, v2
  v_mul_u32_u24 v3, 20, v2
  v_sub_u32_e64 v3, v1, v3
  v_mul_u32_u24 v4, 1280, v2
  v_lshl_add_u32 v200, v3, 4, v4
  v_lshrrev_b32 v203, 4, v2
  v_add_u32 v1, s46, v255
  v_add_u32 v1, 256, v1
  v_mul_u32_u24 v2, 3277, v1
  v_lshrrev_b32 v2, 16, v2
  v_mul_u32_u24 v3, 20, v2
  v_sub_u32_e64 v3, v1, v3
  v_mul_u32_u24 v4, 1280, v2
  v_lshl_add_u32 v201, v3, 4, v4
  v_lshrrev_b32 v204, 4, v2
  v_add_u32 v1, s46, v255
  v_add_u32 v1, 512, v1
  v_mul_u32_u24 v2, 3277, v1
  v_lshrrev_b32 v2, 16, v2
  v_mul_u32_u24 v3, 20, v2
  v_sub_u32_e64 v3, v1, v3
  v_mul_u32_u24 v4, 1280, v2
  v_lshl_add_u32 v202, v3, 4, v4
  v_lshrrev_b32 v205, 4, v2
  v_mov_b32 v5, 0x40000000
  v_cmp_le_u32 vcc, 640, v1
  s_nop 1
  v_cndmask_b32_e64 v202, v202, v5, vcc
  v_cndmask_b32_e64 v205, v205, 0, vcc
  v_and_b32 v1, 15, v255
  v_lshrrev_b32 v2, 2, v1
  v_and_b32 v3, 3, v1
  v_lshrrev_b32_e64 v4, 4, v255
  v_lshl_add_u32 v2, v4, 2, v2
  v_mul_u32_u24 v2, 320, v2
  s_add_u32 s46, s22, 0
  s_cmp_ge_u32 s46, 5
  s_cselect_b32 s47, 1, 0
  s_mul_i32 s48, s47, 5
  s_sub_u32 s48, s46, s48
  s_lshr_b32 s49, s48, 1
  s_lshl_b32 s49, s49, 6
  s_and_b32 s90, s48, 1
  s_lshl_b32 s90, s90, 3
  s_add_u32 s49, s49, s90
  s_mul_i32 s90, s47, 160
  s_add_u32 s49, s49, s90
  s_cmp_eq_u32 s48, 4
  s_cselect_b32 s90, 3, 4
  v_lshlrev_b32 v5, s90, v3
  v_add3_u32 v206, v5, v2, s49
  s_mul_i32 s64, s47, 378880
  s_lshl_b32 s90, s48, 10
  s_add_u32 s64, s64, s90
  s_cmp_ge_u32 s46, 10
  s_cselect_b32 s64, 0x40000000, s64
  s_add_u32 s46, s22, 4
  s_cmp_ge_u32 s46, 5
  s_cselect_b32 s47, 1, 0
  s_mul_i32 s48, s47, 5
  s_sub_u32 s48, s46, s48
  s_lshr_b32 s49, s48, 1
  s_lshl_b32 s49, s49, 6
  s_and_b32 s90, s48, 1
  s_lshl_b32 s90, s90, 3
  s_add_u32 s49, s49, s90
  s_mul_i32 s90, s47, 160
  s_add_u32 s49, s49, s90
  s_cmp_eq_u32 s48, 4
  s_cselect_b32 s90, 3, 4
  v_lshlrev_b32 v5, s90, v3
  v_add3_u32 v207, v5, v2, s49
  s_mul_i32 s65, s47, 378880
  s_lshl_b32 s90, s48, 10
  s_add_u32 s65, s65, s90
  s_cmp_ge_u32 s46, 10
  s_cselect_b32 s65, 0x40000000, s65
  s_add_u32 s46, s22, 8
  s_cmp_ge_u32 s46, 5
  s_cselect_b32 s47, 1, 0
  s_mul_i32 s48, s47, 5
  s_sub_u32 s48, s46, s48
  s_lshr_b32 s49, s48, 1
  s_lshl_b32 s49, s49, 6
  s_and_b32 s90, s48, 1
  s_lshl_b32 s90, s90, 3
  s_add_u32 s49, s49, s90
  s_mul_i32 s90, s47, 160
  s_add_u32 s49, s49, s90
  s_cmp_eq_u32 s48, 4
  s_cselect_b32 s90, 3, 4
  v_lshlrev_b32 v5, s90, v3
  v_add3_u32 v208, v5, v2, s49
  s_mul_i32 s66, s47, 378880
  s_lshl_b32 s90, s48, 10
  s_add_u32 s66, s66, s90
  s_cmp_ge_u32 s46, 10
  s_cselect_b32 s66, 0x40000000, s66
  s_mov_b32 s69, 819200
  s_mov_b32 s70, 2211840
  s_mov_b32 s67, 147456
  v_and_b32 v1, 15, v255
  v_lshrrev_b32 v2, 2, v1
  v_and_b32 v3, 3, v1
  v_lshrrev_b32 v4, 4, v255
  v_lshl_add_u32 v2, v4, 2, v2
  v_lshrrev_b32 v5, 1, v2
  v_and_b32 v5, 3, v5
  v_lshlrev_b32_e64 v2, 7, v2
  v_lshl_add_u32 v2, v3, 3, v2
  v_add_u32 v2, 16384, v2
  v_xor_b32_e64 v6, 0, v5
  v_lshl_add_u32 v160, v6, 5, v2
  v_xor_b32_e64 v6, 1, v5
  v_lshl_add_u32 v161, v6, 5, v2
  v_xor_b32_e64 v6, 2, v5
  v_lshl_add_u32 v162, v6, 5, v2
  v_xor_b32_e64 v6, 3, v5
  v_lshl_add_u32 v163, v6, 5, v2
  v_and_b32 v1, 15, v255
  v_lshrrev_b32 v4, 4, v255
  v_lshrrev_b32 v2, 1, v1
  v_xor_b32 v2, v2, v4
  v_lshlrev_b32_e64 v2, 4, v2
  v_lshl_add_u32 v2, v1, 7, v2
  v_add_u32 v164, 0, v2
  v_xor_b32 v2, 64, v2
  v_add_u32 v165, 0, v2
  s_add_u32 s90, s92, 0
  v_add_u32_e64 v169, s90, v166
  s_add_u32 s90, s92, 9216
  v_add_u32_e64 v170, s90, v167
  s_add_u32 s90, s92, 18432
  v_add_u32_e64 v171, s90, v166
  s_add_u32 s90, s92, 27648
  v_add_u32 v172, s90, v167
  v_add_u32 v173, 0, v168
  v_add_u32 v174, 54272, v168
  v_add_u32 v175, 11776, v168
  v_add_u32 v176, 66048, v168
  v_add_u32 v177, 110592, v168
  v_add_u32 v178, 164864, v168
  v_add_u32 v179, 122368, v168
  v_add_u32 v180, 176640, v168
  v_mov_b32 v232, 0
  v_mov_b32 v233, 0
  v_mov_b32 v234, 0
  v_mov_b32_e64 v235, 0
  s_nop 1
  v_mfma_f32_32x32x16_bf16 v[0:15], v[232:235], v[232:235], 0
  v_mfma_f32_32x32x16_bf16 v[16:31], v[232:235], v[232:235], 0
  v_mfma_f32_32x32x16_bf16 v[32:47], v[232:235], v[232:235], 0
  v_mfma_f32_32x32x16_bf16 v[48:63], v[232:235], v[232:235], 0
  v_mfma_f32_32x32x16_bf16 v[64:79], v[232:235], v[232:235], 0
  v_mfma_f32_32x32x16_bf16 v[80:95], v[232:235], v[232:235], 0
  v_mfma_f32_32x32x16_bf16 v[96:111], v[232:235], v[232:235], 0
  v_mfma_f32_32x32x16_bf16 v[112:127], v[232:235], v[232:235], 0
  v_mfma_f32_32x32x16_bf16 v[128:143], v[232:235], v[232:235], 0
  v_mov_b32 v254, 0x3f803f80
  v_accvgpr_write_b32 a240, v254
  v_accvgpr_write_b32 a241, v254
  v_accvgpr_write_b32 a242, v254
  v_accvgpr_write_b32 a243, v254
  v_mov_b32 v249, 0
  s_lshl_b32 s39, s38, 7
  s_mul_i32 s40, s38, 221184
  s_mov_b32 s41, 49152
  s_add_u32 m0, s41, 0
  s_nop 0
  buffer_load_dwordx4 v169, s[24:27], s39 offen offset:0 lds
  buffer_load_dwordx4 v170, s[24:27], s39 offen offset:1024 lds
  buffer_load_dwordx4 v171, s[24:27], s39 offen offset:2048 lds
  buffer_load_dwordx4 v172, s[24:27], s39 offen offset:3072 lds
  s_add_u32 m0, s41, 16384
  s_nop 0
  buffer_load_dwordx4 v173, s[28:31], s40 offen offset:0 lds
  buffer_load_dwordx4 v174, s[28:31], s40 offen offset:1024 lds
  buffer_load_dwordx4 v175, s[28:31], s40 offen offset:2048 lds
  buffer_load_dwordx4 v176, s[28:31], s40 offen offset:3072 lds
  s_add_u32 m0, s41, 20480
  s_nop 0
  buffer_load_dwordx4 v177, s[28:31], s40 offen offset:0 lds
  buffer_load_dwordx4 v178, s[28:31], s40 offen offset:1024 lds
  buffer_load_dwordx4 v179, s[28:31], s40 offen offset:2048 lds
  buffer_load_dwordx4 v180, s[28:31], s40 offen offset:3072 lds
  s_add_u32 s38, s38, 1
  s_cmp_eq_u32 s38, 10
  s_cselect_b32 s38, 0, s38
  s_lshr_b32 s46, s68, 2
  s_and_b32 s47, s68, 3
  s_mul_i32 s48, s46, 52
  s_lshr_b32 s48, s48, 8
  s_mul_i32 s49, s48, 5
  s_sub_u32 s49, s46, s49
  s_mul_i32 s48, s48, 160
  s_lshl_b32 s90, s49, 5
  s_cmp_ge_u32 s49, 2
  s_cselect_b32 s91, 16, 0
  s_add_u32 s90, s90, s91
  s_cmp_eq_u32 s49, 4
  s_cselect_b32 s90, 64, s90
  s_cselect_b32 s91, 81920, 0
  s_add_u32 s90, s90, s48
  s_sub_u32 s48, s46, 20
  s_lshl_b32 s48, s48, 5
  s_cmp_lt_u32 s46, 20
  s_cselect_b32 s90, s90, s48
  s_cselect_b32 s91, s91, 0
  s_cselect_b32 s60, s8, s14
  s_cselect_b32 s61, s9, s15
  s_cselect_b32 s62, s69, s70
  s_and_b32 s61, s61, 0xffff
  s_mov_b32 s63, 0x20000
  s_mul_i32 s90, s90, 1280
  s_mul_i32 s47, s47, 320
  s_add_u32 s90, s90, s47
  s_cmp_ge_u32 s68, 296
  s_cselect_b32 s90, 0x7f000000, s90
  s_lshl_b32 s46, s22, 10
  s_add_u32 s46, s46, s67
  v_mad_u32_u24 v210, v203, s91, v200
  s_add_u32 m0, s46, 0
  s_nop 0
  buffer_load_dwordx4 v210, s[60:63], s90 offen lds
  v_mad_u32_u24 v211, v204, s91, v201
  s_add_u32 m0, s46, 4096
  s_nop 0
  buffer_load_dwordx4 v211, s[60:63], s90 offen lds
  v_mad_u32_u24 v212, v205, s91, v202
  s_add_u32 s47, s46, 8192
  s_cmp_ge_u32 s22, 2
  s_cselect_b32 m0, 161792, s47
  s_nop 0
  buffer_load_dwordx4 v212, s[60:63], s90 offen lds
  s_and_b32 s46, s2, 7
  s_lshr_b32 s47, s2, 3
  s_lshr_b32 s80, s47, 3
  s_lshl_b32 s46, s46, 2
  s_add_u32 s80, s80, s46
  s_and_b32 s81, s47, 7
  s_lshr_b32 s89, s80, 1
  s_lshl_b32 s89, s89, 2
  s_mul_i32 s83, s81, 378880
  s_add_u32 s83, s83, 10485760
  s_mul_i32 s84, s80, 303104
  s_mul_i32 s85, s22, 12288
  s_add_u32 s85, s85, 49152
  s_mul_i32 s86, s22, 13312
  s_add_u32 s86, s86, 98304
  s_mul_i32 s46, s81, 7
  s_lshr_b32 s46, s46, 2
  s_and_b32 s47, s80, 3
  s_mul_i32 s47, s47, 7
  s_lshr_b32 s47, s47, 1
  s_add_u32 s46, s46, s47
  s_sub_u32 s47, s46, 14
  s_cmp_ge_u32 s46, 14
  s_cselect_b32 s46, s47, s46
  s_lshl_b32 s46, s46, 2
  s_add_u32 s46, s46, s22
  s_add_u32 s46, s46, 20
  s_lshl_b32 s4, s46, 10
  s_cmp_ge_u32 s46, 74
  s_cselect_b32 s4, 0x10000000, s4
  s_add_u32 s46, s46, 4
  s_sub_u32 s47, s46, 56
  s_cmp_ge_u32 s46, 76
  s_cselect_b32 s46, s47, s46
  s_lshl_b32 s5, s46, 10
  s_cmp_ge_u32 s46, 74
  s_cselect_b32 s5, 0x10000000, s5
  s_add_u32 s46, s46, 4
  s_sub_u32 s47, s46, 56
  s_cmp_ge_u32 s46, 76
  s_cselect_b32 s46, s47, s46
  s_lshl_b32 s6, s46, 10
  s_cmp_ge_u32 s46, 74
  s_cselect_b32 s6, 0x10000000, s6
  s_add_u32 s46, s46, 4
  s_sub_u32 s47, s46, 56
  s_cmp_ge_u32 s46, 76
  s_cselect_b32 s46, s47, s46
  s_lshl_b32 s7, s46, 10
  s_cmp_ge_u32 s46, 74
  s_cselect_b32 s7, 0x10000000, s7
  s_add_u32 s46, s46, 4
  s_sub_u32 s47, s46, 56
  s_cmp_ge_u32 s46, 76
  s_cselect_b32 s46, s47, s46
  s_lshl_b32 s8, s46, 10
  s_cmp_ge_u32 s46, 74
  s_cselect_b32 s8, 0x10000000, s8
  s_add_u32 s46, s46, 4
  s_sub_u32 s47, s46, 56
  s_cmp_ge_u32 s46, 76
  s_cselect_b32 s46, s47, s46
  s_lshl_b32 s9, s46, 10
  s_cmp_ge_u32 s46, 74
  s_cselect_b32 s9, 0x10000000, s9
  s_add_u32 s46, s46, 4
  s_sub_u32 s47, s46, 56
  s_cmp_ge_u32 s46, 76
  s_cselect_b32 s46, s47, s46
  s_lshl_b32 s10, s46, 10
  s_cmp_ge_u32 s46, 74
  s_cselect_b32 s10, 0x10000000, s10
  s_add_u32 s46, s46, 4
  s_sub_u32 s47, s46, 56
  s_cmp_ge_u32 s46, 76
  s_cselect_b32 s46, s47, s46
  s_lshl_b32 s11, s46, 10
  s_cmp_ge_u32 s46, 74
  s_cselect_b32 s11, 0x10000000, s11
  s_add_u32 s46, s46, 4
  s_sub_u32 s47, s46, 56
  s_cmp_ge_u32 s46, 76
  s_cselect_b32 s46, s47, s46
  s_lshl_b32 s12, s46, 10
  s_cmp_ge_u32 s46, 74
  s_cselect_b32 s12, 0x10000000, s12
  s_add_u32 s46, s46, 4
  s_sub_u32 s47, s46, 56
  s_cmp_ge_u32 s46, 76
  s_cselect_b32 s46, s47, s46
  s_lshl_b32 s13, s46, 10
  s_cmp_ge_u32 s46, 74
  s_cselect_b32 s13, 0x10000000, s13
  s_add_u32 s46, s46, 4
  s_sub_u32 s47, s46, 56
  s_cmp_ge_u32 s46, 76
  s_cselect_b32 s46, s47, s46
  s_lshl_b32 s14, s46, 10
  s_cmp_ge_u32 s46, 74
  s_cselect_b32 s14, 0x10000000, s14
  s_add_u32 s46, s46, 4
  s_sub_u32 s47, s46, 56
  s_cmp_ge_u32 s46, 76
  s_cselect_b32 s46, s47, s46
  s_lshl_b32 s15, s46, 10
  s_cmp_ge_u32 s46, 74
  s_cselect_b32 s15, 0x10000000, s15
  s_add_u32 s46, s46, 4
  s_sub_u32 s47, s46, 56
  s_cmp_ge_u32 s46, 76
  s_cselect_b32 s46, s47, s46
  s_lshl_b32 s18, s46, 10
  s_cmp_ge_u32 s46, 74
  s_cselect_b32 s18, 0x10000000, s18
  s_add_u32 s46, s46, 4
  s_sub_u32 s47, s46, 56
  s_cmp_ge_u32 s46, 76
  s_cselect_b32 s46, s47, s46
  s_lshl_b32 s19, s46, 10
  s_cmp_ge_u32 s46, 74
  s_cselect_b32 s19, 0x10000000, s19
  v_add_u32 v245, 4096, v241
  s_lshl_b32 s45, s2, 7
  s_add_u32 s45, s45, 15728640
  s_lshl_b32 s39, s38, 7
  s_mul_i32 s40, s38, 221184
  s_mov_b32 s41, 98304
  s_mov_b32 s94, 49152
  s_mov_b32 s95, 4294868992
  s_mov_b32 s43, 0
  s_waitcnt vmcnt(15) lgkmcnt(0)
  s_barrier
  ds_read_b128 a[40:43], v164 offset:0
  ds_read_b128 a[44:47], v164 offset:2048
  ds_read_b128 a[48:51], v164 offset:4096
  ds_read_b128 a[52:55], v164 offset:6144
  ds_read_b64_tr_b16 a[0:1], v160 offset:0
  ds_read_b64_tr_b16 a[2:3], v160 offset:2048
  ds_read_b64_tr_b16 a[4:5], v161 offset:0
  ds_read_b64_tr_b16 a[6:7], v161 offset:2048
  ds_read_b64_tr_b16 a[8:9], v162 offset:0
  ds_read_b64_tr_b16 a[10:11], v162 offset:2048
  ds_read_b64_tr_b16 a[12:13], v163 offset:0
  ds_read_b64_tr_b16 a[14:15], v163 offset:2048
L_loop_ffn_0:
  ds_read_b64_tr_b16 a[16:17], v160 offset:8192
  s_waitcnt lgkmcnt(5)
  v_mfma_f32_16x16x32_bf16 v[0:3], a[0:3], a[40:43], v[0:3]
  ds_read_b64_tr_b16 a[18:19], v160 offset:10240
  v_mfma_f32_16x16x32_bf16 v[32:35], a[0:3], a[44:47], v[32:35]
  s_cmp_lg_u32 s43, 7
  s_cbranch_scc0 L_pp_ffn_0
L_np_ffn_0:
  s_cmp_lg_u32 s43, 1
  s_cbranch_scc0 L_pu_ffn_0
L_nu_ffn_0:
  s_cmp_lg_u32 s43, 2
  s_cbranch_scc0 L_ps_ffn_0
L_ns_ffn_0:
  v_mfma_f32_16x16x32_bf16 v[64:67], a[0:3], a[48:51], v[64:67]
  v_mfma_f32_16x16x32_bf16 v[96:99], a[0:3], a[52:55], v[96:99]
  v_mfma_f32_16x16x32_bf16 v[128:131], a[0:3], a[240:243], v[128:131]
  s_add_u32 m0, s41, 0
  ds_read_b64_tr_b16 a[20:21], v161 offset:8192
  v_mfma_f32_16x16x32_bf16 v[4:7], a[4:7], a[40:43], v[4:7]
  ds_read_b64_tr_b16 a[22:23], v161 offset:10240
  v_mfma_f32_16x16x32_bf16 v[36:39], a[4:7], a[44:47], v[36:39]
  v_mfma_f32_16x16x32_bf16 v[68:71], a[4:7], a[48:51], v[68:71]
  v_mfma_f32_16x16x32_bf16 v[100:103], a[4:7], a[52:55], v[100:103]
  buffer_load_dwordx4 v169, s[24:27], s39 offen offset:0 lds
  v_mfma_f32_16x16x32_bf16 v[132:135], a[4:7], a[240:243], v[132:135]
  ds_read_b64_tr_b16 a[24:25], v162 offset:8192
  ds_read_b64_tr_b16 a[26:27], v162 offset:10240
  s_waitcnt lgkmcnt(6)
  v_mfma_f32_16x16x32_bf16 v[8:11], a[8:11], a[40:43], v[8:11]
  ds_read_b128 a[56:59], v165 offset:0
  v_mfma_f32_16x16x32_bf16 v[40:43], a[8:11], a[44:47], v[40:43]
  ds_read_b128 a[60:63], v165 offset:2048
  v_mfma_f32_16x16x32_bf16 v[72:75], a[8:11], a[48:51], v[72:75]
  buffer_load_dwordx4 v170, s[24:27], s39 offen offset:1024 lds
  ds_read_b128 a[64:67], v165 offset:4096
  v_mfma_f32_16x16x32_bf16 v[104:107], a[8:11], a[52:55], v[104:107]
  ds_read_b128 a[68:71], v165 offset:6144
  v_mfma_f32_16x16x32_bf16 v[136:139], a[8:11], a[240:243], v[136:139]
  ds_read_b64_tr_b16 a[28:29], v163 offset:8192
  v_mfma_f32_16x16x32_bf16 v[12:15], a[12:15], a[40:43], v[12:15]
  ds_read_b64_tr_b16 a[30:31], v163 offset:10240
  v_mfma_f32_16x16x32_bf16 v[44:47], a[12:15], a[44:47], v[44:47]
  buffer_load_dwordx4 v171, s[24:27], s39 offen offset:2048 lds
  v_mfma_f32_16x16x32_bf16 v[76:79], a[12:15], a[48:51], v[76:79]
  v_mfma_f32_16x16x32_bf16 v[108:111], a[12:15], a[52:55], v[108:111]
  v_mfma_f32_16x16x32_bf16 v[140:143], a[12:15], a[240:243], v[140:143]
  ds_read_b64_tr_b16 a[0:1], v160 offset:4096
  s_waitcnt lgkmcnt(9)
  v_mfma_f32_16x16x32_bf16 v[16:19], a[16:19], a[40:43], v[16:19]
  buffer_load_dwordx4 v172, s[24:27], s39 offen offset:3072 lds
  s_add_u32 m0, s41, 16384
  ds_read_b64_tr_b16 a[2:3], v160 offset:6144
  v_mfma_f32_16x16x32_bf16 v[48:51], a[16:19], a[44:47], v[48:51]
  v_mfma_f32_16x16x32_bf16 v[80:83], a[16:19], a[48:51], v[80:83]
  v_mfma_f32_16x16x32_bf16 v[112:115], a[16:19], a[52:55], v[112:115]
  ds_read_b64_tr_b16 a[4:5], v161 offset:4096
  v_mfma_f32_16x16x32_bf16 v[20:23], a[20:23], a[40:43], v[20:23]
  buffer_load_dwordx4 v173, s[28:31], s40 offen offset:0 lds
  ds_read_b64_tr_b16 a[6:7], v161 offset:6144
  v_mfma_f32_16x16x32_bf16 v[52:55], a[20:23], a[44:47], v[52:55]
  v_mfma_f32_16x16x32_bf16 v[84:87], a[20:23], a[48:51], v[84:87]
  v_mfma_f32_16x16x32_bf16 v[116:119], a[20:23], a[52:55], v[116:119]
  ds_read_b64_tr_b16 a[8:9], v162 offset:4096
  s_waitcnt lgkmcnt(9)
  v_mfma_f32_16x16x32_bf16 v[24:27], a[24:27], a[40:43], v[24:27]
  buffer_load_dwordx4 v174, s[28:31], s40 offen offset:1024 lds
  ds_read_b64_tr_b16 a[10:11], v162 offset:6144
  v_mfma_f32_16x16x32_bf16 v[56:59], a[24:27], a[44:47], v[56:59]
  v_mfma_f32_16x16x32_bf16 v[88:91], a[24:27], a[48:51], v[88:91]
  v_mfma_f32_16x16x32_bf16 v[120:123], a[24:27], a[52:55], v[120:123]
  buffer_load_dwordx4 v175, s[28:31], s40 offen offset:2048 lds
  ds_read_b64_tr_b16 a[12:13], v163 offset:4096
  s_waitcnt lgkmcnt(5)
  v_mfma_f32_16x16x32_bf16 v[28:31], a[28:31], a[40:43], v[28:31]
  ds_read_b64_tr_b16 a[14:15], v163 offset:6144
  v_mfma_f32_16x16x32_bf16 v[60:63], a[28:31], a[44:47], v[60:63]
  v_mfma_f32_16x16x32_bf16 v[92:95], a[28:31], a[48:51], v[92:95]
  v_mfma_f32_16x16x32_bf16 v[124:127], a[28:31], a[52:55], v[124:127]
  buffer_load_dwordx4 v176, s[28:31], s40 offen offset:3072 lds
  s_add_u32 m0, s41, 20480
  ds_read_b64_tr_b16 a[16:17], v160 offset:12288
  v_mfma_f32_16x16x32_bf16 v[0:3], a[0:3], a[56:59], v[0:3]
  ds_read_b64_tr_b16 a[18:19], v160 offset:14336
  v_mfma_f32_16x16x32_bf16 v[32:35], a[0:3], a[60:63], v[32:35]
  v_mfma_f32_16x16x32_bf16 v[64:67], a[0:3], a[64:67], v[64:67]
  v_mfma_f32_16x16x32_bf16 v[96:99], a[0:3], a[68:71], v[96:99]
  buffer_load_dwordx4 v177, s[28:31], s40 offen offset:0 lds
  v_mfma_f32_16x16x32_bf16 v[128:131], a[0:3], a[240:243], v[128:131]
  ds_read_b64_tr_b16 a[20:21], v161 offset:12288
  s_waitcnt lgkmcnt(5)
  v_mfma_f32_16x16x32_bf16 v[4:7], a[4:7], a[56:59], v[4:7]
  ds_read_b64_tr_b16 a[22:23], v161 offset:14336
  v_mfma_f32_16x16x32_bf16 v[36:39], a[4:7], a[60:63], v[36:39]
  v_mfma_f32_16x16x32_bf16 v[68:71], a[4:7], a[64:67], v[68:71]
  buffer_load_dwordx4 v178, s[28:31], s40 offen offset:1024 lds
  v_mfma_f32_16x16x32_bf16 v[100:103], a[4:7], a[68:71], v[100:103]
  v_mfma_f32_16x16x32_bf16 v[132:135], a[4:7], a[240:243], v[132:135]
  ds_read_b64_tr_b16 a[24:25], v162 offset:12288
  v_mfma_f32_16x16x32_bf16 v[8:11], a[8:11], a[56:59], v[8:11]
  ds_read_b64_tr_b16 a[26:27], v162 offset:14336
  v_mfma_f32_16x16x32_bf16 v[40:43], a[8:11], a[60:63], v[40:43]
  buffer_load_dwordx4 v179, s[28:31], s40 offen offset:2048 lds
  v_mfma_f32_16x16x32_bf16 v[72:75], a[8:11], a[64:67], v[72:75]
  v_mfma_f32_16x16x32_bf16 v[104:107], a[8:11], a[68:71], v[104:107]
  v_mfma_f32_16x16x32_bf16 v[136:139], a[8:11], a[240:243], v[136:139]
  ds_read_b64_tr_b16 a[28:29], v163 offset:12288
  s_waitcnt lgkmcnt(5)
  v_mfma_f32_16x16x32_bf16 v[12:15], a[12:15], a[56:59], v[12:15]
  buffer_load_dwordx4 v180, s[28:31], s40 offen offset:3072 lds
  ds_read_b64_tr_b16 a[30:31], v163 offset:14336
  v_mfma_f32_16x16x32_bf16 v[44:47], a[12:15], a[60:63], v[44:47]
  v_mfma_f32_16x16x32_bf16 v[76:79], a[12:15], a[64:67], v[76:79]
  v_mfma_f32_16x16x32_bf16 v[108:111], a[12:15], a[68:71], v[108:111]
  v_mfma_f32_16x16x32_bf16 v[140:143], a[12:15], a[240:243], v[140:143]
  v_mfma_f32_16x16x32_bf16 v[16:19], a[16:19], a[56:59], v[16:19]
  v_mfma_f32_16x16x32_bf16 v[48:51], a[16:19], a[60:63], v[48:51]
  v_mfma_f32_16x16x32_bf16 v[80:83], a[16:19], a[64:67], v[80:83]
  v_mfma_f32_16x16x32_bf16 v[112:115], a[16:19], a[68:71], v[112:115]
  s_waitcnt lgkmcnt(2)
  v_mfma_f32_16x16x32_bf16 v[20:23], a[20:23], a[56:59], v[20:23]
  v_mfma_f32_16x16x32_bf16 v[52:55], a[20:23], a[60:63], v[52:55]
  v_mfma_f32_16x16x32_bf16 v[84:87], a[20:23], a[64:67], v[84:87]
  v_mfma_f32_16x16x32_bf16 v[116:119], a[20:23], a[68:71], v[116:119]
  s_waitcnt vmcnt(12) lgkmcnt(0)
  s_barrier
  v_mfma_f32_16x16x32_bf16 v[24:27], a[24:27], a[56:59], v[24:27]
  s_cmp_eq_u32 s41, 49152
  s_cselect_b32 s42, s95, s94
  v_add_u32 v160, s42, v160
  v_add_u32 v161, s42, v161
  v_mfma_f32_16x16x32_bf16 v[56:59], a[24:27], a[60:63], v[56:59]
  v_add_u32 v162, s42, v162
  v_add_u32 v163, s42, v163
  v_add_u32 v164, s42, v164
  v_add_u32 v165, s42, v165
  v_mfma_f32_16x16x32_bf16 v[88:91], a[24:27], a[64:67], v[88:91]
  ds_read_b128 a[40:43], v164 offset:0
  ds_read_b128 a[44:47], v164 offset:2048
  ds_read_b128 a[48:51], v164 offset:4096
  ds_read_b128 a[52:55], v164 offset:6144
  v_mfma_f32_16x16x32_bf16 v[120:123], a[24:27], a[68:71], v[120:123]
  ds_read_b64_tr_b16 a[0:1], v160 offset:0
  ds_read_b64_tr_b16 a[2:3], v160 offset:2048
  ds_read_b64_tr_b16 a[4:5], v161 offset:0
  ds_read_b64_tr_b16 a[6:7], v161 offset:2048
  v_mfma_f32_16x16x32_bf16 v[28:31], a[28:31], a[56:59], v[28:31]
  ds_read_b64_tr_b16 a[8:9], v162 offset:0
  ds_read_b64_tr_b16 a[10:11], v162 offset:2048
  ds_read_b64_tr_b16 a[12:13], v163 offset:0
  ds_read_b64_tr_b16 a[14:15], v163 offset:2048
  v_mfma_f32_16x16x32_bf16 v[60:63], a[28:31], a[60:63], v[60:63]
  s_add_u32 s38, s38, 1
  s_cmp_eq_u32 s38, 10
  s_cselect_b32 s38, 0, s38
  s_lshl_b32 s39, s38, 7
  v_mfma_f32_16x16x32_bf16 v[92:95], a[28:31], a[64:67], v[92:95]
  s_mul_i32 s40, s38, 221184
  s_cmp_eq_u32 s41, 98304
  s_cselect_b32 s42, s95, s94
  s_add_u32 s41, s41, s42
  v_mfma_f32_16x16x32_bf16 v[124:127], a[28:31], a[68:71], v[124:127]
  s_add_u32 s43, s43, 1
  s_cmp_lt_u32 s43, 8
  s_cbranch_scc1 L_loop_ffn_0
  v_readfirstlane_b32 s23, v252
  s_nop 3
  s_cmp_lg_u32 s23, 0
  s_cbranch_scc1 L_nok_ffn_0
  s_mov_b32 s47, 0
  v_mov_b32_e64 v251, 0
L_nspin_ffn_0:
  buffer_load_dword v250, v251, s[76:79], 0 offen sc1
  s_waitcnt vmcnt(0)
  v_readfirstlane_b32 s23, v250
  s_nop 3
  s_cmp_lg_u32 s23, 0
  s_cbranch_scc1 L_nok_ffn_0
  s_sleep 8
  s_add_u32 s47, s47, 1
  s_cmp_lt_u32 s47, 200000
  s_cbranch_scc1 L_nspin_ffn_0
L_nok_ffn_0:
  v_readfirstlane_b32 s46, v253
  s_nop 3
  s_cmp_ge_u32 s46, 128
  s_cbranch_scc1 L_cok_p_ffn_0
  s_mov_b32 s47, 0
  v_mov_b32_e64 v251, 0
L_cspin_p_ffn_0:
  buffer_load_dword v250, v251, s[76:79], 0 offen offset:4 sc1
  s_waitcnt vmcnt(0)
  v_readfirstlane_b32 s46, v250
  s_nop 3
  s_cmp_ge_u32 s46, 128
  s_cbranch_scc1 L_cok_p_ffn_0
  s_sleep 40
  s_add_u32 s47, s47, 1
  s_cmp_lt_u32 s47, 200000
  s_cbranch_scc1 L_cspin_p_ffn_0
L_cok_p_ffn_0:
  ds_read_b64_tr_b16 a[16:17], v160 offset:8192
  s_waitcnt lgkmcnt(5)
  v_mfma_f32_16x16x32_bf16 v[0:3], a[0:3], a[40:43], v[0:3]
  ds_read_b64_tr_b16 a[18:19], v160 offset:10240
  v_mfma_f32_16x16x32_bf16 v[32:35], a[0:3], a[44:47], v[32:35]
  s_mul_i32 s87, s4, 5
  s_add_u32 s87, s87, s83
  s_add_u32 m0, s85, 0
  s_add_u32 s88, s87, 0
  buffer_load_dwordx4 v241, s[32:35], s88 offen sc1 lds
  v_mfma_f32_16x16x32_bf16 v[64:67], a[0:3], a[48:51], v[64:67]
  v_mfma_f32_16x16x32_bf16 v[96:99], a[0:3], a[52:55], v[96:99]
  v_mfma_f32_16x16x32_bf16 v[128:131], a[0:3], a[240:243], v[128:131]
  ds_read_b64_tr_b16 a[20:21], v161 offset:8192
  v_mfma_f32_16x16x32_bf16 v[4:7], a[4:7], a[40:43], v[4:7]
  s_add_u32 m0, s85, 1024
  s_add_u32 s88, s87, 1024
  buffer_load_dwordx4 v241, s[32:35], s88 offen sc1 lds
  ds_read_b64_tr_b16 a[22:23], v161 offset:10240
  v_mfma_f32_16x16x32_bf16 v[36:39], a[4:7], a[44:47], v[36:39]
  v_mfma_f32_16x16x32_bf16 v[68:71], a[4:7], a[48:51], v[68:71]
  v_mfma_f32_16x16x32_bf16 v[100:103], a[4:7], a[52:55], v[100:103]
  v_mfma_f32_16x16x32_bf16 v[132:135], a[4:7], a[240:243], v[132:135]
  ds_read_b64_tr_b16 a[24:25], v162 offset:8192
  ds_read_b64_tr_b16 a[26:27], v162 offset:10240
  s_waitcnt lgkmcnt(6)
  v_mfma_f32_16x16x32_bf16 v[8:11], a[8:11], a[40:43], v[8:11]
  s_add_u32 m0, s85, 2048
  s_add_u32 s88, s87, 2048
  buffer_load_dwordx4 v241, s[32:35], s88 offen sc1 lds
  ds_read_b128 a[56:59], v165 offset:0
  v_mfma_f32_16x16x32_bf16 v[40:43], a[8:11], a[44:47], v[40:43]
  ds_read_b128 a[60:63], v165 offset:2048
  v_mfma_f32_16x16x32_bf16 v[72:75], a[8:11], a[48:51], v[72:75]
  ds_read_b128 a[64:67], v165 offset:4096
  v_mfma_f32_16x16x32_bf16 v[104:107], a[8:11], a[52:55], v[104:107]
  ds_read_b128 a[68:71], v165 offset:6144
  v_mfma_f32_16x16x32_bf16 v[136:139], a[8:11], a[240:243], v[136:139]
  s_add_u32 m0, s85, 3072
  s_add_u32 s88, s87, 3072
  buffer_load_dwordx4 v241, s[32:35], s88 offen sc1 lds
  ds_read_b64_tr_b16 a[28:29], v163 offset:8192
  v_mfma_f32_16x16x32_bf16 v[12:15], a[12:15], a[40:43], v[12:15]
  ds_read_b64_tr_b16 a[30:31], v163 offset:10240
  v_mfma_f32_16x16x32_bf16 v[44:47], a[12:15], a[44:47], v[44:47]
  v_mfma_f32_16x16x32_bf16 v[76:79], a[12:15], a[48:51], v[76:79]
  v_mfma_f32_16x16x32_bf16 v[108:111], a[12:15], a[52:55], v[108:111]
  v_mfma_f32_16x16x32_bf16 v[140:143], a[12:15], a[240:243], v[140:143]
  s_add_u32 m0, s85, 4096
  s_add_u32 s88, s87, 4096
  buffer_load_dwordx4 v241, s[32:35], s88 offen sc1 lds
  ds_read_b64_tr_b16 a[0:1], v160 offset:4096
  s_waitcnt lgkmcnt(9)
  v_mfma_f32_16x16x32_bf16 v[16:19], a[16:19], a[40:43], v[16:19]
  ds_read_b64_tr_b16 a[2:3], v160 offset:6144
  v_mfma_f32_16x16x32_bf16 v[48:51], a[16:19], a[44:47], v[48:51]
  v_mfma_f32_16x16x32_bf16 v[80:83], a[16:19], a[48:51], v[80:83]
  v_mfma_f32_16x16x32_bf16 v[112:115], a[16:19], a[52:55], v[112:115]
  s_mul_i32 s87, s5, 5
  s_add_u32 s87, s87, s83
  s_add_u32 m0, s85, 5120
  s_add_u32 s88, s87, 0
  buffer_load_dwordx4 v241, s[32:35], s88 offen sc1 lds
  ds_read_b64_tr_b16 a[4:5], v161 offset:4096
  v_mfma_f32_16x16x32_bf16 v[20:23], a[20:23], a[40:43], v[20:23]
  ds_read_b64_tr_b16 a[6:7], v161 offset:6144
  v_mfma_f32_16x16x32_bf16 v[52:55], a[20:23], a[44:47], v[52:55]
  v_mfma_f32_16x16x32_bf16 v[84:87], a[20:23], a[48:51], v[84:87]
  v_mfma_f32_16x16x32_bf16 v[116:119], a[20:23], a[52:55], v[116:119]
  ds_read_b64_tr_b16 a[8:9], v162 offset:4096
  s_waitcnt lgkmcnt(9)
  v_mfma_f32_16x16x32_bf16 v[24:27], a[24:27], a[40:43], v[24:27]
  s_add_u32 m0, s85, 6144
  s_add_u32 s88, s87, 1024
  buffer_load_dwordx4 v241, s[32:35], s88 offen sc1 lds
  ds_read_b64_tr_b16 a[10:11], v162 offset:6144
  v_mfma_f32_16x16x32_bf16 v[56:59], a[24:27], a[44:47], v[56:59]
  v_mfma_f32_16x16x32_bf16 v[88:91], a[24:27], a[48:51], v[88:91]
  v_mfma_f32_16x16x32_bf16 v[120:123], a[24:27], a[52:55], v[120:123]
  ds_read_b64_tr_b16 a[12:13], v163 offset:4096
  s_waitcnt lgkmcnt(5)
  v_mfma_f32_16x16x32_bf16 v[28:31], a[28:31], a[40:43], v[28:31]
  s_add_u32 m0, s85, 7168
  s_add_u32 s88, s87, 2048
  buffer_load_dwordx4 v241, s[32:35], s88 offen sc1 lds
  ds_read_b64_tr_b16 a[14:15], v163 offset:6144
  v_mfma_f32_16x16x32_bf16 v[60:63], a[28:31], a[44:47], v[60:63]
  v_mfma_f32_16x16x32_bf16 v[92:95], a[28:31], a[48:51], v[92:95]
  v_mfma_f32_16x16x32_bf16 v[124:127], a[28:31], a[52:55], v[124:127]
  ds_read_b64_tr_b16 a[16:17], v160 offset:12288
  v_mfma_f32_16x16x32_bf16 v[0:3], a[0:3], a[56:59], v[0:3]
  ds_read_b64_tr_b16 a[18:19], v160 offset:14336
  v_mfma_f32_16x16x32_bf16 v[32:35], a[0:3], a[60:63], v[32:35]
  s_add_u32 m0, s85, 8192
  s_add_u32 s88, s87, 3072
  buffer_load_dwordx4 v241, s[32:35], s88 offen sc1 lds
  v_mfma_f32_16x16x32_bf16 v[64:67], a[0:3], a[64:67], v[64:67]
  v_mfma_f32_16x16x32_bf16 v[96:99], a[0:3], a[68:71], v[96:99]
  v_mfma_f32_16x16x32_bf16 v[128:131], a[0:3], a[240:243], v[128:131]
  ds_read_b64_tr_b16 a[20:21], v161 offset:12288
  s_waitcnt lgkmcnt(5)
  v_mfma_f32_16x16x32_bf16 v[4:7], a[4:7], a[56:59], v[4:7]
  s_add_u32 m0, s85, 9216
  s_add_u32 s88, s87, 4096
  buffer_load_dwordx4 v241, s[32:35], s88 offen sc1 lds
  ds_read_b64_tr_b16 a[22:23], v161 offset:14336
  v_mfma_f32_16x16x32_bf16 v[36:39], a[4:7], a[60:63], v[36:39]
  v_mfma_f32_16x16x32_bf16 v[68:71], a[4:7], a[64:67], v[68:71]
  v_mfma_f32_16x16x32_bf16 v[100:103], a[4:7], a[68:71], v[100:103]
  v_mfma_f32_16x16x32_bf16 v[132:135], a[4:7], a[240:243], v[132:135]
  ds_read_b64_tr_b16 a[24:25], v162 offset:12288
  v_mfma_f32_16x16x32_bf16 v[8:11], a[8:11], a[56:59], v[8:11]
  s_mul_i32 s87, s6, 5
  s_add_u32 s87, s87, s83
  s_add_u32 m0, s85, 10240
  s_add_u32 s88, s87, 0
  buffer_load_dwordx4 v241, s[32:35], s88 offen sc1 lds
  ds_read_b64_tr_b16 a[26:27], v162 offset:14336
  v_mfma_f32_16x16x32_bf16 v[40:43], a[8:11], a[60:63], v[40:43]
  v_mfma_f32_16x16x32_bf16 v[72:75], a[8:11], a[64:67], v[72:75]
  v_mfma_f32_16x16x32_bf16 v[104:107], a[8:11], a[68:71], v[104:107]
  v_mfma_f32_16x16x32_bf16 v[136:139], a[8:11], a[240:243], v[136:139]
  s_add_u32 m0, s85, 11264
  s_add_u32 s88, s87, 1024
  buffer_load_dwordx4 v241, s[32:35], s88 offen sc1 lds
  ds_read_b64_tr_b16 a[28:29], v163 offset:12288
  s_waitcnt lgkmcnt(5)
  v_mfma_f32_16x16x32_bf16 v[12:15], a[12:15], a[56:59], v[12:15]
  ds_read_b64_tr_b16 a[30:31], v163 offset:14336
  v_mfma_f32_16x16x32_bf16 v[44:47], a[12:15], a[60:63], v[44:47]
  v_mfma_f32_16x16x32_bf16 v[76:79], a[12:15], a[64:67], v[76:79]
  v_mfma_f32_16x16x32_bf16 v[108:111], a[12:15], a[68:71], v[108:111]
  v_mfma_f32_16x16x32_bf16 v[140:143], a[12:15], a[240:243], v[140:143]
  v_mfma_f32_16x16x32_bf16 v[16:19], a[16:19], a[56:59], v[16:19]
  v_mfma_f32_16x16x32_bf16 v[48:51], a[16:19], a[60:63], v[48:51]
  v_mfma_f32_16x16x32_bf16 v[80:83], a[16:19], a[64:67], v[80:83]
  v_mfma_f32_16x16x32_bf16 v[112:115], a[16:19], a[68:71], v[112:115]
  s_waitcnt lgkmcnt(2)
  v_mfma_f32_16x16x32_bf16 v[20:23], a[20:23], a[56:59], v[20:23]
  v_mfma_f32_16x16x32_bf16 v[52:55], a[20:23], a[60:63], v[52:55]
  v_mfma_f32_16x16x32_bf16 v[84:87], a[20:23], a[64:67], v[84:87]
  v_mfma_f32_16x16x32_bf16 v[116:119], a[20:23], a[68:71], v[116:119]
  s_waitcnt vmcnt(12) lgkmcnt(0)
  s_barrier
  v_mfma_f32_16x16x32_bf16 v[24:27], a[24:27], a[56:59], v[24:27]
  s_cmp_eq_u32 s41, 49152
  s_cselect_b32 s42, s95, s94
  v_add_u32_e64 v160, s42, v160
  v_mfma_f32_16x16x32_bf16 v[56:59], a[24:27], a[60:63], v[56:59]
  v_add_u32 v161, s42, v161
  v_add_u32 v162, s42, v162
  v_add_u32_e64 v163, s42, v163
  v_mfma_f32_16x16x32_bf16 v[88:91], a[24:27], a[64:67], v[88:91]
  v_add_u32 v164, s42, v164
  v_add_u32 v165, s42, v165
  ds_read_b128 a[40:43], v164 offset:0
  v_mfma_f32_16x16x32_bf16 v[120:123], a[24:27], a[68:71], v[120:123]
  ds_read_b128 a[44:47], v164 offset:2048
  ds_read_b128 a[48:51], v164 offset:4096
  ds_read_b128 a[52:55], v164 offset:6144
  v_mfma_f32_16x16x32_bf16 v[28:31], a[28:31], a[56:59], v[28:31]
  ds_read_b64_tr_b16 a[0:1], v160 offset:0
  ds_read_b64_tr_b16 a[2:3], v160 offset:2048
  ds_read_b64_tr_b16 a[4:5], v161 offset:0
  v_mfma_f32_16x16x32_bf16 v[60:63], a[28:31], a[60:63], v[60:63]
  ds_read_b64_tr_b16 a[6:7], v161 offset:2048
  ds_read_b64_tr_b16 a[8:9], v162 offset:0
  ds_read_b64_tr_b16 a[10:11], v162 offset:2048
  v_mfma_f32_16x16x32_bf16 v[92:95], a[28:31], a[64:67], v[92:95]
  ds_read_b64_tr_b16 a[12:13], v163 offset:0
  ds_read_b64_tr_b16 a[14:15], v163 offset:2048
  v_mfma_f32_16x16x32_bf16 v[124:127], a[28:31], a[68:71], v[124:127]
  v_and_b32 v251, 15, v255
  v_lshlrev_b32_e64 v251, 4, v251
  s_lshl_b32 s73, s36, 7
  s_add_u32 s73, s73, 0
  s_add_u32 s74, s73, 16
  s_add_u32 s75, s73, 32
  s_add_u32 s101, s73, 48
  ds_read_b64_tr_b16 a[16:17], v160 offset:8192
  s_waitcnt lgkmcnt(5)
  v_mfma_f32_16x16x32_bf16 v[0:3], a[0:3], a[40:43], v[0:3]
  ds_read_b64_tr_b16 a[18:19], v160 offset:10240
  v_mfma_f32_16x16x32_bf16 v[32:35], a[0:3], a[44:47], v[32:35]
  s_lshl_b32 s88, s73, 4
  s_add_u32 s88, s88, 14745600
  buffer_load_dwordx4 v[200:203], v251, s[32:35], s88 offen sc1
  v_mfma_f32_16x16x32_bf16 v[64:67], a[0:3], a[48:51], v[64:67]
  v_mfma_f32_16x16x32_bf16 v[96:99], a[0:3], a[52:55], v[96:99]
  v_mfma_f32_16x16x32_bf16 v[128:131], a[0:3], a[240:243], v[128:131]
  s_lshl_b32 s88, s74, 4
  s_add_u32 s88, s88, 14745600
  buffer_load_dwordx4 v[204:207], v251, s[32:35], s88 offen sc1
  ds_read_b64_tr_b16 a[20:21], v161 offset:8192
  v_mfma_f32_16x16x32_bf16 v[4:7], a[4:7], a[40:43], v[4:7]
  ds_read_b64_tr_b16 a[22:23], v161 offset:10240
  v_mfma_f32_16x16x32_bf16 v[36:39], a[4:7], a[44:47], v[36:39]
  v_mfma_f32_16x16x32_bf16 v[68:71], a[4:7], a[48:51], v[68:71]
  s_lshl_b32 s88, s75, 4
  s_add_u32 s88, s88, 14745600
  buffer_load_dwordx4 v[208:211], v251, s[32:35], s88 offen sc1
  v_mfma_f32_16x16x32_bf16 v[100:103], a[4:7], a[52:55], v[100:103]
  v_mfma_f32_16x16x32_bf16 v[132:135], a[4:7], a[240:243], v[132:135]
  ds_read_b64_tr_b16 a[24:25], v162 offset:8192
  ds_read_b64_tr_b16 a[26:27], v162 offset:10240
  s_waitcnt lgkmcnt(6)
  v_mfma_f32_16x16x32_bf16 v[8:11], a[8:11], a[40:43], v[8:11]
  s_lshl_b32 s88, s101, 4
  s_add_u32 s88, s88, 14745600
  buffer_load_dwordx4 v[212:215], v251, s[32:35], s88 offen sc1
  ds_read_b128 a[56:59], v165 offset:0
  v_mfma_f32_16x16x32_bf16 v[40:43], a[8:11], a[44:47], v[40:43]
  ds_read_b128 a[60:63], v165 offset:2048
  v_mfma_f32_16x16x32_bf16 v[72:75], a[8:11], a[48:51], v[72:75]
  ds_read_b128 a[64:67], v165 offset:4096
  v_mfma_f32_16x16x32_bf16 v[104:107], a[8:11], a[52:55], v[104:107]
  s_mul_i32 s87, s6, 5
  s_add_u32 s87, s87, s83
  s_add_u32 m0, s86, 0
  s_add_u32 s88, s87, 2048
  buffer_load_dwordx4 v241, s[32:35], s88 offen sc1 lds
  ds_read_b128 a[68:71], v165 offset:6144
  v_mfma_f32_16x16x32_bf16 v[136:139], a[8:11], a[240:243], v[136:139]
  ds_read_b64_tr_b16 a[28:29], v163 offset:8192
  v_mfma_f32_16x16x32_bf16 v[12:15], a[12:15], a[40:43], v[12:15]
  ds_read_b64_tr_b16 a[30:31], v163 offset:10240
  v_mfma_f32_16x16x32_bf16 v[44:47], a[12:15], a[44:47], v[44:47]
  s_add_u32 m0, s86, 1024
  s_add_u32 s88, s87, 3072
  buffer_load_dwordx4 v241, s[32:35], s88 offen sc1 lds
  v_mfma_f32_16x16x32_bf16 v[76:79], a[12:15], a[48:51], v[76:79]
  v_mfma_f32_16x16x32_bf16 v[108:111], a[12:15], a[52:55], v[108:111]
  v_mfma_f32_16x16x32_bf16 v[140:143], a[12:15], a[240:243], v[140:143]
  ds_read_b64_tr_b16 a[0:1], v160 offset:4096
  s_waitcnt lgkmcnt(9)
  v_mfma_f32_16x16x32_bf16 v[16:19], a[16:19], a[40:43], v[16:19]
  s_add_u32 m0, s86, 2048
  s_add_u32 s88, s87, 4096
  buffer_load_dwordx4 v241, s[32:35], s88 offen sc1 lds
  ds_read_b64_tr_b16 a[2:3], v160 offset:6144
  v_mfma_f32_16x16x32_bf16 v[48:51], a[16:19], a[44:47], v[48:51]
  v_mfma_f32_16x16x32_bf16 v[80:83], a[16:19], a[48:51], v[80:83]
  v_mfma_f32_16x16x32_bf16 v[112:115], a[16:19], a[52:55], v[112:115]
  s_mul_i32 s87, s7, 5
  s_add_u32 s87, s87, s83
  s_add_u32 m0, s86, 3072
  s_add_u32 s88, s87, 0
  buffer_load_dwordx4 v241, s[32:35], s88 offen sc1 lds
  ds_read_b64_tr_b16 a[4:5], v161 offset:4096
  v_mfma_f32_16x16x32_bf16 v[20:23], a[20:23], a[40:43], v[20:23]
  ds_read_b64_tr_b16 a[6:7], v161 offset:6144
  v_mfma_f32_16x16x32_bf16 v[52:55], a[20:23], a[44:47], v[52:55]
  v_mfma_f32_16x16x32_bf16 v[84:87], a[20:23], a[48:51], v[84:87]
  s_add_u32 m0, s86, 4096
  s_add_u32 s88, s87, 1024
  buffer_load_dwordx4 v241, s[32:35], s88 offen sc1 lds
  v_mfma_f32_16x16x32_bf16 v[116:119], a[20:23], a[52:55], v[116:119]
  ds_read_b64_tr_b16 a[8:9], v162 offset:4096
  s_waitcnt lgkmcnt(9)
  v_mfma_f32_16x16x32_bf16 v[24:27], a[24:27], a[40:43], v[24:27]
  ds_read_b64_tr_b16 a[10:11], v162 offset:6144
  v_mfma_f32_16x16x32_bf16 v[56:59], a[24:27], a[44:47], v[56:59]
  s_add_u32 m0, s86, 5120
  s_add_u32 s88, s87, 2048
  buffer_load_dwordx4 v241, s[32:35], s88 offen sc1 lds
  v_mfma_f32_16x16x32_bf16 v[88:91], a[24:27], a[48:51], v[88:91]
  v_mfma_f32_16x16x32_bf16 v[120:123], a[24:27], a[52:55], v[120:123]
  ds_read_b64_tr_b16 a[12:13], v163 offset:4096
  s_waitcnt lgkmcnt(5)
  v_mfma_f32_16x16x32_bf16 v[28:31], a[28:31], a[40:43], v[28:31]
  s_add_u32 m0, s86, 6144
  s_add_u32 s88, s87, 3072
  buffer_load_dwordx4 v241, s[32:35], s88 offen sc1 lds
  ds_read_b64_tr_b16 a[14:15], v163 offset:6144
  v_mfma_f32_16x16x32_bf16 v[60:63], a[28:31], a[44:47], v[60:63]
  v_mfma_f32_16x16x32_bf16 v[92:95], a[28:31], a[48:51], v[92:95]
  v_mfma_f32_16x16x32_bf16 v[124:127], a[28:31], a[52:55], v[124:127]
  s_add_u32 m0, s86, 7168
  s_add_u32 s88, s87, 4096
  buffer_load_dwordx4 v241, s[32:35], s88 offen sc1 lds
  ds_read_b64_tr_b16 a[16:17], v160 offset:12288
  v_mfma_f32_16x16x32_bf16 v[0:3], a[0:3], a[56:59], v[0:3]
  ds_read_b64_tr_b16 a[18:19], v160 offset:14336
  v_mfma_f32_16x16x32_bf16 v[32:35], a[0:3], a[60:63], v[32:35]
  v_mfma_f32_16x16x32_bf16 v[64:67], a[0:3], a[64:67], v[64:67]
  v_mfma_f32_16x16x32_bf16 v[96:99], a[0:3], a[68:71], v[96:99]
  s_mul_i32 s87, s8, 5
  s_add_u32 s87, s87, s83
  s_add_u32 m0, s86, 8192
  s_add_u32 s88, s87, 0
  buffer_load_dwordx4 v241, s[32:35], s88 offen sc1 lds
  v_mfma_f32_16x16x32_bf16 v[128:131], a[0:3], a[240:243], v[128:131]
  ds_read_b64_tr_b16 a[20:21], v161 offset:12288
  s_waitcnt lgkmcnt(5)
  v_mfma_f32_16x16x32_bf16 v[4:7], a[4:7], a[56:59], v[4:7]
  ds_read_b64_tr_b16 a[22:23], v161 offset:14336
  v_mfma_f32_16x16x32_bf16 v[36:39], a[4:7], a[60:63], v[36:39]
  s_add_u32 m0, s86, 9216
  s_add_u32 s88, s87, 1024
  buffer_load_dwordx4 v241, s[32:35], s88 offen sc1 lds
  v_mfma_f32_16x16x32_bf16 v[68:71], a[4:7], a[64:67], v[68:71]
  v_mfma_f32_16x16x32_bf16 v[100:103], a[4:7], a[68:71], v[100:103]
  v_mfma_f32_16x16x32_bf16 v[132:135], a[4:7], a[240:243], v[132:135]
  s_add_u32 m0, s86, 10240
  s_add_u32 s88, s87, 2048
  buffer_load_dwordx4 v241, s[32:35], s88 offen sc1 lds
  ds_read_b64_tr_b16 a[24:25], v162 offset:12288
  v_mfma_f32_16x16x32_bf16 v[8:11], a[8:11], a[56:59], v[8:11]
  ds_read_b64_tr_b16 a[26:27], v162 offset:14336
  v_mfma_f32_16x16x32_bf16 v[40:43], a[8:11], a[60:63], v[40:43]
  v_mfma_f32_16x16x32_bf16 v[72:75], a[8:11], a[64:67], v[72:75]
  s_add_u32 m0, s86, 11264
  s_add_u32 s88, s87, 3072
  buffer_load_dwordx4 v241, s[32:35], s88 offen sc1 lds
  v_mfma_f32_16x16x32_bf16 v[104:107], a[8:11], a[68:71], v[104:107]
  v_mfma_f32_16x16x32_bf16 v[136:139], a[8:11], a[240:243], v[136:139]
  ds_read_b64_tr_b16 a[28:29], v163 offset:12288
  s_waitcnt lgkmcnt(5)
  v_mfma_f32_16x16x32_bf16 v[12:15], a[12:15], a[56:59], v[12:15]
  s_add_u32 m0, s86, 12288
  s_add_u32 s88, s87, 4096
  buffer_load_dwordx4 v241, s[32:35], s88 offen sc1 lds
  ds_read_b64_tr_b16 a[30:31], v163 offset:14336
  v_mfma_f32_16x16x32_bf16 v[44:47], a[12:15], a[60:63], v[44:47]
  v_mfma_f32_16x16x32_bf16 v[76:79], a[12:15], a[64:67], v[76:79]
  v_mfma_f32_16x16x32_bf16 v[108:111], a[12:15], a[68:71], v[108:111]
  v_mfma_f32_16x16x32_bf16 v[140:143], a[12:15], a[240:243], v[140:143]
  v_mfma_f32_16x16x32_bf16 v[16:19], a[16:19], a[56:59], v[16:19]
  v_mfma_f32_16x16x32_bf16 v[48:51], a[16:19], a[60:63], v[48:51]
  v_mfma_f32_16x16x32_bf16 v[80:83], a[16:19], a[64:67], v[80:83]
  v_mfma_f32_16x16x32_bf16 v[112:115], a[16:19], a[68:71], v[112:115]
  s_waitcnt lgkmcnt(2)
  v_mfma_f32_16x16x32_bf16 v[20:23], a[20:23], a[56:59], v[20:23]
  v_mfma_f32_16x16x32_bf16 v[52:55], a[20:23], a[60:63], v[52:55]
  v_mfma_f32_16x16x32_bf16 v[84:87], a[20:23], a[64:67], v[84:87]
  v_mfma_f32_16x16x32_bf16 v[116:119], a[20:23], a[68:71], v[116:119]
  s_waitcnt lgkmcnt(0)
  s_barrier
  v_mfma_f32_16x16x32_bf16 v[24:27], a[24:27], a[56:59], v[24:27]
  v_mfma_f32_16x16x32_bf16 v[56:59], a[24:27], a[60:63], v[56:59]
  v_mfma_f32_16x16x32_bf16 v[88:91], a[24:27], a[64:67], v[88:91]
  v_mfma_f32_16x16x32_bf16 v[120:123], a[24:27], a[68:71], v[120:123]
  v_mfma_f32_16x16x32_bf16 v[28:31], a[28:31], a[56:59], v[28:31]
  v_mfma_f32_16x16x32_bf16 v[60:63], a[28:31], a[60:63], v[60:63]
  v_mfma_f32_16x16x32_bf16 v[92:95], a[28:31], a[64:67], v[92:95]
  v_mfma_f32_16x16x32_bf16 v[124:127], a[28:31], a[68:71], v[124:127]
  s_branch L_ep_ffn
L_pp_ffn_0:
  buffer_load_dwordx2 v[252:253], v249, s[76:79], 0 offen sc1
  s_branch L_np_ffn_0
L_pu_ffn_0:
  s_lshr_b32 s46, s68, 2
  s_and_b32 s47, s68, 3
  s_mul_i32 s46, s46, 5120
  s_mul_i32 s47, s47, 757760
  s_add_u32 s46, s46, s47
  s_add_u32 s46, s46, 10485760
  s_cmp_ge_u32 s68, 296
  s_cselect_b32 s46, 0x30000000, s46
  v_add_u32_e64 v213, s67, v206
  ds_read_b64_tr_b16 v[216:217], v213
  ds_read_b64_tr_b16 v[218:219], v213 offset:5120
  v_add_u32_e64 v214, s67, v207
  ds_read_b64_tr_b16 v[220:221], v214
  ds_read_b64_tr_b16 v[222:223], v214 offset:5120
  v_add_u32_e64 v215, s67, v208
  ds_read_b64_tr_b16 v[224:225], v215
  ds_read_b64_tr_b16 v[226:227], v215 offset:5120
  s_add_u32 s47, s46, s64
  s_waitcnt lgkmcnt(0)
  buffer_store_dwordx4 v[216:219], v241, s[32:35], s47 offen sc1
  s_add_u32 s47, s46, s65
  s_waitcnt lgkmcnt(0)
  buffer_store_dwordx4 v[220:223], v241, s[32:35], s47 offen sc1
  s_add_u32 s47, s46, s66
  s_waitcnt lgkmcnt(0)
  buffer_store_dwordx4 v[224:227], v241, s[32:35], s47 offen sc1
  s_branch L_nu_ffn_0
L_ps_ffn_0:
  v_mov_b32 v250, 1
  v_mov_b32_e64 v251, 0
  s_mov_b32 exec_lo, 1
  s_mov_b32 exec_hi, 0
  buffer_atomic_add v250, v251, s[76:79], 0 offen offset:4 sc1
  s_mov_b64 exec, -1
  s_branch L_ns_ffn_0
L_ffn_1:
  v_lshlrev_b32 v241, 4, v255
  s_lshl_b32 s46, s22, 6
  v_add_u32_e64 v1, s46, v255
  v_mul_u32_u24 v2, 3277, v1
  v_lshrrev_b32 v2, 16, v2
  v_mul_u32_u24 v3, 20, v2
  v_sub_u32_e64 v3, v1, v3
  v_mul_u32_u24 v4, 1280, v2
  v_lshl_add_u32 v200, v3, 4, v4
  v_lshrrev_b32 v203, 4, v2
  v_add_u32 v1, s46, v255
  v_add_u32 v1, 256, v1
  v_mul_u32_u24 v2, 3277, v1
  v_lshrrev_b32 v2, 16, v2
  v_mul_u32_u24 v3, 20, v2
  v_sub_u32_e64 v3, v1, v3
  v_mul_u32_u24 v4, 1280, v2
  v_lshl_add_u32 v201, v3, 4, v4
  v_lshrrev_b32 v204, 4, v2
  v_add_u32 v1, s46, v255
  v_add_u32 v1, 512, v1
  v_mul_u32_u24 v2, 3277, v1
  v_lshrrev_b32 v2, 16, v2
  v_mul_u32_u24 v3, 20, v2
  v_sub_u32_e64 v3, v1, v3
  v_mul_u32_u24 v4, 1280, v2
  v_lshl_add_u32 v202, v3, 4, v4
  v_lshrrev_b32 v205, 4, v2
  v_mov_b32 v5, 0x40000000
  v_cmp_le_u32 vcc, 640, v1
  s_nop 1
  v_cndmask_b32_e64 v202, v202, v5, vcc
  v_cndmask_b32_e64 v205, v205, 0, vcc
  v_and_b32 v1, 15, v255
  v_lshrrev_b32 v2, 2, v1
  v_and_b32 v3, 3, v1
  v_lshrrev_b32_e64 v4, 4, v255
  v_lshl_add_u32 v2, v4, 2, v2
  v_mul_u32_u24 v2, 320, v2
  s_add_u32 s46, s22, 0
  s_cmp_ge_u32 s46, 5
  s_cselect_b32 s47, 1, 0
  s_mul_i32 s48, s47, 5
  s_sub_u32 s48, s46, s48
  s_lshr_b32 s49, s48, 1
  s_lshl_b32 s49, s49, 6
  s_and_b32 s90, s48, 1
  s_lshl_b32 s90, s90, 3
  s_add_u32 s49, s49, s90
  s_mul_i32 s90, s47, 160
  s_add_u32 s49, s49, s90
  s_cmp_eq_u32 s48, 4
  s_cselect_b32 s90, 3, 4
  v_lshlrev_b32 v5, s90, v3
  v_add3_u32 v206, v5, v2, s49
  s_mul_i32 s64, s47, 378880
  s_lshl_b32 s90, s48, 10
  s_add_u32 s64, s64, s90
  s_cmp_ge_u32 s46, 10
  s_cselect_b32 s64, 0x40000000, s64
  s_add_u32 s46, s22, 4
  s_cmp_ge_u32 s46, 5
  s_cselect_b32 s47, 1, 0
  s_mul_i32 s48, s47, 5
  s_sub_u32 s48, s46, s48
  s_lshr_b32 s49, s48, 1
  s_lshl_b32 s49, s49, 6
  s_and_b32 s90, s48, 1
  s_lshl_b32 s90, s90, 3
  s_add_u32 s49, s49, s90
  s_mul_i32 s90, s47, 160
  s_add_u32 s49, s49, s90
  s_cmp_eq_u32 s48, 4
  s_cselect_b32 s90, 3, 4
  v_lshlrev_b32 v5, s90, v3
  v_add3_u32 v207, v5, v2, s49
  s_mul_i32 s65, s47, 378880
  s_lshl_b32 s90, s48, 10
  s_add_u32 s65, s65, s90
  s_cmp_ge_u32 s46, 10
  s_cselect_b32 s65, 0x40000000, s65
  s_add_u32 s46, s22, 8
  s_cmp_ge_u32 s46, 5
  s_cselect_b32 s47, 1, 0
  s_mul_i32 s48, s47, 5
  s_sub_u32 s48, s46, s48
  s_lshr_b32 s49, s48, 1
  s_lshl_b32 s49, s49, 6
  s_and_b32 s90, s48, 1
  s_lshl_b32 s90, s90, 3
  s_add_u32 s49, s49, s90
  s_mul_i32 s90, s47, 160
  s_add_u32 s49, s49, s90
  s_cmp_eq_u32 s48, 4
  s_cselect_b32 s90, 3, 4
  v_lshlrev_b32 v5, s90, v3
  v_add3_u32 v208, v5, v2, s49
  s_mul_i32 s66, s47, 378880
  s_lshl_b32 s90, s48, 10
  s_add_u32 s66, s66, s90
  s_cmp_ge_u32 s46, 10
  s_cselect_b32 s66, 0x40000000, s66
  s_mov_b32 s69, 819200
  s_mov_b32 s70, 2211840
  s_mov_b32 s67, 147456
  v_and_b32 v1, 15, v255
  v_lshrrev_b32 v2, 2, v1
  v_and_b32 v3, 3, v1
  v_lshrrev_b32 v4, 4, v255
  v_lshl_add_u32 v2, v4, 2, v2
  v_lshrrev_b32 v5, 1, v2
  v_and_b32 v5, 3, v5
  v_lshlrev_b32_e64 v2, 7, v2
  v_lshl_add_u32 v2, v3, 3, v2
  v_add_u32 v2, 16384, v2
  v_xor_b32_e64 v6, 0, v5
  v_lshl_add_u32 v160, v6, 5, v2
  v_xor_b32_e64 v6, 1, v5
  v_lshl_add_u32 v161, v6, 5, v2
  v_xor_b32_e64 v6, 2, v5
  v_lshl_add_u32 v162, v6, 5, v2
  v_xor_b32_e64 v6, 3, v5
  v_lshl_add_u32 v163, v6, 5, v2
  v_and_b32 v1, 15, v255
  v_lshrrev_b32 v4, 4, v255
  v_lshrrev_b32 v2, 1, v1
  v_xor_b32 v2, v2, v4
  v_lshlrev_b32_e64 v2, 4, v2
  v_lshl_add_u32 v2, v1, 7, v2
  v_add_u32 v164, 0, v2
  v_xor_b32 v2, 64, v2
  v_add_u32_e64 v165, 0, v2
  s_add_u32 s90, s92, 40960
  v_add_u32_e64 v169, s90, v166
  s_add_u32 s90, s92, 50176
  v_add_u32_e64 v170, s90, v167
  s_add_u32 s90, s92, 59392
  v_add_u32_e64 v171, s90, v166
  s_add_u32 s90, s92, 68608
  v_add_u32_e64 v172, s90, v167
  v_add_u32 v173, 128, v168
  v_add_u32 v174, 54400, v168
  v_add_u32 v175, 11904, v168
  v_add_u32 v176, 66176, v168
  v_add_u32 v177, 110720, v168
  v_add_u32 v178, 164992, v168
  v_add_u32 v179, 122496, v168
  v_add_u32 v180, 176768, v168
  v_mov_b32 v232, 0
  v_mov_b32 v233, 0
  v_mov_b32 v234, 0
  v_mov_b32_e64 v235, 0
  s_nop 1
  v_mfma_f32_32x32x16_bf16 v[0:15], v[232:235], v[232:235], 0
  v_mfma_f32_32x32x16_bf16 v[16:31], v[232:235], v[232:235], 0
  v_mfma_f32_32x32x16_bf16 v[32:47], v[232:235], v[232:235], 0
  v_mfma_f32_32x32x16_bf16 v[48:63], v[232:235], v[232:235], 0
  v_mfma_f32_32x32x16_bf16 v[64:79], v[232:235], v[232:235], 0
  v_mfma_f32_32x32x16_bf16 v[80:95], v[232:235], v[232:235], 0
  v_mfma_f32_32x32x16_bf16 v[96:111], v[232:235], v[232:235], 0
  v_mfma_f32_32x32x16_bf16 v[112:127], v[232:235], v[232:235], 0
  v_mfma_f32_32x32x16_bf16 v[128:143], v[232:235], v[232:235], 0
  v_mov_b32 v254, 0x3f803f80
  v_accvgpr_write_b32 a240, v254
  v_accvgpr_write_b32 a241, v254
  v_accvgpr_write_b32 a242, v254
  v_accvgpr_write_b32 a243, v254
  v_mov_b32 v249, 0
  s_lshl_b32 s39, s38, 7
  s_mul_i32 s40, s38, 221184
  s_mov_b32 s41, 49152
  s_add_u32 m0, s41, 4096
  s_nop 0
  buffer_load_dwordx4 v169, s[24:27], s39 offen offset:0 lds
  buffer_load_dwordx4 v170, s[24:27], s39 offen offset:1024 lds
  buffer_load_dwordx4 v171, s[24:27], s39 offen offset:2048 lds
  buffer_load_dwordx4 v172, s[24:27], s39 offen offset:3072 lds
  s_add_u32 m0, s41, 24576
  s_nop 0
  buffer_load_dwordx4 v173, s[28:31], s40 offen offset:0 lds
  buffer_load_dwordx4 v174, s[28:31], s40 offen offset:1024 lds
  buffer_load_dwordx4 v175, s[28:31], s40 offen offset:2048 lds
  buffer_load_dwordx4 v176, s[28:31], s40 offen offset:3072 lds
  s_add_u32 m0, s41, 28672
  s_nop 0
  buffer_load_dwordx4 v177, s[28:31], s40 offen offset:0 lds
  buffer_load_dwordx4 v178, s[28:31], s40 offen offset:1024 lds
  buffer_load_dwordx4 v179, s[28:31], s40 offen offset:2048 lds
  buffer_load_dwordx4 v180, s[28:31], s40 offen offset:3072 lds
  s_add_u32 s38, s38, 1
  s_cmp_eq_u32 s38, 10
  s_cselect_b32 s38, 0, s38
  s_lshr_b32 s46, s68, 2
  s_and_b32 s47, s68, 3
  s_mul_i32 s48, s46, 52
  s_lshr_b32 s48, s48, 8
  s_mul_i32 s49, s48, 5
  s_sub_u32 s49, s46, s49
  s_mul_i32 s48, s48, 160
  s_lshl_b32 s90, s49, 5
  s_cmp_ge_u32 s49, 2
  s_cselect_b32 s91, 16, 0
  s_add_u32 s90, s90, s91
  s_cmp_eq_u32 s49, 4
  s_cselect_b32 s90, 64, s90
  s_cselect_b32 s91, 81920, 0
  s_add_u32 s90, s90, s48
  s_sub_u32 s48, s46, 20
  s_lshl_b32 s48, s48, 5
  s_cmp_lt_u32 s46, 20
  s_cselect_b32 s90, s90, s48
  s_cselect_b32 s91, s91, 0
  s_cselect_b32 s60, s8, s14
  s_cselect_b32 s61, s9, s15
  s_cselect_b32 s62, s69, s70
  s_and_b32 s61, s61, 0xffff
  s_mov_b32 s63, 0x20000
  s_mul_i32 s90, s90, 1280
  s_mul_i32 s47, s47, 320
  s_add_u32 s90, s90, s47
  s_cmp_ge_u32 s68, 296
  s_cselect_b32 s90, 0x7f000000, s90
  s_lshl_b32 s46, s22, 10
  s_add_u32 s46, s46, s67
  v_mad_u32_u24 v210, v203, s91, v200
  s_add_u32 m0, s46, 0
  s_nop 0
  buffer_load_dwordx4 v210, s[60:63], s90 offen lds
  v_mad_u32_u24 v211, v204, s91, v201
  s_add_u32 m0, s46, 4096
  s_nop 0
  buffer_load_dwordx4 v211, s[60:63], s90 offen lds
  v_mad_u32_u24 v212, v205, s91, v202
  s_add_u32 s47, s46, 8192
  s_cmp_ge_u32 s22, 2
  s_cselect_b32 m0, 161792, s47
  s_nop 0
  buffer_load_dwordx4 v212, s[60:63], s90 offen lds
  s_and_b32 s46, s2, 7
  s_lshr_b32 s47, s2, 3
  s_lshr_b32 s80, s47, 3
  s_lshl_b32 s46, s46, 2
  s_add_u32 s80, s80, s46
  s_and_b32 s81, s47, 7
  s_lshr_b32 s89, s80, 1
  s_lshl_b32 s89, s89, 2
  s_mul_i32 s83, s81, 378880
  s_add_u32 s83, s83, 10485760
  s_mul_i32 s84, s80, 303104
  s_mul_i32 s85, s22, 12288
  s_add_u32 s85, s85, 49152
  s_mul_i32 s86, s22, 13312
  s_add_u32 s86, s86, 98304
  s_mul_i32 s46, s81, 7
  s_lshr_b32 s46, s46, 2
  s_and_b32 s47, s80, 3
  s_mul_i32 s47, s47, 7
  s_lshr_b32 s47, s47, 1
  s_add_u32 s46, s46, s47
  s_sub_u32 s47, s46, 14
  s_cmp_ge_u32 s46, 14
  s_cselect_b32 s46, s47, s46
  s_lshl_b32 s46, s46, 2
  s_add_u32 s46, s46, s22
  s_add_u32 s46, s46, 20
  s_lshl_b32 s4, s46, 10
  s_cmp_ge_u32 s46, 74
  s_cselect_b32 s4, 0x10000000, s4
  s_add_u32 s46, s46, 4
  s_sub_u32 s47, s46, 56
  s_cmp_ge_u32 s46, 76
  s_cselect_b32 s46, s47, s46
  s_lshl_b32 s5, s46, 10
  s_cmp_ge_u32 s46, 74
  s_cselect_b32 s5, 0x10000000, s5
  s_add_u32 s46, s46, 4
  s_sub_u32 s47, s46, 56
  s_cmp_ge_u32 s46, 76
  s_cselect_b32 s46, s47, s46
  s_lshl_b32 s6, s46, 10
  s_cmp_ge_u32 s46, 74
  s_cselect_b32 s6, 0x10000000, s6
  s_add_u32 s46, s46, 4
  s_sub_u32 s47, s46, 56
  s_cmp_ge_u32 s46, 76
  s_cselect_b32 s46, s47, s46
  s_lshl_b32 s7, s46, 10
  s_cmp_ge_u32 s46, 74
  s_cselect_b32 s7, 0x10000000, s7
  s_add_u32 s46, s46, 4
  s_sub_u32 s47, s46, 56
  s_cmp_ge_u32 s46, 76
  s_cselect_b32 s46, s47, s46
  s_lshl_b32 s8, s46, 10
  s_cmp_ge_u32 s46, 74
  s_cselect_b32 s8, 0x10000000, s8
  s_add_u32 s46, s46, 4
  s_sub_u32 s47, s46, 56
  s_cmp_ge_u32 s46, 76
  s_cselect_b32 s46, s47, s46
  s_lshl_b32 s9, s46, 10
  s_cmp_ge_u32 s46, 74
  s_cselect_b32 s9, 0x10000000, s9
  s_add_u32 s46, s46, 4
  s_sub_u32 s47, s46, 56
  s_cmp_ge_u32 s46, 76
  s_cselect_b32 s46, s47, s46
  s_lshl_b32 s10, s46, 10
  s_cmp_ge_u32 s46, 74
  s_cselect_b32 s10, 0x10000000, s10
  s_add_u32 s46, s46, 4
  s_sub_u32 s47, s46, 56
  s_cmp_ge_u32 s46, 76
  s_cselect_b32 s46, s47, s46
  s_lshl_b32 s11, s46, 10
  s_cmp_ge_u32 s46, 74
  s_cselect_b32 s11, 0x10000000, s11
  s_add_u32 s46, s46, 4
  s_sub_u32 s47, s46, 56
  s_cmp_ge_u32 s46, 76
  s_cselect_b32 s46, s47, s46
  s_lshl_b32 s12, s46, 10
  s_cmp_ge_u32 s46, 74
  s_cselect_b32 s12, 0x10000000, s12
  s_add_u32 s46, s46, 4
  s_sub_u32 s47, s46, 56
  s_cmp_ge_u32 s46, 76
  s_cselect_b32 s46, s47, s46
  s_lshl_b32 s13, s46, 10
  s_cmp_ge_u32 s46, 74
  s_cselect_b32 s13, 0x10000000, s13
  s_add_u32 s46, s46, 4
  s_sub_u32 s47, s46, 56
  s_cmp_ge_u32 s46, 76
  s_cselect_b32 s46, s47, s46
  s_lshl_b32 s14, s46, 10
  s_cmp_ge_u32 s46, 74
  s_cselect_b32 s14, 0x10000000, s14
  s_add_u32 s46, s46, 4
  s_sub_u32 s47, s46, 56
  s_cmp_ge_u32 s46, 76
  s_cselect_b32 s46, s47, s46
  s_lshl_b32 s15, s46, 10
  s_cmp_ge_u32 s46, 74
  s_cselect_b32 s15, 0x10000000, s15
  s_add_u32 s46, s46, 4
  s_sub_u32 s47, s46, 56
  s_cmp_ge_u32 s46, 76
  s_cselect_b32 s46, s47, s46
  s_lshl_b32 s18, s46, 10
  s_cmp_ge_u32 s46, 74
  s_cselect_b32 s18, 0x10000000, s18
  s_add_u32 s46, s46, 4
  s_sub_u32 s47, s46, 56
  s_cmp_ge_u32 s46, 76
  s_cselect_b32 s46, s47, s46
  s_lshl_b32 s19, s46, 10
  s_cmp_ge_u32 s46, 74
  s_cselect_b32 s19, 0x10000000, s19
  v_add_u32 v245, 4096, v241
  s_lshl_b32 s45, s2, 7
  s_add_u32 s45, s45, 15728640
  s_lshl_b32 s39, s38, 7
  s_mul_i32 s40, s38, 221184
  s_mov_b32 s41, 98304
  s_mov_b32 s94, 49152
  s_mov_b32 s95, 4294868992
  s_mov_b32 s43, 0
  s_waitcnt vmcnt(15) lgkmcnt(0)
  s_barrier
  ds_read_b128 a[40:43], v164 offset:0
  ds_read_b128 a[44:47], v164 offset:2048
  ds_read_b128 a[48:51], v164 offset:4096
  ds_read_b128 a[52:55], v164 offset:6144
  ds_read_b64_tr_b16 a[0:1], v160 offset:16384
  ds_read_b64_tr_b16 a[2:3], v160 offset:18432
  ds_read_b64_tr_b16 a[4:5], v161 offset:16384
  ds_read_b64_tr_b16 a[6:7], v161 offset:18432
  ds_read_b64_tr_b16 a[8:9], v162 offset:16384
  ds_read_b64_tr_b16 a[10:11], v162 offset:18432
  ds_read_b64_tr_b16 a[12:13], v163 offset:16384
  ds_read_b64_tr_b16 a[14:15], v163 offset:18432
L_loop_ffn_1:
  ds_read_b64_tr_b16 a[16:17], v160 offset:24576
  s_waitcnt lgkmcnt(5)
  v_mfma_f32_16x16x32_bf16 v[0:3], a[0:3], a[40:43], v[0:3]
  ds_read_b64_tr_b16 a[18:19], v160 offset:26624
  v_mfma_f32_16x16x32_bf16 v[32:35], a[0:3], a[44:47], v[32:35]
  v_mfma_f32_16x16x32_bf16 v[64:67], a[0:3], a[48:51], v[64:67]
  s_cmp_lg_u32 s43, 7
  s_cbranch_scc0 L_pp_ffn_1
L_np_ffn_1:
  s_cmp_lg_u32 s43, 1
  s_cbranch_scc0 L_pu_ffn_1
L_nu_ffn_1:
  v_mfma_f32_16x16x32_bf16 v[96:99], a[0:3], a[52:55], v[96:99]
  v_mfma_f32_16x16x32_bf16 v[128:131], a[0:3], a[240:243], v[128:131]
  ds_read_b64_tr_b16 a[20:21], v161 offset:24576
  v_mfma_f32_16x16x32_bf16 v[4:7], a[4:7], a[40:43], v[4:7]
  s_add_u32 m0, s41, 4096
  ds_read_b64_tr_b16 a[22:23], v161 offset:26624
  v_mfma_f32_16x16x32_bf16 v[36:39], a[4:7], a[44:47], v[36:39]
  v_mfma_f32_16x16x32_bf16 v[68:71], a[4:7], a[48:51], v[68:71]
  v_mfma_f32_16x16x32_bf16 v[100:103], a[4:7], a[52:55], v[100:103]
  v_mfma_f32_16x16x32_bf16 v[132:135], a[4:7], a[240:243], v[132:135]
  buffer_load_dwordx4 v169, s[24:27], s39 offen offset:0 lds
  ds_read_b64_tr_b16 a[24:25], v162 offset:24576
  ds_read_b64_tr_b16 a[26:27], v162 offset:26624
  s_waitcnt lgkmcnt(6)
  v_mfma_f32_16x16x32_bf16 v[8:11], a[8:11], a[40:43], v[8:11]
  ds_read_b128 a[56:59], v165 offset:0
  v_mfma_f32_16x16x32_bf16 v[40:43], a[8:11], a[44:47], v[40:43]
  ds_read_b128 a[60:63], v165 offset:2048
  v_mfma_f32_16x16x32_bf16 v[72:75], a[8:11], a[48:51], v[72:75]
  ds_read_b128 a[64:67], v165 offset:4096
  v_mfma_f32_16x16x32_bf16 v[104:107], a[8:11], a[52:55], v[104:107]
  buffer_load_dwordx4 v170, s[24:27], s39 offen offset:1024 lds
  ds_read_b128 a[68:71], v165 offset:6144
  v_mfma_f32_16x16x32_bf16 v[136:139], a[8:11], a[240:243], v[136:139]
  ds_read_b64_tr_b16 a[28:29], v163 offset:24576
  v_mfma_f32_16x16x32_bf16 v[12:15], a[12:15], a[40:43], v[12:15]
  ds_read_b64_tr_b16 a[30:31], v163 offset:26624
  v_mfma_f32_16x16x32_bf16 v[44:47], a[12:15], a[44:47], v[44:47]
  v_mfma_f32_16x16x32_bf16 v[76:79], a[12:15], a[48:51], v[76:79]
  buffer_load_dwordx4 v171, s[24:27], s39 offen offset:2048 lds
  v_mfma_f32_16x16x32_bf16 v[108:111], a[12:15], a[52:55], v[108:111]
  v_mfma_f32_16x16x32_bf16 v[140:143], a[12:15], a[240:243], v[140:143]
  ds_read_b64_tr_b16 a[0:1], v160 offset:20480
  s_waitcnt lgkmcnt(9)
  v_mfma_f32_16x16x32_bf16 v[16:19], a[16:19], a[40:43], v[16:19]
  buffer_load_dwordx4 v172, s[24:27], s39 offen offset:3072 lds
  s_add_u32 m0, s41, 24576
  ds_read_b64_tr_b16 a[2:3], v160 offset:22528
  v_mfma_f32_16x16x32_bf16 v[48:51], a[16:19], a[44:47], v[48:51]
  v_mfma_f32_16x16x32_bf16 v[80:83], a[16:19], a[48:51], v[80:83]
  v_mfma_f32_16x16x32_bf16 v[112:115], a[16:19], a[52:55], v[112:115]
  ds_read_b64_tr_b16 a[4:5], v161 offset:20480
  v_mfma_f32_16x16x32_bf16 v[20:23], a[20:23], a[40:43], v[20:23]
  buffer_load_dwordx4 v173, s[28:31], s40 offen offset:0 lds
  ds_read_b64_tr_b16 a[6:7], v161 offset:22528
  v_mfma_f32_16x16x32_bf16 v[52:55], a[20:23], a[44:47], v[52:55]
  v_mfma_f32_16x16x32_bf16 v[84:87], a[20:23], a[48:51], v[84:87]
  v_mfma_f32_16x16x32_bf16 v[116:119], a[20:23], a[52:55], v[116:119]
  ds_read_b64_tr_b16 a[8:9], v162 offset:20480
  s_waitcnt lgkmcnt(9)
  v_mfma_f32_16x16x32_bf16 v[24:27], a[24:27], a[40:43], v[24:27]
  buffer_load_dwordx4 v174, s[28:31], s40 offen offset:1024 lds
  ds_read_b64_tr_b16 a[10:11], v162 offset:22528
  v_mfma_f32_16x16x32_bf16 v[56:59], a[24:27], a[44:47], v[56:59]
  v_mfma_f32_16x16x32_bf16 v[88:91], a[24:27], a[48:51], v[88:91]
  v_mfma_f32_16x16x32_bf16 v[120:123], a[24:27], a[52:55], v[120:123]
  ds_read_b64_tr_b16 a[12:13], v163 offset:20480
  s_waitcnt lgkmcnt(5)
  v_mfma_f32_16x16x32_bf16 v[28:31], a[28:31], a[40:43], v[28:31]
  buffer_load_dwordx4 v175, s[28:31], s40 offen offset:2048 lds
  ds_read_b64_tr_b16 a[14:15], v163 offset:22528
  v_mfma_f32_16x16x32_bf16 v[60:63], a[28:31], a[44:47], v[60:63]
  v_mfma_f32_16x16x32_bf16 v[92:95], a[28:31], a[48:51], v[92:95]
  v_mfma_f32_16x16x32_bf16 v[124:127], a[28:31], a[52:55], v[124:127]
  ds_read_b64_tr_b16 a[16:17], v160 offset:28672
  v_mfma_f32_16x16x32_bf16 v[0:3], a[0:3], a[56:59], v[0:3]
  buffer_load_dwordx4 v176, s[28:31], s40 offen offset:3072 lds
  s_add_u32 m0, s41, 28672
  ds_read_b64_tr_b16 a[18:19], v160 offset:30720
  v_mfma_f32_16x16x32_bf16 v[32:35], a[0:3], a[60:63], v[32:35]
  v_mfma_f32_16x16x32_bf16 v[64:67], a[0:3], a[64:67], v[64:67]
  v_mfma_f32_16x16x32_bf16 v[96:99], a[0:3], a[68:71], v[96:99]
  buffer_load_dwordx4 v177, s[28:31], s40 offen offset:0 lds
  v_mfma_f32_16x16x32_bf16 v[128:131], a[0:3], a[240:243], v[128:131]
  ds_read_b64_tr_b16 a[20:21], v161 offset:28672
  s_waitcnt lgkmcnt(5)
  v_mfma_f32_16x16x32_bf16 v[4:7], a[4:7], a[56:59], v[4:7]
  ds_read_b64_tr_b16 a[22:23], v161 offset:30720
  v_mfma_f32_16x16x32_bf16 v[36:39], a[4:7], a[60:63], v[36:39]
  v_mfma_f32_16x16x32_bf16 v[68:71], a[4:7], a[64:67], v[68:71]
  buffer_load_dwordx4 v178, s[28:31], s40 offen offset:1024 lds
  v_mfma_f32_16x16x32_bf16 v[100:103], a[4:7], a[68:71], v[100:103]
  v_mfma_f32_16x16x32_bf16 v[132:135], a[4:7], a[240:243], v[132:135]
  ds_read_b64_tr_b16 a[24:25], v162 offset:28672
  v_mfma_f32_16x16x32_bf16 v[8:11], a[8:11], a[56:59], v[8:11]
  ds_read_b64_tr_b16 a[26:27], v162 offset:30720
  v_mfma_f32_16x16x32_bf16 v[40:43], a[8:11], a[60:63], v[40:43]
  buffer_load_dwordx4 v179, s[28:31], s40 offen offset:2048 lds
  v_mfma_f32_16x16x32_bf16 v[72:75], a[8:11], a[64:67], v[72:75]
  v_mfma_f32_16x16x32_bf16 v[104:107], a[8:11], a[68:71], v[104:107]
  v_mfma_f32_16x16x32_bf16 v[136:139], a[8:11], a[240:243], v[136:139]
  ds_read_b64_tr_b16 a[28:29], v163 offset:28672
  s_waitcnt lgkmcnt(5)
  v_mfma_f32_16x16x32_bf16 v[12:15], a[12:15], a[56:59], v[12:15]
  buffer_load_dwordx4 v180, s[28:31], s40 offen offset:3072 lds
  ds_read_b64_tr_b16 a[30:31], v163 offset:30720
  v_mfma_f32_16x16x32_bf16 v[44:47], a[12:15], a[60:63], v[44:47]
  v_mfma_f32_16x16x32_bf16 v[76:79], a[12:15], a[64:67], v[76:79]
  v_mfma_f32_16x16x32_bf16 v[108:111], a[12:15], a[68:71], v[108:111]
  v_mfma_f32_16x16x32_bf16 v[140:143], a[12:15], a[240:243], v[140:143]
  v_mfma_f32_16x16x32_bf16 v[16:19], a[16:19], a[56:59], v[16:19]
  v_mfma_f32_16x16x32_bf16 v[48:51], a[16:19], a[60:63], v[48:51]
  v_mfma_f32_16x16x32_bf16 v[80:83], a[16:19], a[64:67], v[80:83]
  v_mfma_f32_16x16x32_bf16 v[112:115], a[16:19], a[68:71], v[112:115]
  s_waitcnt lgkmcnt(2)
  v_mfma_f32_16x16x32_bf16 v[20:23], a[20:23], a[56:59], v[20:23]
  v_mfma_f32_16x16x32_bf16 v[52:55], a[20:23], a[60:63], v[52:55]
  v_mfma_f32_16x16x32_bf16 v[84:87], a[20:23], a[64:67], v[84:87]
  v_mfma_f32_16x16x32_bf16 v[116:119], a[20:23], a[68:71], v[116:119]
  s_waitcnt vmcnt(12) lgkmcnt(0)
  s_barrier
  v_mfma_f32_16x16x32_bf16 v[24:27], a[24:27], a[56:59], v[24:27]
  s_cmp_eq_u32 s41, 49152
  s_cselect_b32 s42, s95, s94
  v_add_u32 v160, s42, v160
  v_add_u32 v161, s42, v161
  v_mfma_f32_16x16x32_bf16 v[56:59], a[24:27], a[60:63], v[56:59]
  v_add_u32 v162, s42, v162
  v_add_u32 v163, s42, v163
  v_add_u32 v164, s42, v164
  v_add_u32 v165, s42, v165
  v_mfma_f32_16x16x32_bf16 v[88:91], a[24:27], a[64:67], v[88:91]
  ds_read_b128 a[40:43], v164 offset:0
  ds_read_b128 a[44:47], v164 offset:2048
  ds_read_b128 a[48:51], v164 offset:4096
  ds_read_b128 a[52:55], v164 offset:6144
  v_mfma_f32_16x16x32_bf16 v[120:123], a[24:27], a[68:71], v[120:123]
  ds_read_b64_tr_b16 a[0:1], v160 offset:16384
  ds_read_b64_tr_b16 a[2:3], v160 offset:18432
  ds_read_b64_tr_b16 a[4:5], v161 offset:16384
  ds_read_b64_tr_b16 a[6:7], v161 offset:18432
  v_mfma_f32_16x16x32_bf16 v[28:31], a[28:31], a[56:59], v[28:31]
  ds_read_b64_tr_b16 a[8:9], v162 offset:16384
  ds_read_b64_tr_b16 a[10:11], v162 offset:18432
  ds_read_b64_tr_b16 a[12:13], v163 offset:16384
  ds_read_b64_tr_b16 a[14:15], v163 offset:18432
  v_mfma_f32_16x16x32_bf16 v[60:63], a[28:31], a[60:63], v[60:63]
  s_add_u32 s38, s38, 1
  s_cmp_eq_u32 s38, 10
  s_cselect_b32 s38, 0, s38
  s_lshl_b32 s39, s38, 7
  v_mfma_f32_16x16x32_bf16 v[92:95], a[28:31], a[64:67], v[92:95]
  s_mul_i32 s40, s38, 221184
  s_cmp_eq_u32 s41, 98304
  s_cselect_b32 s42, s95, s94
  s_add_u32 s41, s41, s42
  v_mfma_f32_16x16x32_bf16 v[124:127], a[28:31], a[68:71], v[124:127]
  s_add_u32 s43, s43, 1
  s_cmp_lt_u32 s43, 8
  s_cbranch_scc1 L_loop_ffn_1
  v_readfirstlane_b32 s23, v252
  s_nop 3
  s_cmp_lg_u32 s23, 0
  s_cbranch_scc1 L_nok_ffn_1
  s_mov_b32 s47, 0
  v_mov_b32_e64 v251, 0
L_nspin_ffn_1:
  buffer_load_dword v250, v251, s[76:79], 0 offen sc1
  s_waitcnt vmcnt(0)
  v_readfirstlane_b32 s23, v250
  s_nop 3
  s_cmp_lg_u32 s23, 0
  s_cbranch_scc1 L_nok_ffn_1
  s_sleep 8
  s_add_u32 s47, s47, 1
  s_cmp_lt_u32 s47, 200000
  s_cbranch_scc1 L_nspin_ffn_1
L_nok_ffn_1:
  v_readfirstlane_b32 s46, v253
  s_nop 3
  s_cmp_ge_u32 s46, 128
  s_cbranch_scc1 L_cok_p_ffn_1
  s_mov_b32 s47, 0
  v_mov_b32_e64 v251, 0
L_cspin_p_ffn_1:
  buffer_load_dword v250, v251, s[76:79], 0 offen offset:4 sc1
  s_waitcnt vmcnt(0)
  v_readfirstlane_b32 s46, v250
  s_nop 3
  s_cmp_ge_u32 s46, 128
  s_cbranch_scc1 L_cok_p_ffn_1
  s_sleep 40
  s_add_u32 s47, s47, 1
  s_cmp_lt_u32 s47, 200000
  s_cbranch_scc1 L_cspin_p_ffn_1
L_cok_p_ffn_1:
  ds_read_b64_tr_b16 a[16:17], v160 offset:24576
  s_waitcnt lgkmcnt(5)
  v_mfma_f32_16x16x32_bf16 v[0:3], a[0:3], a[40:43], v[0:3]
  ds_read_b64_tr_b16 a[18:19], v160 offset:26624
  v_mfma_f32_16x16x32_bf16 v[32:35], a[0:3], a[44:47], v[32:35]
  v_mfma_f32_16x16x32_bf16 v[64:67], a[0:3], a[48:51], v[64:67]
  s_mul_i32 s87, s4, 5
  s_add_u32 s87, s87, s83
  s_add_u32 m0, s85, 0
  s_add_u32 s88, s87, 0
  buffer_load_dwordx4 v241, s[32:35], s88 offen sc1 lds
  v_mfma_f32_16x16x32_bf16 v[96:99], a[0:3], a[52:55], v[96:99]
  v_mfma_f32_16x16x32_bf16 v[128:131], a[0:3], a[240:243], v[128:131]
  ds_read_b64_tr_b16 a[20:21], v161 offset:24576
  v_mfma_f32_16x16x32_bf16 v[4:7], a[4:7], a[40:43], v[4:7]
  ds_read_b64_tr_b16 a[22:23], v161 offset:26624
  v_mfma_f32_16x16x32_bf16 v[36:39], a[4:7], a[44:47], v[36:39]
  s_add_u32 m0, s85, 1024
  s_add_u32 s88, s87, 1024
  buffer_load_dwordx4 v241, s[32:35], s88 offen sc1 lds
  v_mfma_f32_16x16x32_bf16 v[68:71], a[4:7], a[48:51], v[68:71]
  v_mfma_f32_16x16x32_bf16 v[100:103], a[4:7], a[52:55], v[100:103]
  v_mfma_f32_16x16x32_bf16 v[132:135], a[4:7], a[240:243], v[132:135]
  ds_read_b64_tr_b16 a[24:25], v162 offset:24576
  ds_read_b64_tr_b16 a[26:27], v162 offset:26624
  s_waitcnt lgkmcnt(6)
  v_mfma_f32_16x16x32_bf16 v[8:11], a[8:11], a[40:43], v[8:11]
  s_add_u32 m0, s85, 2048
  s_add_u32 s88, s87, 2048
  buffer_load_dwordx4 v241, s[32:35], s88 offen sc1 lds
  ds_read_b128 a[56:59], v165 offset:0
  v_mfma_f32_16x16x32_bf16 v[40:43], a[8:11], a[44:47], v[40:43]
  ds_read_b128 a[60:63], v165 offset:2048
  v_mfma_f32_16x16x32_bf16 v[72:75], a[8:11], a[48:51], v[72:75]
  ds_read_b128 a[64:67], v165 offset:4096
  v_mfma_f32_16x16x32_bf16 v[104:107], a[8:11], a[52:55], v[104:107]
  ds_read_b128 a[68:71], v165 offset:6144
  v_mfma_f32_16x16x32_bf16 v[136:139], a[8:11], a[240:243], v[136:139]
  ds_read_b64_tr_b16 a[28:29], v163 offset:24576
  v_mfma_f32_16x16x32_bf16 v[12:15], a[12:15], a[40:43], v[12:15]
  s_add_u32 m0, s85, 3072
  s_add_u32 s88, s87, 3072
  buffer_load_dwordx4 v241, s[32:35], s88 offen sc1 lds
  ds_read_b64_tr_b16 a[30:31], v163 offset:26624
  v_mfma_f32_16x16x32_bf16 v[44:47], a[12:15], a[44:47], v[44:47]
  v_mfma_f32_16x16x32_bf16 v[76:79], a[12:15], a[48:51], v[76:79]
  v_mfma_f32_16x16x32_bf16 v[108:111], a[12:15], a[52:55], v[108:111]
  v_mfma_f32_16x16x32_bf16 v[140:143], a[12:15], a[240:243], v[140:143]
  s_add_u32 m0, s85, 4096
  s_add_u32 s88, s87, 4096
  buffer_load_dwordx4 v241, s[32:35], s88 offen sc1 lds
  ds_read_b64_tr_b16 a[0:1], v160 offset:20480
  s_waitcnt lgkmcnt(9)
  v_mfma_f32_16x16x32_bf16 v[16:19], a[16:19], a[40:43], v[16:19]
  ds_read_b64_tr_b16 a[2:3], v160 offset:22528
  v_mfma_f32_16x16x32_bf16 v[48:51], a[16:19], a[44:47], v[48:51]
  v_mfma_f32_16x16x32_bf16 v[80:83], a[16:19], a[48:51], v[80:83]
  v_mfma_f32_16x16x32_bf16 v[112:115], a[16:19], a[52:55], v[112:115]
  ds_read_b64_tr_b16 a[4:5], v161 offset:20480
  v_mfma_f32_16x16x32_bf16 v[20:23], a[20:23], a[40:43], v[20:23]
  s_mul_i32 s87, s5, 5
  s_add_u32 s87, s87, s83
  s_add_u32 m0, s85, 5120
  s_add_u32 s88, s87, 0
  buffer_load_dwordx4 v241, s[32:35], s88 offen sc1 lds
  ds_read_b64_tr_b16 a[6:7], v161 offset:22528
  v_mfma_f32_16x16x32_bf16 v[52:55], a[20:23], a[44:47], v[52:55]
  v_mfma_f32_16x16x32_bf16 v[84:87], a[20:23], a[48:51], v[84:87]
  v_mfma_f32_16x16x32_bf16 v[116:119], a[20:23], a[52:55], v[116:119]
  ds_read_b64_tr_b16 a[8:9], v162 offset:20480
  s_waitcnt lgkmcnt(9)
  v_mfma_f32_16x16x32_bf16 v[24:27], a[24:27], a[40:43], v[24:27]
  s_add_u32 m0, s85, 6144
  s_add_u32 s88, s87, 1024
  buffer_load_dwordx4 v241, s[32:35], s88 offen sc1 lds
  ds_read_b64_tr_b16 a[10:11], v162 offset:22528
  v_mfma_f32_16x16x32_bf16 v[56:59], a[24:27], a[44:47], v[56:59]
  v_mfma_f32_16x16x32_bf16 v[88:91], a[24:27], a[48:51], v[88:91]
  v_mfma_f32_16x16x32_bf16 v[120:123], a[24:27], a[52:55], v[120:123]
  ds_read_b64_tr_b16 a[12:13], v163 offset:20480
  s_waitcnt lgkmcnt(5)
  v_mfma_f32_16x16x32_bf16 v[28:31], a[28:31], a[40:43], v[28:31]
  s_add_u32 m0, s85, 7168
  s_add_u32 s88, s87, 2048
  buffer_load_dwordx4 v241, s[32:35], s88 offen sc1 lds
  ds_read_b64_tr_b16 a[14:15], v163 offset:22528
  v_mfma_f32_16x16x32_bf16 v[60:63], a[28:31], a[44:47], v[60:63]
  v_mfma_f32_16x16x32_bf16 v[92:95], a[28:31], a[48:51], v[92:95]
  v_mfma_f32_16x16x32_bf16 v[124:127], a[28:31], a[52:55], v[124:127]
  ds_read_b64_tr_b16 a[16:17], v160 offset:28672
  v_mfma_f32_16x16x32_bf16 v[0:3], a[0:3], a[56:59], v[0:3]
  ds_read_b64_tr_b16 a[18:19], v160 offset:30720
  v_mfma_f32_16x16x32_bf16 v[32:35], a[0:3], a[60:63], v[32:35]
  s_add_u32 m0, s85, 8192
  s_add_u32 s88, s87, 3072
  buffer_load_dwordx4 v241, s[32:35], s88 offen sc1 lds
  v_mfma_f32_16x16x32_bf16 v[64:67], a[0:3], a[64:67], v[64:67]
  v_mfma_f32_16x16x32_bf16 v[96:99], a[0:3], a[68:71], v[96:99]
  v_mfma_f32_16x16x32_bf16 v[128:131], a[0:3], a[240:243], v[128:131]
  ds_read_b64_tr_b16 a[20:21], v161 offset:28672
  s_waitcnt lgkmcnt(5)
  v_mfma_f32_16x16x32_bf16 v[4:7], a[4:7], a[56:59], v[4:7]
  s_add_u32 m0, s85, 9216
  s_add_u32 s88, s87, 4096
  buffer_load_dwordx4 v241, s[32:35], s88 offen sc1 lds
  ds_read_b64_tr_b16 a[22:23], v161 offset:30720
  v_mfma_f32_16x16x32_bf16 v[36:39], a[4:7], a[60:63], v[36:39]
  v_mfma_f32_16x16x32_bf16 v[68:71], a[4:7], a[64:67], v[68:71]
  v_mfma_f32_16x16x32_bf16 v[100:103], a[4:7], a[68:71], v[100:103]
  v_mfma_f32_16x16x32_bf16 v[132:135], a[4:7], a[240:243], v[132:135]
  ds_read_b64_tr_b16 a[24:25], v162 offset:28672
  v_mfma_f32_16x16x32_bf16 v[8:11], a[8:11], a[56:59], v[8:11]
  s_mul_i32 s87, s6, 5
  s_add_u32 s87, s87, s83
  s_add_u32 m0, s85, 10240
  s_add_u32 s88, s87, 0
  buffer_load_dwordx4 v241, s[32:35], s88 offen sc1 lds
  ds_read_b64_tr_b16 a[26:27], v162 offset:30720
  v_mfma_f32_16x16x32_bf16 v[40:43], a[8:11], a[60:63], v[40:43]
  v_mfma_f32_16x16x32_bf16 v[72:75], a[8:11], a[64:67], v[72:75]
  v_mfma_f32_16x16x32_bf16 v[104:107], a[8:11], a[68:71], v[104:107]
  v_mfma_f32_16x16x32_bf16 v[136:139], a[8:11], a[240:243], v[136:139]
  s_add_u32 m0, s85, 11264
  s_add_u32 s88, s87, 1024
  buffer_load_dwordx4 v241, s[32:35], s88 offen sc1 lds
  ds_read_b64_tr_b16 a[28:29], v163 offset:28672
  s_waitcnt lgkmcnt(5)
  v_mfma_f32_16x16x32_bf16 v[12:15], a[12:15], a[56:59], v[12:15]
  ds_read_b64_tr_b16 a[30:31], v163 offset:30720
  v_mfma_f32_16x16x32_bf16 v[44:47], a[12:15], a[60:63], v[44:47]
  v_mfma_f32_16x16x32_bf16 v[76:79], a[12:15], a[64:67], v[76:79]
  v_mfma_f32_16x16x32_bf16 v[108:111], a[12:15], a[68:71], v[108:111]
  v_mfma_f32_16x16x32_bf16 v[140:143], a[12:15], a[240:243], v[140:143]
  v_mfma_f32_16x16x32_bf16 v[16:19], a[16:19], a[56:59], v[16:19]
  v_mfma_f32_16x16x32_bf16 v[48:51], a[16:19], a[60:63], v[48:51]
  v_mfma_f32_16x16x32_bf16 v[80:83], a[16:19], a[64:67], v[80:83]
  v_mfma_f32_16x16x32_bf16 v[112:115], a[16:19], a[68:71], v[112:115]
  s_waitcnt lgkmcnt(2)
  v_mfma_f32_16x16x32_bf16 v[20:23], a[20:23], a[56:59], v[20:23]
  v_mfma_f32_16x16x32_bf16 v[52:55], a[20:23], a[60:63], v[52:55]
  v_mfma_f32_16x16x32_bf16 v[84:87], a[20:23], a[64:67], v[84:87]
  v_mfma_f32_16x16x32_bf16 v[116:119], a[20:23], a[68:71], v[116:119]
  s_waitcnt vmcnt(12) lgkmcnt(0)
  s_barrier
  v_mfma_f32_16x16x32_bf16 v[24:27], a[24:27], a[56:59], v[24:27]
  s_cmp_eq_u32 s41, 49152
  s_cselect_b32 s42, s95, s94
  v_add_u32_e64 v160, s42, v160
  v_mfma_f32_16x16x32_bf16 v[56:59], a[24:27], a[60:63], v[56:59]
  v_add_u32 v161, s42, v161
  v_add_u32 v162, s42, v162
  v_add_u32_e64 v163, s42, v163
  v_mfma_f32_16x16x32_bf16 v[88:91], a[24:27], a[64:67], v[88:91]
  v_add_u32 v164, s42, v164
  v_add_u32 v165, s42, v165
  ds_read_b128 a[40:43], v164 offset:0
  v_mfma_f32_16x16x32_bf16 v[120:123], a[24:27], a[68:71], v[120:123]
  ds_read_b128 a[44:47], v164 offset:2048
  ds_read_b128 a[48:51], v164 offset:4096
  ds_read_b128 a[52:55], v164 offset:6144
  v_mfma_f32_16x16x32_bf16 v[28:31], a[28:31], a[56:59], v[28:31]
  ds_read_b64_tr_b16 a[0:1], v160 offset:16384
  ds_read_b64_tr_b16 a[2:3], v160 offset:18432
  ds_read_b64_tr_b16 a[4:5], v161 offset:16384
  v_mfma_f32_16x16x32_bf16 v[60:63], a[28:31], a[60:63], v[60:63]
  ds_read_b64_tr_b16 a[6:7], v161 offset:18432
  ds_read_b64_tr_b16 a[8:9], v162 offset:16384
  ds_read_b64_tr_b16 a[10:11], v162 offset:18432
  v_mfma_f32_16x16x32_bf16 v[92:95], a[28:31], a[64:67], v[92:95]
  ds_read_b64_tr_b16 a[12:13], v163 offset:16384
  ds_read_b64_tr_b16 a[14:15], v163 offset:18432
  v_mfma_f32_16x16x32_bf16 v[124:127], a[28:31], a[68:71], v[124:127]
  v_and_b32 v251, 15, v255
  v_lshlrev_b32_e64 v251, 4, v251
  s_lshl_b32 s73, s36, 7
  s_add_u32 s73, s73, 0
  s_add_u32 s74, s73, 16
  s_add_u32 s75, s73, 32
  s_add_u32 s101, s73, 48
  ds_read_b64_tr_b16 a[16:17], v160 offset:24576
  s_waitcnt lgkmcnt(5)
  v_mfma_f32_16x16x32_bf16 v[0:3], a[0:3], a[40:43], v[0:3]
  ds_read_b64_tr_b16 a[18:19], v160 offset:26624
  v_mfma_f32_16x16x32_bf16 v[32:35], a[0:3], a[44:47], v[32:35]
  v_mfma_f32_16x16x32_bf16 v[64:67], a[0:3], a[48:51], v[64:67]
  s_lshl_b32 s88, s73, 4
  s_add_u32 s88, s88, 14745600
  buffer_load_dwordx4 v[200:203], v251, s[32:35], s88 offen sc1
  v_mfma_f32_16x16x32_bf16 v[96:99], a[0:3], a[52:55], v[96:99]
  v_mfma_f32_16x16x32_bf16 v[128:131], a[0:3], a[240:243], v[128:131]
  ds_read_b64_tr_b16 a[20:21], v161 offset:24576
  v_mfma_f32_16x16x32_bf16 v[4:7], a[4:7], a[40:43], v[4:7]
  s_lshl_b32 s88, s74, 4
  s_add_u32 s88, s88, 14745600
  buffer_load_dwordx4 v[204:207], v251, s[32:35], s88 offen sc1
  ds_read_b64_tr_b16 a[22:23], v161 offset:26624
  v_mfma_f32_16x16x32_bf16 v[36:39], a[4:7], a[44:47], v[36:39]
  v_mfma_f32_16x16x32_bf16 v[68:71], a[4:7], a[48:51], v[68:71]
  v_mfma_f32_16x16x32_bf16 v[100:103], a[4:7], a[52:55], v[100:103]
  s_lshl_b32 s88, s75, 4
  s_add_u32 s88, s88, 14745600
  buffer_load_dwordx4 v[208:211], v251, s[32:35], s88 offen sc1
  v_mfma_f32_16x16x32_bf16 v[132:135], a[4:7], a[240:243], v[132:135]
  ds_read_b64_tr_b16 a[24:25], v162 offset:24576
  ds_read_b64_tr_b16 a[26:27], v162 offset:26624
  s_waitcnt lgkmcnt(6)
  v_mfma_f32_16x16x32_bf16 v[8:11], a[8:11], a[40:43], v[8:11]
  ds_read_b128 a[56:59], v165 offset:0
  v_mfma_f32_16x16x32_bf16 v[40:43], a[8:11], a[44:47], v[40:43]
  s_lshl_b32 s88, s101, 4
  s_add_u32 s88, s88, 14745600
  buffer_load_dwordx4 v[212:215], v251, s[32:35], s88 offen sc1
  ds_read_b128 a[60:63], v165 offset:2048
  v_mfma_f32_16x16x32_bf16 v[72:75], a[8:11], a[48:51], v[72:75]
  ds_read_b128 a[64:67], v165 offset:4096
  v_mfma_f32_16x16x32_bf16 v[104:107], a[8:11], a[52:55], v[104:107]
  ds_read_b128 a[68:71], v165 offset:6144
  v_mfma_f32_16x16x32_bf16 v[136:139], a[8:11], a[240:243], v[136:139]
  s_mul_i32 s87, s6, 5
  s_add_u32 s87, s87, s83
  s_add_u32 m0, s86, 0
  s_add_u32 s88, s87, 2048
  buffer_load_dwordx4 v241, s[32:35], s88 offen sc1 lds
  ds_read_b64_tr_b16 a[28:29], v163 offset:24576
  v_mfma_f32_16x16x32_bf16 v[12:15], a[12:15], a[40:43], v[12:15]
  ds_read_b64_tr_b16 a[30:31], v163 offset:26624
  v_mfma_f32_16x16x32_bf16 v[44:47], a[12:15], a[44:47], v[44:47]
  v_mfma_f32_16x16x32_bf16 v[76:79], a[12:15], a[48:51], v[76:79]
  s_add_u32 m0, s86, 1024
  s_add_u32 s88, s87, 3072
  buffer_load_dwordx4 v241, s[32:35], s88 offen sc1 lds
  v_mfma_f32_16x16x32_bf16 v[108:111], a[12:15], a[52:55], v[108:111]
  v_mfma_f32_16x16x32_bf16 v[140:143], a[12:15], a[240:243], v[140:143]
  ds_read_b64_tr_b16 a[0:1], v160 offset:20480
  s_waitcnt lgkmcnt(9)
  v_mfma_f32_16x16x32_bf16 v[16:19], a[16:19], a[40:43], v[16:19]
  s_add_u32 m0, s86, 2048
  s_add_u32 s88, s87, 4096
  buffer_load_dwordx4 v241, s[32:35], s88 offen sc1 lds
  ds_read_b64_tr_b16 a[2:3], v160 offset:22528
  v_mfma_f32_16x16x32_bf16 v[48:51], a[16:19], a[44:47], v[48:51]
  v_mfma_f32_16x16x32_bf16 v[80:83], a[16:19], a[48:51], v[80:83]
  v_mfma_f32_16x16x32_bf16 v[112:115], a[16:19], a[52:55], v[112:115]
  s_mul_i32 s87, s7, 5
  s_add_u32 s87, s87, s83
  s_add_u32 m0, s86, 3072
  s_add_u32 s88, s87, 0
  buffer_load_dwordx4 v241, s[32:35], s88 offen sc1 lds
  ds_read_b64_tr_b16 a[4:5], v161 offset:20480
  v_mfma_f32_16x16x32_bf16 v[20:23], a[20:23], a[40:43], v[20:23]
  ds_read_b64_tr_b16 a[6:7], v161 offset:22528
  v_mfma_f32_16x16x32_bf16 v[52:55], a[20:23], a[44:47], v[52:55]
  v_mfma_f32_16x16x32_bf16 v[84:87], a[20:23], a[48:51], v[84:87]
  s_add_u32 m0, s86, 4096
  s_add_u32 s88, s87, 1024
  buffer_load_dwordx4 v241, s[32:35], s88 offen sc1 lds
  v_mfma_f32_16x16x32_bf16 v[116:119], a[20:23], a[52:55], v[116:119]
  ds_read_b64_tr_b16 a[8:9], v162 offset:20480
  s_waitcnt lgkmcnt(9)
  v_mfma_f32_16x16x32_bf16 v[24:27], a[24:27], a[40:43], v[24:27]
  ds_read_b64_tr_b16 a[10:11], v162 offset:22528
  v_mfma_f32_16x16x32_bf16 v[56:59], a[24:27], a[44:47], v[56:59]
  v_mfma_f32_16x16x32_bf16 v[88:91], a[24:27], a[48:51], v[88:91]
  s_add_u32 m0, s86, 5120
  s_add_u32 s88, s87, 2048
  buffer_load_dwordx4 v241, s[32:35], s88 offen sc1 lds
  v_mfma_f32_16x16x32_bf16 v[120:123], a[24:27], a[52:55], v[120:123]
  ds_read_b64_tr_b16 a[12:13], v163 offset:20480
  s_waitcnt lgkmcnt(5)
  v_mfma_f32_16x16x32_bf16 v[28:31], a[28:31], a[40:43], v[28:31]
  ds_read_b64_tr_b16 a[14:15], v163 offset:22528
  v_mfma_f32_16x16x32_bf16 v[60:63], a[28:31], a[44:47], v[60:63]
  s_add_u32 m0, s86, 6144
  s_add_u32 s88, s87, 3072
  buffer_load_dwordx4 v241, s[32:35], s88 offen sc1 lds
  v_mfma_f32_16x16x32_bf16 v[92:95], a[28:31], a[48:51], v[92:95]
  v_mfma_f32_16x16x32_bf16 v[124:127], a[28:31], a[52:55], v[124:127]
  ds_read_b64_tr_b16 a[16:17], v160 offset:28672
  v_mfma_f32_16x16x32_bf16 v[0:3], a[0:3], a[56:59], v[0:3]
  s_add_u32 m0, s86, 7168
  s_add_u32 s88, s87, 4096
  buffer_load_dwordx4 v241, s[32:35], s88 offen sc1 lds
  ds_read_b64_tr_b16 a[18:19], v160 offset:30720
  v_mfma_f32_16x16x32_bf16 v[32:35], a[0:3], a[60:63], v[32:35]
  v_mfma_f32_16x16x32_bf16 v[64:67], a[0:3], a[64:67], v[64:67]
  v_mfma_f32_16x16x32_bf16 v[96:99], a[0:3], a[68:71], v[96:99]
  s_mul_i32 s87, s8, 5
  s_add_u32 s87, s87, s83
  s_add_u32 m0, s86, 8192
  s_add_u32 s88, s87, 0
  buffer_load_dwordx4 v241, s[32:35], s88 offen sc1 lds
  v_mfma_f32_16x16x32_bf16 v[128:131], a[0:3], a[240:243], v[128:131]
  ds_read_b64_tr_b16 a[20:21], v161 offset:28672
  s_waitcnt lgkmcnt(5)
  v_mfma_f32_16x16x32_bf16 v[4:7], a[4:7], a[56:59], v[4:7]
  ds_read_b64_tr_b16 a[22:23], v161 offset:30720
  v_mfma_f32_16x16x32_bf16 v[36:39], a[4:7], a[60:63], v[36:39]
  s_add_u32 m0, s86, 9216
  s_add_u32 s88, s87, 1024
  buffer_load_dwordx4 v241, s[32:35], s88 offen sc1 lds
  v_mfma_f32_16x16x32_bf16 v[68:71], a[4:7], a[64:67], v[68:71]
  v_mfma_f32_16x16x32_bf16 v[100:103], a[4:7], a[68:71], v[100:103]
  v_mfma_f32_16x16x32_bf16 v[132:135], a[4:7], a[240:243], v[132:135]
  s_add_u32 m0, s86, 10240
  s_add_u32 s88, s87, 2048
  buffer_load_dwordx4 v241, s[32:35], s88 offen sc1 lds
  ds_read_b64_tr_b16 a[24:25], v162 offset:28672
  v_mfma_f32_16x16x32_bf16 v[8:11], a[8:11], a[56:59], v[8:11]
  ds_read_b64_tr_b16 a[26:27], v162 offset:30720
  v_mfma_f32_16x16x32_bf16 v[40:43], a[8:11], a[60:63], v[40:43]
  v_mfma_f32_16x16x32_bf16 v[72:75], a[8:11], a[64:67], v[72:75]
  s_add_u32 m0, s86, 11264
  s_add_u32 s88, s87, 3072
  buffer_load_dwordx4 v241, s[32:35], s88 offen sc1 lds
  v_mfma_f32_16x16x32_bf16 v[104:107], a[8:11], a[68:71], v[104:107]
  v_mfma_f32_16x16x32_bf16 v[136:139], a[8:11], a[240:243], v[136:139]
  ds_read_b64_tr_b16 a[28:29], v163 offset:28672
  s_waitcnt lgkmcnt(5)
  v_mfma_f32_16x16x32_bf16 v[12:15], a[12:15], a[56:59], v[12:15]
  s_add_u32 m0, s86, 12288
  s_add_u32 s88, s87, 4096
  buffer_load_dwordx4 v241, s[32:35], s88 offen sc1 lds
  ds_read_b64_tr_b16 a[30:31], v163 offset:30720
  v_mfma_f32_16x16x32_bf16 v[44:47], a[12:15], a[60:63], v[44:47]
  v_mfma_f32_16x16x32_bf16 v[76:79], a[12:15], a[64:67], v[76:79]
  v_mfma_f32_16x16x32_bf16 v[108:111], a[12:15], a[68:71], v[108:111]
  v_mfma_f32_16x16x32_bf16 v[140:143], a[12:15], a[240:243], v[140:143]
  v_mfma_f32_16x16x32_bf16 v[16:19], a[16:19], a[56:59], v[16:19]
  v_mfma_f32_16x16x32_bf16 v[48:51], a[16:19], a[60:63], v[48:51]
  v_mfma_f32_16x16x32_bf16 v[80:83], a[16:19], a[64:67], v[80:83]
  v_mfma_f32_16x16x32_bf16 v[112:115], a[16:19], a[68:71], v[112:115]
  s_waitcnt lgkmcnt(2)
  v_mfma_f32_16x16x32_bf16 v[20:23], a[20:23], a[56:59], v[20:23]
  v_mfma_f32_16x16x32_bf16 v[52:55], a[20:23], a[60:63], v[52:55]
  v_mfma_f32_16x16x32_bf16 v[84:87], a[20:23], a[64:67], v[84:87]
  v_mfma_f32_16x16x32_bf16 v[116:119], a[20:23], a[68:71], v[116:119]
  s_waitcnt lgkmcnt(0)
  s_barrier
  v_mfma_f32_16x16x32_bf16 v[24:27], a[24:27], a[56:59], v[24:27]
  v_mfma_f32_16x16x32_bf16 v[56:59], a[24:27], a[60:63], v[56:59]
  v_mfma_f32_16x16x32_bf16 v[88:91], a[24:27], a[64:67], v[88:91]
  v_mfma_f32_16x16x32_bf16 v[120:123], a[24:27], a[68:71], v[120:123]
  v_mfma_f32_16x16x32_bf16 v[28:31], a[28:31], a[56:59], v[28:31]
  v_mfma_f32_16x16x32_bf16 v[60:63], a[28:31], a[60:63], v[60:63]
  v_mfma_f32_16x16x32_bf16 v[92:95], a[28:31], a[64:67], v[92:95]
  v_mfma_f32_16x16x32_bf16 v[124:127], a[28:31], a[68:71], v[124:127]
  s_branch L_ep_ffn
L_pp_ffn_1:
  buffer_load_dwordx2 v[252:253], v249, s[76:79], 0 offen sc1
  s_branch L_np_ffn_1
L_pu_ffn_1:
  s_lshr_b32 s46, s68, 2
  s_and_b32 s47, s68, 3
  s_mul_i32 s46, s46, 5120
  s_mul_i32 s47, s47, 757760
  s_add_u32 s46, s46, s47
  s_add_u32 s46, s46, 10485760
  s_cmp_ge_u32 s68, 296
  s_cselect_b32 s46, 0x30000000, s46
  v_add_u32_e64 v213, s67, v206
  ds_read_b64_tr_b16 v[216:217], v213
  ds_read_b64_tr_b16 v[218:219], v213 offset:5120
  v_add_u32_e64 v214, s67, v207
  ds_read_b64_tr_b16 v[220:221], v214
  ds_read_b64_tr_b16 v[222:223], v214 offset:5120
  v_add_u32_e64 v215, s67, v208
  ds_read_b64_tr_b16 v[224:225], v215
  ds_read_b64_tr_b16 v[226:227], v215 offset:5120
  s_add_u32 s47, s46, s64
  s_waitcnt lgkmcnt(0)
  buffer_store_dwordx4 v[216:219], v241, s[32:35], s47 offen sc1
  s_add_u32 s47, s46, s65
  s_waitcnt lgkmcnt(0)
  buffer_store_dwordx4 v[220:223], v241, s[32:35], s47 offen sc1
  s_add_u32 s47, s46, s66
  s_waitcnt lgkmcnt(0)
  buffer_store_dwordx4 v[224:227], v241, s[32:35], s47 offen sc1
  s_branch L_nu_ffn_1
L_ffn_2:
  v_lshlrev_b32 v241, 4, v255
  s_lshl_b32 s46, s22, 6
  v_add_u32 v1, s46, v255
  v_mul_u32_u24 v2, 3277, v1
  v_lshrrev_b32 v2, 16, v2
  v_mul_u32_u24 v3, 20, v2
  v_sub_u32_e64 v3, v1, v3
  v_mul_u32_u24 v4, 1280, v2
  v_lshl_add_u32 v200, v3, 4, v4
  v_lshrrev_b32 v203, 4, v2
  v_add_u32 v1, s46, v255
  v_add_u32 v1, 256, v1
  v_mul_u32_u24 v2, 3277, v1
  v_lshrrev_b32 v2, 16, v2
  v_mul_u32_u24 v3, 20, v2
  v_sub_u32_e64 v3, v1, v3
  v_mul_u32_u24 v4, 1280, v2
  v_lshl_add_u32 v201, v3, 4, v4
  v_lshrrev_b32 v204, 4, v2
  v_add_u32 v1, s46, v255
  v_add_u32 v1, 512, v1
  v_mul_u32_u24 v2, 3277, v1
  v_lshrrev_b32 v2, 16, v2
  v_mul_u32_u24 v3, 20, v2
  v_sub_u32_e64 v3, v1, v3
  v_mul_u32_u24 v4, 1280, v2
  v_lshl_add_u32 v202, v3, 4, v4
  v_lshrrev_b32 v205, 4, v2
  v_mov_b32 v5, 0x40000000
  v_cmp_le_u32 vcc, 640, v1
  s_nop 1
  v_cndmask_b32_e64 v202, v202, v5, vcc
  v_cndmask_b32_e64 v205, v205, 0, vcc
  v_and_b32 v1, 15, v255
  v_lshrrev_b32 v2, 2, v1
  v_and_b32 v3, 3, v1
  v_lshrrev_b32_e64 v4, 4, v255
  v_lshl_add_u32 v2, v4, 2, v2
  v_mul_u32_u24 v2, 320, v2
  s_add_u32 s46, s22, 0
  s_cmp_ge_u32 s46, 5
  s_cselect_b32 s47, 1, 0
  s_mul_i32 s48, s47, 5
  s_sub_u32 s48, s46, s48
  s_lshr_b32 s49, s48, 1
  s_lshl_b32 s49, s49, 6
  s_and_b32 s90, s48, 1
  s_lshl_b32 s90, s90, 3
  s_add_u32 s49, s49, s90
  s_mul_i32 s90, s47, 160
  s_add_u32 s49, s49, s90
  s_cmp_eq_u32 s48, 4
  s_cselect_b32 s90, 3, 4
  v_lshlrev_b32 v5, s90, v3
  v_add3_u32 v206, v5, v2, s49
  s_mul_i32 s64, s47, 378880
  s_lshl_b32 s90, s48, 10
  s_add_u32 s64, s64, s90
  s_cmp_ge_u32 s46, 10
  s_cselect_b32 s64, 0x40000000, s64
  s_add_u32 s46, s22, 4
  s_cmp_ge_u32 s46, 5
  s_cselect_b32 s47, 1, 0
  s_mul_i32 s48, s47, 5
  s_sub_u32 s48, s46, s48
  s_lshr_b32 s49, s48, 1
  s_lshl_b32 s49, s49, 6
  s_and_b32 s90, s48, 1
  s_lshl_b32 s90, s90, 3
  s_add_u32 s49, s49, s90
  s_mul_i32 s90, s47, 160
  s_add_u32 s49, s49, s90
  s_cmp_eq_u32 s48, 4
  s_cselect_b32 s90, 3, 4
  v_lshlrev_b32 v5, s90, v3
  v_add3_u32 v207, v5, v2, s49
  s_mul_i32 s65, s47, 378880
  s_lshl_b32 s90, s48, 10
  s_add_u32 s65, s65, s90
  s_cmp_ge_u32 s46, 10
  s_cselect_b32 s65, 0x40000000, s65
  s_add_u32 s46, s22, 8
  s_cmp_ge_u32 s46, 5
  s_cselect_b32 s47, 1, 0
  s_mul_i32 s48, s47, 5
  s_sub_u32 s48, s46, s48
  s_lshr_b32 s49, s48, 1
  s_lshl_b32 s49, s49, 6
  s_and_b32 s90, s48, 1
  s_lshl_b32 s90, s90, 3
  s_add_u32 s49, s49, s90
  s_mul_i32 s90, s47, 160
  s_add_u32 s49, s49, s90
  s_cmp_eq_u32 s48, 4
  s_cselect_b32 s90, 3, 4
  v_lshlrev_b32 v5, s90, v3
  v_add3_u32 v208, v5, v2, s49
  s_mul_i32 s66, s47, 378880
  s_lshl_b32 s90, s48, 10
  s_add_u32 s66, s66, s90
  s_cmp_ge_u32 s46, 10
  s_cselect_b32 s66, 0x40000000, s66
  s_mov_b32 s69, 819200
  s_mov_b32 s70, 2211840
  s_mov_b32 s67, 147456
  v_and_b32 v1, 15, v255
  v_lshrrev_b32 v2, 2, v1
  v_and_b32 v3, 3, v1
  v_lshrrev_b32 v4, 4, v255
  v_lshl_add_u32 v2, v4, 2, v2
  v_lshrrev_b32 v5, 1, v2
  v_and_b32 v5, 3, v5
  v_lshlrev_b32_e64 v2, 7, v2
  v_lshl_add_u32 v2, v3, 3, v2
  v_add_u32 v2, 16384, v2
  v_xor_b32_e64 v6, 0, v5
  v_lshl_add_u32 v160, v6, 5, v2
  v_xor_b32_e64 v6, 1, v5
  v_lshl_add_u32 v161, v6, 5, v2
  v_xor_b32_e64 v6, 2, v5
  v_lshl_add_u32 v162, v6, 5, v2
  v_xor_b32_e64 v6, 3, v5
  v_lshl_add_u32 v163, v6, 5, v2
  v_and_b32 v1, 15, v255
  v_lshrrev_b32 v4, 4, v255
  v_lshrrev_b32 v2, 1, v1
  v_xor_b32 v2, v2, v4
  v_lshlrev_b32_e64 v2, 4, v2
  v_lshl_add_u32 v2, v1, 7, v2
  v_add_u32 v164, 0, v2
  v_xor_b32 v2, 64, v2
  v_add_u32_e64 v165, 0, v2
  s_add_u32 s90, s92, 81920
  v_add_u32_e64 v169, s90, v166
  s_add_u32 s90, s92, 91136
  v_add_u32_e64 v170, s90, v167
  s_add_u32 s90, s92, 100352
  v_add_u32_e64 v171, s90, v166
  s_add_u32 s90, s92, 109568
  v_add_u32_e64 v172, s90, v167
  v_add_u32 v173, 256, v168
  v_add_u32 v174, 54528, v168
  v_add_u32 v175, 12032, v168
  v_add_u32 v176, 66304, v168
  v_add_u32 v177, 110848, v168
  v_add_u32 v178, 165120, v168
  v_add_u32 v179, 122624, v168
  v_add_u32 v180, 176896, v168
  v_mov_b32 v232, 0
  v_mov_b32 v233, 0
  v_mov_b32 v234, 0
  v_mov_b32_e64 v235, 0
  s_nop 1
  v_mfma_f32_32x32x16_bf16 v[0:15], v[232:235], v[232:235], 0
  v_mfma_f32_32x32x16_bf16 v[16:31], v[232:235], v[232:235], 0
  v_mfma_f32_32x32x16_bf16 v[32:47], v[232:235], v[232:235], 0
  v_mfma_f32_32x32x16_bf16 v[48:63], v[232:235], v[232:235], 0
  v_mfma_f32_32x32x16_bf16 v[64:79], v[232:235], v[232:235], 0
  v_mfma_f32_32x32x16_bf16 v[80:95], v[232:235], v[232:235], 0
  v_mfma_f32_32x32x16_bf16 v[96:111], v[232:235], v[232:235], 0
  v_mfma_f32_32x32x16_bf16 v[112:127], v[232:235], v[232:235], 0
  v_mfma_f32_32x32x16_bf16 v[128:143], v[232:235], v[232:235], 0
  v_mov_b32 v254, 0x3f803f80
  v_accvgpr_write_b32 a240, v254
  v_accvgpr_write_b32 a241, v254
  v_accvgpr_write_b32 a242, v254
  v_accvgpr_write_b32 a243, v254
  v_mov_b32 v249, 0
  s_lshl_b32 s39, s38, 7
  s_mul_i32 s40, s38, 221184
  s_mov_b32 s41, 49152
  s_add_u32 m0, s41, 8192
  s_nop 0
  buffer_load_dwordx4 v169, s[24:27], s39 offen offset:0 lds
  buffer_load_dwordx4 v170, s[24:27], s39 offen offset:1024 lds
  buffer_load_dwordx4 v171, s[24:27], s39 offen offset:2048 lds
  buffer_load_dwordx4 v172, s[24:27], s39 offen offset:3072 lds
  s_add_u32 m0, s41, 32768
  s_nop 0
  buffer_load_dwordx4 v173, s[28:31], s40 offen offset:0 lds
  buffer_load_dwordx4 v174, s[28:31], s40 offen offset:1024 lds
  buffer_load_dwordx4 v175, s[28:31], s40 offen offset:2048 lds
  buffer_load_dwordx4 v176, s[28:31], s40 offen offset:3072 lds
  s_add_u32 m0, s41, 36864
  s_nop 0
  buffer_load_dwordx4 v177, s[28:31], s40 offen offset:0 lds
  buffer_load_dwordx4 v178, s[28:31], s40 offen offset:1024 lds
  buffer_load_dwordx4 v179, s[28:31], s40 offen offset:2048 lds
  buffer_load_dwordx4 v180, s[28:31], s40 offen offset:3072 lds
  s_add_u32 s38, s38, 1
  s_cmp_eq_u32 s38, 10
  s_cselect_b32 s38, 0, s38
  s_lshr_b32 s46, s68, 2
  s_and_b32 s47, s68, 3
  s_mul_i32 s48, s46, 52
  s_lshr_b32 s48, s48, 8
  s_mul_i32 s49, s48, 5
  s_sub_u32 s49, s46, s49
  s_mul_i32 s48, s48, 160
  s_lshl_b32 s90, s49, 5
  s_cmp_ge_u32 s49, 2
  s_cselect_b32 s91, 16, 0
  s_add_u32 s90, s90, s91
  s_cmp_eq_u32 s49, 4
  s_cselect_b32 s90, 64, s90
  s_cselect_b32 s91, 81920, 0
  s_add_u32 s90, s90, s48
  s_sub_u32 s48, s46, 20
  s_lshl_b32 s48, s48, 5
  s_cmp_lt_u32 s46, 20
  s_cselect_b32 s90, s90, s48
  s_cselect_b32 s91, s91, 0
  s_cselect_b32 s60, s8, s14
  s_cselect_b32 s61, s9, s15
  s_cselect_b32 s62, s69, s70
  s_and_b32 s61, s61, 0xffff
  s_mov_b32 s63, 0x20000
  s_mul_i32 s90, s90, 1280
  s_mul_i32 s47, s47, 320
  s_add_u32 s90, s90, s47
  s_cmp_ge_u32 s68, 296
  s_cselect_b32 s90, 0x7f000000, s90
  s_lshl_b32 s46, s22, 10
  s_add_u32 s46, s46, s67
  v_mad_u32_u24 v210, v203, s91, v200
  s_add_u32 m0, s46, 0
  s_nop 0
  buffer_load_dwordx4 v210, s[60:63], s90 offen lds
  v_mad_u32_u24 v211, v204, s91, v201
  s_add_u32 m0, s46, 4096
  s_nop 0
  buffer_load_dwordx4 v211, s[60:63], s90 offen lds
  v_mad_u32_u24 v212, v205, s91, v202
  s_add_u32 s47, s46, 8192
  s_cmp_ge_u32 s22, 2
  s_cselect_b32 m0, 161792, s47
  s_nop 0
  buffer_load_dwordx4 v212, s[60:63], s90 offen lds
  s_and_b32 s46, s2, 7
  s_lshr_b32 s47, s2, 3
  s_lshr_b32 s80, s47, 3
  s_lshl_b32 s46, s46, 2
  s_add_u32 s80, s80, s46
  s_and_b32 s81, s47, 7
  s_lshr_b32 s89, s80, 1
  s_lshl_b32 s89, s89, 2
  s_mul_i32 s83, s81, 378880
  s_add_u32 s83, s83, 10485760
  s_mul_i32 s84, s80, 303104
  s_mul_i32 s85, s22, 12288
  s_add_u32 s85, s85, 49152
  s_mul_i32 s86, s22, 13312
  s_add_u32 s86, s86, 98304
  s_mul_i32 s46, s81, 7
  s_lshr_b32 s46, s46, 2
  s_and_b32 s47, s80, 3
  s_mul_i32 s47, s47, 7
  s_lshr_b32 s47, s47, 1
  s_add_u32 s46, s46, s47
  s_sub_u32 s47, s46, 14
  s_cmp_ge_u32 s46, 14
  s_cselect_b32 s46, s47, s46
  s_lshl_b32 s46, s46, 2
  s_add_u32 s46, s46, s22
  s_add_u32 s46, s46, 20
  s_lshl_b32 s4, s46, 10
  s_cmp_ge_u32 s46, 74
  s_cselect_b32 s4, 0x10000000, s4
  s_add_u32 s46, s46, 4
  s_sub_u32 s47, s46, 56
  s_cmp_ge_u32 s46, 76
  s_cselect_b32 s46, s47, s46
  s_lshl_b32 s5, s46, 10
  s_cmp_ge_u32 s46, 74
  s_cselect_b32 s5, 0x10000000, s5
  s_add_u32 s46, s46, 4
  s_sub_u32 s47, s46, 56
  s_cmp_ge_u32 s46, 76
  s_cselect_b32 s46, s47, s46
  s_lshl_b32 s6, s46, 10
  s_cmp_ge_u32 s46, 74
  s_cselect_b32 s6, 0x10000000, s6
  s_add_u32 s46, s46, 4
  s_sub_u32 s47, s46, 56
  s_cmp_ge_u32 s46, 76
  s_cselect_b32 s46, s47, s46
  s_lshl_b32 s7, s46, 10
  s_cmp_ge_u32 s46, 74
  s_cselect_b32 s7, 0x10000000, s7
  s_add_u32 s46, s46, 4
  s_sub_u32 s47, s46, 56
  s_cmp_ge_u32 s46, 76
  s_cselect_b32 s46, s47, s46
  s_lshl_b32 s8, s46, 10
  s_cmp_ge_u32 s46, 74
  s_cselect_b32 s8, 0x10000000, s8
  s_add_u32 s46, s46, 4
  s_sub_u32 s47, s46, 56
  s_cmp_ge_u32 s46, 76
  s_cselect_b32 s46, s47, s46
  s_lshl_b32 s9, s46, 10
  s_cmp_ge_u32 s46, 74
  s_cselect_b32 s9, 0x10000000, s9
  s_add_u32 s46, s46, 4
  s_sub_u32 s47, s46, 56
  s_cmp_ge_u32 s46, 76
  s_cselect_b32 s46, s47, s46
  s_lshl_b32 s10, s46, 10
  s_cmp_ge_u32 s46, 74
  s_cselect_b32 s10, 0x10000000, s10
  s_add_u32 s46, s46, 4
  s_sub_u32 s47, s46, 56
  s_cmp_ge_u32 s46, 76
  s_cselect_b32 s46, s47, s46
  s_lshl_b32 s11, s46, 10
  s_cmp_ge_u32 s46, 74
  s_cselect_b32 s11, 0x10000000, s11
  s_add_u32 s46, s46, 4
  s_sub_u32 s47, s46, 56
  s_cmp_ge_u32 s46, 76
  s_cselect_b32 s46, s47, s46
  s_lshl_b32 s12, s46, 10
  s_cmp_ge_u32 s46, 74
  s_cselect_b32 s12, 0x10000000, s12
  s_add_u32 s46, s46, 4
  s_sub_u32 s47, s46, 56
  s_cmp_ge_u32 s46, 76
  s_cselect_b32 s46, s47, s46
  s_lshl_b32 s13, s46, 10
  s_cmp_ge_u32 s46, 74
  s_cselect_b32 s13, 0x10000000, s13
  s_add_u32 s46, s46, 4
  s_sub_u32 s47, s46, 56
  s_cmp_ge_u32 s46, 76
  s_cselect_b32 s46, s47, s46
  s_lshl_b32 s14, s46, 10
  s_cmp_ge_u32 s46, 74
  s_cselect_b32 s14, 0x10000000, s14
  s_add_u32 s46, s46, 4
  s_sub_u32 s47, s46, 56
  s_cmp_ge_u32 s46, 76
  s_cselect_b32 s46, s47, s46
  s_lshl_b32 s15, s46, 10
  s_cmp_ge_u32 s46, 74
  s_cselect_b32 s15, 0x10000000, s15
  s_add_u32 s46, s46, 4
  s_sub_u32 s47, s46, 56
  s_cmp_ge_u32 s46, 76
  s_cselect_b32 s46, s47, s46
  s_lshl_b32 s18, s46, 10
  s_cmp_ge_u32 s46, 74
  s_cselect_b32 s18, 0x10000000, s18
  s_add_u32 s46, s46, 4
  s_sub_u32 s47, s46, 56
  s_cmp_ge_u32 s46, 76
  s_cselect_b32 s46, s47, s46
  s_lshl_b32 s19, s46, 10
  s_cmp_ge_u32 s46, 74
  s_cselect_b32 s19, 0x10000000, s19
  v_add_u32 v245, 4096, v241
  s_lshl_b32 s45, s2, 7
  s_add_u32 s45, s45, 15728640
  s_lshl_b32 s39, s38, 7
  s_mul_i32 s40, s38, 221184
  s_mov_b32 s41, 98304
  s_mov_b32 s94, 49152
  s_mov_b32 s95, 4294868992
  s_mov_b32 s43, 0
  s_waitcnt vmcnt(15) lgkmcnt(0)
  s_barrier
  ds_read_b128 a[40:43], v164 offset:8192
  ds_read_b128 a[44:47], v164 offset:10240
  ds_read_b128 a[48:51], v164 offset:12288
  ds_read_b128 a[52:55], v164 offset:14336
  ds_read_b64_tr_b16 a[0:1], v160 offset:0
  ds_read_b64_tr_b16 a[2:3], v160 offset:2048
  ds_read_b64_tr_b16 a[4:5], v161 offset:0
  ds_read_b64_tr_b16 a[6:7], v161 offset:2048
  ds_read_b64_tr_b16 a[8:9], v162 offset:0
  ds_read_b64_tr_b16 a[10:11], v162 offset:2048
  ds_read_b64_tr_b16 a[12:13], v163 offset:0
  ds_read_b64_tr_b16 a[14:15], v163 offset:2048
L_loop_ffn_2:
  ds_read_b64_tr_b16 a[16:17], v160 offset:8192
  s_waitcnt lgkmcnt(5)
  v_mfma_f32_16x16x32_bf16 v[0:3], a[0:3], a[40:43], v[0:3]
  ds_read_b64_tr_b16 a[18:19], v160 offset:10240
  v_mfma_f32_16x16x32_bf16 v[32:35], a[0:3], a[44:47], v[32:35]
  v_mfma_f32_16x16x32_bf16 v[64:67], a[0:3], a[48:51], v[64:67]
  v_mfma_f32_16x16x32_bf16 v[96:99], a[0:3], a[52:55], v[96:99]
  s_cmp_lg_u32 s43, 7
  s_cbranch_scc0 L_pp_ffn_2
L_np_ffn_2:
  s_cmp_lg_u32 s43, 1
  s_cbranch_scc0 L_pu_ffn_2
L_nu_ffn_2:
  ds_read_b64_tr_b16 a[20:21], v161 offset:8192
  v_mfma_f32_16x16x32_bf16 v[4:7], a[4:7], a[40:43], v[4:7]
  ds_read_b64_tr_b16 a[22:23], v161 offset:10240
  v_mfma_f32_16x16x32_bf16 v[36:39], a[4:7], a[44:47], v[36:39]
  v_mfma_f32_16x16x32_bf16 v[68:71], a[4:7], a[48:51], v[68:71]
  s_add_u32 m0, s41, 8192
  v_mfma_f32_16x16x32_bf16 v[100:103], a[4:7], a[52:55], v[100:103]
  ds_read_b64_tr_b16 a[24:25], v162 offset:8192
  ds_read_b64_tr_b16 a[26:27], v162 offset:10240
  s_waitcnt lgkmcnt(6)
  v_mfma_f32_16x16x32_bf16 v[8:11], a[8:11], a[40:43], v[8:11]
  ds_read_b128 a[56:59], v165 offset:8192
  ds_read_b128 a[60:63], v165 offset:10240
  v_mfma_f32_16x16x32_bf16 v[40:43], a[8:11], a[44:47], v[40:43]
  ds_read_b128 a[64:67], v165 offset:12288
  v_mfma_f32_16x16x32_bf16 v[72:75], a[8:11], a[48:51], v[72:75]
  buffer_load_dwordx4 v169, s[24:27], s39 offen offset:0 lds
  ds_read_b128 a[68:71], v165 offset:14336
  v_mfma_f32_16x16x32_bf16 v[104:107], a[8:11], a[52:55], v[104:107]
  ds_read_b64_tr_b16 a[28:29], v163 offset:8192
  v_mfma_f32_16x16x32_bf16 v[12:15], a[12:15], a[40:43], v[12:15]
  ds_read_b64_tr_b16 a[30:31], v163 offset:10240
  v_mfma_f32_16x16x32_bf16 v[44:47], a[12:15], a[44:47], v[44:47]
  buffer_load_dwordx4 v170, s[24:27], s39 offen offset:1024 lds
  v_mfma_f32_16x16x32_bf16 v[76:79], a[12:15], a[48:51], v[76:79]
  v_mfma_f32_16x16x32_bf16 v[108:111], a[12:15], a[52:55], v[108:111]
  ds_read_b64_tr_b16 a[0:1], v160 offset:4096
  s_waitcnt lgkmcnt(9)
  v_mfma_f32_16x16x32_bf16 v[16:19], a[16:19], a[40:43], v[16:19]
  ds_read_b64_tr_b16 a[2:3], v160 offset:6144
  v_mfma_f32_16x16x32_bf16 v[48:51], a[16:19], a[44:47], v[48:51]
  buffer_load_dwordx4 v171, s[24:27], s39 offen offset:2048 lds
  v_mfma_f32_16x16x32_bf16 v[80:83], a[16:19], a[48:51], v[80:83]
  v_mfma_f32_16x16x32_bf16 v[112:115], a[16:19], a[52:55], v[112:115]
  v_mfma_f32_16x16x32_bf16 v[128:131], a[16:19], a[240:243], v[128:131]
  buffer_load_dwordx4 v172, s[24:27], s39 offen offset:3072 lds
  s_add_u32 m0, s41, 32768
  ds_read_b64_tr_b16 a[4:5], v161 offset:4096
  v_mfma_f32_16x16x32_bf16 v[20:23], a[20:23], a[40:43], v[20:23]
  ds_read_b64_tr_b16 a[6:7], v161 offset:6144
  v_mfma_f32_16x16x32_bf16 v[52:55], a[20:23], a[44:47], v[52:55]
  v_mfma_f32_16x16x32_bf16 v[84:87], a[20:23], a[48:51], v[84:87]
  v_mfma_f32_16x16x32_bf16 v[116:119], a[20:23], a[52:55], v[116:119]
  buffer_load_dwordx4 v173, s[28:31], s40 offen offset:0 lds
  v_mfma_f32_16x16x32_bf16 v[132:135], a[20:23], a[240:243], v[132:135]
  ds_read_b64_tr_b16 a[8:9], v162 offset:4096
  s_waitcnt lgkmcnt(9)
  v_mfma_f32_16x16x32_bf16 v[24:27], a[24:27], a[40:43], v[24:27]
  ds_read_b64_tr_b16 a[10:11], v162 offset:6144
  v_mfma_f32_16x16x32_bf16 v[56:59], a[24:27], a[44:47], v[56:59]
  v_mfma_f32_16x16x32_bf16 v[88:91], a[24:27], a[48:51], v[88:91]
  buffer_load_dwordx4 v174, s[28:31], s40 offen offset:1024 lds
  v_mfma_f32_16x16x32_bf16 v[120:123], a[24:27], a[52:55], v[120:123]
  v_mfma_f32_16x16x32_bf16 v[136:139], a[24:27], a[240:243], v[136:139]
  ds_read_b64_tr_b16 a[12:13], v163 offset:4096
  s_waitcnt lgkmcnt(5)
  v_mfma_f32_16x16x32_bf16 v[28:31], a[28:31], a[40:43], v[28:31]
  buffer_load_dwordx4 v175, s[28:31], s40 offen offset:2048 lds
  ds_read_b64_tr_b16 a[14:15], v163 offset:6144
  v_mfma_f32_16x16x32_bf16 v[60:63], a[28:31], a[44:47], v[60:63]
  v_mfma_f32_16x16x32_bf16 v[92:95], a[28:31], a[48:51], v[92:95]
  v_mfma_f32_16x16x32_bf16 v[124:127], a[28:31], a[52:55], v[124:127]
  v_mfma_f32_16x16x32_bf16 v[140:143], a[28:31], a[240:243], v[140:143]
  buffer_load_dwordx4 v176, s[28:31], s40 offen offset:3072 lds
  s_add_u32 m0, s41, 36864
  ds_read_b64_tr_b16 a[16:17], v160 offset:12288
  v_mfma_f32_16x16x32_bf16 v[0:3], a[0:3], a[56:59], v[0:3]
  ds_read_b64_tr_b16 a[18:19], v160 offset:14336
  v_mfma_f32_16x16x32_bf16 v[32:35], a[0:3], a[60:63], v[32:35]
  v_mfma_f32_16x16x32_bf16 v[64:67], a[0:3], a[64:67], v[64:67]
  buffer_load_dwordx4 v177, s[28:31], s40 offen offset:0 lds
  v_mfma_f32_16x16x32_bf16 v[96:99], a[0:3], a[68:71], v[96:99]
  ds_read_b64_tr_b16 a[20:21], v161 offset:12288
  s_waitcnt lgkmcnt(5)
  v_mfma_f32_16x16x32_bf16 v[4:7], a[4:7], a[56:59], v[4:7]
  ds_read_b64_tr_b16 a[22:23], v161 offset:14336
  v_mfma_f32_16x16x32_bf16 v[36:39], a[4:7], a[60:63], v[36:39]
  v_mfma_f32_16x16x32_bf16 v[68:71], a[4:7], a[64:67], v[68:71]
  buffer_load_dwordx4 v178, s[28:31], s40 offen offset:1024 lds
  v_mfma_f32_16x16x32_bf16 v[100:103], a[4:7], a[68:71], v[100:103]
  ds_read_b64_tr_b16 a[24:25], v162 offset:12288
  v_mfma_f32_16x16x32_bf16 v[8:11], a[8:11], a[56:59], v[8:11]
  ds_read_b64_tr_b16 a[26:27], v162 offset:14336
  v_mfma_f32_16x16x32_bf16 v[40:43], a[8:11], a[60:63], v[40:43]
  buffer_load_dwordx4 v179, s[28:31], s40 offen offset:2048 lds
  v_mfma_f32_16x16x32_bf16 v[72:75], a[8:11], a[64:67], v[72:75]
  v_mfma_f32_16x16x32_bf16 v[104:107], a[8:11], a[68:71], v[104:107]
  ds_read_b64_tr_b16 a[28:29], v163 offset:12288
  s_waitcnt lgkmcnt(5)
  v_mfma_f32_16x16x32_bf16 v[12:15], a[12:15], a[56:59], v[12:15]
  ds_read_b64_tr_b16 a[30:31], v163 offset:14336
  v_mfma_f32_16x16x32_bf16 v[44:47], a[12:15], a[60:63], v[44:47]
  buffer_load_dwordx4 v180, s[28:31], s40 offen offset:3072 lds
  v_mfma_f32_16x16x32_bf16 v[76:79], a[12:15], a[64:67], v[76:79]
  v_mfma_f32_16x16x32_bf16 v[108:111], a[12:15], a[68:71], v[108:111]
  v_mfma_f32_16x16x32_bf16 v[16:19], a[16:19], a[56:59], v[16:19]
  v_mfma_f32_16x16x32_bf16 v[48:51], a[16:19], a[60:63], v[48:51]
  v_mfma_f32_16x16x32_bf16 v[80:83], a[16:19], a[64:67], v[80:83]
  v_mfma_f32_16x16x32_bf16 v[112:115], a[16:19], a[68:71], v[112:115]
  v_mfma_f32_16x16x32_bf16 v[128:131], a[16:19], a[240:243], v[128:131]
  s_waitcnt lgkmcnt(2)
  v_mfma_f32_16x16x32_bf16 v[20:23], a[20:23], a[56:59], v[20:23]
  v_mfma_f32_16x16x32_bf16 v[52:55], a[20:23], a[60:63], v[52:55]
  v_mfma_f32_16x16x32_bf16 v[84:87], a[20:23], a[64:67], v[84:87]
  v_mfma_f32_16x16x32_bf16 v[116:119], a[20:23], a[68:71], v[116:119]
  v_mfma_f32_16x16x32_bf16 v[132:135], a[20:23], a[240:243], v[132:135]
  s_waitcnt vmcnt(12) lgkmcnt(0)
  s_barrier
  v_mfma_f32_16x16x32_bf16 v[24:27], a[24:27], a[56:59], v[24:27]
  s_cmp_eq_u32 s41, 49152
  s_cselect_b32 s42, s95, s94
  v_add_u32_e64 v160, s42, v160
  v_mfma_f32_16x16x32_bf16 v[56:59], a[24:27], a[60:63], v[56:59]
  v_add_u32 v161, s42, v161
  v_add_u32 v162, s42, v162
  v_add_u32_e64 v163, s42, v163
  v_mfma_f32_16x16x32_bf16 v[88:91], a[24:27], a[64:67], v[88:91]
  v_add_u32 v164, s42, v164
  v_add_u32 v165, s42, v165
  ds_read_b128 a[40:43], v164 offset:8192
  v_mfma_f32_16x16x32_bf16 v[120:123], a[24:27], a[68:71], v[120:123]
  ds_read_b128 a[44:47], v164 offset:10240
  ds_read_b128 a[48:51], v164 offset:12288
  ds_read_b128 a[52:55], v164 offset:14336
  v_mfma_f32_16x16x32_bf16 v[136:139], a[24:27], a[240:243], v[136:139]
  ds_read_b64_tr_b16 a[0:1], v160 offset:0
  ds_read_b64_tr_b16 a[2:3], v160 offset:2048
  ds_read_b64_tr_b16 a[4:5], v161 offset:0
  v_mfma_f32_16x16x32_bf16 v[28:31], a[28:31], a[56:59], v[28:31]
  ds_read_b64_tr_b16 a[6:7], v161 offset:2048
  ds_read_b64_tr_b16 a[8:9], v162 offset:0
  ds_read_b64_tr_b16 a[10:11], v162 offset:2048
  v_mfma_f32_16x16x32_bf16 v[60:63], a[28:31], a[60:63], v[60:63]
  ds_read_b64_tr_b16 a[12:13], v163 offset:0
  ds_read_b64_tr_b16 a[14:15], v163 offset:2048
  s_add_u32 s38, s38, 1
  v_mfma_f32_16x16x32_bf16 v[92:95], a[28:31], a[64:67], v[92:95]
  s_cmp_eq_u32 s38, 10
  s_cselect_b32 s38, 0, s38
  s_lshl_b32 s39, s38, 7
  v_mfma_f32_16x16x32_bf16 v[124:127], a[28:31], a[68:71], v[124:127]
  s_mul_i32 s40, s38, 221184
  s_cmp_eq_u32 s41, 98304
  s_cselect_b32 s42, s95, s94
  v_mfma_f32_16x16x32_bf16 v[140:143], a[28:31], a[240:243], v[140:143]
  s_add_u32 s41, s41, s42
  s_add_u32 s43, s43, 1
  s_cmp_lt_u32 s43, 8
  s_cbranch_scc1 L_loop_ffn_2
  v_readfirstlane_b32 s23, v252
  s_nop 3
  s_cmp_lg_u32 s23, 0
  s_cbranch_scc1 L_nok_ffn_2
  s_mov_b32 s47, 0
  v_mov_b32_e64 v251, 0
L_nspin_ffn_2:
  buffer_load_dword v250, v251, s[76:79], 0 offen sc1
  s_waitcnt vmcnt(0)
  v_readfirstlane_b32 s23, v250
  s_nop 3
  s_cmp_lg_u32 s23, 0
  s_cbranch_scc1 L_nok_ffn_2
  s_sleep 8
  s_add_u32 s47, s47, 1
  s_cmp_lt_u32 s47, 200000
  s_cbranch_scc1 L_nspin_ffn_2
L_nok_ffn_2:
  v_readfirstlane_b32 s46, v253
  s_nop 3
  s_cmp_ge_u32 s46, 128
  s_cbranch_scc1 L_cok_p_ffn_2
  s_mov_b32 s47, 0
  v_mov_b32_e64 v251, 0
L_cspin_p_ffn_2:
  buffer_load_dword v250, v251, s[76:79], 0 offen offset:4 sc1
  s_waitcnt vmcnt(0)
  v_readfirstlane_b32 s46, v250
  s_nop 3
  s_cmp_ge_u32 s46, 128
  s_cbranch_scc1 L_cok_p_ffn_2
  s_sleep 40
  s_add_u32 s47, s47, 1
  s_cmp_lt_u32 s47, 200000
  s_cbranch_scc1 L_cspin_p_ffn_2
L_cok_p_ffn_2:
  ds_read_b64_tr_b16 a[16:17], v160 offset:8192
  s_waitcnt lgkmcnt(5)
  v_mfma_f32_16x16x32_bf16 v[0:3], a[0:3], a[40:43], v[0:3]
  ds_read_b64_tr_b16 a[18:19], v160 offset:10240
  v_mfma_f32_16x16x32_bf16 v[32:35], a[0:3], a[44:47], v[32:35]
  v_mfma_f32_16x16x32_bf16 v[64:67], a[0:3], a[48:51], v[64:67]
  v_mfma_f32_16x16x32_bf16 v[96:99], a[0:3], a[52:55], v[96:99]
  s_mul_i32 s87, s4, 5
  s_add_u32 s87, s87, s83
  s_add_u32 m0, s85, 0
  s_add_u32 s88, s87, 0
  buffer_load_dwordx4 v241, s[32:35], s88 offen sc1 lds
  ds_read_b64_tr_b16 a[20:21], v161 offset:8192
  v_mfma_f32_16x16x32_bf16 v[4:7], a[4:7], a[40:43], v[4:7]
  ds_read_b64_tr_b16 a[22:23], v161 offset:10240
  v_mfma_f32_16x16x32_bf16 v[36:39], a[4:7], a[44:47], v[36:39]
  v_mfma_f32_16x16x32_bf16 v[68:71], a[4:7], a[48:51], v[68:71]
  v_mfma_f32_16x16x32_bf16 v[100:103], a[4:7], a[52:55], v[100:103]
  s_add_u32 m0, s85, 1024
  s_add_u32 s88, s87, 1024
  buffer_load_dwordx4 v241, s[32:35], s88 offen sc1 lds
  ds_read_b64_tr_b16 a[24:25], v162 offset:8192
  ds_read_b64_tr_b16 a[26:27], v162 offset:10240
  s_waitcnt lgkmcnt(6)
  v_mfma_f32_16x16x32_bf16 v[8:11], a[8:11], a[40:43], v[8:11]
  ds_read_b128 a[56:59], v165 offset:8192
  ds_read_b128 a[60:63], v165 offset:10240
  v_mfma_f32_16x16x32_bf16 v[40:43], a[8:11], a[44:47], v[40:43]
  ds_read_b128 a[64:67], v165 offset:12288
  v_mfma_f32_16x16x32_bf16 v[72:75], a[8:11], a[48:51], v[72:75]
  ds_read_b128 a[68:71], v165 offset:14336
  v_mfma_f32_16x16x32_bf16 v[104:107], a[8:11], a[52:55], v[104:107]
  s_add_u32 m0, s85, 2048
  s_add_u32 s88, s87, 2048
  buffer_load_dwordx4 v241, s[32:35], s88 offen sc1 lds
  ds_read_b64_tr_b16 a[28:29], v163 offset:8192
  v_mfma_f32_16x16x32_bf16 v[12:15], a[12:15], a[40:43], v[12:15]
  ds_read_b64_tr_b16 a[30:31], v163 offset:10240
  v_mfma_f32_16x16x32_bf16 v[44:47], a[12:15], a[44:47], v[44:47]
  v_mfma_f32_16x16x32_bf16 v[76:79], a[12:15], a[48:51], v[76:79]
  v_mfma_f32_16x16x32_bf16 v[108:111], a[12:15], a[52:55], v[108:111]
  s_add_u32 m0, s85, 3072
  s_add_u32 s88, s87, 3072
  buffer_load_dwordx4 v241, s[32:35], s88 offen sc1 lds
  ds_read_b64_tr_b16 a[0:1], v160 offset:4096
  s_waitcnt lgkmcnt(9)
  v_mfma_f32_16x16x32_bf16 v[16:19], a[16:19], a[40:43], v[16:19]
  ds_read_b64_tr_b16 a[2:3], v160 offset:6144
  v_mfma_f32_16x16x32_bf16 v[48:51], a[16:19], a[44:47], v[48:51]
  v_mfma_f32_16x16x32_bf16 v[80:83], a[16:19], a[48:51], v[80:83]
  v_mfma_f32_16x16x32_bf16 v[112:115], a[16:19], a[52:55], v[112:115]
  s_add_u32 m0, s85, 4096
  s_add_u32 s88, s87, 4096
  buffer_load_dwordx4 v241, s[32:35], s88 offen sc1 lds
  v_mfma_f32_16x16x32_bf16 v[128:131], a[16:19], a[240:243], v[128:131]
  ds_read_b64_tr_b16 a[4:5], v161 offset:4096
  v_mfma_f32_16x16x32_bf16 v[20:23], a[20:23], a[40:43], v[20:23]
  ds_read_b64_tr_b16 a[6:7], v161 offset:6144
  v_mfma_f32_16x16x32_bf16 v[52:55], a[20:23], a[44:47], v[52:55]
  v_mfma_f32_16x16x32_bf16 v[84:87], a[20:23], a[48:51], v[84:87]
  s_mul_i32 s87, s5, 5
  s_add_u32 s87, s87, s83
  s_add_u32 m0, s85, 5120
  s_add_u32 s88, s87, 0
  buffer_load_dwordx4 v241, s[32:35], s88 offen sc1 lds
  v_mfma_f32_16x16x32_bf16 v[116:119], a[20:23], a[52:55], v[116:119]
  v_mfma_f32_16x16x32_bf16 v[132:135], a[20:23], a[240:243], v[132:135]
  ds_read_b64_tr_b16 a[8:9], v162 offset:4096
  s_waitcnt lgkmcnt(9)
  v_mfma_f32_16x16x32_bf16 v[24:27], a[24:27], a[40:43], v[24:27]
  ds_read_b64_tr_b16 a[10:11], v162 offset:6144
  v_mfma_f32_16x16x32_bf16 v[56:59], a[24:27], a[44:47], v[56:59]
  v_mfma_f32_16x16x32_bf16 v[88:91], a[24:27], a[48:51], v[88:91]
  s_add_u32 m0, s85, 6144
  s_add_u32 s88, s87, 1024
  buffer_load_dwordx4 v241, s[32:35], s88 offen sc1 lds
  v_mfma_f32_16x16x32_bf16 v[120:123], a[24:27], a[52:55], v[120:123]
  v_mfma_f32_16x16x32_bf16 v[136:139], a[24:27], a[240:243], v[136:139]
  ds_read_b64_tr_b16 a[12:13], v163 offset:4096
  s_waitcnt lgkmcnt(5)
  v_mfma_f32_16x16x32_bf16 v[28:31], a[28:31], a[40:43], v[28:31]
  ds_read_b64_tr_b16 a[14:15], v163 offset:6144
  v_mfma_f32_16x16x32_bf16 v[60:63], a[28:31], a[44:47], v[60:63]
  s_add_u32 m0, s85, 7168
  s_add_u32 s88, s87, 2048
  buffer_load_dwordx4 v241, s[32:35], s88 offen sc1 lds
  v_mfma_f32_16x16x32_bf16 v[92:95], a[28:31], a[48:51], v[92:95]
  v_mfma_f32_16x16x32_bf16 v[124:127], a[28:31], a[52:55], v[124:127]
  v_mfma_f32_16x16x32_bf16 v[140:143], a[28:31], a[240:243], v[140:143]
  ds_read_b64_tr_b16 a[16:17], v160 offset:12288
  v_mfma_f32_16x16x32_bf16 v[0:3], a[0:3], a[56:59], v[0:3]
  s_add_u32 m0, s85, 8192
  s_add_u32 s88, s87, 3072
  buffer_load_dwordx4 v241, s[32:35], s88 offen sc1 lds
  ds_read_b64_tr_b16 a[18:19], v160 offset:14336
  v_mfma_f32_16x16x32_bf16 v[32:35], a[0:3], a[60:63], v[32:35]
  v_mfma_f32_16x16x32_bf16 v[64:67], a[0:3], a[64:67], v[64:67]
  v_mfma_f32_16x16x32_bf16 v[96:99], a[0:3], a[68:71], v[96:99]
  ds_read_b64_tr_b16 a[20:21], v161 offset:12288
  s_waitcnt lgkmcnt(5)
  v_mfma_f32_16x16x32_bf16 v[4:7], a[4:7], a[56:59], v[4:7]
  s_add_u32 m0, s85, 9216
  s_add_u32 s88, s87, 4096
  buffer_load_dwordx4 v241, s[32:35], s88 offen sc1 lds
  ds_read_b64_tr_b16 a[22:23], v161 offset:14336
  v_mfma_f32_16x16x32_bf16 v[36:39], a[4:7], a[60:63], v[36:39]
  v_mfma_f32_16x16x32_bf16 v[68:71], a[4:7], a[64:67], v[68:71]
  v_mfma_f32_16x16x32_bf16 v[100:103], a[4:7], a[68:71], v[100:103]
  ds_read_b64_tr_b16 a[24:25], v162 offset:12288
  v_mfma_f32_16x16x32_bf16 v[8:11], a[8:11], a[56:59], v[8:11]
  s_mul_i32 s87, s6, 5
  s_add_u32 s87, s87, s83
  s_add_u32 m0, s85, 10240
  s_add_u32 s88, s87, 0
  buffer_load_dwordx4 v241, s[32:35], s88 offen sc1 lds
  ds_read_b64_tr_b16 a[26:27], v162 offset:14336
  v_mfma_f32_16x16x32_bf16 v[40:43], a[8:11], a[60:63], v[40:43]
  v_mfma_f32_16x16x32_bf16 v[72:75], a[8:11], a[64:67], v[72:75]
  v_mfma_f32_16x16x32_bf16 v[104:107], a[8:11], a[68:71], v[104:107]
  ds_read_b64_tr_b16 a[28:29], v163 offset:12288
  s_waitcnt lgkmcnt(5)
  v_mfma_f32_16x16x32_bf16 v[12:15], a[12:15], a[56:59], v[12:15]
  s_add_u32 m0, s85, 11264
  s_add_u32 s88, s87, 1024
  buffer_load_dwordx4 v241, s[32:35], s88 offen sc1 lds
  ds_read_b64_tr_b16 a[30:31], v163 offset:14336
  v_mfma_f32_16x16x32_bf16 v[44:47], a[12:15], a[60:63], v[44:47]
  v_mfma_f32_16x16x32_bf16 v[76:79], a[12:15], a[64:67], v[76:79]
  v_mfma_f32_16x16x32_bf16 v[108:111], a[12:15], a[68:71], v[108:111]
  v_mfma_f32_16x16x32_bf16 v[16:19], a[16:19], a[56:59], v[16:19]
  v_mfma_f32_16x16x32_bf16 v[48:51], a[16:19], a[60:63], v[48:51]
  v_mfma_f32_16x16x32_bf16 v[80:83], a[16:19], a[64:67], v[80:83]
  v_mfma_f32_16x16x32_bf16 v[112:115], a[16:19], a[68:71], v[112:115]
  v_mfma_f32_16x16x32_bf16 v[128:131], a[16:19], a[240:243], v[128:131]
  s_waitcnt lgkmcnt(2)
  v_mfma_f32_16x16x32_bf16 v[20:23], a[20:23], a[56:59], v[20:23]
  v_mfma_f32_16x16x32_bf16 v[52:55], a[20:23], a[60:63], v[52:55]
  v_mfma_f32_16x16x32_bf16 v[84:87], a[20:23], a[64:67], v[84:87]
  v_mfma_f32_16x16x32_bf16 v[116:119], a[20:23], a[68:71], v[116:119]
  v_mfma_f32_16x16x32_bf16 v[132:135], a[20:23], a[240:243], v[132:135]
  s_waitcnt vmcnt(12) lgkmcnt(0)
  s_barrier
  v_mfma_f32_16x16x32_bf16 v[24:27], a[24:27], a[56:59], v[24:27]
  s_cmp_eq_u32 s41, 49152
  s_cselect_b32 s42, s95, s94
  v_mfma_f32_16x16x32_bf16 v[56:59], a[24:27], a[60:63], v[56:59]
  v_add_u32 v160, s42, v160
  v_add_u32 v161, s42, v161
  v_mfma_f32_16x16x32_bf16 v[88:91], a[24:27], a[64:67], v[88:91]
  v_add_u32 v162, s42, v162
  v_add_u32 v163, s42, v163
  v_mfma_f32_16x16x32_bf16 v[120:123], a[24:27], a[68:71], v[120:123]
  v_add_u32 v164, s42, v164
  v_add_u32 v165, s42, v165
  v_mfma_f32_16x16x32_bf16 v[136:139], a[24:27], a[240:243], v[136:139]
  ds_read_b128 a[40:43], v164 offset:8192
  ds_read_b128 a[44:47], v164 offset:10240
  v_mfma_f32_16x16x32_bf16 v[28:31], a[28:31], a[56:59], v[28:31]
  ds_read_b128 a[48:51], v164 offset:12288
  ds_read_b128 a[52:55], v164 offset:14336
  v_mfma_f32_16x16x32_bf16 v[60:63], a[28:31], a[60:63], v[60:63]
  ds_read_b64_tr_b16 a[0:1], v160 offset:0
  ds_read_b64_tr_b16 a[2:3], v160 offset:2048
  v_mfma_f32_16x16x32_bf16 v[92:95], a[28:31], a[64:67], v[92:95]
  ds_read_b64_tr_b16 a[4:5], v161 offset:0
  ds_read_b64_tr_b16 a[6:7], v161 offset:2048
  v_mfma_f32_16x16x32_bf16 v[124:127], a[28:31], a[68:71], v[124:127]
  ds_read_b64_tr_b16 a[8:9], v162 offset:0
  ds_read_b64_tr_b16 a[10:11], v162 offset:2048
  v_mfma_f32_16x16x32_bf16 v[140:143], a[28:31], a[240:243], v[140:143]
  ds_read_b64_tr_b16 a[12:13], v163 offset:0
  ds_read_b64_tr_b16 a[14:15], v163 offset:2048
  v_and_b32 v251, 15, v255
  v_lshlrev_b32_e64 v251, 4, v251
  s_lshl_b32 s73, s36, 7
  s_add_u32 s73, s73, 64
  s_add_u32 s74, s73, 16
  s_add_u32 s75, s73, 32
  s_add_u32 s101, s73, 48
  ds_read_b64_tr_b16 a[16:17], v160 offset:8192
  s_waitcnt lgkmcnt(5)
  v_mfma_f32_16x16x32_bf16 v[0:3], a[0:3], a[40:43], v[0:3]
  ds_read_b64_tr_b16 a[18:19], v160 offset:10240
  v_mfma_f32_16x16x32_bf16 v[32:35], a[0:3], a[44:47], v[32:35]
  v_mfma_f32_16x16x32_bf16 v[64:67], a[0:3], a[48:51], v[64:67]
  v_mfma_f32_16x16x32_bf16 v[96:99], a[0:3], a[52:55], v[96:99]
  s_lshl_b32 s88, s73, 4
  s_add_u32 s88, s88, 14745600
  buffer_load_dwordx4 v[200:203], v251, s[32:35], s88 offen sc1
  ds_read_b64_tr_b16 a[20:21], v161 offset:8192
  v_mfma_f32_16x16x32_bf16 v[4:7], a[4:7], a[40:43], v[4:7]
  ds_read_b64_tr_b16 a[22:23], v161 offset:10240
  v_mfma_f32_16x16x32_bf16 v[36:39], a[4:7], a[44:47], v[36:39]
  s_lshl_b32 s88, s74, 4
  s_add_u32 s88, s88, 14745600
  buffer_load_dwordx4 v[204:207], v251, s[32:35], s88 offen sc1
  v_mfma_f32_16x16x32_bf16 v[68:71], a[4:7], a[48:51], v[68:71]
  v_mfma_f32_16x16x32_bf16 v[100:103], a[4:7], a[52:55], v[100:103]
  ds_read_b64_tr_b16 a[24:25], v162 offset:8192
  ds_read_b64_tr_b16 a[26:27], v162 offset:10240
  s_waitcnt lgkmcnt(6)
  v_mfma_f32_16x16x32_bf16 v[8:11], a[8:11], a[40:43], v[8:11]
  s_lshl_b32 s88, s75, 4
  s_add_u32 s88, s88, 14745600
  buffer_load_dwordx4 v[208:211], v251, s[32:35], s88 offen sc1
  ds_read_b128 a[56:59], v165 offset:8192
  ds_read_b128 a[60:63], v165 offset:10240
  v_mfma_f32_16x16x32_bf16 v[40:43], a[8:11], a[44:47], v[40:43]
  ds_read_b128 a[64:67], v165 offset:12288
  v_mfma_f32_16x16x32_bf16 v[72:75], a[8:11], a[48:51], v[72:75]
  ds_read_b128 a[68:71], v165 offset:14336
  v_mfma_f32_16x16x32_bf16 v[104:107], a[8:11], a[52:55], v[104:107]
  s_lshl_b32 s88, s101, 4
  s_add_u32 s88, s88, 14745600
  buffer_load_dwordx4 v[212:215], v251, s[32:35], s88 offen sc1
  ds_read_b64_tr_b16 a[28:29], v163 offset:8192
  v_mfma_f32_16x16x32_bf16 v[12:15], a[12:15], a[40:43], v[12:15]
  ds_read_b64_tr_b16 a[30:31], v163 offset:10240
  v_mfma_f32_16x16x32_bf16 v[44:47], a[12:15], a[44:47], v[44:47]
  v_mfma_f32_16x16x32_bf16 v[76:79], a[12:15], a[48:51], v[76:79]
  s_mul_i32 s87, s6, 5
  s_add_u32 s87, s87, s83
  s_add_u32 m0, s86, 0
  s_add_u32 s88, s87, 2048
  buffer_load_dwordx4 v241, s[32:35], s88 offen sc1 lds
  v_mfma_f32_16x16x32_bf16 v[108:111], a[12:15], a[52:55], v[108:111]
  ds_read_b64_tr_b16 a[0:1], v160 offset:4096
  s_waitcnt lgkmcnt(9)
  v_mfma_f32_16x16x32_bf16 v[16:19], a[16:19], a[40:43], v[16:19]
  ds_read_b64_tr_b16 a[2:3], v160 offset:6144
  v_mfma_f32_16x16x32_bf16 v[48:51], a[16:19], a[44:47], v[48:51]
  s_add_u32 m0, s86, 1024
  s_add_u32 s88, s87, 3072
  buffer_load_dwordx4 v241, s[32:35], s88 offen sc1 lds
  v_mfma_f32_16x16x32_bf16 v[80:83], a[16:19], a[48:51], v[80:83]
  v_mfma_f32_16x16x32_bf16 v[112:115], a[16:19], a[52:55], v[112:115]
  v_mfma_f32_16x16x32_bf16 v[128:131], a[16:19], a[240:243], v[128:131]
  s_add_u32 m0, s86, 2048
  s_add_u32 s88, s87, 4096
  buffer_load_dwordx4 v241, s[32:35], s88 offen sc1 lds
  ds_read_b64_tr_b16 a[4:5], v161 offset:4096
  v_mfma_f32_16x16x32_bf16 v[20:23], a[20:23], a[40:43], v[20:23]
  ds_read_b64_tr_b16 a[6:7], v161 offset:6144
  v_mfma_f32_16x16x32_bf16 v[52:55], a[20:23], a[44:47], v[52:55]
  v_mfma_f32_16x16x32_bf16 v[84:87], a[20:23], a[48:51], v[84:87]
  s_mul_i32 s87, s7, 5
  s_add_u32 s87, s87, s83
  s_add_u32 m0, s86, 3072
  s_add_u32 s88, s87, 0
  buffer_load_dwordx4 v241, s[32:35], s88 offen sc1 lds
  v_mfma_f32_16x16x32_bf16 v[116:119], a[20:23], a[52:55], v[116:119]
  v_mfma_f32_16x16x32_bf16 v[132:135], a[20:23], a[240:243], v[132:135]
  ds_read_b64_tr_b16 a[8:9], v162 offset:4096
  s_waitcnt lgkmcnt(9)
  v_mfma_f32_16x16x32_bf16 v[24:27], a[24:27], a[40:43], v[24:27]
  s_add_u32 m0, s86, 4096
  s_add_u32 s88, s87, 1024
  buffer_load_dwordx4 v241, s[32:35], s88 offen sc1 lds
  ds_read_b64_tr_b16 a[10:11], v162 offset:6144
  v_mfma_f32_16x16x32_bf16 v[56:59], a[24:27], a[44:47], v[56:59]
  v_mfma_f32_16x16x32_bf16 v[88:91], a[24:27], a[48:51], v[88:91]
  v_mfma_f32_16x16x32_bf16 v[120:123], a[24:27], a[52:55], v[120:123]
  s_add_u32 m0, s86, 5120
  s_add_u32 s88, s87, 2048
  buffer_load_dwordx4 v241, s[32:35], s88 offen sc1 lds
  v_mfma_f32_16x16x32_bf16 v[136:139], a[24:27], a[240:243], v[136:139]
  ds_read_b64_tr_b16 a[12:13], v163 offset:4096
  s_waitcnt lgkmcnt(5)
  v_mfma_f32_16x16x32_bf16 v[28:31], a[28:31], a[40:43], v[28:31]
  ds_read_b64_tr_b16 a[14:15], v163 offset:6144
  v_mfma_f32_16x16x32_bf16 v[60:63], a[28:31], a[44:47], v[60:63]
  s_add_u32 m0, s86, 6144
  s_add_u32 s88, s87, 3072
  buffer_load_dwordx4 v241, s[32:35], s88 offen sc1 lds
  v_mfma_f32_16x16x32_bf16 v[92:95], a[28:31], a[48:51], v[92:95]
  v_mfma_f32_16x16x32_bf16 v[124:127], a[28:31], a[52:55], v[124:127]
  v_mfma_f32_16x16x32_bf16 v[140:143], a[28:31], a[240:243], v[140:143]
  s_add_u32 m0, s86, 7168
  s_add_u32 s88, s87, 4096
  buffer_load_dwordx4 v241, s[32:35], s88 offen sc1 lds
  ds_read_b64_tr_b16 a[16:17], v160 offset:12288
  v_mfma_f32_16x16x32_bf16 v[0:3], a[0:3], a[56:59], v[0:3]
  ds_read_b64_tr_b16 a[18:19], v160 offset:14336
  v_mfma_f32_16x16x32_bf16 v[32:35], a[0:3], a[60:63], v[32:35]
  v_mfma_f32_16x16x32_bf16 v[64:67], a[0:3], a[64:67], v[64:67]
  s_mul_i32 s87, s8, 5
  s_add_u32 s87, s87, s83
  s_add_u32 m0, s86, 8192
  s_add_u32 s88, s87, 0
  buffer_load_dwordx4 v241, s[32:35], s88 offen sc1 lds
  v_mfma_f32_16x16x32_bf16 v[96:99], a[0:3], a[68:71], v[96:99]
  ds_read_b64_tr_b16 a[20:21], v161 offset:12288
  s_waitcnt lgkmcnt(5)
  v_mfma_f32_16x16x32_bf16 v[4:7], a[4:7], a[56:59], v[4:7]
  ds_read_b64_tr_b16 a[22:23], v161 offset:14336
  v_mfma_f32_16x16x32_bf16 v[36:39], a[4:7], a[60:63], v[36:39]
  s_add_u32 m0, s86, 9216
  s_add_u32 s88, s87, 1024
  buffer_load_dwordx4 v241, s[32:35], s88 offen sc1 lds
  v_mfma_f32_16x16x32_bf16 v[68:71], a[4:7], a[64:67], v[68:71]
  v_mfma_f32_16x16x32_bf16 v[100:103], a[4:7], a[68:71], v[100:103]
  ds_read_b64_tr_b16 a[24:25], v162 offset:12288
  v_mfma_f32_16x16x32_bf16 v[8:11], a[8:11], a[56:59], v[8:11]
  s_add_u32 m0, s86, 10240
  s_add_u32 s88, s87, 2048
  buffer_load_dwordx4 v241, s[32:35], s88 offen sc1 lds
  ds_read_b64_tr_b16 a[26:27], v162 offset:14336
  v_mfma_f32_16x16x32_bf16 v[40:43], a[8:11], a[60:63], v[40:43]
  v_mfma_f32_16x16x32_bf16 v[72:75], a[8:11], a[64:67], v[72:75]
  v_mfma_f32_16x16x32_bf16 v[104:107], a[8:11], a[68:71], v[104:107]
  s_add_u32 m0, s86, 11264
  s_add_u32 s88, s87, 3072
  buffer_load_dwordx4 v241, s[32:35], s88 offen sc1 lds
  ds_read_b64_tr_b16 a[28:29], v163 offset:12288
  s_waitcnt lgkmcnt(5)
  v_mfma_f32_16x16x32_bf16 v[12:15], a[12:15], a[56:59], v[12:15]
  ds_read_b64_tr_b16 a[30:31], v163 offset:14336
  v_mfma_f32_16x16x32_bf16 v[44:47], a[12:15], a[60:63], v[44:47]
  v_mfma_f32_16x16x32_bf16 v[76:79], a[12:15], a[64:67], v[76:79]
  s_add_u32 m0, s86, 12288
  s_add_u32 s88, s87, 4096
  buffer_load_dwordx4 v241, s[32:35], s88 offen sc1 lds
  v_mfma_f32_16x16x32_bf16 v[108:111], a[12:15], a[68:71], v[108:111]
  v_mfma_f32_16x16x32_bf16 v[16:19], a[16:19], a[56:59], v[16:19]
  v_mfma_f32_16x16x32_bf16 v[48:51], a[16:19], a[60:63], v[48:51]
  v_mfma_f32_16x16x32_bf16 v[80:83], a[16:19], a[64:67], v[80:83]
  v_mfma_f32_16x16x32_bf16 v[112:115], a[16:19], a[68:71], v[112:115]
  v_mfma_f32_16x16x32_bf16 v[128:131], a[16:19], a[240:243], v[128:131]
  s_waitcnt lgkmcnt(2)
  v_mfma_f32_16x16x32_bf16 v[20:23], a[20:23], a[56:59], v[20:23]
  v_mfma_f32_16x16x32_bf16 v[52:55], a[20:23], a[60:63], v[52:55]
  v_mfma_f32_16x16x32_bf16 v[84:87], a[20:23], a[64:67], v[84:87]
  v_mfma_f32_16x16x32_bf16 v[116:119], a[20:23], a[68:71], v[116:119]
  v_mfma_f32_16x16x32_bf16 v[132:135], a[20:23], a[240:243], v[132:135]
  s_waitcnt lgkmcnt(0)
  s_barrier
  v_mfma_f32_16x16x32_bf16 v[24:27], a[24:27], a[56:59], v[24:27]
  v_mfma_f32_16x16x32_bf16 v[56:59], a[24:27], a[60:63], v[56:59]
  v_mfma_f32_16x16x32_bf16 v[88:91], a[24:27], a[64:67], v[88:91]
  v_mfma_f32_16x16x32_bf16 v[120:123], a[24:27], a[68:71], v[120:123]
  v_mfma_f32_16x16x32_bf16 v[136:139], a[24:27], a[240:243], v[136:139]
  v_mfma_f32_16x16x32_bf16 v[28:31], a[28:31], a[56:59], v[28:31]
  v_mfma_f32_16x16x32_bf16 v[60:63], a[28:31], a[60:63], v[60:63]
  v_mfma_f32_16x16x32_bf16 v[92:95], a[28:31], a[64:67], v[92:95]
  v_mfma_f32_16x16x32_bf16 v[124:127], a[28:31], a[68:71], v[124:127]
  v_mfma_f32_16x16x32_bf16 v[140:143], a[28:31], a[240:243], v[140:143]
  s_branch L_ep_ffn
L_pp_ffn_2:
  buffer_load_dwordx2 v[252:253], v249, s[76:79], 0 offen sc1
  s_branch L_np_ffn_2
L_pu_ffn_2:
  s_lshr_b32 s46, s68, 2
  s_and_b32 s47, s68, 3
  s_mul_i32 s46, s46, 5120
  s_mul_i32 s47, s47, 757760
  s_add_u32 s46, s46, s47
  s_add_u32 s46, s46, 10485760
  s_cmp_ge_u32 s68, 296
  s_cselect_b32 s46, 0x30000000, s46
  v_add_u32_e64 v213, s67, v206
  ds_read_b64_tr_b16 v[216:217], v213
  ds_read_b64_tr_b16 v[218:219], v213 offset:5120
  v_add_u32_e64 v214, s67, v207
  ds_read_b64_tr_b16 v[220:221], v214
  ds_read_b64_tr_b16 v[222:223], v214 offset:5120
  v_add_u32_e64 v215, s67, v208
  ds_read_b64_tr_b16 v[224:225], v215
  ds_read_b64_tr_b16 v[226:227], v215 offset:5120
  s_add_u32 s47, s46, s64
  s_waitcnt lgkmcnt(0)
  buffer_store_dwordx4 v[216:219], v241, s[32:35], s47 offen sc1
  s_add_u32 s47, s46, s65
  s_waitcnt lgkmcnt(0)
  buffer_store_dwordx4 v[220:223], v241, s[32:35], s47 offen sc1
  s_add_u32 s47, s46, s66
  s_waitcnt lgkmcnt(0)
  buffer_store_dwordx4 v[224:227], v241, s[32:35], s47 offen sc1
  s_branch L_nu_ffn_2
L_ffn_3:
  v_lshlrev_b32 v241, 4, v255
  s_lshl_b32 s46, s22, 6
  v_add_u32 v1, s46, v255
  v_mul_u32_u24 v2, 3277, v1
  v_lshrrev_b32 v2, 16, v2
  v_mul_u32_u24 v3, 20, v2
  v_sub_u32_e64 v3, v1, v3
  v_mul_u32_u24 v4, 1280, v2
  v_lshl_add_u32 v200, v3, 4, v4
  v_lshrrev_b32 v203, 4, v2
  v_add_u32 v1, s46, v255
  v_add_u32 v1, 256, v1
  v_mul_u32_u24 v2, 3277, v1
  v_lshrrev_b32 v2, 16, v2
  v_mul_u32_u24 v3, 20, v2
  v_sub_u32_e64 v3, v1, v3
  v_mul_u32_u24 v4, 1280, v2
  v_lshl_add_u32 v201, v3, 4, v4
  v_lshrrev_b32 v204, 4, v2
  v_add_u32 v1, s46, v255
  v_add_u32 v1, 512, v1
  v_mul_u32_u24 v2, 3277, v1
  v_lshrrev_b32 v2, 16, v2
  v_mul_u32_u24 v3, 20, v2
  v_sub_u32_e64 v3, v1, v3
  v_mul_u32_u24 v4, 1280, v2
  v_lshl_add_u32 v202, v3, 4, v4
  v_lshrrev_b32 v205, 4, v2
  v_mov_b32 v5, 0x40000000
  v_cmp_le_u32 vcc, 640, v1
  s_nop 1
  v_cndmask_b32_e64 v202, v202, v5, vcc
  v_cndmask_b32_e64 v205, v205, 0, vcc
  v_and_b32 v1, 15, v255
  v_lshrrev_b32 v2, 2, v1
  v_and_b32 v3, 3, v1
  v_lshrrev_b32_e64 v4, 4, v255
  v_lshl_add_u32 v2, v4, 2, v2
  v_mul_u32_u24 v2, 320, v2
  s_add_u32 s46, s22, 0
  s_cmp_ge_u32 s46, 5
  s_cselect_b32 s47, 1, 0
  s_mul_i32 s48, s47, 5
  s_sub_u32 s48, s46, s48
  s_lshr_b32 s49, s48, 1
  s_lshl_b32 s49, s49, 6
  s_and_b32 s90, s48, 1
  s_lshl_b32 s90, s90, 3
  s_add_u32 s49, s49, s90
  s_mul_i32 s90, s47, 160
  s_add_u32 s49, s49, s90
  s_cmp_eq_u32 s48, 4
  s_cselect_b32 s90, 3, 4
  v_lshlrev_b32 v5, s90, v3
  v_add3_u32 v206, v5, v2, s49
  s_mul_i32 s64, s47, 378880
  s_lshl_b32 s90, s48, 10
  s_add_u32 s64, s64, s90
  s_cmp_ge_u32 s46, 10
  s_cselect_b32 s64, 0x40000000, s64
  s_add_u32 s46, s22, 4
  s_cmp_ge_u32 s46, 5
  s_cselect_b32 s47, 1, 0
  s_mul_i32 s48, s47, 5
  s_sub_u32 s48, s46, s48
  s_lshr_b32 s49, s48, 1
  s_lshl_b32 s49, s49, 6
  s_and_b32 s90, s48, 1
  s_lshl_b32 s90, s90, 3
  s_add_u32 s49, s49, s90
  s_mul_i32 s90, s47, 160
  s_add_u32 s49, s49, s90
  s_cmp_eq_u32 s48, 4
  s_cselect_b32 s90, 3, 4
  v_lshlrev_b32 v5, s90, v3
  v_add3_u32 v207, v5, v2, s49
  s_mul_i32 s65, s47, 378880
  s_lshl_b32 s90, s48, 10
  s_add_u32 s65, s65, s90
  s_cmp_ge_u32 s46, 10
  s_cselect_b32 s65, 0x40000000, s65
  s_add_u32 s46, s22, 8
  s_cmp_ge_u32 s46, 5
  s_cselect_b32 s47, 1, 0
  s_mul_i32 s48, s47, 5
  s_sub_u32 s48, s46, s48
  s_lshr_b32 s49, s48, 1
  s_lshl_b32 s49, s49, 6
  s_and_b32 s90, s48, 1
  s_lshl_b32 s90, s90, 3
  s_add_u32 s49, s49, s90
  s_mul_i32 s90, s47, 160
  s_add_u32 s49, s49, s90
  s_cmp_eq_u32 s48, 4
  s_cselect_b32 s90, 3, 4
  v_lshlrev_b32 v5, s90, v3
  v_add3_u32 v208, v5, v2, s49
  s_mul_i32 s66, s47, 378880
  s_lshl_b32 s90, s48, 10
  s_add_u32 s66, s66, s90
  s_cmp_ge_u32 s46, 10
  s_cselect_b32 s66, 0x40000000, s66
  s_mov_b32 s69, 819200
  s_mov_b32 s70, 2211840
  s_mov_b32 s67, 147456
  v_and_b32 v1, 15, v255
  v_lshrrev_b32 v2, 2, v1
  v_and_b32 v3, 3, v1
  v_lshrrev_b32 v4, 4, v255
  v_lshl_add_u32 v2, v4, 2, v2
  v_lshrrev_b32 v5, 1, v2
  v_and_b32 v5, 3, v5
  v_lshlrev_b32_e64 v2, 7, v2
  v_lshl_add_u32 v2, v3, 3, v2
  v_add_u32 v2, 16384, v2
  v_xor_b32_e64 v6, 0, v5
  v_lshl_add_u32 v160, v6, 5, v2
  v_xor_b32_e64 v6, 1, v5
  v_lshl_add_u32 v161, v6, 5, v2
  v_xor_b32_e64 v6, 2, v5
  v_lshl_add_u32 v162, v6, 5, v2
  v_xor_b32_e64 v6, 3, v5
  v_lshl_add_u32 v163, v6, 5, v2
  v_and_b32 v1, 15, v255
  v_lshrrev_b32 v4, 4, v255
  v_lshrrev_b32 v2, 1, v1
  v_xor_b32 v2, v2, v4
  v_lshlrev_b32_e64 v2, 4, v2
  v_lshl_add_u32 v2, v1, 7, v2
  v_add_u32 v164, 0, v2
  v_xor_b32 v2, 64, v2
  v_add_u32_e64 v165, 0, v2
  s_add_u32 s90, s92, 122880
  v_add_u32_e64 v169, s90, v166
  s_add_u32 s90, s92, 132096
  v_add_u32_e64 v170, s90, v167
  s_add_u32 s90, s92, 141312
  v_add_u32_e64 v171, s90, v166
  s_add_u32 s90, s92, 150528
  v_add_u32_e64 v172, s90, v167
  v_add_u32 v173, 384, v168
  v_add_u32 v174, 54656, v168
  v_add_u32 v175, 12160, v168
  v_add_u32 v176, 66432, v168
  v_add_u32 v177, 110976, v168
  v_add_u32 v178, 165248, v168
  v_add_u32 v179, 122752, v168
  v_add_u32 v180, 177024, v168
  v_mov_b32 v232, 0
  v_mov_b32 v233, 0
  v_mov_b32 v234, 0
  v_mov_b32_e64 v235, 0
  s_nop 1
  v_mfma_f32_32x32x16_bf16 v[0:15], v[232:235], v[232:235], 0
  v_mfma_f32_32x32x16_bf16 v[16:31], v[232:235], v[232:235], 0
  v_mfma_f32_32x32x16_bf16 v[32:47], v[232:235], v[232:235], 0
  v_mfma_f32_32x32x16_bf16 v[48:63], v[232:235], v[232:235], 0
  v_mfma_f32_32x32x16_bf16 v[64:79], v[232:235], v[232:235], 0
  v_mfma_f32_32x32x16_bf16 v[80:95], v[232:235], v[232:235], 0
  v_mfma_f32_32x32x16_bf16 v[96:111], v[232:235], v[232:235], 0
  v_mfma_f32_32x32x16_bf16 v[112:127], v[232:235], v[232:235], 0
  v_mfma_f32_32x32x16_bf16 v[128:143], v[232:235], v[232:235], 0
  v_mov_b32 v254, 0x3f803f80
  v_accvgpr_write_b32 a240, v254
  v_accvgpr_write_b32 a241, v254
  v_accvgpr_write_b32 a242, v254
  v_accvgpr_write_b32 a243, v254
  v_mov_b32 v249, 0
  s_lshl_b32 s39, s38, 7
  s_mul_i32 s40, s38, 221184
  s_mov_b32 s41, 49152
  s_add_u32 m0, s41, 12288
  s_nop 0
  buffer_load_dwordx4 v169, s[24:27], s39 offen offset:0 lds
  buffer_load_dwordx4 v170, s[24:27], s39 offen offset:1024 lds
  buffer_load_dwordx4 v171, s[24:27], s39 offen offset:2048 lds
  buffer_load_dwordx4 v172, s[24:27], s39 offen offset:3072 lds
  s_add_u32 m0, s41, 40960
  s_nop 0
  buffer_load_dwordx4 v173, s[28:31], s40 offen offset:0 lds
  buffer_load_dwordx4 v174, s[28:31], s40 offen offset:1024 lds
  buffer_load_dwordx4 v175, s[28:31], s40 offen offset:2048 lds
  buffer_load_dwordx4 v176, s[28:31], s40 offen offset:3072 lds
  s_add_u32 m0, s41, 45056
  s_nop 0
  buffer_load_dwordx4 v177, s[28:31], s40 offen offset:0 lds
  buffer_load_dwordx4 v178, s[28:31], s40 offen offset:1024 lds
  buffer_load_dwordx4 v179, s[28:31], s40 offen offset:2048 lds
  buffer_load_dwordx4 v180, s[28:31], s40 offen offset:3072 lds
  s_add_u32 s38, s38, 1
  s_cmp_eq_u32 s38, 10
  s_cselect_b32 s38, 0, s38
  s_lshr_b32 s46, s68, 2
  s_and_b32 s47, s68, 3
  s_mul_i32 s48, s46, 52
  s_lshr_b32 s48, s48, 8
  s_mul_i32 s49, s48, 5
  s_sub_u32 s49, s46, s49
  s_mul_i32 s48, s48, 160
  s_lshl_b32 s90, s49, 5
  s_cmp_ge_u32 s49, 2
  s_cselect_b32 s91, 16, 0
  s_add_u32 s90, s90, s91
  s_cmp_eq_u32 s49, 4
  s_cselect_b32 s90, 64, s90
  s_cselect_b32 s91, 81920, 0
  s_add_u32 s90, s90, s48
  s_sub_u32 s48, s46, 20
  s_lshl_b32 s48, s48, 5
  s_cmp_lt_u32 s46, 20
  s_cselect_b32 s90, s90, s48
  s_cselect_b32 s91, s91, 0
  s_cselect_b32 s60, s8, s14
  s_cselect_b32 s61, s9, s15
  s_cselect_b32 s62, s69, s70
  s_and_b32 s61, s61, 0xffff
  s_mov_b32 s63, 0x20000
  s_mul_i32 s90, s90, 1280
  s_mul_i32 s47, s47, 320
  s_add_u32 s90, s90, s47
  s_cmp_ge_u32 s68, 296
  s_cselect_b32 s90, 0x7f000000, s90
  s_lshl_b32 s46, s22, 10
  s_add_u32 s46, s46, s67
  v_mad_u32_u24 v210, v203, s91, v200
  s_add_u32 m0, s46, 0
  s_nop 0
  buffer_load_dwordx4 v210, s[60:63], s90 offen lds
  v_mad_u32_u24 v211, v204, s91, v201
  s_add_u32 m0, s46, 4096
  s_nop 0
  buffer_load_dwordx4 v211, s[60:63], s90 offen lds
  v_mad_u32_u24 v212, v205, s91, v202
  s_add_u32 s47, s46, 8192
  s_cmp_ge_u32 s22, 2
  s_cselect_b32 m0, 161792, s47
  s_nop 0
  buffer_load_dwordx4 v212, s[60:63], s90 offen lds
  s_and_b32 s46, s2, 7
  s_lshr_b32 s47, s2, 3
  s_lshr_b32 s80, s47, 3
  s_lshl_b32 s46, s46, 2
  s_add_u32 s80, s80, s46
  s_and_b32 s81, s47, 7
  s_lshr_b32 s89, s80, 1
  s_lshl_b32 s89, s89, 2
  s_mul_i32 s83, s81, 378880
  s_add_u32 s83, s83, 10485760
  s_mul_i32 s84, s80, 303104
  s_mul_i32 s85, s22, 12288
  s_add_u32 s85, s85, 49152
  s_mul_i32 s86, s22, 13312
  s_add_u32 s86, s86, 98304
  s_mul_i32 s46, s81, 7
  s_lshr_b32 s46, s46, 2
  s_and_b32 s47, s80, 3
  s_mul_i32 s47, s47, 7
  s_lshr_b32 s47, s47, 1
  s_add_u32 s46, s46, s47
  s_sub_u32 s47, s46, 14
  s_cmp_ge_u32 s46, 14
  s_cselect_b32 s46, s47, s46
  s_lshl_b32 s46, s46, 2
  s_add_u32 s46, s46, s22
  s_add_u32 s46, s46, 20
  s_lshl_b32 s4, s46, 10
  s_cmp_ge_u32 s46, 74
  s_cselect_b32 s4, 0x10000000, s4
  s_add_u32 s46, s46, 4
  s_sub_u32 s47, s46, 56
  s_cmp_ge_u32 s46, 76
  s_cselect_b32 s46, s47, s46
  s_lshl_b32 s5, s46, 10
  s_cmp_ge_u32 s46, 74
  s_cselect_b32 s5, 0x10000000, s5
  s_add_u32 s46, s46, 4
  s_sub_u32 s47, s46, 56
  s_cmp_ge_u32 s46, 76
  s_cselect_b32 s46, s47, s46
  s_lshl_b32 s6, s46, 10
  s_cmp_ge_u32 s46, 74
  s_cselect_b32 s6, 0x10000000, s6
  s_add_u32 s46, s46, 4
  s_sub_u32 s47, s46, 56
  s_cmp_ge_u32 s46, 76
  s_cselect_b32 s46, s47, s46
  s_lshl_b32 s7, s46, 10
  s_cmp_ge_u32 s46, 74
  s_cselect_b32 s7, 0x10000000, s7
  s_add_u32 s46, s46, 4
  s_sub_u32 s47, s46, 56
  s_cmp_ge_u32 s46, 76
  s_cselect_b32 s46, s47, s46
  s_lshl_b32 s8, s46, 10
  s_cmp_ge_u32 s46, 74
  s_cselect_b32 s8, 0x10000000, s8
  s_add_u32 s46, s46, 4
  s_sub_u32 s47, s46, 56
  s_cmp_ge_u32 s46, 76
  s_cselect_b32 s46, s47, s46
  s_lshl_b32 s9, s46, 10
  s_cmp_ge_u32 s46, 74
  s_cselect_b32 s9, 0x10000000, s9
  s_add_u32 s46, s46, 4
  s_sub_u32 s47, s46, 56
  s_cmp_ge_u32 s46, 76
  s_cselect_b32 s46, s47, s46
  s_lshl_b32 s10, s46, 10
  s_cmp_ge_u32 s46, 74
  s_cselect_b32 s10, 0x10000000, s10
  s_add_u32 s46, s46, 4
  s_sub_u32 s47, s46, 56
  s_cmp_ge_u32 s46, 76
  s_cselect_b32 s46, s47, s46
  s_lshl_b32 s11, s46, 10
  s_cmp_ge_u32 s46, 74
  s_cselect_b32 s11, 0x10000000, s11
  s_add_u32 s46, s46, 4
  s_sub_u32 s47, s46, 56
  s_cmp_ge_u32 s46, 76
  s_cselect_b32 s46, s47, s46
  s_lshl_b32 s12, s46, 10
  s_cmp_ge_u32 s46, 74
  s_cselect_b32 s12, 0x10000000, s12
  s_add_u32 s46, s46, 4
  s_sub_u32 s47, s46, 56
  s_cmp_ge_u32 s46, 76
  s_cselect_b32 s46, s47, s46
  s_lshl_b32 s13, s46, 10
  s_cmp_ge_u32 s46, 74
  s_cselect_b32 s13, 0x10000000, s13
  s_add_u32 s46, s46, 4
  s_sub_u32 s47, s46, 56
  s_cmp_ge_u32 s46, 76
  s_cselect_b32 s46, s47, s46
  s_lshl_b32 s14, s46, 10
  s_cmp_ge_u32 s46, 74
  s_cselect_b32 s14, 0x10000000, s14
  s_add_u32 s46, s46, 4
  s_sub_u32 s47, s46, 56
  s_cmp_ge_u32 s46, 76
  s_cselect_b32 s46, s47, s46
  s_lshl_b32 s15, s46, 10
  s_cmp_ge_u32 s46, 74
  s_cselect_b32 s15, 0x10000000, s15
  s_add_u32 s46, s46, 4
  s_sub_u32 s47, s46, 56
  s_cmp_ge_u32 s46, 76
  s_cselect_b32 s46, s47, s46
  s_lshl_b32 s18, s46, 10
  s_cmp_ge_u32 s46, 74
  s_cselect_b32 s18, 0x10000000, s18
  s_add_u32 s46, s46, 4
  s_sub_u32 s47, s46, 56
  s_cmp_ge_u32 s46, 76
  s_cselect_b32 s46, s47, s46
  s_lshl_b32 s19, s46, 10
  s_cmp_ge_u32 s46, 74
  s_cselect_b32 s19, 0x10000000, s19
  v_add_u32 v245, 4096, v241
  s_lshl_b32 s45, s2, 7
  s_add_u32 s45, s45, 15728640
  s_lshl_b32 s39, s38, 7
  s_mul_i32 s40, s38, 221184
  s_mov_b32 s41, 98304
  s_mov_b32 s94, 49152
  s_mov_b32 s95, 4294868992
  s_mov_b32 s43, 0
  s_waitcnt vmcnt(15) lgkmcnt(0)
  s_barrier
  ds_read_b128 a[40:43], v164 offset:8192
  ds_read_b128 a[44:47], v164 offset:10240
  ds_read_b128 a[48:51], v164 offset:12288
  ds_read_b128 a[52:55], v164 offset:14336
  ds_read_b64_tr_b16 a[0:1], v160 offset:16384
  ds_read_b64_tr_b16 a[2:3], v160 offset:18432
  ds_read_b64_tr_b16 a[4:5], v161 offset:16384
  ds_read_b64_tr_b16 a[6:7], v161 offset:18432
  ds_read_b64_tr_b16 a[8:9], v162 offset:16384
  ds_read_b64_tr_b16 a[10:11], v162 offset:18432
  ds_read_b64_tr_b16 a[12:13], v163 offset:16384
  ds_read_b64_tr_b16 a[14:15], v163 offset:18432
L_loop_ffn_3:
  ds_read_b64_tr_b16 a[16:17], v160 offset:24576
  s_waitcnt lgkmcnt(5)
  v_mfma_f32_16x16x32_bf16 v[0:3], a[0:3], a[40:43], v[0:3]
  ds_read_b64_tr_b16 a[18:19], v160 offset:26624
  v_mfma_f32_16x16x32_bf16 v[32:35], a[0:3], a[44:47], v[32:35]
  v_mfma_f32_16x16x32_bf16 v[64:67], a[0:3], a[48:51], v[64:67]
  v_mfma_f32_16x16x32_bf16 v[96:99], a[0:3], a[52:55], v[96:99]
  ds_read_b64_tr_b16 a[20:21], v161 offset:24576
  v_mfma_f32_16x16x32_bf16 v[4:7], a[4:7], a[40:43], v[4:7]
  s_cmp_lg_u32 s43, 7
  s_cbranch_scc0 L_pp_ffn_3
L_np_ffn_3:
  s_cmp_lg_u32 s43, 1
  s_cbranch_scc0 L_pu_ffn_3
L_nu_ffn_3:
  ds_read_b64_tr_b16 a[22:23], v161 offset:26624
  v_mfma_f32_16x16x32_bf16 v[36:39], a[4:7], a[44:47], v[36:39]
  v_mfma_f32_16x16x32_bf16 v[68:71], a[4:7], a[48:51], v[68:71]
  v_mfma_f32_16x16x32_bf16 v[100:103], a[4:7], a[52:55], v[100:103]
  s_add_u32 m0, s41, 12288
  ds_read_b64_tr_b16 a[24:25], v162 offset:24576
  ds_read_b64_tr_b16 a[26:27], v162 offset:26624
  s_waitcnt lgkmcnt(6)
  v_mfma_f32_16x16x32_bf16 v[8:11], a[8:11], a[40:43], v[8:11]
  ds_read_b128 a[56:59], v165 offset:8192
  ds_read_b128 a[60:63], v165 offset:10240
  v_mfma_f32_16x16x32_bf16 v[40:43], a[8:11], a[44:47], v[40:43]
  ds_read_b128 a[64:67], v165 offset:12288
  v_mfma_f32_16x16x32_bf16 v[72:75], a[8:11], a[48:51], v[72:75]
  ds_read_b128 a[68:71], v165 offset:14336
  v_mfma_f32_16x16x32_bf16 v[104:107], a[8:11], a[52:55], v[104:107]
  buffer_load_dwordx4 v169, s[24:27], s39 offen offset:0 lds
  ds_read_b64_tr_b16 a[28:29], v163 offset:24576
  v_mfma_f32_16x16x32_bf16 v[12:15], a[12:15], a[40:43], v[12:15]
  ds_read_b64_tr_b16 a[30:31], v163 offset:26624
  v_mfma_f32_16x16x32_bf16 v[44:47], a[12:15], a[44:47], v[44:47]
  v_mfma_f32_16x16x32_bf16 v[76:79], a[12:15], a[48:51], v[76:79]
  buffer_load_dwordx4 v170, s[24:27], s39 offen offset:1024 lds
  v_mfma_f32_16x16x32_bf16 v[108:111], a[12:15], a[52:55], v[108:111]
  ds_read_b64_tr_b16 a[0:1], v160 offset:20480
  s_waitcnt lgkmcnt(9)
  v_mfma_f32_16x16x32_bf16 v[16:19], a[16:19], a[40:43], v[16:19]
  ds_read_b64_tr_b16 a[2:3], v160 offset:22528
  v_mfma_f32_16x16x32_bf16 v[48:51], a[16:19], a[44:47], v[48:51]
  v_mfma_f32_16x16x32_bf16 v[80:83], a[16:19], a[48:51], v[80:83]
  buffer_load_dwordx4 v171, s[24:27], s39 offen offset:2048 lds
  v_mfma_f32_16x16x32_bf16 v[112:115], a[16:19], a[52:55], v[112:115]
  v_mfma_f32_16x16x32_bf16 v[128:131], a[16:19], a[240:243], v[128:131]
  ds_read_b64_tr_b16 a[4:5], v161 offset:20480
  v_mfma_f32_16x16x32_bf16 v[20:23], a[20:23], a[40:43], v[20:23]
  buffer_load_dwordx4 v172, s[24:27], s39 offen offset:3072 lds
  s_add_u32 m0, s41, 40960
  ds_read_b64_tr_b16 a[6:7], v161 offset:22528
  v_mfma_f32_16x16x32_bf16 v[52:55], a[20:23], a[44:47], v[52:55]
  v_mfma_f32_16x16x32_bf16 v[84:87], a[20:23], a[48:51], v[84:87]
  v_mfma_f32_16x16x32_bf16 v[116:119], a[20:23], a[52:55], v[116:119]
  v_mfma_f32_16x16x32_bf16 v[132:135], a[20:23], a[240:243], v[132:135]
  buffer_load_dwordx4 v173, s[28:31], s40 offen offset:0 lds
  ds_read_b64_tr_b16 a[8:9], v162 offset:20480
  s_waitcnt lgkmcnt(9)
  v_mfma_f32_16x16x32_bf16 v[24:27], a[24:27], a[40:43], v[24:27]
  ds_read_b64_tr_b16 a[10:11], v162 offset:22528
  v_mfma_f32_16x16x32_bf16 v[56:59], a[24:27], a[44:47], v[56:59]
  v_mfma_f32_16x16x32_bf16 v[88:91], a[24:27], a[48:51], v[88:91]
  buffer_load_dwordx4 v174, s[28:31], s40 offen offset:1024 lds
  v_mfma_f32_16x16x32_bf16 v[120:123], a[24:27], a[52:55], v[120:123]
  v_mfma_f32_16x16x32_bf16 v[136:139], a[24:27], a[240:243], v[136:139]
  ds_read_b64_tr_b16 a[12:13], v163 offset:20480
  s_waitcnt lgkmcnt(5)
  v_mfma_f32_16x16x32_bf16 v[28:31], a[28:31], a[40:43], v[28:31]
  ds_read_b64_tr_b16 a[14:15], v163 offset:22528
  v_mfma_f32_16x16x32_bf16 v[60:63], a[28:31], a[44:47], v[60:63]
  buffer_load_dwordx4 v175, s[28:31], s40 offen offset:2048 lds
  v_mfma_f32_16x16x32_bf16 v[92:95], a[28:31], a[48:51], v[92:95]
  v_mfma_f32_16x16x32_bf16 v[124:127], a[28:31], a[52:55], v[124:127]
  v_mfma_f32_16x16x32_bf16 v[140:143], a[28:31], a[240:243], v[140:143]
  buffer_load_dwordx4 v176, s[28:31], s40 offen offset:3072 lds
  s_add_u32 m0, s41, 45056
  ds_read_b64_tr_b16 a[16:17], v160 offset:28672
  v_mfma_f32_16x16x32_bf16 v[0:3], a[0:3], a[56:59], v[0:3]
  ds_read_b64_tr_b16 a[18:19], v160 offset:30720
  v_mfma_f32_16x16x32_bf16 v[32:35], a[0:3], a[60:63], v[32:35]
  v_mfma_f32_16x16x32_bf16 v[64:67], a[0:3], a[64:67], v[64:67]
  v_mfma_f32_16x16x32_bf16 v[96:99], a[0:3], a[68:71], v[96:99]
  buffer_load_dwordx4 v177, s[28:31], s40 offen offset:0 lds
  ds_read_b64_tr_b16 a[20:21], v161 offset:28672
  s_waitcnt lgkmcnt(5)
  v_mfma_f32_16x16x32_bf16 v[4:7], a[4:7], a[56:59], v[4:7]
  ds_read_b64_tr_b16 a[22:23], v161 offset:30720
  v_mfma_f32_16x16x32_bf16 v[36:39], a[4:7], a[60:63], v[36:39]
  v_mfma_f32_16x16x32_bf16 v[68:71], a[4:7], a[64:67], v[68:71]
  buffer_load_dwordx4 v178, s[28:31], s40 offen offset:1024 lds
  v_mfma_f32_16x16x32_bf16 v[100:103], a[4:7], a[68:71], v[100:103]
  ds_read_b64_tr_b16 a[24:25], v162 offset:28672
  v_mfma_f32_16x16x32_bf16 v[8:11], a[8:11], a[56:59], v[8:11]
  ds_read_b64_tr_b16 a[26:27], v162 offset:30720
  v_mfma_f32_16x16x32_bf16 v[40:43], a[8:11], a[60:63], v[40:43]
  v_mfma_f32_16x16x32_bf16 v[72:75], a[8:11], a[64:67], v[72:75]
  buffer_load_dwordx4 v179, s[28:31], s40 offen offset:2048 lds
  v_mfma_f32_16x16x32_bf16 v[104:107], a[8:11], a[68:71], v[104:107]
  ds_read_b64_tr_b16 a[28:29], v163 offset:28672
  s_waitcnt lgkmcnt(5)
  v_mfma_f32_16x16x32_bf16 v[12:15], a[12:15], a[56:59], v[12:15]
  ds_read_b64_tr_b16 a[30:31], v163 offset:30720
  v_mfma_f32_16x16x32_bf16 v[44:47], a[12:15], a[60:63], v[44:47]
  buffer_load_dwordx4 v180, s[28:31], s40 offen offset:3072 lds
  v_mfma_f32_16x16x32_bf16 v[76:79], a[12:15], a[64:67], v[76:79]
  v_mfma_f32_16x16x32_bf16 v[108:111], a[12:15], a[68:71], v[108:111]
  v_mfma_f32_16x16x32_bf16 v[16:19], a[16:19], a[56:59], v[16:19]
  v_mfma_f32_16x16x32_bf16 v[48:51], a[16:19], a[60:63], v[48:51]
  v_mfma_f32_16x16x32_bf16 v[80:83], a[16:19], a[64:67], v[80:83]
  v_mfma_f32_16x16x32_bf16 v[112:115], a[16:19], a[68:71], v[112:115]
  v_mfma_f32_16x16x32_bf16 v[128:131], a[16:19], a[240:243], v[128:131]
  s_waitcnt lgkmcnt(2)
  v_mfma_f32_16x16x32_bf16 v[20:23], a[20:23], a[56:59], v[20:23]
  v_mfma_f32_16x16x32_bf16 v[52:55], a[20:23], a[60:63], v[52:55]
  v_mfma_f32_16x16x32_bf16 v[84:87], a[20:23], a[64:67], v[84:87]
  v_mfma_f32_16x16x32_bf16 v[116:119], a[20:23], a[68:71], v[116:119]
  v_mfma_f32_16x16x32_bf16 v[132:135], a[20:23], a[240:243], v[132:135]
  s_waitcnt vmcnt(12) lgkmcnt(0)
  s_barrier
  v_mfma_f32_16x16x32_bf16 v[24:27], a[24:27], a[56:59], v[24:27]
  s_cmp_eq_u32 s41, 49152
  s_cselect_b32 s42, s95, s94
  v_add_u32_e64 v160, s42, v160
  v_mfma_f32_16x16x32_bf16 v[56:59], a[24:27], a[60:63], v[56:59]
  v_add_u32 v161, s42, v161
  v_add_u32 v162, s42, v162
  v_add_u32_e64 v163, s42, v163
  v_mfma_f32_16x16x32_bf16 v[88:91], a[24:27], a[64:67], v[88:91]
  v_add_u32 v164, s42, v164
  v_add_u32 v165, s42, v165
  ds_read_b128 a[40:43], v164 offset:8192
  v_mfma_f32_16x16x32_bf16 v[120:123], a[24:27], a[68:71], v[120:123]
  ds_read_b128 a[44:47], v164 offset:10240
  ds_read_b128 a[48:51], v164 offset:12288
  ds_read_b128 a[52:55], v164 offset:14336
  v_mfma_f32_16x16x32_bf16 v[136:139], a[24:27], a[240:243], v[136:139]
  ds_read_b64_tr_b16 a[0:1], v160 offset:16384
  ds_read_b64_tr_b16 a[2:3], v160 offset:18432
  ds_read_b64_tr_b16 a[4:5], v161 offset:16384
  v_mfma_f32_16x16x32_bf16 v[28:31], a[28:31], a[56:59], v[28:31]
  ds_read_b64_tr_b16 a[6:7], v161 offset:18432
  ds_read_b64_tr_b16 a[8:9], v162 offset:16384
  ds_read_b64_tr_b16 a[10:11], v162 offset:18432
  v_mfma_f32_16x16x32_bf16 v[60:63], a[28:31], a[60:63], v[60:63]
  ds_read_b64_tr_b16 a[12:13], v163 offset:16384
  ds_read_b64_tr_b16 a[14:15], v163 offset:18432
  s_add_u32 s38, s38, 1
  v_mfma_f32_16x16x32_bf16 v[92:95], a[28:31], a[64:67], v[92:95]
  s_cmp_eq_u32 s38, 10
  s_cselect_b32 s38, 0, s38
  s_lshl_b32 s39, s38, 7
  v_mfma_f32_16x16x32_bf16 v[124:127], a[28:31], a[68:71], v[124:127]
  s_mul_i32 s40, s38, 221184
  s_cmp_eq_u32 s41, 98304
  s_cselect_b32 s42, s95, s94
  v_mfma_f32_16x16x32_bf16 v[140:143], a[28:31], a[240:243], v[140:143]
  s_add_u32 s41, s41, s42
  s_add_u32 s43, s43, 1
  s_cmp_lt_u32 s43, 8
  s_cbranch_scc1 L_loop_ffn_3
  v_readfirstlane_b32 s23, v252
  s_nop 3
  s_cmp_lg_u32 s23, 0
  s_cbranch_scc1 L_nok_ffn_3
  s_mov_b32 s47, 0
  v_mov_b32_e64 v251, 0
L_nspin_ffn_3:
  buffer_load_dword v250, v251, s[76:79], 0 offen sc1
  s_waitcnt vmcnt(0)
  v_readfirstlane_b32 s23, v250
  s_nop 3
  s_cmp_lg_u32 s23, 0
  s_cbranch_scc1 L_nok_ffn_3
  s_sleep 8
  s_add_u32 s47, s47, 1
  s_cmp_lt_u32 s47, 200000
  s_cbranch_scc1 L_nspin_ffn_3
L_nok_ffn_3:
  v_readfirstlane_b32 s46, v253
  s_nop 3
  s_cmp_ge_u32 s46, 128
  s_cbranch_scc1 L_cok_p_ffn_3
  s_mov_b32 s47, 0
  v_mov_b32_e64 v251, 0
L_cspin_p_ffn_3:
  buffer_load_dword v250, v251, s[76:79], 0 offen offset:4 sc1
  s_waitcnt vmcnt(0)
  v_readfirstlane_b32 s46, v250
  s_nop 3
  s_cmp_ge_u32 s46, 128
  s_cbranch_scc1 L_cok_p_ffn_3
  s_sleep 40
  s_add_u32 s47, s47, 1
  s_cmp_lt_u32 s47, 200000
  s_cbranch_scc1 L_cspin_p_ffn_3
L_cok_p_ffn_3:
  ds_read_b64_tr_b16 a[16:17], v160 offset:24576
  s_waitcnt lgkmcnt(5)
  v_mfma_f32_16x16x32_bf16 v[0:3], a[0:3], a[40:43], v[0:3]
  ds_read_b64_tr_b16 a[18:19], v160 offset:26624
  v_mfma_f32_16x16x32_bf16 v[32:35], a[0:3], a[44:47], v[32:35]
  v_mfma_f32_16x16x32_bf16 v[64:67], a[0:3], a[48:51], v[64:67]
  v_mfma_f32_16x16x32_bf16 v[96:99], a[0:3], a[52:55], v[96:99]
  ds_read_b64_tr_b16 a[20:21], v161 offset:24576
  v_mfma_f32_16x16x32_bf16 v[4:7], a[4:7], a[40:43], v[4:7]
  s_mul_i32 s87, s4, 5
  s_add_u32 s87, s87, s83
  s_add_u32 m0, s85, 0
  s_add_u32 s88, s87, 0
  buffer_load_dwordx4 v241, s[32:35], s88 offen sc1 lds
  ds_read_b64_tr_b16 a[22:23], v161 offset:26624
  v_mfma_f32_16x16x32_bf16 v[36:39], a[4:7], a[44:47], v[36:39]
  v_mfma_f32_16x16x32_bf16 v[68:71], a[4:7], a[48:51], v[68:71]
  v_mfma_f32_16x16x32_bf16 v[100:103], a[4:7], a[52:55], v[100:103]
  ds_read_b64_tr_b16 a[24:25], v162 offset:24576
  ds_read_b64_tr_b16 a[26:27], v162 offset:26624
  s_waitcnt lgkmcnt(6)
  v_mfma_f32_16x16x32_bf16 v[8:11], a[8:11], a[40:43], v[8:11]
  s_add_u32 m0, s85, 1024
  s_add_u32 s88, s87, 1024
  buffer_load_dwordx4 v241, s[32:35], s88 offen sc1 lds
  ds_read_b128 a[56:59], v165 offset:8192
  ds_read_b128 a[60:63], v165 offset:10240
  v_mfma_f32_16x16x32_bf16 v[40:43], a[8:11], a[44:47], v[40:43]
  ds_read_b128 a[64:67], v165 offset:12288
  v_mfma_f32_16x16x32_bf16 v[72:75], a[8:11], a[48:51], v[72:75]
  ds_read_b128 a[68:71], v165 offset:14336
  v_mfma_f32_16x16x32_bf16 v[104:107], a[8:11], a[52:55], v[104:107]
  ds_read_b64_tr_b16 a[28:29], v163 offset:24576
  v_mfma_f32_16x16x32_bf16 v[12:15], a[12:15], a[40:43], v[12:15]
  s_add_u32 m0, s85, 2048
  s_add_u32 s88, s87, 2048
  buffer_load_dwordx4 v241, s[32:35], s88 offen sc1 lds
  ds_read_b64_tr_b16 a[30:31], v163 offset:26624
  v_mfma_f32_16x16x32_bf16 v[44:47], a[12:15], a[44:47], v[44:47]
  v_mfma_f32_16x16x32_bf16 v[76:79], a[12:15], a[48:51], v[76:79]
  v_mfma_f32_16x16x32_bf16 v[108:111], a[12:15], a[52:55], v[108:111]
  ds_read_b64_tr_b16 a[0:1], v160 offset:20480
  s_waitcnt lgkmcnt(9)
  v_mfma_f32_16x16x32_bf16 v[16:19], a[16:19], a[40:43], v[16:19]
  s_add_u32 m0, s85, 3072
  s_add_u32 s88, s87, 3072
  buffer_load_dwordx4 v241, s[32:35], s88 offen sc1 lds
  ds_read_b64_tr_b16 a[2:3], v160 offset:22528
  v_mfma_f32_16x16x32_bf16 v[48:51], a[16:19], a[44:47], v[48:51]
  v_mfma_f32_16x16x32_bf16 v[80:83], a[16:19], a[48:51], v[80:83]
  v_mfma_f32_16x16x32_bf16 v[112:115], a[16:19], a[52:55], v[112:115]
  v_mfma_f32_16x16x32_bf16 v[128:131], a[16:19], a[240:243], v[128:131]
  s_add_u32 m0, s85, 4096
  s_add_u32 s88, s87, 4096
  buffer_load_dwordx4 v241, s[32:35], s88 offen sc1 lds
  ds_read_b64_tr_b16 a[4:5], v161 offset:20480
  v_mfma_f32_16x16x32_bf16 v[20:23], a[20:23], a[40:43], v[20:23]
  ds_read_b64_tr_b16 a[6:7], v161 offset:22528
  v_mfma_f32_16x16x32_bf16 v[52:55], a[20:23], a[44:47], v[52:55]
  v_mfma_f32_16x16x32_bf16 v[84:87], a[20:23], a[48:51], v[84:87]
  v_mfma_f32_16x16x32_bf16 v[116:119], a[20:23], a[52:55], v[116:119]
  s_mul_i32 s87, s5, 5
  s_add_u32 s87, s87, s83
  s_add_u32 m0, s85, 5120
  s_add_u32 s88, s87, 0
  buffer_load_dwordx4 v241, s[32:35], s88 offen sc1 lds
  v_mfma_f32_16x16x32_bf16 v[132:135], a[20:23], a[240:243], v[132:135]
  ds_read_b64_tr_b16 a[8:9], v162 offset:20480
  s_waitcnt lgkmcnt(9)
  v_mfma_f32_16x16x32_bf16 v[24:27], a[24:27], a[40:43], v[24:27]
  ds_read_b64_tr_b16 a[10:11], v162 offset:22528
  v_mfma_f32_16x16x32_bf16 v[56:59], a[24:27], a[44:47], v[56:59]
  v_mfma_f32_16x16x32_bf16 v[88:91], a[24:27], a[48:51], v[88:91]
  s_add_u32 m0, s85, 6144
  s_add_u32 s88, s87, 1024
  buffer_load_dwordx4 v241, s[32:35], s88 offen sc1 lds
  v_mfma_f32_16x16x32_bf16 v[120:123], a[24:27], a[52:55], v[120:123]
  v_mfma_f32_16x16x32_bf16 v[136:139], a[24:27], a[240:243], v[136:139]
  ds_read_b64_tr_b16 a[12:13], v163 offset:20480
  s_waitcnt lgkmcnt(5)
  v_mfma_f32_16x16x32_bf16 v[28:31], a[28:31], a[40:43], v[28:31]
  ds_read_b64_tr_b16 a[14:15], v163 offset:22528
  v_mfma_f32_16x16x32_bf16 v[60:63], a[28:31], a[44:47], v[60:63]
  s_add_u32 m0, s85, 7168
  s_add_u32 s88, s87, 2048
  buffer_load_dwordx4 v241, s[32:35], s88 offen sc1 lds
  v_mfma_f32_16x16x32_bf16 v[92:95], a[28:31], a[48:51], v[92:95]
  v_mfma_f32_16x16x32_bf16 v[124:127], a[28:31], a[52:55], v[124:127]
  v_mfma_f32_16x16x32_bf16 v[140:143], a[28:31], a[240:243], v[140:143]
  ds_read_b64_tr_b16 a[16:17], v160 offset:28672
  v_mfma_f32_16x16x32_bf16 v[0:3], a[0:3], a[56:59], v[0:3]
  s_add_u32 m0, s85, 8192
  s_add_u32 s88, s87, 3072
  buffer_load_dwordx4 v241, s[32:35], s88 offen sc1 lds
  ds_read_b64_tr_b16 a[18:19], v160 offset:30720
  v_mfma_f32_16x16x32_bf16 v[32:35], a[0:3], a[60:63], v[32:35]
  v_mfma_f32_16x16x32_bf16 v[64:67], a[0:3], a[64:67], v[64:67]
  v_mfma_f32_16x16x32_bf16 v[96:99], a[0:3], a[68:71], v[96:99]
  ds_read_b64_tr_b16 a[20:21], v161 offset:28672
  s_waitcnt lgkmcnt(5)
  v_mfma_f32_16x16x32_bf16 v[4:7], a[4:7], a[56:59], v[4:7]
  s_add_u32 m0, s85, 9216
  s_add_u32 s88, s87, 4096
  buffer_load_dwordx4 v241, s[32:35], s88 offen sc1 lds
  ds_read_b64_tr_b16 a[22:23], v161 offset:30720
  v_mfma_f32_16x16x32_bf16 v[36:39], a[4:7], a[60:63], v[36:39]
  v_mfma_f32_16x16x32_bf16 v[68:71], a[4:7], a[64:67], v[68:71]
  v_mfma_f32_16x16x32_bf16 v[100:103], a[4:7], a[68:71], v[100:103]
  ds_read_b64_tr_b16 a[24:25], v162 offset:28672
  v_mfma_f32_16x16x32_bf16 v[8:11], a[8:11], a[56:59], v[8:11]
  s_mul_i32 s87, s6, 5
  s_add_u32 s87, s87, s83
  s_add_u32 m0, s85, 10240
  s_add_u32 s88, s87, 0
  buffer_load_dwordx4 v241, s[32:35], s88 offen sc1 lds
  ds_read_b64_tr_b16 a[26:27], v162 offset:30720
  v_mfma_f32_16x16x32_bf16 v[40:43], a[8:11], a[60:63], v[40:43]
  v_mfma_f32_16x16x32_bf16 v[72:75], a[8:11], a[64:67], v[72:75]
  v_mfma_f32_16x16x32_bf16 v[104:107], a[8:11], a[68:71], v[104:107]
  ds_read_b64_tr_b16 a[28:29], v163 offset:28672
  s_waitcnt lgkmcnt(5)
  v_mfma_f32_16x16x32_bf16 v[12:15], a[12:15], a[56:59], v[12:15]
  s_add_u32 m0, s85, 11264
  s_add_u32 s88, s87, 1024
  buffer_load_dwordx4 v241, s[32:35], s88 offen sc1 lds
  ds_read_b64_tr_b16 a[30:31], v163 offset:30720
  v_mfma_f32_16x16x32_bf16 v[44:47], a[12:15], a[60:63], v[44:47]
  v_mfma_f32_16x16x32_bf16 v[76:79], a[12:15], a[64:67], v[76:79]
  v_mfma_f32_16x16x32_bf16 v[108:111], a[12:15], a[68:71], v[108:111]
  v_mfma_f32_16x16x32_bf16 v[16:19], a[16:19], a[56:59], v[16:19]
  v_mfma_f32_16x16x32_bf16 v[48:51], a[16:19], a[60:63], v[48:51]
  v_mfma_f32_16x16x32_bf16 v[80:83], a[16:19], a[64:67], v[80:83]
  v_mfma_f32_16x16x32_bf16 v[112:115], a[16:19], a[68:71], v[112:115]
  v_mfma_f32_16x16x32_bf16 v[128:131], a[16:19], a[240:243], v[128:131]
  s_waitcnt lgkmcnt(2)
  v_mfma_f32_16x16x32_bf16 v[20:23], a[20:23], a[56:59], v[20:23]
  v_mfma_f32_16x16x32_bf16 v[52:55], a[20:23], a[60:63], v[52:55]
  v_mfma_f32_16x16x32_bf16 v[84:87], a[20:23], a[64:67], v[84:87]
  v_mfma_f32_16x16x32_bf16 v[116:119], a[20:23], a[68:71], v[116:119]
  v_mfma_f32_16x16x32_bf16 v[132:135], a[20:23], a[240:243], v[132:135]
  s_waitcnt vmcnt(12) lgkmcnt(0)
  s_barrier
  v_mfma_f32_16x16x32_bf16 v[24:27], a[24:27], a[56:59], v[24:27]
  s_cmp_eq_u32 s41, 49152
  s_cselect_b32 s42, s95, s94
  v_mfma_f32_16x16x32_bf16 v[56:59], a[24:27], a[60:63], v[56:59]
  v_add_u32 v160, s42, v160
  v_add_u32 v161, s42, v161
  v_mfma_f32_16x16x32_bf16 v[88:91], a[24:27], a[64:67], v[88:91]
  v_add_u32 v162, s42, v162
  v_add_u32 v163, s42, v163
  v_mfma_f32_16x16x32_bf16 v[120:123], a[24:27], a[68:71], v[120:123]
  v_add_u32 v164, s42, v164
  v_add_u32 v165, s42, v165
  v_mfma_f32_16x16x32_bf16 v[136:139], a[24:27], a[240:243], v[136:139]
  ds_read_b128 a[40:43], v164 offset:8192
  ds_read_b128 a[44:47], v164 offset:10240
  v_mfma_f32_16x16x32_bf16 v[28:31], a[28:31], a[56:59], v[28:31]
  ds_read_b128 a[48:51], v164 offset:12288
  ds_read_b128 a[52:55], v164 offset:14336
  v_mfma_f32_16x16x32_bf16 v[60:63], a[28:31], a[60:63], v[60:63]
  ds_read_b64_tr_b16 a[0:1], v160 offset:16384
  ds_read_b64_tr_b16 a[2:3], v160 offset:18432
  v_mfma_f32_16x16x32_bf16 v[92:95], a[28:31], a[64:67], v[92:95]
  ds_read_b64_tr_b16 a[4:5], v161 offset:16384
  ds_read_b64_tr_b16 a[6:7], v161 offset:18432
  v_mfma_f32_16x16x32_bf16 v[124:127], a[28:31], a[68:71], v[124:127]
  ds_read_b64_tr_b16 a[8:9], v162 offset:16384
  ds_read_b64_tr_b16 a[10:11], v162 offset:18432
  v_mfma_f32_16x16x32_bf16 v[140:143], a[28:31], a[240:243], v[140:143]
  ds_read_b64_tr_b16 a[12:13], v163 offset:16384
  ds_read_b64_tr_b16 a[14:15], v163 offset:18432
  v_and_b32 v251, 15, v255
  v_lshlrev_b32_e64 v251, 4, v251
  s_lshl_b32 s73, s36, 7
  s_add_u32 s73, s73, 64
  s_add_u32 s74, s73, 16
  s_add_u32 s75, s73, 32
  s_add_u32 s101, s73, 48
  ds_read_b64_tr_b16 a[16:17], v160 offset:24576
  s_waitcnt lgkmcnt(5)
  v_mfma_f32_16x16x32_bf16 v[0:3], a[0:3], a[40:43], v[0:3]
  ds_read_b64_tr_b16 a[18:19], v160 offset:26624
  v_mfma_f32_16x16x32_bf16 v[32:35], a[0:3], a[44:47], v[32:35]
  v_mfma_f32_16x16x32_bf16 v[64:67], a[0:3], a[48:51], v[64:67]
  v_mfma_f32_16x16x32_bf16 v[96:99], a[0:3], a[52:55], v[96:99]
  ds_read_b64_tr_b16 a[20:21], v161 offset:24576
  v_mfma_f32_16x16x32_bf16 v[4:7], a[4:7], a[40:43], v[4:7]
  s_lshl_b32 s88, s73, 4
  s_add_u32 s88, s88, 14745600
  buffer_load_dwordx4 v[200:203], v251, s[32:35], s88 offen sc1
  ds_read_b64_tr_b16 a[22:23], v161 offset:26624
  v_mfma_f32_16x16x32_bf16 v[36:39], a[4:7], a[44:47], v[36:39]
  v_mfma_f32_16x16x32_bf16 v[68:71], a[4:7], a[48:51], v[68:71]
  s_lshl_b32 s88, s74, 4
  s_add_u32 s88, s88, 14745600
  buffer_load_dwordx4 v[204:207], v251, s[32:35], s88 offen sc1
  v_mfma_f32_16x16x32_bf16 v[100:103], a[4:7], a[52:55], v[100:103]
  ds_read_b64_tr_b16 a[24:25], v162 offset:24576
  ds_read_b64_tr_b16 a[26:27], v162 offset:26624
  s_waitcnt lgkmcnt(6)
  v_mfma_f32_16x16x32_bf16 v[8:11], a[8:11], a[40:43], v[8:11]
  ds_read_b128 a[56:59], v165 offset:8192
  ds_read_b128 a[60:63], v165 offset:10240
  v_mfma_f32_16x16x32_bf16 v[40:43], a[8:11], a[44:47], v[40:43]
  s_lshl_b32 s88, s75, 4
  s_add_u32 s88, s88, 14745600
  buffer_load_dwordx4 v[208:211], v251, s[32:35], s88 offen sc1
  ds_read_b128 a[64:67], v165 offset:12288
  v_mfma_f32_16x16x32_bf16 v[72:75], a[8:11], a[48:51], v[72:75]
  ds_read_b128 a[68:71], v165 offset:14336
  v_mfma_f32_16x16x32_bf16 v[104:107], a[8:11], a[52:55], v[104:107]
  ds_read_b64_tr_b16 a[28:29], v163 offset:24576
  v_mfma_f32_16x16x32_bf16 v[12:15], a[12:15], a[40:43], v[12:15]
  s_lshl_b32 s88, s101, 4
  s_add_u32 s88, s88, 14745600
  buffer_load_dwordx4 v[212:215], v251, s[32:35], s88 offen sc1
  ds_read_b64_tr_b16 a[30:31], v163 offset:26624
  v_mfma_f32_16x16x32_bf16 v[44:47], a[12:15], a[44:47], v[44:47]
  v_mfma_f32_16x16x32_bf16 v[76:79], a[12:15], a[48:51], v[76:79]
  v_mfma_f32_16x16x32_bf16 v[108:111], a[12:15], a[52:55], v[108:111]
  s_mul_i32 s87, s6, 5
  s_add_u32 s87, s87, s83
  s_add_u32 m0, s86, 0
  s_add_u32 s88, s87, 2048
  buffer_load_dwordx4 v241, s[32:35], s88 offen sc1 lds
  ds_read_b64_tr_b16 a[0:1], v160 offset:20480
  s_waitcnt lgkmcnt(9)
  v_mfma_f32_16x16x32_bf16 v[16:19], a[16:19], a[40:43], v[16:19]
  ds_read_b64_tr_b16 a[2:3], v160 offset:22528
  v_mfma_f32_16x16x32_bf16 v[48:51], a[16:19], a[44:47], v[48:51]
  v_mfma_f32_16x16x32_bf16 v[80:83], a[16:19], a[48:51], v[80:83]
  s_add_u32 m0, s86, 1024
  s_add_u32 s88, s87, 3072
  buffer_load_dwordx4 v241, s[32:35], s88 offen sc1 lds
  v_mfma_f32_16x16x32_bf16 v[112:115], a[16:19], a[52:55], v[112:115]
  v_mfma_f32_16x16x32_bf16 v[128:131], a[16:19], a[240:243], v[128:131]
  ds_read_b64_tr_b16 a[4:5], v161 offset:20480
  v_mfma_f32_16x16x32_bf16 v[20:23], a[20:23], a[40:43], v[20:23]
  s_add_u32 m0, s86, 2048
  s_add_u32 s88, s87, 4096
  buffer_load_dwordx4 v241, s[32:35], s88 offen sc1 lds
  ds_read_b64_tr_b16 a[6:7], v161 offset:22528
  v_mfma_f32_16x16x32_bf16 v[52:55], a[20:23], a[44:47], v[52:55]
  v_mfma_f32_16x16x32_bf16 v[84:87], a[20:23], a[48:51], v[84:87]
  v_mfma_f32_16x16x32_bf16 v[116:119], a[20:23], a[52:55], v[116:119]
  s_mul_i32 s87, s7, 5
  s_add_u32 s87, s87, s83
  s_add_u32 m0, s86, 3072
  s_add_u32 s88, s87, 0
  buffer_load_dwordx4 v241, s[32:35], s88 offen sc1 lds
  v_mfma_f32_16x16x32_bf16 v[132:135], a[20:23], a[240:243], v[132:135]
  ds_read_b64_tr_b16 a[8:9], v162 offset:20480
  s_waitcnt lgkmcnt(9)
  v_mfma_f32_16x16x32_bf16 v[24:27], a[24:27], a[40:43], v[24:27]
  ds_read_b64_tr_b16 a[10:11], v162 offset:22528
  v_mfma_f32_16x16x32_bf16 v[56:59], a[24:27], a[44:47], v[56:59]
  s_add_u32 m0, s86, 4096
  s_add_u32 s88, s87, 1024
  buffer_load_dwordx4 v241, s[32:35], s88 offen sc1 lds
  v_mfma_f32_16x16x32_bf16 v[88:91], a[24:27], a[48:51], v[88:91]
  v_mfma_f32_16x16x32_bf16 v[120:123], a[24:27], a[52:55], v[120:123]
  s_add_u32 m0, s86, 5120
  s_add_u32 s88, s87, 2048
  buffer_load_dwordx4 v241, s[32:35], s88 offen sc1 lds
  v_mfma_f32_16x16x32_bf16 v[136:139], a[24:27], a[240:243], v[136:139]
  ds_read_b64_tr_b16 a[12:13], v163 offset:20480
  s_waitcnt lgkmcnt(5)
  v_mfma_f32_16x16x32_bf16 v[28:31], a[28:31], a[40:43], v[28:31]
  ds_read_b64_tr_b16 a[14:15], v163 offset:22528
  v_mfma_f32_16x16x32_bf16 v[60:63], a[28:31], a[44:47], v[60:63]
  s_add_u32 m0, s86, 6144
  s_add_u32 s88, s87, 3072
  buffer_load_dwordx4 v241, s[32:35], s88 offen sc1 lds
  v_mfma_f32_16x16x32_bf16 v[92:95], a[28:31], a[48:51], v[92:95]
  v_mfma_f32_16x16x32_bf16 v[124:127], a[28:31], a[52:55], v[124:127]
  v_mfma_f32_16x16x32_bf16 v[140:143], a[28:31], a[240:243], v[140:143]
  s_add_u32 m0, s86, 7168
  s_add_u32 s88, s87, 4096
  buffer_load_dwordx4 v241, s[32:35], s88 offen sc1 lds
  ds_read_b64_tr_b16 a[16:17], v160 offset:28672
  v_mfma_f32_16x16x32_bf16 v[0:3], a[0:3], a[56:59], v[0:3]
  ds_read_b64_tr_b16 a[18:19], v160 offset:30720
  v_mfma_f32_16x16x32_bf16 v[32:35], a[0:3], a[60:63], v[32:35]
  v_mfma_f32_16x16x32_bf16 v[64:67], a[0:3], a[64:67], v[64:67]
  s_mul_i32 s87, s8, 5
  s_add_u32 s87, s87, s83
  s_add_u32 m0, s86, 8192
  s_add_u32 s88, s87, 0
  buffer_load_dwordx4 v241, s[32:35], s88 offen sc1 lds
  v_mfma_f32_16x16x32_bf16 v[96:99], a[0:3], a[68:71], v[96:99]
  ds_read_b64_tr_b16 a[20:21], v161 offset:28672
  s_waitcnt lgkmcnt(5)
  v_mfma_f32_16x16x32_bf16 v[4:7], a[4:7], a[56:59], v[4:7]
  ds_read_b64_tr_b16 a[22:23], v161 offset:30720
  v_mfma_f32_16x16x32_bf16 v[36:39], a[4:7], a[60:63], v[36:39]
  s_add_u32 m0, s86, 9216
  s_add_u32 s88, s87, 1024
  buffer_load_dwordx4 v241, s[32:35], s88 offen sc1 lds
  v_mfma_f32_16x16x32_bf16 v[68:71], a[4:7], a[64:67], v[68:71]
  v_mfma_f32_16x16x32_bf16 v[100:103], a[4:7], a[68:71], v[100:103]
  ds_read_b64_tr_b16 a[24:25], v162 offset:28672
  v_mfma_f32_16x16x32_bf16 v[8:11], a[8:11], a[56:59], v[8:11]
  s_add_u32 m0, s86, 10240
  s_add_u32 s88, s87, 2048
  buffer_load_dwordx4 v241, s[32:35], s88 offen sc1 lds
  ds_read_b64_tr_b16 a[26:27], v162 offset:30720
  v_mfma_f32_16x16x32_bf16 v[40:43], a[8:11], a[60:63], v[40:43]
  v_mfma_f32_16x16x32_bf16 v[72:75], a[8:11], a[64:67], v[72:75]
  v_mfma_f32_16x16x32_bf16 v[104:107], a[8:11], a[68:71], v[104:107]
  s_add_u32 m0, s86, 11264
  s_add_u32 s88, s87, 3072
  buffer_load_dwordx4 v241, s[32:35], s88 offen sc1 lds
  ds_read_b64_tr_b16 a[28:29], v163 offset:28672
  s_waitcnt lgkmcnt(5)
  v_mfma_f32_16x16x32_bf16 v[12:15], a[12:15], a[56:59], v[12:15]
  ds_read_b64_tr_b16 a[30:31], v163 offset:30720
  v_mfma_f32_16x16x32_bf16 v[44:47], a[12:15], a[60:63], v[44:47]
  v_mfma_f32_16x16x32_bf16 v[76:79], a[12:15], a[64:67], v[76:79]
  s_add_u32 m0, s86, 12288
  s_add_u32 s88, s87, 4096
  buffer_load_dwordx4 v241, s[32:35], s88 offen sc1 lds
  v_mfma_f32_16x16x32_bf16 v[108:111], a[12:15], a[68:71], v[108:111]
  v_mfma_f32_16x16x32_bf16 v[16:19], a[16:19], a[56:59], v[16:19]
  v_mfma_f32_16x16x32_bf16 v[48:51], a[16:19], a[60:63], v[48:51]
  v_mfma_f32_16x16x32_bf16 v[80:83], a[16:19], a[64:67], v[80:83]
  v_mfma_f32_16x16x32_bf16 v[112:115], a[16:19], a[68:71], v[112:115]
  v_mfma_f32_16x16x32_bf16 v[128:131], a[16:19], a[240:243], v[128:131]
  s_waitcnt lgkmcnt(2)
  v_mfma_f32_16x16x32_bf16 v[20:23], a[20:23], a[56:59], v[20:23]
  v_mfma_f32_16x16x32_bf16 v[52:55], a[20:23], a[60:63], v[52:55]
  v_mfma_f32_16x16x32_bf16 v[84:87], a[20:23], a[64:67], v[84:87]
  v_mfma_f32_16x16x32_bf16 v[116:119], a[20:23], a[68:71], v[116:119]
  v_mfma_f32_16x16x32_bf16 v[132:135], a[20:23], a[240:243], v[132:135]
  s_waitcnt lgkmcnt(0)
  s_barrier
  v_mfma_f32_16x16x32_bf16 v[24:27], a[24:27], a[56:59], v[24:27]
  v_mfma_f32_16x16x32_bf16 v[56:59], a[24:27], a[60:63], v[56:59]
  v_mfma_f32_16x16x32_bf16 v[88:91], a[24:27], a[64:67], v[88:91]
  v_mfma_f32_16x16x32_bf16 v[120:123], a[24:27], a[68:71], v[120:123]
  v_mfma_f32_16x16x32_bf16 v[136:139], a[24:27], a[240:243], v[136:139]
  v_mfma_f32_16x16x32_bf16 v[28:31], a[28:31], a[56:59], v[28:31]
  v_mfma_f32_16x16x32_bf16 v[60:63], a[28:31], a[60:63], v[60:63]
  v_mfma_f32_16x16x32_bf16 v[92:95], a[28:31], a[64:67], v[92:95]
  v_mfma_f32_16x16x32_bf16 v[124:127], a[28:31], a[68:71], v[124:127]
  v_mfma_f32_16x16x32_bf16 v[140:143], a[28:31], a[240:243], v[140:143]
  s_branch L_ep_ffn
L_pp_ffn_3:
  buffer_load_dwordx2 v[252:253], v249, s[76:79], 0 offen sc1
  s_branch L_np_ffn_3
L_pu_ffn_3:
  s_lshr_b32 s46, s68, 2
  s_and_b32 s47, s68, 3
  s_mul_i32 s46, s46, 5120
  s_mul_i32 s47, s47, 757760
  s_add_u32 s46, s46, s47
  s_add_u32 s46, s46, 10485760
  s_cmp_ge_u32 s68, 296
  s_cselect_b32 s46, 0x30000000, s46
  v_add_u32_e64 v213, s67, v206
  ds_read_b64_tr_b16 v[216:217], v213
  ds_read_b64_tr_b16 v[218:219], v213 offset:5120
  v_add_u32_e64 v214, s67, v207
  ds_read_b64_tr_b16 v[220:221], v214
  ds_read_b64_tr_b16 v[222:223], v214 offset:5120
  v_add_u32_e64 v215, s67, v208
  ds_read_b64_tr_b16 v[224:225], v215
  ds_read_b64_tr_b16 v[226:227], v215 offset:5120
  s_add_u32 s47, s46, s64
  s_waitcnt lgkmcnt(0)
  buffer_store_dwordx4 v[216:219], v241, s[32:35], s47 offen sc1
  s_add_u32 s47, s46, s65
  s_waitcnt lgkmcnt(0)
  buffer_store_dwordx4 v[220:223], v241, s[32:35], s47 offen sc1
  s_add_u32 s47, s46, s66
  s_waitcnt lgkmcnt(0)
  buffer_store_dwordx4 v[224:227], v241, s[32:35], s47 offen sc1
  s_branch L_nu_ffn_3
L_ep_ffn:
  s_nop 7
  s_nop 1
  s_lshr_b32 s46, s22, 1
  s_and_b32 s47, s22, 1
  v_and_b32 v253, 15, v255
  v_lshlrev_b32 v253, 2, v253
  v_lshrrev_b32 v252, 4, v255
  v_lshlrev_b32 v252, 4, v252
  s_lshl_b32 s48, s46, 8
  s_waitcnt vmcnt(13)
  s_mov_b32 s43, 0
L_stc_ffn:
  s_mov_b64 s[66:67], exec
  v_cmp_eq_u32 vcc, s23, v203
  s_nop 1
  s_and_b64 s[66:67], s[66:67], vcc
  v_cmp_eq_u32 vcc, s23, v207
  s_nop 1
  s_and_b64 s[66:67], s[66:67], vcc
  v_cmp_eq_u32 vcc, s23, v211
  s_nop 1
  s_and_b64 s[66:67], s[66:67], vcc
  v_cmp_eq_u32 vcc, s23, v215
  s_nop 1
  s_and_b64 s[66:67], s[66:67], vcc
  s_cmp_eq_u64 s[66:67], exec
  s_cbranch_scc1 L_stok_ffn
  s_add_u32 s43, s43, 1
  s_cmp_gt_u32 s43, 200000
  s_cbranch_scc1 L_stok_ffn
  s_sleep 8
  s_lshl_b32 s88, s73, 4
  s_add_u32 s88, s88, 14745600
  buffer_load_dwordx4 v[200:203], v251, s[32:35], s88 offen sc1
  s_lshl_b32 s88, s74, 4
  s_add_u32 s88, s88, 14745600
  buffer_load_dwordx4 v[204:207], v251, s[32:35], s88 offen sc1
  s_lshl_b32 s88, s75, 4
  s_add_u32 s88, s88, 14745600
  buffer_load_dwordx4 v[208:211], v251, s[32:35], s88 offen sc1
  s_lshl_b32 s88, s101, 4
  s_add_u32 s88, s88, 14745600
  buffer_load_dwordx4 v[212:215], v251, s[32:35], s88 offen sc1
  s_waitcnt vmcnt(0)
  s_branch L_stc_ffn
L_stok_ffn:
  s_lshl_b32 s49, s47, 9
  v_add_u32 v254, s49, v252
  v_add_u32_e64 v253, s48, v254
  s_mov_b32 exec_lo, 0x00010001
  s_mov_b32 exec_hi, 0x00010001
  ds_write_b128 v253, v[128:131] offset:0
  ds_write_b128 v253, v[132:135] offset:64
  ds_write_b128 v253, v[136:139] offset:128
  ds_write_b128 v253, v[140:143] offset:192
  s_mov_b64 exec, -1
  s_lshl_b32 s48, s36, 1
  s_add_u32 s46, s46, s48
  s_mul_i32 s46, s46, 303104
  s_lshl_b32 s48, s37, 3
  s_lshl_b32 s49, s47, 2
  s_add_u32 s48, s48, s49
  s_add_u32 s48, s48, 20
  s_lshl_b32 s48, s48, 12
  s_add_u32 s46, s46, s48
  s_mul_i32 s48, s37, 2
  s_add_u32 s48, s48, s47
  s_cmp_eq_u32 s48, 13
  s_cselect_b32 s48, 0x7f000000, 0
  s_waitcnt lgkmcnt(0)
  s_barrier
  ds_read_b128 v[160:163], v254 offset:0
  ds_read_b128 v[164:167], v254 offset:64
  ds_read_b128 v[168:171], v254 offset:128
  ds_read_b128 v[172:175], v254 offset:192
  ds_read_b128 v[176:179], v254 offset:256
  ds_read_b128 v[180:183], v254 offset:320
  ds_read_b128 v[184:187], v254 offset:384
  ds_read_b128 v[188:191], v254 offset:448
  s_waitcnt lgkmcnt(7)
  s_nop 0
  v_pk_fma_f32 v[0:1], v[160:161], v[200:201], v[0:1] op_sel_hi:[1,0,1]
  v_pk_fma_f32 v[2:3], v[162:163], v[200:201], v[2:3] op_sel_hi:[1,0,1]
  v_cvt_pk_bf16_f32 v224, v0, v1
  v_cvt_pk_bf16_f32 v225, v2, v3
  v_pk_max_i16 v224, v224, 0
  v_pk_max_i16 v225, v225, 0
  s_waitcnt lgkmcnt(6)
  s_nop 0
  v_pk_fma_f32 v[4:5], v[164:165], v[200:201], v[4:5] op_sel_hi:[1,0,1]
  v_pk_fma_f32 v[6:7], v[166:167], v[200:201], v[6:7] op_sel_hi:[1,0,1]
  v_cvt_pk_bf16_f32 v226, v4, v5
  v_cvt_pk_bf16_f32 v227, v6, v7
  v_pk_max_i16 v226, v226, 0
  v_pk_max_i16 v227, v227, 0
  buffer_store_dwordx4 v[224:227], v241, s[32:35], s46 offen offset:0 sc1
  v_pk_fma_f32 v[32:33], v[160:161], v[204:205], v[32:33] op_sel_hi:[1,0,1]
  v_pk_fma_f32 v[34:35], v[162:163], v[204:205], v[34:35] op_sel_hi:[1,0,1]
  v_cvt_pk_bf16_f32 v228, v32, v33
  v_cvt_pk_bf16_f32 v229, v34, v35
  v_pk_max_i16 v228, v228, 0
  v_pk_max_i16 v229, v229, 0
  v_pk_fma_f32 v[36:37], v[164:165], v[204:205], v[36:37] op_sel_hi:[1,0,1]
  v_pk_fma_f32 v[38:39], v[166:167], v[204:205], v[38:39] op_sel_hi:[1,0,1]
  v_cvt_pk_bf16_f32 v230, v36, v37
  v_cvt_pk_bf16_f32 v231, v38, v39
  v_pk_max_i16 v230, v230, 0
  v_pk_max_i16 v231, v231, 0
  buffer_store_dwordx4 v[228:231], v241, s[32:35], s46 offen offset:1024 sc1
  v_pk_fma_f32 v[64:65], v[160:161], v[208:209], v[64:65] op_sel_hi:[1,0,1]
  v_pk_fma_f32 v[66:67], v[162:163], v[208:209], v[66:67] op_sel_hi:[1,0,1]
  v_cvt_pk_bf16_f32 v232, v64, v65
  v_cvt_pk_bf16_f32 v233, v66, v67
  v_pk_max_i16 v232, v232, 0
  v_pk_max_i16 v233, v233, 0
  v_pk_fma_f32 v[68:69], v[164:165], v[208:209], v[68:69] op_sel_hi:[1,0,1]
  v_pk_fma_f32 v[70:71], v[166:167], v[208:209], v[70:71] op_sel_hi:[1,0,1]
  v_cvt_pk_bf16_f32 v234, v68, v69
  v_cvt_pk_bf16_f32 v235, v70, v71
  v_pk_max_i16 v234, v234, 0
  v_pk_max_i16 v235, v235, 0
  buffer_store_dwordx4 v[232:235], v241, s[32:35], s46 offen offset:2048 sc1
  v_pk_fma_f32 v[96:97], v[160:161], v[212:213], v[96:97] op_sel_hi:[1,0,1]
  v_pk_fma_f32 v[98:99], v[162:163], v[212:213], v[98:99] op_sel_hi:[1,0,1]
  v_cvt_pk_bf16_f32 v236, v96, v97
  v_cvt_pk_bf16_f32 v237, v98, v99
  v_pk_max_i16 v236, v236, 0
  v_pk_max_i16 v237, v237, 0
  v_pk_fma_f32 v[100:101], v[164:165], v[212:213], v[100:101] op_sel_hi:[1,0,1]
  v_pk_fma_f32 v[102:103], v[166:167], v[212:213], v[102:103] op_sel_hi:[1,0,1]
  v_cvt_pk_bf16_f32 v238, v100, v101
  v_cvt_pk_bf16_f32 v239, v102, v103
  v_pk_max_i16 v238, v238, 0
  v_pk_max_i16 v239, v239, 0
  buffer_store_dwordx4 v[236:239], v241, s[32:35], s46 offen offset:3072 sc1
  s_add_u32 s46, s46, 4096
  s_waitcnt lgkmcnt(5)
  s_nop 0
  v_pk_fma_f32 v[8:9], v[168:169], v[200:201], v[8:9] op_sel_hi:[1,0,1]
  v_pk_fma_f32 v[10:11], v[170:171], v[200:201], v[10:11] op_sel_hi:[1,0,1]
  v_cvt_pk_bf16_f32 v224, v8, v9
  v_cvt_pk_bf16_f32 v225, v10, v11
  v_pk_max_i16 v224, v224, 0
  v_pk_max_i16 v225, v225, 0
  s_waitcnt lgkmcnt(4)
  s_nop 0
  v_pk_fma_f32 v[12:13], v[172:173], v[200:201], v[12:13] op_sel_hi:[1,0,1]
  v_pk_fma_f32 v[14:15], v[174:175], v[200:201], v[14:15] op_sel_hi:[1,0,1]
  v_cvt_pk_bf16_f32 v226, v12, v13
  v_cvt_pk_bf16_f32 v227, v14, v15
  v_pk_max_i16 v226, v226, 0
  v_pk_max_i16 v227, v227, 0
  buffer_store_dwordx4 v[224:227], v241, s[32:35], s46 offen offset:0 sc1
  v_pk_fma_f32 v[40:41], v[168:169], v[204:205], v[40:41] op_sel_hi:[1,0,1]
  v_pk_fma_f32 v[42:43], v[170:171], v[204:205], v[42:43] op_sel_hi:[1,0,1]
  v_cvt_pk_bf16_f32 v228, v40, v41
  v_cvt_pk_bf16_f32 v229, v42, v43
  v_pk_max_i16 v228, v228, 0
  v_pk_max_i16 v229, v229, 0
  v_pk_fma_f32 v[44:45], v[172:173], v[204:205], v[44:45] op_sel_hi:[1,0,1]
  v_pk_fma_f32 v[46:47], v[174:175], v[204:205], v[46:47] op_sel_hi:[1,0,1]
  v_cvt_pk_bf16_f32 v230, v44, v45
  v_cvt_pk_bf16_f32 v231, v46, v47
  v_pk_max_i16 v230, v230, 0
  v_pk_max_i16 v231, v231, 0
  buffer_store_dwordx4 v[228:231], v241, s[32:35], s46 offen offset:1024 sc1
  v_pk_fma_f32 v[72:73], v[168:169], v[208:209], v[72:73] op_sel_hi:[1,0,1]
  v_pk_fma_f32 v[74:75], v[170:171], v[208:209], v[74:75] op_sel_hi:[1,0,1]
  v_cvt_pk_bf16_f32 v232, v72, v73
  v_cvt_pk_bf16_f32 v233, v74, v75
  v_pk_max_i16 v232, v232, 0
  v_pk_max_i16 v233, v233, 0
  v_pk_fma_f32 v[76:77], v[172:173], v[208:209], v[76:77] op_sel_hi:[1,0,1]
  v_pk_fma_f32 v[78:79], v[174:175], v[208:209], v[78:79] op_sel_hi:[1,0,1]
  v_cvt_pk_bf16_f32 v234, v76, v77
  v_cvt_pk_bf16_f32 v235, v78, v79
  v_pk_max_i16 v234, v234, 0
  v_pk_max_i16 v235, v235, 0
  buffer_store_dwordx4 v[232:235], v241, s[32:35], s46 offen offset:2048 sc1
  v_pk_fma_f32 v[104:105], v[168:169], v[212:213], v[104:105] op_sel_hi:[1,0,1]
  v_pk_fma_f32 v[106:107], v[170:171], v[212:213], v[106:107] op_sel_hi:[1,0,1]
  v_cvt_pk_bf16_f32 v236, v104, v105
  v_cvt_pk_bf16_f32 v237, v106, v107
  v_pk_max_i16 v236, v236, 0
  v_pk_max_i16 v237, v237, 0
  v_pk_fma_f32 v[108:109], v[172:173], v[212:213], v[108:109] op_sel_hi:[1,0,1]
  v_pk_fma_f32 v[110:111], v[174:175], v[212:213], v[110:111] op_sel_hi:[1,0,1]
  v_cvt_pk_bf16_f32 v238, v108, v109
  v_cvt_pk_bf16_f32 v239, v110, v111
  v_pk_max_i16 v238, v238, 0
  v_pk_max_i16 v239, v239, 0
  buffer_store_dwordx4 v[236:239], v241, s[32:35], s46 offen offset:3072 sc1
  s_add_u32 s46, s46, 4096
  s_add_u32 s46, s46, s48
  s_waitcnt lgkmcnt(3)
  v_pk_fma_f32 v[16:17], v[176:177], v[200:201], v[16:17] op_sel_hi:[1,0,1]
  v_pk_fma_f32 v[18:19], v[178:179], v[200:201], v[18:19] op_sel_hi:[1,0,1]
  v_cvt_pk_bf16_f32 v224, v16, v17
  v_cvt_pk_bf16_f32 v225, v18, v19
  v_pk_max_i16 v224, v224, 0
  v_pk_max_i16 v225, v225, 0
  s_waitcnt lgkmcnt(2)
  s_nop 0
  v_pk_fma_f32 v[20:21], v[180:181], v[200:201], v[20:21] op_sel_hi:[1,0,1]
  v_pk_fma_f32 v[22:23], v[182:183], v[200:201], v[22:23] op_sel_hi:[1,0,1]
  v_cvt_pk_bf16_f32 v226, v20, v21
  v_cvt_pk_bf16_f32 v227, v22, v23
  v_pk_max_i16 v226, v226, 0
  v_pk_max_i16 v227, v227, 0
  buffer_store_dwordx4 v[224:227], v241, s[32:35], s46 offen offset:0 sc1
  v_pk_fma_f32 v[48:49], v[176:177], v[204:205], v[48:49] op_sel_hi:[1,0,1]
  v_pk_fma_f32 v[50:51], v[178:179], v[204:205], v[50:51] op_sel_hi:[1,0,1]
  v_cvt_pk_bf16_f32 v228, v48, v49
  v_cvt_pk_bf16_f32 v229, v50, v51
  v_pk_max_i16 v228, v228, 0
  v_pk_max_i16 v229, v229, 0
  v_pk_fma_f32 v[52:53], v[180:181], v[204:205], v[52:53] op_sel_hi:[1,0,1]
  v_pk_fma_f32 v[54:55], v[182:183], v[204:205], v[54:55] op_sel_hi:[1,0,1]
  v_cvt_pk_bf16_f32 v230, v52, v53
  v_cvt_pk_bf16_f32 v231, v54, v55
  v_pk_max_i16 v230, v230, 0
  v_pk_max_i16 v231, v231, 0
  buffer_store_dwordx4 v[228:231], v241, s[32:35], s46 offen offset:1024 sc1
  v_pk_fma_f32 v[80:81], v[176:177], v[208:209], v[80:81] op_sel_hi:[1,0,1]
  v_pk_fma_f32 v[82:83], v[178:179], v[208:209], v[82:83] op_sel_hi:[1,0,1]
  v_cvt_pk_bf16_f32 v232, v80, v81
  v_cvt_pk_bf16_f32 v233, v82, v83
  v_pk_max_i16 v232, v232, 0
  v_pk_max_i16 v233, v233, 0
  v_pk_fma_f32 v[84:85], v[180:181], v[208:209], v[84:85] op_sel_hi:[1,0,1]
  v_pk_fma_f32 v[86:87], v[182:183], v[208:209], v[86:87] op_sel_hi:[1,0,1]
  v_cvt_pk_bf16_f32 v234, v84, v85
  v_cvt_pk_bf16_f32 v235, v86, v87
  v_pk_max_i16 v234, v234, 0
  v_pk_max_i16 v235, v235, 0
  buffer_store_dwordx4 v[232:235], v241, s[32:35], s46 offen offset:2048 sc1
  v_pk_fma_f32 v[112:113], v[176:177], v[212:213], v[112:113] op_sel_hi:[1,0,1]
  v_pk_fma_f32 v[114:115], v[178:179], v[212:213], v[114:115] op_sel_hi:[1,0,1]
  v_cvt_pk_bf16_f32 v236, v112, v113
  v_cvt_pk_bf16_f32 v237, v114, v115
  v_pk_max_i16 v236, v236, 0
  v_pk_max_i16 v237, v237, 0
  v_pk_fma_f32 v[116:117], v[180:181], v[212:213], v[116:117] op_sel_hi:[1,0,1]
  v_pk_fma_f32 v[118:119], v[182:183], v[212:213], v[118:119] op_sel_hi:[1,0,1]
  v_cvt_pk_bf16_f32 v238, v116, v117
  v_cvt_pk_bf16_f32 v239, v118, v119
  v_pk_max_i16 v238, v238, 0
  v_pk_max_i16 v239, v239, 0
  buffer_store_dwordx4 v[236:239], v241, s[32:35], s46 offen offset:3072 sc1
  s_add_u32 s46, s46, 4096
  s_waitcnt lgkmcnt(1)
  s_nop 0
  v_pk_fma_f32 v[24:25], v[184:185], v[200:201], v[24:25] op_sel_hi:[1,0,1]
  v_pk_fma_f32 v[26:27], v[186:187], v[200:201], v[26:27] op_sel_hi:[1,0,1]
  v_cvt_pk_bf16_f32 v224, v24, v25
  v_cvt_pk_bf16_f32 v225, v26, v27
  v_pk_max_i16 v224, v224, 0
  v_pk_max_i16 v225, v225, 0
  s_waitcnt lgkmcnt(0)
  s_nop 0
  v_pk_fma_f32 v[28:29], v[188:189], v[200:201], v[28:29] op_sel_hi:[1,0,1]
  v_pk_fma_f32 v[30:31], v[190:191], v[200:201], v[30:31] op_sel_hi:[1,0,1]
  v_cvt_pk_bf16_f32 v226, v28, v29
  v_cvt_pk_bf16_f32 v227, v30, v31
  v_pk_max_i16 v226, v226, 0
  v_pk_max_i16 v227, v227, 0
  buffer_store_dwordx4 v[224:227], v241, s[32:35], s46 offen offset:0 sc1
  v_pk_fma_f32 v[56:57], v[184:185], v[204:205], v[56:57] op_sel_hi:[1,0,1]
  v_pk_fma_f32 v[58:59], v[186:187], v[204:205], v[58:59] op_sel_hi:[1,0,1]
  v_cvt_pk_bf16_f32 v228, v56, v57
  v_cvt_pk_bf16_f32 v229, v58, v59
  v_pk_max_i16 v228, v228, 0
  v_pk_max_i16 v229, v229, 0
  v_pk_fma_f32 v[60:61], v[188:189], v[204:205], v[60:61] op_sel_hi:[1,0,1]
  v_pk_fma_f32 v[62:63], v[190:191], v[204:205], v[62:63] op_sel_hi:[1,0,1]
  v_cvt_pk_bf16_f32 v230, v60, v61
  v_cvt_pk_bf16_f32 v231, v62, v63
  v_pk_max_i16 v230, v230, 0
  v_pk_max_i16 v231, v231, 0
  buffer_store_dwordx4 v[228:231], v241, s[32:35], s46 offen offset:1024 sc1
  v_pk_fma_f32 v[88:89], v[184:185], v[208:209], v[88:89] op_sel_hi:[1,0,1]
  v_pk_fma_f32 v[90:91], v[186:187], v[208:209], v[90:91] op_sel_hi:[1,0,1]
  v_cvt_pk_bf16_f32 v232, v88, v89
  v_cvt_pk_bf16_f32 v233, v90, v91
  v_pk_max_i16 v232, v232, 0
  v_pk_max_i16 v233, v233, 0
  v_pk_fma_f32 v[92:93], v[188:189], v[208:209], v[92:93] op_sel_hi:[1,0,1]
  v_pk_fma_f32 v[94:95], v[190:191], v[208:209], v[94:95] op_sel_hi:[1,0,1]
  v_cvt_pk_bf16_f32 v234, v92, v93
  v_cvt_pk_bf16_f32 v235, v94, v95
  v_pk_max_i16 v234, v234, 0
  v_pk_max_i16 v235, v235, 0
  buffer_store_dwordx4 v[232:235], v241, s[32:35], s46 offen offset:2048 sc1
  v_pk_fma_f32 v[120:121], v[184:185], v[212:213], v[120:121] op_sel_hi:[1,0,1]
  v_pk_fma_f32 v[122:123], v[186:187], v[212:213], v[122:123] op_sel_hi:[1,0,1]
  v_cvt_pk_bf16_f32 v236, v120, v121
  v_cvt_pk_bf16_f32 v237, v122, v123
  v_pk_max_i16 v236, v236, 0
  v_pk_max_i16 v237, v237, 0
  v_pk_fma_f32 v[124:125], v[188:189], v[212:213], v[124:125] op_sel_hi:[1,0,1]
  v_pk_fma_f32 v[126:127], v[190:191], v[212:213], v[126:127] op_sel_hi:[1,0,1]
  v_cvt_pk_bf16_f32 v238, v124, v125
  v_cvt_pk_bf16_f32 v239, v126, v127
  v_pk_max_i16 v238, v238, 0
  v_pk_max_i16 v239, v239, 0
  buffer_store_dwordx4 v[236:239], v241, s[32:35], s46 offen offset:3072 sc1
  s_add_u32 s46, s46, 4096
  s_mov_b32 s100, 1
  v_lshlrev_b32 v243, 2, v255
  buffer_load_dword v243, v243, s[32:35], s45 offen sc1
  s_mul_i32 s87, s9, 5
  s_add_u32 s87, s87, s83
  buffer_load_dwordx4 a[0:3], v241, s[32:35], s87 offen offset:0 sc1
  buffer_load_dwordx4 a[4:7], v241, s[32:35], s87 offen offset:1024 sc1
  buffer_load_dwordx4 a[8:11], v241, s[32:35], s87 offen offset:2048 sc1
  buffer_load_dwordx4 a[12:15], v241, s[32:35], s87 offen offset:3072 sc1
  buffer_load_dwordx4 a[16:19], v245, s[32:35], s87 offen sc1
  s_mul_i32 s87, s10, 5
  s_add_u32 s87, s87, s83
  buffer_load_dwordx4 a[20:23], v241, s[32:35], s87 offen offset:0 sc1
  buffer_load_dwordx4 a[24:27], v241, s[32:35], s87 offen offset:1024 sc1
  buffer_load_dwordx4 a[28:31], v241, s[32:35], s87 offen offset:2048 sc1
  buffer_load_dwordx4 a[32:35], v241, s[32:35], s87 offen offset:3072 sc1
  buffer_load_dwordx4 a[36:39], v245, s[32:35], s87 offen sc1
  s_mul_i32 s87, s11, 5
  s_add_u32 s87, s87, s83
  buffer_load_dwordx4 a[40:43], v241, s[32:35], s87 offen offset:0 sc1
  buffer_load_dwordx4 a[44:47], v241, s[32:35], s87 offen offset:1024 sc1
  s_waitcnt vmcnt(12)
  s_barrier
  s_cmp_lg_u32 s22, 0
  s_cbranch_scc1 L_nosig_ffn
  s_and_b32 s46, s36, 1
  s_lshl_b32 s46, s46, 4
  v_add_u32 v1, s46, v255
  v_lshlrev_b32 v1, 3, v1
  s_lshr_b32 s46, s36, 1
  v_add_u32 v1, s46, v1
  v_lshlrev_b32 v1, 7, v1
  s_lshl_b32 s46, s82, 2
  s_add_u32 s46, s46, 15728640
  v_mov_b32_e64 v2, s23
  s_mov_b32 exec_lo, 0xffff
  s_mov_b32 exec_hi, 0
  buffer_store_dword v2, v1, s[32:35], s46 offen sc1
  s_mov_b64 exec, -1
L_nosig_ffn:
  buffer_load_dwordx4 a[48:51], v241, s[32:35], s87 offen offset:2048 sc1
  buffer_load_dwordx4 a[52:55], v241, s[32:35], s87 offen offset:3072 sc1
  buffer_load_dwordx4 a[56:59], v245, s[32:35], s87 offen sc1
  s_mul_i32 s87, s12, 5
  s_add_u32 s87, s87, s83
  buffer_load_dwordx4 a[60:63], v241, s[32:35], s87 offen offset:0 sc1
  buffer_load_dwordx4 a[64:67], v241, s[32:35], s87 offen offset:1024 sc1
  buffer_load_dwordx4 a[68:71], v241, s[32:35], s87 offen offset:2048 sc1
  buffer_load_dwordx4 a[72:75], v241, s[32:35], s87 offen offset:3072 sc1
  buffer_load_dwordx4 a[76:79], v245, s[32:35], s87 offen sc1
  s_mul_i32 s87, s13, 5
  s_add_u32 s87, s87, s83
  buffer_load_dwordx4 a[80:83], v241, s[32:35], s87 offen offset:0 sc1
  buffer_load_dwordx4 a[84:87], v241, s[32:35], s87 offen offset:1024 sc1
  buffer_load_dwordx4 a[88:91], v241, s[32:35], s87 offen offset:2048 sc1
  buffer_load_dwordx4 a[92:95], v241, s[32:35], s87 offen offset:3072 sc1
  buffer_load_dwordx4 a[96:99], v245, s[32:35], s87 offen sc1
  s_mul_i32 s87, s14, 5
  s_add_u32 s87, s87, s83
  buffer_load_dwordx4 a[100:103], v241, s[32:35], s87 offen offset:0 sc1
  buffer_load_dwordx4 a[104:107], v241, s[32:35], s87 offen offset:1024 sc1
  buffer_load_dwordx4 a[108:111], v241, s[32:35], s87 offen offset:2048 sc1
  buffer_load_dwordx4 a[112:115], v241, s[32:35], s87 offen offset:3072 sc1
  buffer_load_dwordx4 a[116:119], v245, s[32:35], s87 offen sc1
  s_mul_i32 s87, s15, 5
  s_add_u32 s87, s87, s83
  buffer_load_dwordx4 a[120:123], v241, s[32:35], s87 offen offset:0 sc1
  buffer_load_dwordx4 a[124:127], v241, s[32:35], s87 offen offset:1024 sc1
  buffer_load_dwordx4 a[128:131], v241, s[32:35], s87 offen offset:2048 sc1
  buffer_load_dwordx4 a[132:135], v241, s[32:35], s87 offen offset:3072 sc1
  buffer_load_dwordx4 a[136:139], v245, s[32:35], s87 offen sc1
  s_mul_i32 s87, s18, 5
  s_add_u32 s87, s87, s83
  buffer_load_dwordx4 a[140:143], v241, s[32:35], s87 offen offset:0 sc1
  buffer_load_dwordx4 a[144:147], v241, s[32:35], s87 offen offset:1024 sc1
  buffer_load_dwordx4 a[148:151], v241, s[32:35], s87 offen offset:2048 sc1
  buffer_load_dwordx4 a[152:155], v241, s[32:35], s87 offen offset:3072 sc1
  buffer_load_dwordx4 a[156:159], v245, s[32:35], s87 offen sc1
  s_mul_i32 s87, s19, 5
  s_add_u32 s87, s87, s83
  buffer_load_dwordx4 a[160:163], v241, s[32:35], s87 offen offset:0 sc1
  buffer_load_dwordx4 a[164:167], v241, s[32:35], s87 offen offset:1024 sc1
  buffer_load_dwordx4 a[168:171], v241, s[32:35], s87 offen offset:2048 sc1
  buffer_load_dwordx4 a[172:175], v241, s[32:35], s87 offen offset:3072 sc1
  buffer_load_dwordx4 a[176:179], v245, s[32:35], s87 offen sc1
  s_mul_i32 s87, s22, 5120
  s_add_u32 s87, s87, s83
  s_add_u32 s87, s87, 0
  buffer_load_dwordx4 a[180:183], v241, s[32:35], s87 offen offset:0 sc1
  buffer_load_dwordx4 a[184:187], v241, s[32:35], s87 offen offset:1024 sc1
  buffer_load_dwordx4 a[188:191], v241, s[32:35], s87 offen offset:2048 sc1
  buffer_load_dwordx4 a[192:195], v241, s[32:35], s87 offen offset:3072 sc1
  buffer_load_dwordx4 a[196:199], v245, s[32:35], s87 offen sc1
  s_mul_i32 s87, s22, 5120
  s_add_u32 s87, s87, s83
  s_add_u32 s87, s87, 20480
  buffer_load_dwordx4 a[200:203], v241, s[32:35], s87 offen offset:0 sc1
  buffer_load_dwordx4 a[204:207], v241, s[32:35], s87 offen offset:1024 sc1
  buffer_load_dwordx4 a[208:211], v241, s[32:35], s87 offen offset:2048 sc1
  buffer_load_dwordx4 a[212:215], v241, s[32:35], s87 offen offset:3072 sc1
  buffer_load_dwordx4 a[216:219], v245, s[32:35], s87 offen sc1
  s_mul_i32 s87, s22, 5120
  s_add_u32 s87, s87, s83
  s_add_u32 s87, s87, 40960
  buffer_load_dwordx4 a[220:223], v241, s[32:35], s87 offen offset:0 sc1
  buffer_load_dwordx4 a[224:227], v241, s[32:35], s87 offen offset:1024 sc1
  buffer_load_dwordx4 a[228:231], v241, s[32:35], s87 offen offset:2048 sc1
  buffer_load_dwordx4 a[232:235], v241, s[32:35], s87 offen offset:3072 sc1
  buffer_load_dwordx4 a[236:239], v245, s[32:35], s87 offen sc1
  s_branch L_ph2
L_ph2:
  s_add_u32 s46, s22, 0
  s_and_b32 s46, s46, 3
  s_lshl_b32 s46, s46, 10
  v_add_u32 v244, s46, v241
  s_add_u32 s46, s22, 1
  s_and_b32 s46, s46, 3
  s_lshl_b32 s46, s46, 10
  v_add_u32 v246, s46, v241
  s_add_u32 s46, s22, 2
  s_and_b32 s46, s46, 3
  s_lshl_b32 s46, s46, 10
  v_add_u32 v248, s46, v241
  s_add_u32 s46, s22, 3
  s_and_b32 s46, s46, 3
  s_lshl_b32 s46, s46, 10
  v_add_u32_e64 v249, s46, v241
  v_cmp_eq_u32 vcc, s23, v243
  s_nop 3
  s_and_b32 s46, vcc_lo, 0x7f
  s_cmp_eq_u32 s46, 0x7f
  s_cbranch_scc1 L_ph2_ok2
  s_mov_b32 s47, 0
  v_lshlrev_b32_e64 v251, 2, v255
L_spin_f:
  buffer_load_dword v250, v251, s[32:35], s45 offen sc1
  s_waitcnt vmcnt(0)
  v_cmp_eq_u32 vcc, s23, v250
  s_nop 3
  s_and_b32 s46, vcc_lo, 0x7f
  s_cmp_eq_u32 s46, 0x7f
  s_cbranch_scc1 L_ok_f
  s_sleep 8
  s_add_u32 s47, s47, 1
  s_cmp_lt_u32 s47, 200000
  s_cbranch_scc1 L_spin_f
L_ok_f:
L_ph2_ok2:
  s_lshl_b32 s90, s4, 2
  s_add_u32 s90, s90, s84
  buffer_load_dwordx4 v[80:83], v244, s[32:35], s90 offen sc1
  buffer_load_dwordx4 v[84:87], v246, s[32:35], s90 offen sc1
  buffer_load_dwordx4 v[88:91], v248, s[32:35], s90 offen sc1
  buffer_load_dwordx4 v[92:95], v249, s[32:35], s90 offen sc1
  s_lshl_b32 s90, s5, 2
  s_add_u32 s90, s90, s84
  buffer_load_dwordx4 v[96:99], v244, s[32:35], s90 offen sc1
  buffer_load_dwordx4 v[100:103], v246, s[32:35], s90 offen sc1
  buffer_load_dwordx4 v[104:107], v248, s[32:35], s90 offen sc1
  buffer_load_dwordx4 v[108:111], v249, s[32:35], s90 offen sc1
  s_lshl_b32 s90, s6, 2
  s_add_u32 s90, s90, s84
  buffer_load_dwordx4 v[112:115], v244, s[32:35], s90 offen sc1
  buffer_load_dwordx4 v[116:119], v246, s[32:35], s90 offen sc1
  buffer_load_dwordx4 v[120:123], v248, s[32:35], s90 offen sc1
  buffer_load_dwordx4 v[124:127], v249, s[32:35], s90 offen sc1
  s_lshl_b32 s90, s7, 2
  s_add_u32 s90, s90, s84
  buffer_load_dwordx4 v[128:131], v244, s[32:35], s90 offen sc1
  buffer_load_dwordx4 v[132:135], v246, s[32:35], s90 offen sc1
  buffer_load_dwordx4 v[136:139], v248, s[32:35], s90 offen sc1
  buffer_load_dwordx4 v[140:143], v249, s[32:35], s90 offen sc1
  s_lshl_b32 s90, s8, 2
  s_add_u32 s90, s90, s84
  buffer_load_dwordx4 v[144:147], v244, s[32:35], s90 offen sc1
  buffer_load_dwordx4 v[148:151], v246, s[32:35], s90 offen sc1
  buffer_load_dwordx4 v[152:155], v248, s[32:35], s90 offen sc1
  buffer_load_dwordx4 v[156:159], v249, s[32:35], s90 offen sc1
  s_lshl_b32 s90, s9, 2
  s_add_u32 s90, s90, s84
  buffer_load_dwordx4 v[160:163], v244, s[32:35], s90 offen sc1
  buffer_load_dwordx4 v[164:167], v246, s[32:35], s90 offen sc1
  buffer_load_dwordx4 v[168:171], v248, s[32:35], s90 offen sc1
  buffer_load_dwordx4 v[172:175], v249, s[32:35], s90 offen sc1
  s_branch L_ph2_main_F
L_ph2_main_F:
  v_add_u32 v216, s85, v241
  v_add_u32 v217, s86, v241
  ds_read_b128 v[176:179], v216 offset:0
  ds_read_b128 v[180:183], v216 offset:1024
  ds_read_b128 v[184:187], v216 offset:2048
  ds_read_b128 v[188:191], v216 offset:3072
  ds_read_b128 v[192:195], v216 offset:4096
  v_lshlrev_b32_e64 v218, 2, v255
  s_add_u32 s46, s22, 1
  s_and_b32 s46, s46, 3
  s_mul_i32 s46, s46, 15360
  s_add_u32 s46, s46, 0
  v_add_u32 v237, s46, v241
  s_add_u32 s46, s22, 2
  s_and_b32 s46, s46, 3
  s_mul_i32 s46, s46, 15360
  s_add_u32 s46, s46, 5120
  v_add_u32_e64 v238, s46, v241
  s_add_u32 s46, s22, 3
  s_and_b32 s46, s46, 3
  s_mul_i32 s46, s46, 15360
  s_add_u32 s46, s46, 10240
  v_add_u32 v239, s46, v241
  s_waitcnt vmcnt(23) lgkmcnt(4)
  v_mfma_f32_16x16x32_bf16 v[0:3], v[176:179], v[80:83], 0
  s_waitcnt vmcnt(22)
  v_mfma_f32_16x16x32_bf16 v[20:23], v[176:179], v[84:87], 0
  s_waitcnt vmcnt(21)
  v_mfma_f32_16x16x32_bf16 v[40:43], v[176:179], v[88:91], 0
  s_waitcnt vmcnt(20)
  v_mfma_f32_16x16x32_bf16 v[60:63], v[176:179], v[92:95], 0
  ds_read_b128 v[196:199], v216 offset:5120
  s_waitcnt lgkmcnt(4)
  v_mfma_f32_16x16x32_bf16 v[4:7], v[180:183], v[80:83], 0
  v_mfma_f32_16x16x32_bf16 v[24:27], v[180:183], v[84:87], 0
  v_mfma_f32_16x16x32_bf16 v[44:47], v[180:183], v[88:91], 0
  v_mfma_f32_16x16x32_bf16 v[64:67], v[180:183], v[92:95], 0
  ds_read_b128 v[200:203], v216 offset:6144
  s_waitcnt lgkmcnt(4)
  v_mfma_f32_16x16x32_bf16 v[8:11], v[184:187], v[80:83], 0
  v_mfma_f32_16x16x32_bf16 v[28:31], v[184:187], v[84:87], 0
  v_mfma_f32_16x16x32_bf16 v[48:51], v[184:187], v[88:91], 0
  v_mfma_f32_16x16x32_bf16 v[68:71], v[184:187], v[92:95], 0
  ds_read_b128 v[204:207], v216 offset:7168
  s_waitcnt lgkmcnt(4)
  v_mfma_f32_16x16x32_bf16 v[12:15], v[188:191], v[80:83], 0
  v_mfma_f32_16x16x32_bf16 v[32:35], v[188:191], v[84:87], 0
  v_mfma_f32_16x16x32_bf16 v[52:55], v[188:191], v[88:91], 0
  v_mfma_f32_16x16x32_bf16 v[72:75], v[188:191], v[92:95], 0
  ds_read_b128 v[208:211], v216 offset:8192
  s_waitcnt lgkmcnt(4)
  v_mfma_f32_16x16x32_bf16 v[16:19], v[192:195], v[80:83], 0
  v_mfma_f32_16x16x32_bf16 v[36:39], v[192:195], v[84:87], 0
  v_mfma_f32_16x16x32_bf16 v[56:59], v[192:195], v[88:91], 0
  v_mfma_f32_16x16x32_bf16 v[76:79], v[192:195], v[92:95], 0
  ds_read_b128 v[212:215], v216 offset:9216
  s_waitcnt vmcnt(19) lgkmcnt(4)
  v_mfma_f32_16x16x32_bf16 v[0:3], v[196:199], v[96:99], v[0:3]
  s_waitcnt vmcnt(18)
  v_mfma_f32_16x16x32_bf16 v[20:23], v[196:199], v[100:103], v[20:23]
  s_waitcnt vmcnt(17)
  v_mfma_f32_16x16x32_bf16 v[40:43], v[196:199], v[104:107], v[40:43]
  ds_read_b128 v[176:179], v216 offset:10240
  s_waitcnt vmcnt(16)
  v_mfma_f32_16x16x32_bf16 v[60:63], v[196:199], v[108:111], v[60:63]
  s_waitcnt lgkmcnt(4)
  v_mfma_f32_16x16x32_bf16 v[4:7], v[200:203], v[96:99], v[4:7]
  ds_read_b128 v[180:183], v216 offset:11264
  v_mfma_f32_16x16x32_bf16 v[24:27], v[200:203], v[100:103], v[24:27]
  v_mfma_f32_16x16x32_bf16 v[44:47], v[200:203], v[104:107], v[44:47]
  ds_read_b128 v[184:187], v217 offset:0
  v_mfma_f32_16x16x32_bf16 v[64:67], v[200:203], v[108:111], v[64:67]
  s_waitcnt lgkmcnt(5)
  v_mfma_f32_16x16x32_bf16 v[8:11], v[204:207], v[96:99], v[8:11]
  ds_read_b128 v[188:191], v217 offset:1024
  v_mfma_f32_16x16x32_bf16 v[28:31], v[204:207], v[100:103], v[28:31]
  v_mfma_f32_16x16x32_bf16 v[48:51], v[204:207], v[104:107], v[48:51]
  v_mfma_f32_16x16x32_bf16 v[68:71], v[204:207], v[108:111], v[68:71]
  ds_read_b128 v[192:195], v217 offset:2048
  s_waitcnt lgkmcnt(6)
  v_mfma_f32_16x16x32_bf16 v[12:15], v[208:211], v[96:99], v[12:15]
  v_mfma_f32_16x16x32_bf16 v[32:35], v[208:211], v[100:103], v[32:35]
  s_lshl_b32 s90, s10, 2
  s_add_u32 s90, s90, s84
  buffer_load_dwordx4 v[80:83], v244, s[32:35], s90 offen sc1
  v_mfma_f32_16x16x32_bf16 v[52:55], v[208:211], v[104:107], v[52:55]
  v_mfma_f32_16x16x32_bf16 v[72:75], v[208:211], v[108:111], v[72:75]
  buffer_load_dwordx4 v[84:87], v246, s[32:35], s90 offen sc1
  s_waitcnt lgkmcnt(5)
  v_mfma_f32_16x16x32_bf16 v[16:19], v[212:215], v[96:99], v[16:19]
  v_mfma_f32_16x16x32_bf16 v[36:39], v[212:215], v[100:103], v[36:39]
  buffer_load_dwordx4 v[88:91], v248, s[32:35], s90 offen sc1
  v_mfma_f32_16x16x32_bf16 v[56:59], v[212:215], v[104:107], v[56:59]
  v_mfma_f32_16x16x32_bf16 v[76:79], v[212:215], v[108:111], v[76:79]
  buffer_load_dwordx4 v[92:95], v249, s[32:35], s90 offen sc1
  s_waitcnt vmcnt(19) lgkmcnt(4)
  v_mfma_f32_16x16x32_bf16 v[0:3], v[176:179], v[112:115], v[0:3]
  s_waitcnt vmcnt(18)
  v_mfma_f32_16x16x32_bf16 v[20:23], v[176:179], v[116:119], v[20:23]
  s_waitcnt vmcnt(17)
  v_mfma_f32_16x16x32_bf16 v[40:43], v[176:179], v[120:123], v[40:43]
  ds_read_b128 v[196:199], v217 offset:3072
  s_waitcnt vmcnt(16)
  v_mfma_f32_16x16x32_bf16 v[60:63], v[176:179], v[124:127], v[60:63]
  s_waitcnt lgkmcnt(4)
  v_mfma_f32_16x16x32_bf16 v[4:7], v[180:183], v[112:115], v[4:7]
  ds_read_b128 v[200:203], v217 offset:4096
  v_mfma_f32_16x16x32_bf16 v[24:27], v[180:183], v[116:119], v[24:27]
  v_mfma_f32_16x16x32_bf16 v[44:47], v[180:183], v[120:123], v[44:47]
  ds_read_b128 v[204:207], v217 offset:5120
  v_mfma_f32_16x16x32_bf16 v[64:67], v[180:183], v[124:127], v[64:67]
  s_waitcnt lgkmcnt(5)
  v_mfma_f32_16x16x32_bf16 v[8:11], v[184:187], v[112:115], v[8:11]
  ds_read_b128 v[208:211], v217 offset:6144
  v_mfma_f32_16x16x32_bf16 v[28:31], v[184:187], v[116:119], v[28:31]
  v_mfma_f32_16x16x32_bf16 v[48:51], v[184:187], v[120:123], v[48:51]
  v_mfma_f32_16x16x32_bf16 v[68:71], v[184:187], v[124:127], v[68:71]
  ds_read_b128 v[212:215], v217 offset:7168
  s_waitcnt lgkmcnt(6)
  v_mfma_f32_16x16x32_bf16 v[12:15], v[188:191], v[112:115], v[12:15]
  v_mfma_f32_16x16x32_bf16 v[32:35], v[188:191], v[116:119], v[32:35]
  s_lshl_b32 s90, s11, 2
  s_add_u32 s90, s90, s84
  buffer_load_dwordx4 v[96:99], v244, s[32:35], s90 offen sc1
  v_mfma_f32_16x16x32_bf16 v[52:55], v[188:191], v[120:123], v[52:55]
  v_mfma_f32_16x16x32_bf16 v[72:75], v[188:191], v[124:127], v[72:75]
  buffer_load_dwordx4 v[100:103], v246, s[32:35], s90 offen sc1
  s_waitcnt lgkmcnt(5)
  v_mfma_f32_16x16x32_bf16 v[16:19], v[192:195], v[112:115], v[16:19]
  v_mfma_f32_16x16x32_bf16 v[36:39], v[192:195], v[116:119], v[36:39]
  buffer_load_dwordx4 v[104:107], v248, s[32:35], s90 offen sc1
  v_mfma_f32_16x16x32_bf16 v[56:59], v[192:195], v[120:123], v[56:59]
  v_mfma_f32_16x16x32_bf16 v[76:79], v[192:195], v[124:127], v[76:79]
  buffer_load_dwordx4 v[108:111], v249, s[32:35], s90 offen sc1
  s_waitcnt vmcnt(19) lgkmcnt(4)
  v_mfma_f32_16x16x32_bf16 v[0:3], v[196:199], v[128:131], v[0:3]
  s_waitcnt vmcnt(18)
  v_mfma_f32_16x16x32_bf16 v[20:23], v[196:199], v[132:135], v[20:23]
  s_waitcnt vmcnt(17)
  v_mfma_f32_16x16x32_bf16 v[40:43], v[196:199], v[136:139], v[40:43]
  ds_read_b128 v[176:179], v217 offset:8192
  s_waitcnt vmcnt(16)
  v_mfma_f32_16x16x32_bf16 v[60:63], v[196:199], v[140:143], v[60:63]
  s_waitcnt lgkmcnt(4)
  v_mfma_f32_16x16x32_bf16 v[4:7], v[200:203], v[128:131], v[4:7]
  ds_read_b128 v[180:183], v217 offset:9216
  v_mfma_f32_16x16x32_bf16 v[24:27], v[200:203], v[132:135], v[24:27]
  v_mfma_f32_16x16x32_bf16 v[44:47], v[200:203], v[136:139], v[44:47]
  ds_read_b128 v[184:187], v217 offset:10240
  v_mfma_f32_16x16x32_bf16 v[64:67], v[200:203], v[140:143], v[64:67]
  s_waitcnt lgkmcnt(5)
  v_mfma_f32_16x16x32_bf16 v[8:11], v[204:207], v[128:131], v[8:11]
  ds_read_b128 v[188:191], v217 offset:11264
  v_mfma_f32_16x16x32_bf16 v[28:31], v[204:207], v[132:135], v[28:31]
  v_mfma_f32_16x16x32_bf16 v[48:51], v[204:207], v[136:139], v[48:51]
  v_mfma_f32_16x16x32_bf16 v[68:71], v[204:207], v[140:143], v[68:71]
  ds_read_b128 v[192:195], v217 offset:12288
  s_waitcnt lgkmcnt(6)
  v_mfma_f32_16x16x32_bf16 v[12:15], v[208:211], v[128:131], v[12:15]
  v_mfma_f32_16x16x32_bf16 v[32:35], v[208:211], v[132:135], v[32:35]
  s_lshl_b32 s90, s12, 2
  s_add_u32 s90, s90, s84
  buffer_load_dwordx4 v[112:115], v244, s[32:35], s90 offen sc1
  v_mfma_f32_16x16x32_bf16 v[52:55], v[208:211], v[136:139], v[52:55]
  v_mfma_f32_16x16x32_bf16 v[72:75], v[208:211], v[140:143], v[72:75]
  buffer_load_dwordx4 v[116:119], v246, s[32:35], s90 offen sc1
  s_waitcnt lgkmcnt(5)
  v_mfma_f32_16x16x32_bf16 v[16:19], v[212:215], v[128:131], v[16:19]
  v_mfma_f32_16x16x32_bf16 v[36:39], v[212:215], v[132:135], v[36:39]
  buffer_load_dwordx4 v[120:123], v248, s[32:35], s90 offen sc1
  v_mfma_f32_16x16x32_bf16 v[56:59], v[212:215], v[136:139], v[56:59]
  v_mfma_f32_16x16x32_bf16 v[76:79], v[212:215], v[140:143], v[76:79]
  buffer_load_dwordx4 v[124:127], v249, s[32:35], s90 offen sc1
  s_waitcnt vmcnt(19) lgkmcnt(4)
  v_mfma_f32_16x16x32_bf16 v[0:3], v[176:179], v[144:147], v[0:3]
  s_waitcnt vmcnt(18)
  v_mfma_f32_16x16x32_bf16 v[20:23], v[176:179], v[148:151], v[20:23]
  s_waitcnt vmcnt(17)
  v_mfma_f32_16x16x32_bf16 v[40:43], v[176:179], v[152:155], v[40:43]
  s_waitcnt vmcnt(16)
  v_mfma_f32_16x16x32_bf16 v[60:63], v[176:179], v[156:159], v[60:63]
  s_waitcnt lgkmcnt(3)
  v_mfma_f32_16x16x32_bf16 v[4:7], v[180:183], v[144:147], v[4:7]
  s_lshl_b32 s90, s13, 2
  s_add_u32 s90, s90, s84
  buffer_load_dwordx4 v[128:131], v244, s[32:35], s90 offen sc1
  v_mfma_f32_16x16x32_bf16 v[24:27], v[180:183], v[148:151], v[24:27]
  v_mfma_f32_16x16x32_bf16 v[44:47], v[180:183], v[152:155], v[44:47]
  v_mfma_f32_16x16x32_bf16 v[64:67], v[180:183], v[156:159], v[64:67]
  s_waitcnt lgkmcnt(2)
  v_mfma_f32_16x16x32_bf16 v[8:11], v[184:187], v[144:147], v[8:11]
  v_mfma_f32_16x16x32_bf16 v[28:31], v[184:187], v[148:151], v[28:31]
  buffer_load_dwordx4 v[132:135], v246, s[32:35], s90 offen sc1
  v_mfma_f32_16x16x32_bf16 v[48:51], v[184:187], v[152:155], v[48:51]
  v_mfma_f32_16x16x32_bf16 v[68:71], v[184:187], v[156:159], v[68:71]
  s_waitcnt lgkmcnt(1)
  v_mfma_f32_16x16x32_bf16 v[12:15], v[188:191], v[144:147], v[12:15]
  v_mfma_f32_16x16x32_bf16 v[32:35], v[188:191], v[148:151], v[32:35]
  v_mfma_f32_16x16x32_bf16 v[52:55], v[188:191], v[152:155], v[52:55]
  buffer_load_dwordx4 v[136:139], v248, s[32:35], s90 offen sc1
  v_mfma_f32_16x16x32_bf16 v[72:75], v[188:191], v[156:159], v[72:75]
  s_waitcnt lgkmcnt(0)
  v_mfma_f32_16x16x32_bf16 v[16:19], v[192:195], v[144:147], v[16:19]
  v_mfma_f32_16x16x32_bf16 v[36:39], v[192:195], v[148:151], v[36:39]
  v_mfma_f32_16x16x32_bf16 v[56:59], v[192:195], v[152:155], v[56:59]
  v_mfma_f32_16x16x32_bf16 v[76:79], v[192:195], v[156:159], v[76:79]
  buffer_load_dwordx4 v[140:143], v249, s[32:35], s90 offen sc1
  s_waitcnt vmcnt(19)
  v_mfma_f32_16x16x32_bf16 v[0:3], a[0:3], v[160:163], v[0:3]
  s_waitcnt vmcnt(18)
  v_mfma_f32_16x16x32_bf16 v[20:23], a[0:3], v[164:167], v[20:23]
  s_waitcnt vmcnt(17)
  v_mfma_f32_16x16x32_bf16 v[40:43], a[0:3], v[168:171], v[40:43]
  s_waitcnt vmcnt(16)
  v_mfma_f32_16x16x32_bf16 v[60:63], a[0:3], v[172:175], v[60:63]
  s_lshl_b32 s90, s14, 2
  s_add_u32 s90, s90, s84
  buffer_load_dwordx4 v[144:147], v244, s[32:35], s90 offen sc1
  v_mfma_f32_16x16x32_bf16 v[4:7], a[4:7], v[160:163], v[4:7]
  v_mfma_f32_16x16x32_bf16 v[24:27], a[4:7], v[164:167], v[24:27]
  v_mfma_f32_16x16x32_bf16 v[44:47], a[4:7], v[168:171], v[44:47]
  buffer_load_dwordx4 v[148:151], v246, s[32:35], s90 offen sc1
  v_mfma_f32_16x16x32_bf16 v[64:67], a[4:7], v[172:175], v[64:67]
  v_mfma_f32_16x16x32_bf16 v[8:11], a[8:11], v[160:163], v[8:11]
  v_mfma_f32_16x16x32_bf16 v[28:31], a[8:11], v[164:167], v[28:31]
  buffer_load_dwordx4 v[152:155], v248, s[32:35], s90 offen sc1
  v_mfma_f32_16x16x32_bf16 v[48:51], a[8:11], v[168:171], v[48:51]
  v_mfma_f32_16x16x32_bf16 v[68:71], a[8:11], v[172:175], v[68:71]
  v_mfma_f32_16x16x32_bf16 v[12:15], a[12:15], v[160:163], v[12:15]
  v_mfma_f32_16x16x32_bf16 v[32:35], a[12:15], v[164:167], v[32:35]
  buffer_load_dwordx4 v[156:159], v249, s[32:35], s90 offen sc1
  v_mfma_f32_16x16x32_bf16 v[52:55], a[12:15], v[168:171], v[52:55]
  v_mfma_f32_16x16x32_bf16 v[72:75], a[12:15], v[172:175], v[72:75]
  v_mfma_f32_16x16x32_bf16 v[16:19], a[16:19], v[160:163], v[16:19]
  buffer_load_dword v219, v218, s[32:35], s45 offen sc1
  v_mfma_f32_16x16x32_bf16 v[36:39], a[16:19], v[164:167], v[36:39]
  v_mfma_f32_16x16x32_bf16 v[56:59], a[16:19], v[168:171], v[56:59]
  v_mfma_f32_16x16x32_bf16 v[76:79], a[16:19], v[172:175], v[76:79]
  s_barrier
  s_waitcnt vmcnt(20)
  v_mfma_f32_16x16x32_bf16 v[0:3], a[20:23], v[80:83], v[0:3]
  s_waitcnt vmcnt(19)
  v_mfma_f32_16x16x32_bf16 v[20:23], a[20:23], v[84:87], v[20:23]
  s_waitcnt vmcnt(18)
  v_mfma_f32_16x16x32_bf16 v[40:43], a[20:23], v[88:91], v[40:43]
  s_waitcnt vmcnt(17)
  v_mfma_f32_16x16x32_bf16 v[60:63], a[20:23], v[92:95], v[60:63]
  v_mfma_f32_16x16x32_bf16 v[4:7], a[24:27], v[80:83], v[4:7]
  s_lshl_b32 s90, s15, 2
  s_add_u32 s90, s90, s84
  buffer_load_dwordx4 v[160:163], v244, s[32:35], s90 offen sc1
  v_mfma_f32_16x16x32_bf16 v[24:27], a[24:27], v[84:87], v[24:27]
  v_mfma_f32_16x16x32_bf16 v[44:47], a[24:27], v[88:91], v[44:47]
  v_mfma_f32_16x16x32_bf16 v[64:67], a[24:27], v[92:95], v[64:67]
  v_mfma_f32_16x16x32_bf16 v[8:11], a[28:31], v[80:83], v[8:11]
  v_mfma_f32_16x16x32_bf16 v[28:31], a[28:31], v[84:87], v[28:31]
  buffer_load_dwordx4 v[164:167], v246, s[32:35], s90 offen sc1
  v_mfma_f32_16x16x32_bf16 v[48:51], a[28:31], v[88:91], v[48:51]
  v_mfma_f32_16x16x32_bf16 v[68:71], a[28:31], v[92:95], v[68:71]
  v_mfma_f32_16x16x32_bf16 v[12:15], a[32:35], v[80:83], v[12:15]
  v_mfma_f32_16x16x32_bf16 v[32:35], a[32:35], v[84:87], v[32:35]
  v_mfma_f32_16x16x32_bf16 v[52:55], a[32:35], v[88:91], v[52:55]
  buffer_load_dwordx4 v[168:171], v248, s[32:35], s90 offen sc1
  v_mfma_f32_16x16x32_bf16 v[72:75], a[32:35], v[92:95], v[72:75]
  v_mfma_f32_16x16x32_bf16 v[16:19], a[36:39], v[80:83], v[16:19]
  v_mfma_f32_16x16x32_bf16 v[36:39], a[36:39], v[84:87], v[36:39]
  v_mfma_f32_16x16x32_bf16 v[56:59], a[36:39], v[88:91], v[56:59]
  v_mfma_f32_16x16x32_bf16 v[76:79], a[36:39], v[92:95], v[76:79]
  buffer_load_dwordx4 v[172:175], v249, s[32:35], s90 offen sc1
  s_waitcnt vmcnt(20)
  v_mfma_f32_16x16x32_bf16 v[0:3], a[40:43], v[96:99], v[0:3]
  s_waitcnt vmcnt(19)
  v_mfma_f32_16x16x32_bf16 v[20:23], a[40:43], v[100:103], v[20:23]
  s_waitcnt vmcnt(18)
  v_mfma_f32_16x16x32_bf16 v[40:43], a[40:43], v[104:107], v[40:43]
  s_waitcnt vmcnt(17)
  v_mfma_f32_16x16x32_bf16 v[60:63], a[40:43], v[108:111], v[60:63]
  v_mfma_f32_16x16x32_bf16 v[4:7], a[44:47], v[96:99], v[4:7]
  s_lshl_b32 s90, s18, 2
  s_add_u32 s90, s90, s84
  buffer_load_dwordx4 v[80:83], v244, s[32:35], s90 offen sc1
  v_mfma_f32_16x16x32_bf16 v[24:27], a[44:47], v[100:103], v[24:27]
  v_mfma_f32_16x16x32_bf16 v[44:47], a[44:47], v[104:107], v[44:47]
  v_mfma_f32_16x16x32_bf16 v[64:67], a[44:47], v[108:111], v[64:67]
  v_mfma_f32_16x16x32_bf16 v[8:11], a[48:51], v[96:99], v[8:11]
  v_mfma_f32_16x16x32_bf16 v[28:31], a[48:51], v[100:103], v[28:31]
  buffer_load_dwordx4 v[84:87], v246, s[32:35], s90 offen sc1
  v_mfma_f32_16x16x32_bf16 v[48:51], a[48:51], v[104:107], v[48:51]
  v_mfma_f32_16x16x32_bf16 v[68:71], a[48:51], v[108:111], v[68:71]
  v_mfma_f32_16x16x32_bf16 v[12:15], a[52:55], v[96:99], v[12:15]
  v_mfma_f32_16x16x32_bf16 v[32:35], a[52:55], v[100:103], v[32:35]
  v_mfma_f32_16x16x32_bf16 v[52:55], a[52:55], v[104:107], v[52:55]
  buffer_load_dwordx4 v[88:91], v248, s[32:35], s90 offen sc1
  v_mfma_f32_16x16x32_bf16 v[72:75], a[52:55], v[108:111], v[72:75]
  v_mfma_f32_16x16x32_bf16 v[16:19], a[56:59], v[96:99], v[16:19]
  v_mfma_f32_16x16x32_bf16 v[36:39], a[56:59], v[100:103], v[36:39]
  v_mfma_f32_16x16x32_bf16 v[56:59], a[56:59], v[104:107], v[56:59]
  v_mfma_f32_16x16x32_bf16 v[76:79], a[56:59], v[108:111], v[76:79]
  buffer_load_dwordx4 v[92:95], v249, s[32:35], s90 offen sc1
  s_waitcnt vmcnt(20)
  v_mfma_f32_16x16x32_bf16 v[0:3], a[60:63], v[112:115], v[0:3]
  s_waitcnt vmcnt(19)
  v_mfma_f32_16x16x32_bf16 v[20:23], a[60:63], v[116:119], v[20:23]
  s_waitcnt vmcnt(18)
  v_mfma_f32_16x16x32_bf16 v[40:43], a[60:63], v[120:123], v[40:43]
  s_waitcnt vmcnt(17)
  v_mfma_f32_16x16x32_bf16 v[60:63], a[60:63], v[124:127], v[60:63]
  v_mfma_f32_16x16x32_bf16 v[4:7], a[64:67], v[112:115], v[4:7]
  s_lshl_b32 s90, s19, 2
  s_add_u32 s90, s90, s84
  buffer_load_dwordx4 v[96:99], v244, s[32:35], s90 offen sc1
  v_mfma_f32_16x16x32_bf16 v[24:27], a[64:67], v[116:119], v[24:27]
  v_mfma_f32_16x16x32_bf16 v[44:47], a[64:67], v[120:123], v[44:47]
  v_mfma_f32_16x16x32_bf16 v[64:67], a[64:67], v[124:127], v[64:67]
  v_mfma_f32_16x16x32_bf16 v[8:11], a[68:71], v[112:115], v[8:11]
  v_mfma_f32_16x16x32_bf16 v[28:31], a[68:71], v[116:119], v[28:31]
  buffer_load_dwordx4 v[100:103], v246, s[32:35], s90 offen sc1
  v_mfma_f32_16x16x32_bf16 v[48:51], a[68:71], v[120:123], v[48:51]
  v_mfma_f32_16x16x32_bf16 v[68:71], a[68:71], v[124:127], v[68:71]
  v_mfma_f32_16x16x32_bf16 v[12:15], a[72:75], v[112:115], v[12:15]
  v_mfma_f32_16x16x32_bf16 v[32:35], a[72:75], v[116:119], v[32:35]
  v_mfma_f32_16x16x32_bf16 v[52:55], a[72:75], v[120:123], v[52:55]
  buffer_load_dwordx4 v[104:107], v248, s[32:35], s90 offen sc1
  v_mfma_f32_16x16x32_bf16 v[72:75], a[72:75], v[124:127], v[72:75]
  v_mfma_f32_16x16x32_bf16 v[16:19], a[76:79], v[112:115], v[16:19]
  v_mfma_f32_16x16x32_bf16 v[36:39], a[76:79], v[116:119], v[36:39]
  v_mfma_f32_16x16x32_bf16 v[56:59], a[76:79], v[120:123], v[56:59]
  v_mfma_f32_16x16x32_bf16 v[76:79], a[76:79], v[124:127], v[76:79]
  buffer_load_dwordx4 v[108:111], v249, s[32:35], s90 offen sc1
  s_waitcnt vmcnt(12)
  v_cmp_eq_u32 vcc, s23, v219
  s_nop 3
  s_and_b32 s46, vcc_lo, 0xff00
  s_cmp_eq_u32 s46, 0xff00
  s_cbranch_scc1 L_ok_aF
  s_mov_b32 s47, 0
  v_lshlrev_b32 v251, 2, v255
L_spin_aF:
  buffer_load_dword v250, v251, s[32:35], s45 offen sc1
  s_waitcnt vmcnt(0)
  v_cmp_eq_u32 vcc, s23, v250
  s_nop 3
  s_and_b32 s46, vcc_lo, 0xff00
  s_cmp_eq_u32 s46, 0xff00
  s_cbranch_scc1 L_ok_aF
  s_sleep 8
  s_add_u32 s47, s47, 1
  s_cmp_lt_u32 s47, 200000
  s_cbranch_scc1 L_spin_aF
L_ok_aF:
  v_mfma_f32_16x16x32_bf16 v[0:3], a[80:83], v[128:131], v[0:3]
  v_mfma_f32_16x16x32_bf16 v[20:23], a[80:83], v[132:135], v[20:23]
  v_mfma_f32_16x16x32_bf16 v[40:43], a[80:83], v[136:139], v[40:43]
  v_mfma_f32_16x16x32_bf16 v[60:63], a[80:83], v[140:143], v[60:63]
  v_mfma_f32_16x16x32_bf16 v[4:7], a[84:87], v[128:131], v[4:7]
  s_lshl_b32 s90, s22, 12
  s_add_u32 s90, s90, s84
  s_add_u32 s90, s90, 0
  buffer_load_dwordx4 v[112:115], v244, s[32:35], s90 offen sc1
  v_mfma_f32_16x16x32_bf16 v[24:27], a[84:87], v[132:135], v[24:27]
  v_mfma_f32_16x16x32_bf16 v[44:47], a[84:87], v[136:139], v[44:47]
  v_mfma_f32_16x16x32_bf16 v[64:67], a[84:87], v[140:143], v[64:67]
  v_mfma_f32_16x16x32_bf16 v[8:11], a[88:91], v[128:131], v[8:11]
  v_mfma_f32_16x16x32_bf16 v[28:31], a[88:91], v[132:135], v[28:31]
  buffer_load_dwordx4 v[116:119], v246, s[32:35], s90 offen sc1
  v_mfma_f32_16x16x32_bf16 v[48:51], a[88:91], v[136:139], v[48:51]
  v_mfma_f32_16x16x32_bf16 v[68:71], a[88:91], v[140:143], v[68:71]
  v_mfma_f32_16x16x32_bf16 v[12:15], a[92:95], v[128:131], v[12:15]
  v_mfma_f32_16x16x32_bf16 v[32:35], a[92:95], v[132:135], v[32:35]
  v_mfma_f32_16x16x32_bf16 v[52:55], a[92:95], v[136:139], v[52:55]
  buffer_load_dwordx4 v[120:123], v248, s[32:35], s90 offen sc1
  v_mfma_f32_16x16x32_bf16 v[72:75], a[92:95], v[140:143], v[72:75]
  v_mfma_f32_16x16x32_bf16 v[16:19], a[96:99], v[128:131], v[16:19]
  v_mfma_f32_16x16x32_bf16 v[36:39], a[96:99], v[132:135], v[36:39]
  v_mfma_f32_16x16x32_bf16 v[56:59], a[96:99], v[136:139], v[56:59]
  v_mfma_f32_16x16x32_bf16 v[76:79], a[96:99], v[140:143], v[76:79]
  buffer_load_dwordx4 v[124:127], v249, s[32:35], s90 offen sc1
  v_mfma_f32_16x16x32_bf16 v[0:3], a[100:103], v[144:147], v[0:3]
  v_mfma_f32_16x16x32_bf16 v[20:23], a[100:103], v[148:151], v[20:23]
  v_mfma_f32_16x16x32_bf16 v[40:43], a[100:103], v[152:155], v[40:43]
  s_lshl_b32 s90, s22, 12
  s_add_u32 s90, s90, s84
  s_add_u32 s90, s90, 16384
  buffer_load_dwordx4 v[128:131], v244, s[32:35], s90 offen sc1
  v_mfma_f32_16x16x32_bf16 v[60:63], a[100:103], v[156:159], v[60:63]
  v_mfma_f32_16x16x32_bf16 v[4:7], a[104:107], v[144:147], v[4:7]
  buffer_load_dwordx4 v[132:135], v246, s[32:35], s90 offen sc1
  v_mfma_f32_16x16x32_bf16 v[24:27], a[104:107], v[148:151], v[24:27]
  v_mfma_f32_16x16x32_bf16 v[44:47], a[104:107], v[152:155], v[44:47]
  buffer_load_dwordx4 v[136:139], v248, s[32:35], s90 offen sc1
  v_mfma_f32_16x16x32_bf16 v[64:67], a[104:107], v[156:159], v[64:67]
  v_mfma_f32_16x16x32_bf16 v[8:11], a[108:111], v[144:147], v[8:11]
  buffer_load_dwordx4 v[140:143], v249, s[32:35], s90 offen sc1
  v_mfma_f32_16x16x32_bf16 v[28:31], a[108:111], v[148:151], v[28:31]
  v_mfma_f32_16x16x32_bf16 v[48:51], a[108:111], v[152:155], v[48:51]
  v_mfma_f32_16x16x32_bf16 v[68:71], a[108:111], v[156:159], v[68:71]
  s_mul_i32 s87, s22, 5120
  s_add_u32 s87, s87, s83
  s_add_u32 s87, s87, 61440
  buffer_load_dwordx4 a[0:3], v241, s[32:35], s87 offen offset:0 sc1
  v_mfma_f32_16x16x32_bf16 v[12:15], a[112:115], v[144:147], v[12:15]
  v_mfma_f32_16x16x32_bf16 v[32:35], a[112:115], v[148:151], v[32:35]
  buffer_load_dwordx4 a[4:7], v241, s[32:35], s87 offen offset:1024 sc1
  v_mfma_f32_16x16x32_bf16 v[52:55], a[112:115], v[152:155], v[52:55]
  v_mfma_f32_16x16x32_bf16 v[72:75], a[112:115], v[156:159], v[72:75]
  buffer_load_dwordx4 a[8:11], v241, s[32:35], s87 offen offset:2048 sc1
  v_mfma_f32_16x16x32_bf16 v[16:19], a[116:119], v[144:147], v[16:19]
  v_mfma_f32_16x16x32_bf16 v[36:39], a[116:119], v[148:151], v[36:39]
  buffer_load_dwordx4 a[12:15], v241, s[32:35], s87 offen offset:3072 sc1
  v_mfma_f32_16x16x32_bf16 v[56:59], a[116:119], v[152:155], v[56:59]
  v_mfma_f32_16x16x32_bf16 v[76:79], a[116:119], v[156:159], v[76:79]
  buffer_load_dwordx4 a[16:19], v245, s[32:35], s87 offen sc1
  s_waitcnt vmcnt(24)
  v_mfma_f32_16x16x32_bf16 v[0:3], a[120:123], v[160:163], v[0:3]
  s_waitcnt vmcnt(23)
  v_mfma_f32_16x16x32_bf16 v[20:23], a[120:123], v[164:167], v[20:23]
  s_waitcnt vmcnt(22)
  v_mfma_f32_16x16x32_bf16 v[40:43], a[120:123], v[168:171], v[40:43]
  s_lshl_b32 s90, s22, 12
  s_add_u32 s90, s90, s84
  s_add_u32 s90, s90, 32768
  buffer_load_dwordx4 v[144:147], v244, s[32:35], s90 offen sc1
  s_waitcnt vmcnt(22)
  v_mfma_f32_16x16x32_bf16 v[60:63], a[120:123], v[172:175], v[60:63]
  v_mfma_f32_16x16x32_bf16 v[4:7], a[124:127], v[160:163], v[4:7]
  buffer_load_dwordx4 v[148:151], v246, s[32:35], s90 offen sc1
  v_mfma_f32_16x16x32_bf16 v[24:27], a[124:127], v[164:167], v[24:27]
  v_mfma_f32_16x16x32_bf16 v[44:47], a[124:127], v[168:171], v[44:47]
  buffer_load_dwordx4 v[152:155], v248, s[32:35], s90 offen sc1
  v_mfma_f32_16x16x32_bf16 v[64:67], a[124:127], v[172:175], v[64:67]
  v_mfma_f32_16x16x32_bf16 v[8:11], a[128:131], v[160:163], v[8:11]
  buffer_load_dwordx4 v[156:159], v249, s[32:35], s90 offen sc1
  v_mfma_f32_16x16x32_bf16 v[28:31], a[128:131], v[164:167], v[28:31]
  v_mfma_f32_16x16x32_bf16 v[48:51], a[128:131], v[168:171], v[48:51]
  v_mfma_f32_16x16x32_bf16 v[68:71], a[128:131], v[172:175], v[68:71]
  s_mul_i32 s87, s22, 5120
  s_add_u32 s87, s87, s83
  s_add_u32 s87, s87, 81920
  buffer_load_dwordx4 a[20:23], v241, s[32:35], s87 offen offset:0 sc1
  v_mfma_f32_16x16x32_bf16 v[12:15], a[132:135], v[160:163], v[12:15]
  v_mfma_f32_16x16x32_bf16 v[32:35], a[132:135], v[164:167], v[32:35]
  buffer_load_dwordx4 a[24:27], v241, s[32:35], s87 offen offset:1024 sc1
  v_mfma_f32_16x16x32_bf16 v[52:55], a[132:135], v[168:171], v[52:55]
  v_mfma_f32_16x16x32_bf16 v[72:75], a[132:135], v[172:175], v[72:75]
  buffer_load_dwordx4 a[28:31], v241, s[32:35], s87 offen offset:2048 sc1
  v_mfma_f32_16x16x32_bf16 v[16:19], a[136:139], v[160:163], v[16:19]
  v_mfma_f32_16x16x32_bf16 v[36:39], a[136:139], v[164:167], v[36:39]
  buffer_load_dwordx4 a[32:35], v241, s[32:35], s87 offen offset:3072 sc1
  v_mfma_f32_16x16x32_bf16 v[56:59], a[136:139], v[168:171], v[56:59]
  v_mfma_f32_16x16x32_bf16 v[76:79], a[136:139], v[172:175], v[76:79]
  buffer_load_dwordx4 a[36:39], v245, s[32:35], s87 offen sc1
  s_waitcnt vmcnt(29)
  v_mfma_f32_16x16x32_bf16 v[0:3], a[140:143], v[80:83], v[0:3]
  s_waitcnt vmcnt(28)
  v_mfma_f32_16x16x32_bf16 v[20:23], a[140:143], v[84:87], v[20:23]
  s_waitcnt vmcnt(27)
  v_mfma_f32_16x16x32_bf16 v[40:43], a[140:143], v[88:91], v[40:43]
  s_waitcnt vmcnt(26)
  v_mfma_f32_16x16x32_bf16 v[60:63], a[140:143], v[92:95], v[60:63]
  v_mfma_f32_16x16x32_bf16 v[4:7], a[144:147], v[80:83], v[4:7]
  s_lshl_b32 s90, s22, 12
  s_add_u32 s90, s90, s84
  s_add_u32 s90, s90, 49152
  buffer_load_dwordx4 v[160:163], v244, s[32:35], s90 offen sc1
  v_mfma_f32_16x16x32_bf16 v[24:27], a[144:147], v[84:87], v[24:27]
  v_mfma_f32_16x16x32_bf16 v[44:47], a[144:147], v[88:91], v[44:47]
  v_mfma_f32_16x16x32_bf16 v[64:67], a[144:147], v[92:95], v[64:67]
  v_mfma_f32_16x16x32_bf16 v[8:11], a[148:151], v[80:83], v[8:11]
  v_mfma_f32_16x16x32_bf16 v[28:31], a[148:151], v[84:87], v[28:31]
  buffer_load_dwordx4 v[164:167], v246, s[32:35], s90 offen sc1
  v_mfma_f32_16x16x32_bf16 v[48:51], a[148:151], v[88:91], v[48:51]
  v_mfma_f32_16x16x32_bf16 v[68:71], a[148:151], v[92:95], v[68:71]
  v_mfma_f32_16x16x32_bf16 v[12:15], a[152:155], v[80:83], v[12:15]
  v_mfma_f32_16x16x32_bf16 v[32:35], a[152:155], v[84:87], v[32:35]
  v_mfma_f32_16x16x32_bf16 v[52:55], a[152:155], v[88:91], v[52:55]
  buffer_load_dwordx4 v[168:171], v248, s[32:35], s90 offen sc1
  v_mfma_f32_16x16x32_bf16 v[72:75], a[152:155], v[92:95], v[72:75]
  v_mfma_f32_16x16x32_bf16 v[16:19], a[156:159], v[80:83], v[16:19]
  v_mfma_f32_16x16x32_bf16 v[36:39], a[156:159], v[84:87], v[36:39]
  v_mfma_f32_16x16x32_bf16 v[56:59], a[156:159], v[88:91], v[56:59]
  v_mfma_f32_16x16x32_bf16 v[76:79], a[156:159], v[92:95], v[76:79]
  buffer_load_dwordx4 v[172:175], v249, s[32:35], s90 offen sc1
  s_waitcnt vmcnt(29)
  v_mfma_f32_16x16x32_bf16 v[0:3], a[160:163], v[96:99], v[0:3]
  s_waitcnt vmcnt(28)
  v_mfma_f32_16x16x32_bf16 v[20:23], a[160:163], v[100:103], v[20:23]
  s_waitcnt vmcnt(27)
  v_mfma_f32_16x16x32_bf16 v[40:43], a[160:163], v[104:107], v[40:43]
  s_waitcnt vmcnt(26)
  v_mfma_f32_16x16x32_bf16 v[60:63], a[160:163], v[108:111], v[60:63]
  v_mfma_f32_16x16x32_bf16 v[4:7], a[164:167], v[96:99], v[4:7]
  s_lshl_b32 s90, s22, 12
  s_add_u32 s90, s90, s84
  s_add_u32 s90, s90, 65536
  buffer_load_dwordx4 v[80:83], v244, s[32:35], s90 offen sc1
  v_mfma_f32_16x16x32_bf16 v[24:27], a[164:167], v[100:103], v[24:27]
  v_mfma_f32_16x16x32_bf16 v[44:47], a[164:167], v[104:107], v[44:47]
  v_mfma_f32_16x16x32_bf16 v[64:67], a[164:167], v[108:111], v[64:67]
  v_mfma_f32_16x16x32_bf16 v[8:11], a[168:171], v[96:99], v[8:11]
  v_mfma_f32_16x16x32_bf16 v[28:31], a[168:171], v[100:103], v[28:31]
  buffer_load_dwordx4 v[84:87], v246, s[32:35], s90 offen sc1
  v_mfma_f32_16x16x32_bf16 v[48:51], a[168:171], v[104:107], v[48:51]
  v_mfma_f32_16x16x32_bf16 v[68:71], a[168:171], v[108:111], v[68:71]
  v_mfma_f32_16x16x32_bf16 v[12:15], a[172:175], v[96:99], v[12:15]
  v_mfma_f32_16x16x32_bf16 v[32:35], a[172:175], v[100:103], v[32:35]
  v_mfma_f32_16x16x32_bf16 v[52:55], a[172:175], v[104:107], v[52:55]
  buffer_load_dwordx4 v[88:91], v248, s[32:35], s90 offen sc1
  v_mfma_f32_16x16x32_bf16 v[72:75], a[172:175], v[108:111], v[72:75]
  v_mfma_f32_16x16x32_bf16 v[16:19], a[176:179], v[96:99], v[16:19]
  v_mfma_f32_16x16x32_bf16 v[36:39], a[176:179], v[100:103], v[36:39]
  v_mfma_f32_16x16x32_bf16 v[56:59], a[176:179], v[104:107], v[56:59]
  v_mfma_f32_16x16x32_bf16 v[76:79], a[176:179], v[108:111], v[76:79]
  buffer_load_dwordx4 v[92:95], v249, s[32:35], s90 offen sc1
  s_waitcnt vmcnt(29)
  v_mfma_f32_16x16x32_bf16 v[0:3], a[180:183], v[112:115], v[0:3]
  s_waitcnt vmcnt(28)
  v_mfma_f32_16x16x32_bf16 v[20:23], a[180:183], v[116:119], v[20:23]
  v_and_b32 v220, 15, v255
  s_waitcnt vmcnt(27)
  v_mfma_f32_16x16x32_bf16 v[40:43], a[180:183], v[120:123], v[40:43]
  v_lshrrev_b32 v221, 4, v255
  s_waitcnt vmcnt(26)
  v_mfma_f32_16x16x32_bf16 v[60:63], a[180:183], v[124:127], v[60:63]
  s_lshl_b32 s46, s80, 6
  v_mfma_f32_16x16x32_bf16 v[4:7], a[184:187], v[112:115], v[4:7]
  s_lshl_b32 s47, s22, 4
  v_mfma_f32_16x16x32_bf16 v[24:27], a[184:187], v[116:119], v[24:27]
  s_add_u32 s46, s46, s47
  v_mfma_f32_16x16x32_bf16 v[44:47], a[184:187], v[120:123], v[44:47]
  v_mfma_f32_16x16x32_bf16 v[64:67], a[184:187], v[124:127], v[64:67]
  v_add_u32 v220, s46, v220
  v_mfma_f32_16x16x32_bf16 v[8:11], a[188:191], v[112:115], v[8:11]
  v_lshlrev_b32_e64 v222, 4, v220
  v_mfma_f32_16x16x32_bf16 v[28:31], a[188:191], v[116:119], v[28:31]
  v_mul_u32_u24 v220, 1280, v220
  v_mfma_f32_16x16x32_bf16 v[48:51], a[188:191], v[120:123], v[48:51]
  s_mul_i32 s47, s81, 160
  v_mfma_f32_16x16x32_bf16 v[68:71], a[188:191], v[124:127], v[68:71]
  v_add_u32_e64 v220, s47, v220
  v_mfma_f32_16x16x32_bf16 v[12:15], a[192:195], v[112:115], v[12:15]
  v_lshl_add_u32 v240, v221, 4, v220
  v_mfma_f32_16x16x32_bf16 v[32:35], a[192:195], v[116:119], v[32:35]
  v_mfma_f32_16x16x32_bf16 v[52:55], a[192:195], v[120:123], v[52:55]
  v_lshl_add_u32 v242, v221, 3, v220
  v_mfma_f32_16x16x32_bf16 v[72:75], a[192:195], v[124:127], v[72:75]
  s_mov_b32 s48, 14745604
  v_mfma_f32_16x16x32_bf16 v[16:19], a[196:199], v[112:115], v[16:19]
  buffer_load_dwordx4 v[224:227], v240, s[24:27], 0 offen
  v_mfma_f32_16x16x32_bf16 v[36:39], a[196:199], v[116:119], v[36:39]
  buffer_load_dwordx4 v[228:231], v240, s[24:27], 0 offen offset:64
  v_mfma_f32_16x16x32_bf16 v[56:59], a[196:199], v[120:123], v[56:59]
  buffer_load_dwordx2 v[232:233], v242, s[24:27], 0 offen offset:128
  v_mfma_f32_16x16x32_bf16 v[76:79], a[196:199], v[124:127], v[76:79]
  buffer_load_dword v234, v222, s[32:35], s48 offen sc1
  s_waitcnt vmcnt(29)
  v_mfma_f32_16x16x32_bf16 v[0:3], a[200:203], v[128:131], v[0:3]
  s_waitcnt vmcnt(28)
  v_mfma_f32_16x16x32_bf16 v[20:23], a[200:203], v[132:135], v[20:23]
  s_waitcnt vmcnt(27)
  v_mfma_f32_16x16x32_bf16 v[40:43], a[200:203], v[136:139], v[40:43]
  s_waitcnt vmcnt(26)
  v_mfma_f32_16x16x32_bf16 v[60:63], a[200:203], v[140:143], v[60:63]
  v_mfma_f32_16x16x32_bf16 v[4:7], a[204:207], v[128:131], v[4:7]
  v_mfma_f32_16x16x32_bf16 v[24:27], a[204:207], v[132:135], v[24:27]
  v_mfma_f32_16x16x32_bf16 v[44:47], a[204:207], v[136:139], v[44:47]
  v_mfma_f32_16x16x32_bf16 v[64:67], a[204:207], v[140:143], v[64:67]
  v_mfma_f32_16x16x32_bf16 v[8:11], a[208:211], v[128:131], v[8:11]
  v_mfma_f32_16x16x32_bf16 v[28:31], a[208:211], v[132:135], v[28:31]
  v_mfma_f32_16x16x32_bf16 v[48:51], a[208:211], v[136:139], v[48:51]
  v_mfma_f32_16x16x32_bf16 v[68:71], a[208:211], v[140:143], v[68:71]
  v_mfma_f32_16x16x32_bf16 v[12:15], a[212:215], v[128:131], v[12:15]
  v_mfma_f32_16x16x32_bf16 v[32:35], a[212:215], v[132:135], v[32:35]
  v_mfma_f32_16x16x32_bf16 v[52:55], a[212:215], v[136:139], v[52:55]
  v_mfma_f32_16x16x32_bf16 v[72:75], a[212:215], v[140:143], v[72:75]
  v_mfma_f32_16x16x32_bf16 v[16:19], a[216:219], v[128:131], v[16:19]
  v_mfma_f32_16x16x32_bf16 v[36:39], a[216:219], v[132:135], v[36:39]
  v_mfma_f32_16x16x32_bf16 v[56:59], a[216:219], v[136:139], v[56:59]
  v_mfma_f32_16x16x32_bf16 v[76:79], a[216:219], v[140:143], v[76:79]
  s_waitcnt vmcnt(20)
  v_mfma_f32_16x16x32_bf16 v[0:3], a[220:223], v[144:147], v[0:3]
  s_waitcnt vmcnt(19)
  v_mfma_f32_16x16x32_bf16 v[20:23], a[220:223], v[148:151], v[20:23]
  s_waitcnt vmcnt(18)
  v_mfma_f32_16x16x32_bf16 v[40:43], a[220:223], v[152:155], v[40:43]
  s_waitcnt vmcnt(17)
  v_mfma_f32_16x16x32_bf16 v[60:63], a[220:223], v[156:159], v[60:63]
  v_mfma_f32_16x16x32_bf16 v[4:7], a[224:227], v[144:147], v[4:7]
  v_mfma_f32_16x16x32_bf16 v[24:27], a[224:227], v[148:151], v[24:27]
  v_mfma_f32_16x16x32_bf16 v[44:47], a[224:227], v[152:155], v[44:47]
  v_mfma_f32_16x16x32_bf16 v[64:67], a[224:227], v[156:159], v[64:67]
  v_mfma_f32_16x16x32_bf16 v[8:11], a[228:231], v[144:147], v[8:11]
  v_mfma_f32_16x16x32_bf16 v[28:31], a[228:231], v[148:151], v[28:31]
  v_mfma_f32_16x16x32_bf16 v[48:51], a[228:231], v[152:155], v[48:51]
  v_mfma_f32_16x16x32_bf16 v[68:71], a[228:231], v[156:159], v[68:71]
  v_mfma_f32_16x16x32_bf16 v[12:15], a[232:235], v[144:147], v[12:15]
  v_mfma_f32_16x16x32_bf16 v[32:35], a[232:235], v[148:151], v[32:35]
  v_mfma_f32_16x16x32_bf16 v[52:55], a[232:235], v[152:155], v[52:55]
  v_mfma_f32_16x16x32_bf16 v[72:75], a[232:235], v[156:159], v[72:75]
  v_mfma_f32_16x16x32_bf16 v[16:19], a[236:239], v[144:147], v[16:19]
  v_mfma_f32_16x16x32_bf16 v[36:39], a[236:239], v[148:151], v[36:39]
  v_mfma_f32_16x16x32_bf16 v[56:59], a[236:239], v[152:155], v[56:59]
  v_mfma_f32_16x16x32_bf16 v[76:79], a[236:239], v[156:159], v[76:79]
  s_waitcnt vmcnt(11)
  v_mfma_f32_16x16x32_bf16 v[0:3], a[0:3], v[160:163], v[0:3]
  s_waitcnt vmcnt(10)
  v_mfma_f32_16x16x32_bf16 v[20:23], a[0:3], v[164:167], v[20:23]
  s_waitcnt vmcnt(9)
  v_mfma_f32_16x16x32_bf16 v[40:43], a[0:3], v[168:171], v[40:43]
  s_waitcnt vmcnt(8)
  v_mfma_f32_16x16x32_bf16 v[60:63], a[0:3], v[172:175], v[60:63]
  v_mfma_f32_16x16x32_bf16 v[4:7], a[4:7], v[160:163], v[4:7]
  v_mfma_f32_16x16x32_bf16 v[24:27], a[4:7], v[164:167], v[24:27]
  v_mfma_f32_16x16x32_bf16 v[44:47], a[4:7], v[168:171], v[44:47]
  v_mfma_f32_16x16x32_bf16 v[64:67], a[4:7], v[172:175], v[64:67]
  v_mfma_f32_16x16x32_bf16 v[8:11], a[8:11], v[160:163], v[8:11]
  v_mfma_f32_16x16x32_bf16 v[28:31], a[8:11], v[164:167], v[28:31]
  v_mfma_f32_16x16x32_bf16 v[48:51], a[8:11], v[168:171], v[48:51]
  v_mfma_f32_16x16x32_bf16 v[68:71], a[8:11], v[172:175], v[68:71]
  v_mfma_f32_16x16x32_bf16 v[12:15], a[12:15], v[160:163], v[12:15]
  v_mfma_f32_16x16x32_bf16 v[32:35], a[12:15], v[164:167], v[32:35]
  v_mfma_f32_16x16x32_bf16 v[52:55], a[12:15], v[168:171], v[52:55]
  v_mfma_f32_16x16x32_bf16 v[72:75], a[12:15], v[172:175], v[72:75]
  v_mfma_f32_16x16x32_bf16 v[16:19], a[16:19], v[160:163], v[16:19]
  v_mfma_f32_16x16x32_bf16 v[36:39], a[16:19], v[164:167], v[36:39]
  v_mfma_f32_16x16x32_bf16 v[56:59], a[16:19], v[168:171], v[56:59]
  v_mfma_f32_16x16x32_bf16 v[76:79], a[16:19], v[172:175], v[76:79]
  s_waitcnt vmcnt(6)
  v_mfma_f32_16x16x32_bf16 v[20:23], a[20:23], v[84:87], v[20:23]
  v_mfma_f32_16x16x32_bf16 v[24:27], a[24:27], v[84:87], v[24:27]
  v_mfma_f32_16x16x32_bf16 v[28:31], a[28:31], v[84:87], v[28:31]
  v_mfma_f32_16x16x32_bf16 v[32:35], a[32:35], v[84:87], v[32:35]
  v_mfma_f32_16x16x32_bf16 v[36:39], a[36:39], v[84:87], v[36:39]
  s_waitcnt vmcnt(5)
  v_mfma_f32_16x16x32_bf16 v[40:43], a[20:23], v[88:91], v[40:43]
  s_nop 1
  ds_write_b128 v237, v[20:23] offset:0
  v_mfma_f32_16x16x32_bf16 v[44:47], a[24:27], v[88:91], v[44:47]
  ds_write_b128 v237, v[24:27] offset:1024
  v_mfma_f32_16x16x32_bf16 v[48:51], a[28:31], v[88:91], v[48:51]
  ds_write_b128 v237, v[28:31] offset:2048
  v_mfma_f32_16x16x32_bf16 v[52:55], a[32:35], v[88:91], v[52:55]
  ds_write_b128 v237, v[32:35] offset:3072
  v_mfma_f32_16x16x32_bf16 v[56:59], a[36:39], v[88:91], v[56:59]
  ds_write_b128 v237, v[36:39] offset:4096
  s_waitcnt vmcnt(4)
  v_mfma_f32_16x16x32_bf16 v[60:63], a[20:23], v[92:95], v[60:63]
  ds_write_b128 v238, v[40:43] offset:0
  v_mfma_f32_16x16x32_bf16 v[64:67], a[24:27], v[92:95], v[64:67]
  ds_write_b128 v238, v[44:47] offset:1024
  v_mfma_f32_16x16x32_bf16 v[68:71], a[28:31], v[92:95], v[68:71]
  ds_write_b128 v238, v[48:51] offset:2048
  v_mfma_f32_16x16x32_bf16 v[72:75], a[32:35], v[92:95], v[72:75]
  ds_write_b128 v238, v[52:55] offset:3072
  v_mfma_f32_16x16x32_bf16 v[76:79], a[36:39], v[92:95], v[76:79]
  ds_write_b128 v238, v[56:59] offset:4096
  v_mfma_f32_16x16x32_bf16 v[0:3], a[20:23], v[80:83], v[0:3]
  ds_write_b128 v239, v[60:63] offset:0
  v_mfma_f32_16x16x32_bf16 v[4:7], a[24:27], v[80:83], v[4:7]
  ds_write_b128 v239, v[64:67] offset:1024
  v_mfma_f32_16x16x32_bf16 v[8:11], a[28:31], v[80:83], v[8:11]
  ds_write_b128 v239, v[68:71] offset:2048
  v_mfma_f32_16x16x32_bf16 v[12:15], a[32:35], v[80:83], v[12:15]
  ds_write_b128 v239, v[72:75] offset:3072
  v_mfma_f32_16x16x32_bf16 v[16:19], a[36:39], v[80:83], v[16:19]
  ds_write_b128 v239, v[76:79] offset:4096
  s_branch L_ph2_tail
L_ph2_main_A:
  v_add_u32 v216, s85, v241
  v_add_u32_e64 v217, s86, v241
  ds_read_b128 v[176:179], v216 offset:0
  ds_read_b128 v[180:183], v216 offset:1024
  ds_read_b128 v[184:187], v216 offset:2048
  ds_read_b128 v[188:191], v216 offset:3072
  ds_read_b128 v[192:195], v216 offset:4096
  v_lshlrev_b32_e64 v218, 2, v255
  s_add_u32 s46, s22, 1
  s_and_b32 s46, s46, 3
  s_mul_i32 s46, s46, 15360
  s_add_u32 s46, s46, 0
  v_add_u32 v237, s46, v241
  s_add_u32 s46, s22, 2
  s_and_b32 s46, s46, 3
  s_mul_i32 s46, s46, 15360
  s_add_u32 s46, s46, 5120
  v_add_u32_e64 v238, s46, v241
  s_add_u32 s46, s22, 3
  s_and_b32 s46, s46, 3
  s_mul_i32 s46, s46, 15360
  s_add_u32 s46, s46, 10240
  v_add_u32 v239, s46, v241
  s_waitcnt vmcnt(23) lgkmcnt(4)
  v_mfma_f32_16x16x32_bf16 v[0:3], v[176:179], v[80:83], 0
  s_waitcnt vmcnt(22)
  v_mfma_f32_16x16x32_bf16 v[20:23], v[176:179], v[84:87], 0
  s_waitcnt vmcnt(21)
  v_mfma_f32_16x16x32_bf16 v[40:43], v[176:179], v[88:91], 0
  s_waitcnt vmcnt(20)
  v_mfma_f32_16x16x32_bf16 v[60:63], v[176:179], v[92:95], 0
  ds_read_b128 v[196:199], v216 offset:5120
  s_waitcnt lgkmcnt(4)
  v_mfma_f32_16x16x32_bf16 v[4:7], v[180:183], v[80:83], 0
  v_mfma_f32_16x16x32_bf16 v[24:27], v[180:183], v[84:87], 0
  v_mfma_f32_16x16x32_bf16 v[44:47], v[180:183], v[88:91], 0
  v_mfma_f32_16x16x32_bf16 v[64:67], v[180:183], v[92:95], 0
  ds_read_b128 v[200:203], v216 offset:6144
  s_waitcnt lgkmcnt(4)
  v_mfma_f32_16x16x32_bf16 v[8:11], v[184:187], v[80:83], 0
  v_mfma_f32_16x16x32_bf16 v[28:31], v[184:187], v[84:87], 0
  v_mfma_f32_16x16x32_bf16 v[48:51], v[184:187], v[88:91], 0
  v_mfma_f32_16x16x32_bf16 v[68:71], v[184:187], v[92:95], 0
  ds_read_b128 v[204:207], v216 offset:7168
  s_waitcnt lgkmcnt(4)
  v_mfma_f32_16x16x32_bf16 v[12:15], v[188:191], v[80:83], 0
  v_mfma_f32_16x16x32_bf16 v[32:35], v[188:191], v[84:87], 0
  v_mfma_f32_16x16x32_bf16 v[52:55], v[188:191], v[88:91], 0
  v_mfma_f32_16x16x32_bf16 v[72:75], v[188:191], v[92:95], 0
  ds_read_b128 v[208:211], v216 offset:8192
  s_waitcnt lgkmcnt(4)
  v_mfma_f32_16x16x32_bf16 v[16:19], v[192:195], v[80:83], 0
  v_mfma_f32_16x16x32_bf16 v[36:39], v[192:195], v[84:87], 0
  v_mfma_f32_16x16x32_bf16 v[56:59], v[192:195], v[88:91], 0
  v_mfma_f32_16x16x32_bf16 v[76:79], v[192:195], v[92:95], 0
  ds_read_b128 v[212:215], v216 offset:9216
  s_barrier
  s_cmp_lg_u32 s22, 0
  s_cbranch_scc1 L_nosig_attn
  s_and_b32 s46, s36, 1
  s_lshl_b32 s46, s46, 4
  v_add_u32 v220, s46, v255
  v_lshlrev_b32 v220, 3, v220
  s_lshr_b32 s46, s36, 1
  v_add_u32 v220, s46, v220
  v_lshlrev_b32 v220, 7, v220
  s_lshl_b32 s46, s82, 2
  s_add_u32 s46, s46, 15728640
  v_mov_b32_e64 v221, s23
  s_mov_b32 exec_lo, 0xffff
  s_mov_b32 exec_hi, 0
  buffer_store_dword v221, v220, s[32:35], s46 offen sc1
  s_mov_b64 exec, -1
L_nosig_attn:
  s_waitcnt vmcnt(19) lgkmcnt(4)
  v_mfma_f32_16x16x32_bf16 v[0:3], v[196:199], v[96:99], v[0:3]
  s_waitcnt vmcnt(18)
  v_mfma_f32_16x16x32_bf16 v[20:23], v[196:199], v[100:103], v[20:23]
  s_waitcnt vmcnt(17)
  v_mfma_f32_16x16x32_bf16 v[40:43], v[196:199], v[104:107], v[40:43]
  ds_read_b128 v[176:179], v216 offset:10240
  s_waitcnt vmcnt(16)
  v_mfma_f32_16x16x32_bf16 v[60:63], v[196:199], v[108:111], v[60:63]
  s_waitcnt lgkmcnt(4)
  v_mfma_f32_16x16x32_bf16 v[4:7], v[200:203], v[96:99], v[4:7]
  ds_read_b128 v[180:183], v216 offset:11264
  v_mfma_f32_16x16x32_bf16 v[24:27], v[200:203], v[100:103], v[24:27]
  v_mfma_f32_16x16x32_bf16 v[44:47], v[200:203], v[104:107], v[44:47]
  ds_read_b128 v[184:187], v217 offset:0
  v_mfma_f32_16x16x32_bf16 v[64:67], v[200:203], v[108:111], v[64:67]
  s_waitcnt lgkmcnt(5)
  v_mfma_f32_16x16x32_bf16 v[8:11], v[204:207], v[96:99], v[8:11]
  ds_read_b128 v[188:191], v217 offset:1024
  v_mfma_f32_16x16x32_bf16 v[28:31], v[204:207], v[100:103], v[28:31]
  v_mfma_f32_16x16x32_bf16 v[48:51], v[204:207], v[104:107], v[48:51]
  v_mfma_f32_16x16x32_bf16 v[68:71], v[204:207], v[108:111], v[68:71]
  ds_read_b128 v[192:195], v217 offset:2048
  s_waitcnt lgkmcnt(6)
  v_mfma_f32_16x16x32_bf16 v[12:15], v[208:211], v[96:99], v[12:15]
  v_mfma_f32_16x16x32_bf16 v[32:35], v[208:211], v[100:103], v[32:35]
  s_lshl_b32 s90, s10, 2
  s_add_u32 s90, s90, s84
  buffer_load_dwordx4 v[80:83], v244, s[32:35], s90 offen sc1
  v_mfma_f32_16x16x32_bf16 v[52:55], v[208:211], v[104:107], v[52:55]
  v_mfma_f32_16x16x32_bf16 v[72:75], v[208:211], v[108:111], v[72:75]
  buffer_load_dwordx4 v[84:87], v246, s[32:35], s90 offen sc1
  s_waitcnt lgkmcnt(5)
  v_mfma_f32_16x16x32_bf16 v[16:19], v[212:215], v[96:99], v[16:19]
  v_mfma_f32_16x16x32_bf16 v[36:39], v[212:215], v[100:103], v[36:39]
  buffer_load_dwordx4 v[88:91], v248, s[32:35], s90 offen sc1
  v_mfma_f32_16x16x32_bf16 v[56:59], v[212:215], v[104:107], v[56:59]
  v_mfma_f32_16x16x32_bf16 v[76:79], v[212:215], v[108:111], v[76:79]
  buffer_load_dwordx4 v[92:95], v249, s[32:35], s90 offen sc1
  s_waitcnt vmcnt(19) lgkmcnt(4)
  v_mfma_f32_16x16x32_bf16 v[0:3], v[176:179], v[112:115], v[0:3]
  s_waitcnt vmcnt(18)
  v_mfma_f32_16x16x32_bf16 v[20:23], v[176:179], v[116:119], v[20:23]
  s_waitcnt vmcnt(17)
  v_mfma_f32_16x16x32_bf16 v[40:43], v[176:179], v[120:123], v[40:43]
  ds_read_b128 v[196:199], v217 offset:3072
  s_waitcnt vmcnt(16)
  v_mfma_f32_16x16x32_bf16 v[60:63], v[176:179], v[124:127], v[60:63]
  s_waitcnt lgkmcnt(4)
  v_mfma_f32_16x16x32_bf16 v[4:7], v[180:183], v[112:115], v[4:7]
  ds_read_b128 v[200:203], v217 offset:4096
  v_mfma_f32_16x16x32_bf16 v[24:27], v[180:183], v[116:119], v[24:27]
  v_mfma_f32_16x16x32_bf16 v[44:47], v[180:183], v[120:123], v[44:47]
  ds_read_b128 v[204:207], v217 offset:5120
  v_mfma_f32_16x16x32_bf16 v[64:67], v[180:183], v[124:127], v[64:67]
  s_waitcnt lgkmcnt(5)
  v_mfma_f32_16x16x32_bf16 v[8:11], v[184:187], v[112:115], v[8:11]
  ds_read_b128 v[208:211], v217 offset:6144
  v_mfma_f32_16x16x32_bf16 v[28:31], v[184:187], v[116:119], v[28:31]
  v_mfma_f32_16x16x32_bf16 v[48:51], v[184:187], v[120:123], v[48:51]
  v_mfma_f32_16x16x32_bf16 v[68:71], v[184:187], v[124:127], v[68:71]
  ds_read_b128 v[212:215], v217 offset:7168
  s_waitcnt lgkmcnt(6)
  v_mfma_f32_16x16x32_bf16 v[12:15], v[188:191], v[112:115], v[12:15]
  v_mfma_f32_16x16x32_bf16 v[32:35], v[188:191], v[116:119], v[32:35]
  s_lshl_b32 s90, s11, 2
  s_add_u32 s90, s90, s84
  buffer_load_dwordx4 v[96:99], v244, s[32:35], s90 offen sc1
  v_mfma_f32_16x16x32_bf16 v[52:55], v[188:191], v[120:123], v[52:55]
  v_mfma_f32_16x16x32_bf16 v[72:75], v[188:191], v[124:127], v[72:75]
  buffer_load_dwordx4 v[100:103], v246, s[32:35], s90 offen sc1
  s_waitcnt lgkmcnt(5)
  v_mfma_f32_16x16x32_bf16 v[16:19], v[192:195], v[112:115], v[16:19]
  v_mfma_f32_16x16x32_bf16 v[36:39], v[192:195], v[116:119], v[36:39]
  buffer_load_dwordx4 v[104:107], v248, s[32:35], s90 offen sc1
  v_mfma_f32_16x16x32_bf16 v[56:59], v[192:195], v[120:123], v[56:59]
  v_mfma_f32_16x16x32_bf16 v[76:79], v[192:195], v[124:127], v[76:79]
  buffer_load_dwordx4 v[108:111], v249, s[32:35], s90 offen sc1
  s_waitcnt vmcnt(19) lgkmcnt(4)
  v_mfma_f32_16x16x32_bf16 v[0:3], v[196:199], v[128:131], v[0:3]
  s_waitcnt vmcnt(18)
  v_mfma_f32_16x16x32_bf16 v[20:23], v[196:199], v[132:135], v[20:23]
  s_waitcnt vmcnt(17)
  v_mfma_f32_16x16x32_bf16 v[40:43], v[196:199], v[136:139], v[40:43]
  ds_read_b128 v[176:179], v217 offset:8192
  s_waitcnt vmcnt(16)
  v_mfma_f32_16x16x32_bf16 v[60:63], v[196:199], v[140:143], v[60:63]
  s_waitcnt lgkmcnt(4)
  v_mfma_f32_16x16x32_bf16 v[4:7], v[200:203], v[128:131], v[4:7]
  ds_read_b128 v[180:183], v217 offset:9216
  v_mfma_f32_16x16x32_bf16 v[24:27], v[200:203], v[132:135], v[24:27]
  v_mfma_f32_16x16x32_bf16 v[44:47], v[200:203], v[136:139], v[44:47]
  ds_read_b128 v[184:187], v217 offset:10240
  v_mfma_f32_16x16x32_bf16 v[64:67], v[200:203], v[140:143], v[64:67]
  s_waitcnt lgkmcnt(5)
  v_mfma_f32_16x16x32_bf16 v[8:11], v[204:207], v[128:131], v[8:11]
  ds_read_b128 v[188:191], v217 offset:11264
  v_mfma_f32_16x16x32_bf16 v[28:31], v[204:207], v[132:135], v[28:31]
  v_mfma_f32_16x16x32_bf16 v[48:51], v[204:207], v[136:139], v[48:51]
  v_mfma_f32_16x16x32_bf16 v[68:71], v[204:207], v[140:143], v[68:71]
  ds_read_b128 v[192:195], v217 offset:12288
  s_waitcnt lgkmcnt(6)
  v_mfma_f32_16x16x32_bf16 v[12:15], v[208:211], v[128:131], v[12:15]
  v_mfma_f32_16x16x32_bf16 v[32:35], v[208:211], v[132:135], v[32:35]
  s_lshl_b32 s90, s12, 2
  s_add_u32 s90, s90, s84
  buffer_load_dwordx4 v[112:115], v244, s[32:35], s90 offen sc1
  v_mfma_f32_16x16x32_bf16 v[52:55], v[208:211], v[136:139], v[52:55]
  v_mfma_f32_16x16x32_bf16 v[72:75], v[208:211], v[140:143], v[72:75]
  buffer_load_dwordx4 v[116:119], v246, s[32:35], s90 offen sc1
  s_waitcnt lgkmcnt(5)
  v_mfma_f32_16x16x32_bf16 v[16:19], v[212:215], v[128:131], v[16:19]
  v_mfma_f32_16x16x32_bf16 v[36:39], v[212:215], v[132:135], v[36:39]
  buffer_load_dwordx4 v[120:123], v248, s[32:35], s90 offen sc1
  v_mfma_f32_16x16x32_bf16 v[56:59], v[212:215], v[136:139], v[56:59]
  v_mfma_f32_16x16x32_bf16 v[76:79], v[212:215], v[140:143], v[76:79]
  buffer_load_dwordx4 v[124:127], v249, s[32:35], s90 offen sc1
  s_waitcnt vmcnt(19) lgkmcnt(4)
  v_mfma_f32_16x16x32_bf16 v[0:3], v[176:179], v[144:147], v[0:3]
  s_waitcnt vmcnt(18)
  v_mfma_f32_16x16x32_bf16 v[20:23], v[176:179], v[148:151], v[20:23]
  s_waitcnt vmcnt(17)
  v_mfma_f32_16x16x32_bf16 v[40:43], v[176:179], v[152:155], v[40:43]
  s_waitcnt vmcnt(16)
  v_mfma_f32_16x16x32_bf16 v[60:63], v[176:179], v[156:159], v[60:63]
  s_waitcnt lgkmcnt(3)
  v_mfma_f32_16x16x32_bf16 v[4:7], v[180:183], v[144:147], v[4:7]
  s_lshl_b32 s90, s13, 2
  s_add_u32 s90, s90, s84
  buffer_load_dwordx4 v[128:131], v244, s[32:35], s90 offen sc1
  v_mfma_f32_16x16x32_bf16 v[24:27], v[180:183], v[148:151], v[24:27]
  v_mfma_f32_16x16x32_bf16 v[44:47], v[180:183], v[152:155], v[44:47]
  v_mfma_f32_16x16x32_bf16 v[64:67], v[180:183], v[156:159], v[64:67]
  s_waitcnt lgkmcnt(2)
  v_mfma_f32_16x16x32_bf16 v[8:11], v[184:187], v[144:147], v[8:11]
  v_mfma_f32_16x16x32_bf16 v[28:31], v[184:187], v[148:151], v[28:31]
  buffer_load_dwordx4 v[132:135], v246, s[32:35], s90 offen sc1
  v_mfma_f32_16x16x32_bf16 v[48:51], v[184:187], v[152:155], v[48:51]
  v_mfma_f32_16x16x32_bf16 v[68:71], v[184:187], v[156:159], v[68:71]
  s_waitcnt lgkmcnt(1)
  v_mfma_f32_16x16x32_bf16 v[12:15], v[188:191], v[144:147], v[12:15]
  v_mfma_f32_16x16x32_bf16 v[32:35], v[188:191], v[148:151], v[32:35]
  v_mfma_f32_16x16x32_bf16 v[52:55], v[188:191], v[152:155], v[52:55]
  buffer_load_dwordx4 v[136:139], v248, s[32:35], s90 offen sc1
  v_mfma_f32_16x16x32_bf16 v[72:75], v[188:191], v[156:159], v[72:75]
  s_waitcnt lgkmcnt(0)
  v_mfma_f32_16x16x32_bf16 v[16:19], v[192:195], v[144:147], v[16:19]
  v_mfma_f32_16x16x32_bf16 v[36:39], v[192:195], v[148:151], v[36:39]
  v_mfma_f32_16x16x32_bf16 v[56:59], v[192:195], v[152:155], v[56:59]
  v_mfma_f32_16x16x32_bf16 v[76:79], v[192:195], v[156:159], v[76:79]
  buffer_load_dwordx4 v[140:143], v249, s[32:35], s90 offen sc1
  s_waitcnt vmcnt(19)
  v_mfma_f32_16x16x32_bf16 v[0:3], a[0:3], v[160:163], v[0:3]
  s_waitcnt vmcnt(18)
  v_mfma_f32_16x16x32_bf16 v[20:23], a[0:3], v[164:167], v[20:23]
  s_waitcnt vmcnt(17)
  v_mfma_f32_16x16x32_bf16 v[40:43], a[0:3], v[168:171], v[40:43]
  s_waitcnt vmcnt(16)
  v_mfma_f32_16x16x32_bf16 v[60:63], a[0:3], v[172:175], v[60:63]
  s_lshl_b32 s90, s14, 2
  s_add_u32 s90, s90, s84
  buffer_load_dwordx4 v[144:147], v244, s[32:35], s90 offen sc1
  v_mfma_f32_16x16x32_bf16 v[4:7], a[4:7], v[160:163], v[4:7]
  v_mfma_f32_16x16x32_bf16 v[24:27], a[4:7], v[164:167], v[24:27]
  v_mfma_f32_16x16x32_bf16 v[44:47], a[4:7], v[168:171], v[44:47]
  buffer_load_dwordx4 v[148:151], v246, s[32:35], s90 offen sc1
  v_mfma_f32_16x16x32_bf16 v[64:67], a[4:7], v[172:175], v[64:67]
  v_mfma_f32_16x16x32_bf16 v[8:11], a[8:11], v[160:163], v[8:11]
  v_mfma_f32_16x16x32_bf16 v[28:31], a[8:11], v[164:167], v[28:31]
  buffer_load_dwordx4 v[152:155], v248, s[32:35], s90 offen sc1
  v_mfma_f32_16x16x32_bf16 v[48:51], a[8:11], v[168:171], v[48:51]
  v_mfma_f32_16x16x32_bf16 v[68:71], a[8:11], v[172:175], v[68:71]
  v_mfma_f32_16x16x32_bf16 v[12:15], a[12:15], v[160:163], v[12:15]
  v_mfma_f32_16x16x32_bf16 v[32:35], a[12:15], v[164:167], v[32:35]
  buffer_load_dwordx4 v[156:159], v249, s[32:35], s90 offen sc1
  v_mfma_f32_16x16x32_bf16 v[52:55], a[12:15], v[168:171], v[52:55]
  v_mfma_f32_16x16x32_bf16 v[72:75], a[12:15], v[172:175], v[72:75]
  v_mfma_f32_16x16x32_bf16 v[16:19], a[16:19], v[160:163], v[16:19]
  buffer_load_dword v219, v218, s[32:35], s45 offen sc1
  v_mfma_f32_16x16x32_bf16 v[36:39], a[16:19], v[164:167], v[36:39]
  v_mfma_f32_16x16x32_bf16 v[56:59], a[16:19], v[168:171], v[56:59]
  v_mfma_f32_16x16x32_bf16 v[76:79], a[16:19], v[172:175], v[76:79]
  s_barrier
  s_waitcnt vmcnt(20)
  v_mfma_f32_16x16x32_bf16 v[0:3], a[20:23], v[80:83], v[0:3]
  s_waitcnt vmcnt(19)
  v_mfma_f32_16x16x32_bf16 v[20:23], a[20:23], v[84:87], v[20:23]
  s_waitcnt vmcnt(18)
  v_mfma_f32_16x16x32_bf16 v[40:43], a[20:23], v[88:91], v[40:43]
  s_waitcnt vmcnt(17)
  v_mfma_f32_16x16x32_bf16 v[60:63], a[20:23], v[92:95], v[60:63]
  v_mfma_f32_16x16x32_bf16 v[4:7], a[24:27], v[80:83], v[4:7]
  s_lshl_b32 s90, s15, 2
  s_add_u32 s90, s90, s84
  buffer_load_dwordx4 v[160:163], v244, s[32:35], s90 offen sc1
  v_mfma_f32_16x16x32_bf16 v[24:27], a[24:27], v[84:87], v[24:27]
  v_mfma_f32_16x16x32_bf16 v[44:47], a[24:27], v[88:91], v[44:47]
  v_mfma_f32_16x16x32_bf16 v[64:67], a[24:27], v[92:95], v[64:67]
  v_mfma_f32_16x16x32_bf16 v[8:11], a[28:31], v[80:83], v[8:11]
  v_mfma_f32_16x16x32_bf16 v[28:31], a[28:31], v[84:87], v[28:31]
  buffer_load_dwordx4 v[164:167], v246, s[32:35], s90 offen sc1
  v_mfma_f32_16x16x32_bf16 v[48:51], a[28:31], v[88:91], v[48:51]
  v_mfma_f32_16x16x32_bf16 v[68:71], a[28:31], v[92:95], v[68:71]
  v_mfma_f32_16x16x32_bf16 v[12:15], a[32:35], v[80:83], v[12:15]
  v_mfma_f32_16x16x32_bf16 v[32:35], a[32:35], v[84:87], v[32:35]
  v_mfma_f32_16x16x32_bf16 v[52:55], a[32:35], v[88:91], v[52:55]
  buffer_load_dwordx4 v[168:171], v248, s[32:35], s90 offen sc1
  v_mfma_f32_16x16x32_bf16 v[72:75], a[32:35], v[92:95], v[72:75]
  v_mfma_f32_16x16x32_bf16 v[16:19], a[36:39], v[80:83], v[16:19]
  v_mfma_f32_16x16x32_bf16 v[36:39], a[36:39], v[84:87], v[36:39]
  v_mfma_f32_16x16x32_bf16 v[56:59], a[36:39], v[88:91], v[56:59]
  v_mfma_f32_16x16x32_bf16 v[76:79], a[36:39], v[92:95], v[76:79]
  buffer_load_dwordx4 v[172:175], v249, s[32:35], s90 offen sc1
  s_waitcnt vmcnt(20)
  v_mfma_f32_16x16x32_bf16 v[0:3], a[40:43], v[96:99], v[0:3]
  s_waitcnt vmcnt(19)
  v_mfma_f32_16x16x32_bf16 v[20:23], a[40:43], v[100:103], v[20:23]
  s_waitcnt vmcnt(18)
  v_mfma_f32_16x16x32_bf16 v[40:43], a[40:43], v[104:107], v[40:43]
  s_waitcnt vmcnt(17)
  v_mfma_f32_16x16x32_bf16 v[60:63], a[40:43], v[108:111], v[60:63]
  v_mfma_f32_16x16x32_bf16 v[4:7], a[44:47], v[96:99], v[4:7]
  s_lshl_b32 s90, s18, 2
  s_add_u32 s90, s90, s84
  buffer_load_dwordx4 v[80:83], v244, s[32:35], s90 offen sc1
  v_mfma_f32_16x16x32_bf16 v[24:27], a[44:47], v[100:103], v[24:27]
  v_mfma_f32_16x16x32_bf16 v[44:47], a[44:47], v[104:107], v[44:47]
  v_mfma_f32_16x16x32_bf16 v[64:67], a[44:47], v[108:111], v[64:67]
  v_mfma_f32_16x16x32_bf16 v[8:11], a[48:51], v[96:99], v[8:11]
  v_mfma_f32_16x16x32_bf16 v[28:31], a[48:51], v[100:103], v[28:31]
  buffer_load_dwordx4 v[84:87], v246, s[32:35], s90 offen sc1
  v_mfma_f32_16x16x32_bf16 v[48:51], a[48:51], v[104:107], v[48:51]
  v_mfma_f32_16x16x32_bf16 v[68:71], a[48:51], v[108:111], v[68:71]
  v_mfma_f32_16x16x32_bf16 v[12:15], a[52:55], v[96:99], v[12:15]
  v_mfma_f32_16x16x32_bf16 v[32:35], a[52:55], v[100:103], v[32:35]
  v_mfma_f32_16x16x32_bf16 v[52:55], a[52:55], v[104:107], v[52:55]
  buffer_load_dwordx4 v[88:91], v248, s[32:35], s90 offen sc1
  v_mfma_f32_16x16x32_bf16 v[72:75], a[52:55], v[108:111], v[72:75]
  v_mfma_f32_16x16x32_bf16 v[16:19], a[56:59], v[96:99], v[16:19]
  v_mfma_f32_16x16x32_bf16 v[36:39], a[56:59], v[100:103], v[36:39]
  v_mfma_f32_16x16x32_bf16 v[56:59], a[56:59], v[104:107], v[56:59]
  v_mfma_f32_16x16x32_bf16 v[76:79], a[56:59], v[108:111], v[76:79]
  buffer_load_dwordx4 v[92:95], v249, s[32:35], s90 offen sc1
  s_waitcnt vmcnt(20)
  v_mfma_f32_16x16x32_bf16 v[0:3], a[60:63], v[112:115], v[0:3]
  s_waitcnt vmcnt(19)
  v_mfma_f32_16x16x32_bf16 v[20:23], a[60:63], v[116:119], v[20:23]
  s_waitcnt vmcnt(18)
  v_mfma_f32_16x16x32_bf16 v[40:43], a[60:63], v[120:123], v[40:43]
  s_waitcnt vmcnt(17)
  v_mfma_f32_16x16x32_bf16 v[60:63], a[60:63], v[124:127], v[60:63]
  v_mfma_f32_16x16x32_bf16 v[4:7], a[64:67], v[112:115], v[4:7]
  s_lshl_b32 s90, s19, 2
  s_add_u32 s90, s90, s84
  buffer_load_dwordx4 v[96:99], v244, s[32:35], s90 offen sc1
  v_mfma_f32_16x16x32_bf16 v[24:27], a[64:67], v[116:119], v[24:27]
  v_mfma_f32_16x16x32_bf16 v[44:47], a[64:67], v[120:123], v[44:47]
  v_mfma_f32_16x16x32_bf16 v[64:67], a[64:67], v[124:127], v[64:67]
  v_mfma_f32_16x16x32_bf16 v[8:11], a[68:71], v[112:115], v[8:11]
  v_mfma_f32_16x16x32_bf16 v[28:31], a[68:71], v[116:119], v[28:31]
  buffer_load_dwordx4 v[100:103], v246, s[32:35], s90 offen sc1
  v_mfma_f32_16x16x32_bf16 v[48:51], a[68:71], v[120:123], v[48:51]
  v_mfma_f32_16x16x32_bf16 v[68:71], a[68:71], v[124:127], v[68:71]
  v_mfma_f32_16x16x32_bf16 v[12:15], a[72:75], v[112:115], v[12:15]
  v_mfma_f32_16x16x32_bf16 v[32:35], a[72:75], v[116:119], v[32:35]
  v_mfma_f32_16x16x32_bf16 v[52:55], a[72:75], v[120:123], v[52:55]
  buffer_load_dwordx4 v[104:107], v248, s[32:35], s90 offen sc1
  v_mfma_f32_16x16x32_bf16 v[72:75], a[72:75], v[124:127], v[72:75]
  v_mfma_f32_16x16x32_bf16 v[16:19], a[76:79], v[112:115], v[16:19]
  v_mfma_f32_16x16x32_bf16 v[36:39], a[76:79], v[116:119], v[36:39]
  v_mfma_f32_16x16x32_bf16 v[56:59], a[76:79], v[120:123], v[56:59]
  v_mfma_f32_16x16x32_bf16 v[76:79], a[76:79], v[124:127], v[76:79]
  buffer_load_dwordx4 v[108:111], v249, s[32:35], s90 offen sc1
  s_waitcnt vmcnt(12)
  v_cmp_eq_u32 vcc, s23, v219
  s_nop 3
  s_and_b32 s46, vcc_lo, 0xff00
  s_cmp_eq_u32 s46, 0xff00
  s_cbranch_scc1 L_ok_aA
  s_mov_b32 s47, 0
  v_lshlrev_b32_e64 v251, 2, v255
L_spin_aA:
  buffer_load_dword v250, v251, s[32:35], s45 offen sc1
  s_waitcnt vmcnt(0)
  v_cmp_eq_u32 vcc, s23, v250
  s_nop 3
  s_and_b32 s46, vcc_lo, 0xff00
  s_cmp_eq_u32 s46, 0xff00
  s_cbranch_scc1 L_ok_aA
  s_sleep 8
  s_add_u32 s47, s47, 1
  s_cmp_lt_u32 s47, 200000
  s_cbranch_scc1 L_spin_aA
L_ok_aA:
  v_mfma_f32_16x16x32_bf16 v[0:3], a[80:83], v[128:131], v[0:3]
  v_mfma_f32_16x16x32_bf16 v[20:23], a[80:83], v[132:135], v[20:23]
  v_mfma_f32_16x16x32_bf16 v[40:43], a[80:83], v[136:139], v[40:43]
  v_mfma_f32_16x16x32_bf16 v[60:63], a[80:83], v[140:143], v[60:63]
  v_mfma_f32_16x16x32_bf16 v[4:7], a[84:87], v[128:131], v[4:7]
  s_lshl_b32 s90, s22, 12
  s_add_u32 s90, s90, s84
  s_add_u32 s90, s90, 0
  buffer_load_dwordx4 v[112:115], v244, s[32:35], s90 offen sc1
  v_mfma_f32_16x16x32_bf16 v[24:27], a[84:87], v[132:135], v[24:27]
  v_mfma_f32_16x16x32_bf16 v[44:47], a[84:87], v[136:139], v[44:47]
  v_mfma_f32_16x16x32_bf16 v[64:67], a[84:87], v[140:143], v[64:67]
  v_mfma_f32_16x16x32_bf16 v[8:11], a[88:91], v[128:131], v[8:11]
  v_mfma_f32_16x16x32_bf16 v[28:31], a[88:91], v[132:135], v[28:31]
  buffer_load_dwordx4 v[116:119], v246, s[32:35], s90 offen sc1
  v_mfma_f32_16x16x32_bf16 v[48:51], a[88:91], v[136:139], v[48:51]
  v_mfma_f32_16x16x32_bf16 v[68:71], a[88:91], v[140:143], v[68:71]
  v_mfma_f32_16x16x32_bf16 v[12:15], a[92:95], v[128:131], v[12:15]
  v_mfma_f32_16x16x32_bf16 v[32:35], a[92:95], v[132:135], v[32:35]
  v_mfma_f32_16x16x32_bf16 v[52:55], a[92:95], v[136:139], v[52:55]
  buffer_load_dwordx4 v[120:123], v248, s[32:35], s90 offen sc1
  v_mfma_f32_16x16x32_bf16 v[72:75], a[92:95], v[140:143], v[72:75]
  v_mfma_f32_16x16x32_bf16 v[16:19], a[96:99], v[128:131], v[16:19]
  v_mfma_f32_16x16x32_bf16 v[36:39], a[96:99], v[132:135], v[36:39]
  v_mfma_f32_16x16x32_bf16 v[56:59], a[96:99], v[136:139], v[56:59]
  v_mfma_f32_16x16x32_bf16 v[76:79], a[96:99], v[140:143], v[76:79]
  buffer_load_dwordx4 v[124:127], v249, s[32:35], s90 offen sc1
  v_mfma_f32_16x16x32_bf16 v[0:3], a[100:103], v[144:147], v[0:3]
  v_mfma_f32_16x16x32_bf16 v[20:23], a[100:103], v[148:151], v[20:23]
  v_mfma_f32_16x16x32_bf16 v[40:43], a[100:103], v[152:155], v[40:43]
  s_lshl_b32 s90, s22, 12
  s_add_u32 s90, s90, s84
  s_add_u32 s90, s90, 16384
  buffer_load_dwordx4 v[128:131], v244, s[32:35], s90 offen sc1
  v_mfma_f32_16x16x32_bf16 v[60:63], a[100:103], v[156:159], v[60:63]
  v_mfma_f32_16x16x32_bf16 v[4:7], a[104:107], v[144:147], v[4:7]
  buffer_load_dwordx4 v[132:135], v246, s[32:35], s90 offen sc1
  v_mfma_f32_16x16x32_bf16 v[24:27], a[104:107], v[148:151], v[24:27]
  v_mfma_f32_16x16x32_bf16 v[44:47], a[104:107], v[152:155], v[44:47]
  buffer_load_dwordx4 v[136:139], v248, s[32:35], s90 offen sc1
  v_mfma_f32_16x16x32_bf16 v[64:67], a[104:107], v[156:159], v[64:67]
  v_mfma_f32_16x16x32_bf16 v[8:11], a[108:111], v[144:147], v[8:11]
  buffer_load_dwordx4 v[140:143], v249, s[32:35], s90 offen sc1
  v_mfma_f32_16x16x32_bf16 v[28:31], a[108:111], v[148:151], v[28:31]
  v_mfma_f32_16x16x32_bf16 v[48:51], a[108:111], v[152:155], v[48:51]
  v_mfma_f32_16x16x32_bf16 v[68:71], a[108:111], v[156:159], v[68:71]
  s_mul_i32 s87, s22, 5120
  s_add_u32 s87, s87, s83
  s_add_u32 s87, s87, 61440
  buffer_load_dwordx4 a[0:3], v241, s[32:35], s87 offen offset:0 sc1
  v_mfma_f32_16x16x32_bf16 v[12:15], a[112:115], v[144:147], v[12:15]
  v_mfma_f32_16x16x32_bf16 v[32:35], a[112:115], v[148:151], v[32:35]
  buffer_load_dwordx4 a[4:7], v241, s[32:35], s87 offen offset:1024 sc1
  v_mfma_f32_16x16x32_bf16 v[52:55], a[112:115], v[152:155], v[52:55]
  v_mfma_f32_16x16x32_bf16 v[72:75], a[112:115], v[156:159], v[72:75]
  buffer_load_dwordx4 a[8:11], v241, s[32:35], s87 offen offset:2048 sc1
  v_mfma_f32_16x16x32_bf16 v[16:19], a[116:119], v[144:147], v[16:19]
  v_mfma_f32_16x16x32_bf16 v[36:39], a[116:119], v[148:151], v[36:39]
  buffer_load_dwordx4 a[12:15], v241, s[32:35], s87 offen offset:3072 sc1
  v_mfma_f32_16x16x32_bf16 v[56:59], a[116:119], v[152:155], v[56:59]
  v_mfma_f32_16x16x32_bf16 v[76:79], a[116:119], v[156:159], v[76:79]
  buffer_load_dwordx4 a[16:19], v245, s[32:35], s87 offen sc1
  s_waitcnt vmcnt(24)
  v_mfma_f32_16x16x32_bf16 v[0:3], a[120:123], v[160:163], v[0:3]
  s_waitcnt vmcnt(23)
  v_mfma_f32_16x16x32_bf16 v[20:23], a[120:123], v[164:167], v[20:23]
  s_waitcnt vmcnt(22)
  v_mfma_f32_16x16x32_bf16 v[40:43], a[120:123], v[168:171], v[40:43]
  s_lshl_b32 s90, s22, 12
  s_add_u32 s90, s90, s84
  s_add_u32 s90, s90, 32768
  buffer_load_dwordx4 v[144:147], v244, s[32:35], s90 offen sc1
  s_waitcnt vmcnt(22)
  v_mfma_f32_16x16x32_bf16 v[60:63], a[120:123], v[172:175], v[60:63]
  v_mfma_f32_16x16x32_bf16 v[4:7], a[124:127], v[160:163], v[4:7]
  buffer_load_dwordx4 v[148:151], v246, s[32:35], s90 offen sc1
  v_mfma_f32_16x16x32_bf16 v[24:27], a[124:127], v[164:167], v[24:27]
  v_mfma_f32_16x16x32_bf16 v[44:47], a[124:127], v[168:171], v[44:47]
  buffer_load_dwordx4 v[152:155], v248, s[32:35], s90 offen sc1
  v_mfma_f32_16x16x32_bf16 v[64:67], a[124:127], v[172:175], v[64:67]
  v_mfma_f32_16x16x32_bf16 v[8:11], a[128:131], v[160:163], v[8:11]
  buffer_load_dwordx4 v[156:159], v249, s[32:35], s90 offen sc1
  v_mfma_f32_16x16x32_bf16 v[28:31], a[128:131], v[164:167], v[28:31]
  v_mfma_f32_16x16x32_bf16 v[48:51], a[128:131], v[168:171], v[48:51]
  v_mfma_f32_16x16x32_bf16 v[68:71], a[128:131], v[172:175], v[68:71]
  s_mul_i32 s87, s22, 5120
  s_add_u32 s87, s87, s83
  s_add_u32 s87, s87, 81920
  buffer_load_dwordx4 a[20:23], v241, s[32:35], s87 offen offset:0 sc1
  v_mfma_f32_16x16x32_bf16 v[12:15], a[132:135], v[160:163], v[12:15]
  v_mfma_f32_16x16x32_bf16 v[32:35], a[132:135], v[164:167], v[32:35]
  buffer_load_dwordx4 a[24:27], v241, s[32:35], s87 offen offset:1024 sc1
  v_mfma_f32_16x16x32_bf16 v[52:55], a[132:135], v[168:171], v[52:55]
  v_mfma_f32_16x16x32_bf16 v[72:75], a[132:135], v[172:175], v[72:75]
  buffer_load_dwordx4 a[28:31], v241, s[32:35], s87 offen offset:2048 sc1
  v_mfma_f32_16x16x32_bf16 v[16:19], a[136:139], v[160:163], v[16:19]
  v_mfma_f32_16x16x32_bf16 v[36:39], a[136:139], v[164:167], v[36:39]
  buffer_load_dwordx4 a[32:35], v241, s[32:35], s87 offen offset:3072 sc1
  v_mfma_f32_16x16x32_bf16 v[56:59], a[136:139], v[168:171], v[56:59]
  v_mfma_f32_16x16x32_bf16 v[76:79], a[136:139], v[172:175], v[76:79]
  buffer_load_dwordx4 a[36:39], v245, s[32:35], s87 offen sc1
  s_waitcnt vmcnt(29)
  v_mfma_f32_16x16x32_bf16 v[0:3], a[140:143], v[80:83], v[0:3]
  s_waitcnt vmcnt(28)
  v_mfma_f32_16x16x32_bf16 v[20:23], a[140:143], v[84:87], v[20:23]
  s_waitcnt vmcnt(27)
  v_mfma_f32_16x16x32_bf16 v[40:43], a[140:143], v[88:91], v[40:43]
  s_waitcnt vmcnt(26)
  v_mfma_f32_16x16x32_bf16 v[60:63], a[140:143], v[92:95], v[60:63]
  v_mfma_f32_16x16x32_bf16 v[4:7], a[144:147], v[80:83], v[4:7]
  s_lshl_b32 s90, s22, 12
  s_add_u32 s90, s90, s84
  s_add_u32 s90, s90, 49152
  buffer_load_dwordx4 v[160:163], v244, s[32:35], s90 offen sc1
  v_mfma_f32_16x16x32_bf16 v[24:27], a[144:147], v[84:87], v[24:27]
  v_mfma_f32_16x16x32_bf16 v[44:47], a[144:147], v[88:91], v[44:47]
  v_mfma_f32_16x16x32_bf16 v[64:67], a[144:147], v[92:95], v[64:67]
  v_mfma_f32_16x16x32_bf16 v[8:11], a[148:151], v[80:83], v[8:11]
  v_mfma_f32_16x16x32_bf16 v[28:31], a[148:151], v[84:87], v[28:31]
  buffer_load_dwordx4 v[164:167], v246, s[32:35], s90 offen sc1
  v_mfma_f32_16x16x32_bf16 v[48:51], a[148:151], v[88:91], v[48:51]
  v_mfma_f32_16x16x32_bf16 v[68:71], a[148:151], v[92:95], v[68:71]
  v_mfma_f32_16x16x32_bf16 v[12:15], a[152:155], v[80:83], v[12:15]
  v_mfma_f32_16x16x32_bf16 v[32:35], a[152:155], v[84:87], v[32:35]
  v_mfma_f32_16x16x32_bf16 v[52:55], a[152:155], v[88:91], v[52:55]
  buffer_load_dwordx4 v[168:171], v248, s[32:35], s90 offen sc1
  v_mfma_f32_16x16x32_bf16 v[72:75], a[152:155], v[92:95], v[72:75]
  v_mfma_f32_16x16x32_bf16 v[16:19], a[156:159], v[80:83], v[16:19]
  v_mfma_f32_16x16x32_bf16 v[36:39], a[156:159], v[84:87], v[36:39]
  v_mfma_f32_16x16x32_bf16 v[56:59], a[156:159], v[88:91], v[56:59]
  v_mfma_f32_16x16x32_bf16 v[76:79], a[156:159], v[92:95], v[76:79]
  buffer_load_dwordx4 v[172:175], v249, s[32:35], s90 offen sc1
  s_waitcnt vmcnt(29)
  v_mfma_f32_16x16x32_bf16 v[0:3], a[160:163], v[96:99], v[0:3]
  s_waitcnt vmcnt(28)
  v_mfma_f32_16x16x32_bf16 v[20:23], a[160:163], v[100:103], v[20:23]
  s_waitcnt vmcnt(27)
  v_mfma_f32_16x16x32_bf16 v[40:43], a[160:163], v[104:107], v[40:43]
  s_waitcnt vmcnt(26)
  v_mfma_f32_16x16x32_bf16 v[60:63], a[160:163], v[108:111], v[60:63]
  v_mfma_f32_16x16x32_bf16 v[4:7], a[164:167], v[96:99], v[4:7]
  s_lshl_b32 s90, s22, 12
  s_add_u32 s90, s90, s84
  s_add_u32 s90, s90, 65536
  buffer_load_dwordx4 v[80:83], v244, s[32:35], s90 offen sc1
  v_mfma_f32_16x16x32_bf16 v[24:27], a[164:167], v[100:103], v[24:27]
  v_mfma_f32_16x16x32_bf16 v[44:47], a[164:167], v[104:107], v[44:47]
  v_mfma_f32_16x16x32_bf16 v[64:67], a[164:167], v[108:111], v[64:67]
  v_mfma_f32_16x16x32_bf16 v[8:11], a[168:171], v[96:99], v[8:11]
  v_mfma_f32_16x16x32_bf16 v[28:31], a[168:171], v[100:103], v[28:31]
  buffer_load_dwordx4 v[84:87], v246, s[32:35], s90 offen sc1
  v_mfma_f32_16x16x32_bf16 v[48:51], a[168:171], v[104:107], v[48:51]
  v_mfma_f32_16x16x32_bf16 v[68:71], a[168:171], v[108:111], v[68:71]
  v_mfma_f32_16x16x32_bf16 v[12:15], a[172:175], v[96:99], v[12:15]
  v_mfma_f32_16x16x32_bf16 v[32:35], a[172:175], v[100:103], v[32:35]
  v_mfma_f32_16x16x32_bf16 v[52:55], a[172:175], v[104:107], v[52:55]
  buffer_load_dwordx4 v[88:91], v248, s[32:35], s90 offen sc1
  v_mfma_f32_16x16x32_bf16 v[72:75], a[172:175], v[108:111], v[72:75]
  v_mfma_f32_16x16x32_bf16 v[16:19], a[176:179], v[96:99], v[16:19]
  v_mfma_f32_16x16x32_bf16 v[36:39], a[176:179], v[100:103], v[36:39]
  v_mfma_f32_16x16x32_bf16 v[56:59], a[176:179], v[104:107], v[56:59]
  v_mfma_f32_16x16x32_bf16 v[76:79], a[176:179], v[108:111], v[76:79]
  buffer_load_dwordx4 v[92:95], v249, s[32:35], s90 offen sc1
  s_waitcnt vmcnt(29)
  v_mfma_f32_16x16x32_bf16 v[0:3], a[180:183], v[112:115], v[0:3]
  s_waitcnt vmcnt(28)
  v_mfma_f32_16x16x32_bf16 v[20:23], a[180:183], v[116:119], v[20:23]
  v_and_b32 v220, 15, v255
  s_waitcnt vmcnt(27)
  v_mfma_f32_16x16x32_bf16 v[40:43], a[180:183], v[120:123], v[40:43]
  v_lshrrev_b32 v221, 4, v255
  s_waitcnt vmcnt(26)
  v_mfma_f32_16x16x32_bf16 v[60:63], a[180:183], v[124:127], v[60:63]
  s_lshl_b32 s46, s80, 6
  v_mfma_f32_16x16x32_bf16 v[4:7], a[184:187], v[112:115], v[4:7]
  s_lshl_b32 s47, s22, 4
  v_mfma_f32_16x16x32_bf16 v[24:27], a[184:187], v[116:119], v[24:27]
  s_add_u32 s46, s46, s47
  v_mfma_f32_16x16x32_bf16 v[44:47], a[184:187], v[120:123], v[44:47]
  v_mfma_f32_16x16x32_bf16 v[64:67], a[184:187], v[124:127], v[64:67]
  v_add_u32 v220, s46, v220
  v_mfma_f32_16x16x32_bf16 v[8:11], a[188:191], v[112:115], v[8:11]
  v_lshlrev_b32_e64 v222, 4, v220
  v_mfma_f32_16x16x32_bf16 v[28:31], a[188:191], v[116:119], v[28:31]
  v_mul_u32_u24 v220, 1280, v220
  v_mfma_f32_16x16x32_bf16 v[48:51], a[188:191], v[120:123], v[48:51]
  s_mul_i32 s47, s81, 160
  v_mfma_f32_16x16x32_bf16 v[68:71], a[188:191], v[124:127], v[68:71]
  v_add_u32_e64 v220, s47, v220
  v_mfma_f32_16x16x32_bf16 v[12:15], a[192:195], v[112:115], v[12:15]
  v_lshl_add_u32 v240, v221, 4, v220
  v_mfma_f32_16x16x32_bf16 v[32:35], a[192:195], v[116:119], v[32:35]
  v_mfma_f32_16x16x32_bf16 v[52:55], a[192:195], v[120:123], v[52:55]
  v_lshl_add_u32 v242, v221, 3, v220
  v_mfma_f32_16x16x32_bf16 v[72:75], a[192:195], v[124:127], v[72:75]
  s_mov_b32 s48, 14745604
  v_mfma_f32_16x16x32_bf16 v[16:19], a[196:199], v[112:115], v[16:19]
  buffer_load_dwordx4 v[224:227], v240, s[24:27], 0 offen
  v_mfma_f32_16x16x32_bf16 v[36:39], a[196:199], v[116:119], v[36:39]
  buffer_load_dwordx4 v[228:231], v240, s[24:27], 0 offen offset:64
  v_mfma_f32_16x16x32_bf16 v[56:59], a[196:199], v[120:123], v[56:59]
  buffer_load_dwordx2 v[232:233], v242, s[24:27], 0 offen offset:128
  v_mfma_f32_16x16x32_bf16 v[76:79], a[196:199], v[124:127], v[76:79]
  buffer_load_dword v234, v222, s[32:35], s48 offen sc1
  s_waitcnt vmcnt(29)
  v_mfma_f32_16x16x32_bf16 v[0:3], a[200:203], v[128:131], v[0:3]
  s_waitcnt vmcnt(28)
  v_mfma_f32_16x16x32_bf16 v[20:23], a[200:203], v[132:135], v[20:23]
  s_waitcnt vmcnt(27)
  v_mfma_f32_16x16x32_bf16 v[40:43], a[200:203], v[136:139], v[40:43]
  s_waitcnt vmcnt(26)
  v_mfma_f32_16x16x32_bf16 v[60:63], a[200:203], v[140:143], v[60:63]
  v_mfma_f32_16x16x32_bf16 v[4:7], a[204:207], v[128:131], v[4:7]
  v_mfma_f32_16x16x32_bf16 v[24:27], a[204:207], v[132:135], v[24:27]
  v_mfma_f32_16x16x32_bf16 v[44:47], a[204:207], v[136:139], v[44:47]
  v_mfma_f32_16x16x32_bf16 v[64:67], a[204:207], v[140:143], v[64:67]
  v_mfma_f32_16x16x32_bf16 v[8:11], a[208:211], v[128:131], v[8:11]
  v_mfma_f32_16x16x32_bf16 v[28:31], a[208:211], v[132:135], v[28:31]
  v_mfma_f32_16x16x32_bf16 v[48:51], a[208:211], v[136:139], v[48:51]
  v_mfma_f32_16x16x32_bf16 v[68:71], a[208:211], v[140:143], v[68:71]
  v_mfma_f32_16x16x32_bf16 v[12:15], a[212:215], v[128:131], v[12:15]
  v_mfma_f32_16x16x32_bf16 v[32:35], a[212:215], v[132:135], v[32:35]
  v_mfma_f32_16x16x32_bf16 v[52:55], a[212:215], v[136:139], v[52:55]
  v_mfma_f32_16x16x32_bf16 v[72:75], a[212:215], v[140:143], v[72:75]
  v_mfma_f32_16x16x32_bf16 v[16:19], a[216:219], v[128:131], v[16:19]
  v_mfma_f32_16x16x32_bf16 v[36:39], a[216:219], v[132:135], v[36:39]
  v_mfma_f32_16x16x32_bf16 v[56:59], a[216:219], v[136:139], v[56:59]
  v_mfma_f32_16x16x32_bf16 v[76:79], a[216:219], v[140:143], v[76:79]
  s_waitcnt vmcnt(20)
  v_mfma_f32_16x16x32_bf16 v[0:3], a[220:223], v[144:147], v[0:3]
  s_waitcnt vmcnt(19)
  v_mfma_f32_16x16x32_bf16 v[20:23], a[220:223], v[148:151], v[20:23]
  s_waitcnt vmcnt(18)
  v_mfma_f32_16x16x32_bf16 v[40:43], a[220:223], v[152:155], v[40:43]
  s_waitcnt vmcnt(17)
  v_mfma_f32_16x16x32_bf16 v[60:63], a[220:223], v[156:159], v[60:63]
  v_mfma_f32_16x16x32_bf16 v[4:7], a[224:227], v[144:147], v[4:7]
  v_mfma_f32_16x16x32_bf16 v[24:27], a[224:227], v[148:151], v[24:27]
  v_mfma_f32_16x16x32_bf16 v[44:47], a[224:227], v[152:155], v[44:47]
  v_mfma_f32_16x16x32_bf16 v[64:67], a[224:227], v[156:159], v[64:67]
  v_mfma_f32_16x16x32_bf16 v[8:11], a[228:231], v[144:147], v[8:11]
  v_mfma_f32_16x16x32_bf16 v[28:31], a[228:231], v[148:151], v[28:31]
  v_mfma_f32_16x16x32_bf16 v[48:51], a[228:231], v[152:155], v[48:51]
  v_mfma_f32_16x16x32_bf16 v[68:71], a[228:231], v[156:159], v[68:71]
  v_mfma_f32_16x16x32_bf16 v[12:15], a[232:235], v[144:147], v[12:15]
  v_mfma_f32_16x16x32_bf16 v[32:35], a[232:235], v[148:151], v[32:35]
  v_mfma_f32_16x16x32_bf16 v[52:55], a[232:235], v[152:155], v[52:55]
  v_mfma_f32_16x16x32_bf16 v[72:75], a[232:235], v[156:159], v[72:75]
  v_mfma_f32_16x16x32_bf16 v[16:19], a[236:239], v[144:147], v[16:19]
  v_mfma_f32_16x16x32_bf16 v[36:39], a[236:239], v[148:151], v[36:39]
  v_mfma_f32_16x16x32_bf16 v[56:59], a[236:239], v[152:155], v[56:59]
  v_mfma_f32_16x16x32_bf16 v[76:79], a[236:239], v[156:159], v[76:79]
  s_waitcnt vmcnt(11)
  v_mfma_f32_16x16x32_bf16 v[0:3], a[0:3], v[160:163], v[0:3]
  s_waitcnt vmcnt(10)
  v_mfma_f32_16x16x32_bf16 v[20:23], a[0:3], v[164:167], v[20:23]
  s_waitcnt vmcnt(9)
  v_mfma_f32_16x16x32_bf16 v[40:43], a[0:3], v[168:171], v[40:43]
  s_waitcnt vmcnt(8)
  v_mfma_f32_16x16x32_bf16 v[60:63], a[0:3], v[172:175], v[60:63]
  v_mfma_f32_16x16x32_bf16 v[4:7], a[4:7], v[160:163], v[4:7]
  v_mfma_f32_16x16x32_bf16 v[24:27], a[4:7], v[164:167], v[24:27]
  v_mfma_f32_16x16x32_bf16 v[44:47], a[4:7], v[168:171], v[44:47]
  v_mfma_f32_16x16x32_bf16 v[64:67], a[4:7], v[172:175], v[64:67]
  v_mfma_f32_16x16x32_bf16 v[8:11], a[8:11], v[160:163], v[8:11]
  v_mfma_f32_16x16x32_bf16 v[28:31], a[8:11], v[164:167], v[28:31]
  v_mfma_f32_16x16x32_bf16 v[48:51], a[8:11], v[168:171], v[48:51]
  v_mfma_f32_16x16x32_bf16 v[68:71], a[8:11], v[172:175], v[68:71]
  v_mfma_f32_16x16x32_bf16 v[12:15], a[12:15], v[160:163], v[12:15]
  v_mfma_f32_16x16x32_bf16 v[32:35], a[12:15], v[164:167], v[32:35]
  v_mfma_f32_16x16x32_bf16 v[52:55], a[12:15], v[168:171], v[52:55]
  v_mfma_f32_16x16x32_bf16 v[72:75], a[12:15], v[172:175], v[72:75]
  v_mfma_f32_16x16x32_bf16 v[16:19], a[16:19], v[160:163], v[16:19]
  v_mfma_f32_16x16x32_bf16 v[36:39], a[16:19], v[164:167], v[36:39]
  v_mfma_f32_16x16x32_bf16 v[56:59], a[16:19], v[168:171], v[56:59]
  v_mfma_f32_16x16x32_bf16 v[76:79], a[16:19], v[172:175], v[76:79]
  s_waitcnt vmcnt(6)
  v_mfma_f32_16x16x32_bf16 v[20:23], a[20:23], v[84:87], v[20:23]
  v_mfma_f32_16x16x32_bf16 v[24:27], a[24:27], v[84:87], v[24:27]
  v_mfma_f32_16x16x32_bf16 v[28:31], a[28:31], v[84:87], v[28:31]
  v_mfma_f32_16x16x32_bf16 v[32:35], a[32:35], v[84:87], v[32:35]
  v_mfma_f32_16x16x32_bf16 v[36:39], a[36:39], v[84:87], v[36:39]
  s_waitcnt vmcnt(5)
  v_mfma_f32_16x16x32_bf16 v[40:43], a[20:23], v[88:91], v[40:43]
  s_nop 1
  ds_write_b128 v237, v[20:23] offset:0
  v_mfma_f32_16x16x32_bf16 v[44:47], a[24:27], v[88:91], v[44:47]
  ds_write_b128 v237, v[24:27] offset:1024
  v_mfma_f32_16x16x32_bf16 v[48:51], a[28:31], v[88:91], v[48:51]
  ds_write_b128 v237, v[28:31] offset:2048
  v_mfma_f32_16x16x32_bf16 v[52:55], a[32:35], v[88:91], v[52:55]
  ds_write_b128 v237, v[32:35] offset:3072
  v_mfma_f32_16x16x32_bf16 v[56:59], a[36:39], v[88:91], v[56:59]
  ds_write_b128 v237, v[36:39] offset:4096
  s_waitcnt vmcnt(4)
  v_mfma_f32_16x16x32_bf16 v[60:63], a[20:23], v[92:95], v[60:63]
  ds_write_b128 v238, v[40:43] offset:0
  v_mfma_f32_16x16x32_bf16 v[64:67], a[24:27], v[92:95], v[64:67]
  ds_write_b128 v238, v[44:47] offset:1024
  v_mfma_f32_16x16x32_bf16 v[68:71], a[28:31], v[92:95], v[68:71]
  ds_write_b128 v238, v[48:51] offset:2048
  v_mfma_f32_16x16x32_bf16 v[72:75], a[32:35], v[92:95], v[72:75]
  ds_write_b128 v238, v[52:55] offset:3072
  v_mfma_f32_16x16x32_bf16 v[76:79], a[36:39], v[92:95], v[76:79]
  ds_write_b128 v238, v[56:59] offset:4096
  v_mfma_f32_16x16x32_bf16 v[0:3], a[20:23], v[80:83], v[0:3]
  ds_write_b128 v239, v[60:63] offset:0
  v_mfma_f32_16x16x32_bf16 v[4:7], a[24:27], v[80:83], v[4:7]
  ds_write_b128 v239, v[64:67] offset:1024
  v_mfma_f32_16x16x32_bf16 v[8:11], a[28:31], v[80:83], v[8:11]
  ds_write_b128 v239, v[68:71] offset:2048
  v_mfma_f32_16x16x32_bf16 v[12:15], a[32:35], v[80:83], v[12:15]
  ds_write_b128 v239, v[72:75] offset:3072
  v_mfma_f32_16x16x32_bf16 v[16:19], a[36:39], v[80:83], v[16:19]
  ds_write_b128 v239, v[76:79] offset:4096
  s_branch L_ph2_tail
  s_nop 7
L_ph2_tail:
  s_mov_b32 s28, s16
  s_and_b32 s29, s17, 0xffff
  s_mov_b32 s30, 2621440
  s_mov_b32 s31, 0x20000
  s_mul_i32 s46, s22, 15360
  v_add_u32 v236, s46, v241
  s_waitcnt vmcnt(3)
  v_lshlrev_b32 v180, 16, v224
  v_and_b32 v181, 0xffff0000, v224
  v_lshlrev_b32_e64 v182, 16, v225
  v_and_b32 v183, 0xffff0000, v225
  v_lshlrev_b32_e64 v184, 16, v226
  v_and_b32 v185, 0xffff0000, v226
  v_lshlrev_b32_e64 v186, 16, v227
  v_and_b32 v187, 0xffff0000, v227
  s_waitcnt vmcnt(2)
  v_lshlrev_b32 v188, 16, v228
  v_and_b32 v189, 0xffff0000, v228
  v_lshlrev_b32_e64 v190, 16, v229
  v_and_b32 v191, 0xffff0000, v229
  v_lshlrev_b32_e64 v192, 16, v230
  v_and_b32 v193, 0xffff0000, v230
  v_lshlrev_b32_e64 v194, 16, v231
  v_and_b32 v195, 0xffff0000, v231
  s_waitcnt vmcnt(1)
  v_lshlrev_b32 v196, 16, v232
  v_and_b32 v197, 0xffff0000, v232
  v_lshlrev_b32_e64 v198, 16, v233
  v_and_b32 v199, 0xffff0000, v233
  s_waitcnt lgkmcnt(0)
  s_barrier
  ds_read_b128 v[80:83], v236 offset:0
  ds_read_b128 v[84:87], v236 offset:1024
  ds_read_b128 v[88:91], v236 offset:2048
  ds_read_b128 v[92:95], v236 offset:3072
  ds_read_b128 v[96:99], v236 offset:4096
  ds_read_b128 v[100:103], v236 offset:5120
  ds_read_b128 v[104:107], v236 offset:6144
  ds_read_b128 v[108:111], v236 offset:7168
  ds_read_b128 v[112:115], v236 offset:8192
  ds_read_b128 v[116:119], v236 offset:9216
  ds_read_b128 v[120:123], v236 offset:10240
  ds_read_b128 v[124:127], v236 offset:11264
  ds_read_b128 v[128:131], v236 offset:12288
  ds_read_b128 v[132:135], v236 offset:13312
  ds_read_b128 v[136:139], v236 offset:14336
  s_waitcnt lgkmcnt(14)
  v_pk_add_f32 v[0:1], v[0:1], v[80:81]
  v_pk_add_f32 v[2:3], v[2:3], v[82:83]
  s_waitcnt lgkmcnt(13)
  v_pk_add_f32 v[4:5], v[4:5], v[84:85]
  v_pk_add_f32 v[6:7], v[6:7], v[86:87]
  s_waitcnt lgkmcnt(12)
  v_pk_add_f32 v[8:9], v[8:9], v[88:89]
  v_pk_add_f32 v[10:11], v[10:11], v[90:91]
  s_waitcnt lgkmcnt(11)
  v_pk_add_f32 v[12:13], v[12:13], v[92:93]
  v_pk_add_f32 v[14:15], v[14:15], v[94:95]
  s_waitcnt lgkmcnt(10)
  v_pk_add_f32 v[16:17], v[16:17], v[96:97]
  v_pk_add_f32 v[18:19], v[18:19], v[98:99]
  s_waitcnt lgkmcnt(9)
  v_pk_add_f32 v[0:1], v[0:1], v[100:101]
  v_pk_add_f32 v[2:3], v[2:3], v[102:103]
  s_waitcnt lgkmcnt(8)
  v_pk_add_f32 v[4:5], v[4:5], v[104:105]
  v_pk_add_f32 v[6:7], v[6:7], v[106:107]
  s_waitcnt lgkmcnt(7)
  v_pk_add_f32 v[8:9], v[8:9], v[108:109]
  v_pk_add_f32 v[10:11], v[10:11], v[110:111]
  s_waitcnt lgkmcnt(6)
  v_pk_add_f32 v[12:13], v[12:13], v[112:113]
  v_pk_add_f32 v[14:15], v[14:15], v[114:115]
  s_waitcnt lgkmcnt(5)
  v_pk_add_f32 v[16:17], v[16:17], v[116:117]
  v_pk_add_f32 v[18:19], v[18:19], v[118:119]
  s_waitcnt lgkmcnt(4)
  v_pk_add_f32 v[0:1], v[0:1], v[120:121]
  s_waitcnt vmcnt(0)
  v_pk_fma_f32 v[180:181], v[0:1], v[234:235], v[180:181] op_sel_hi:[1,0,1]
  v_cvt_pk_bf16_f32 v150, v180, v181
  v_pk_add_f32 v[2:3], v[2:3], v[122:123]
  v_pk_fma_f32 v[182:183], v[2:3], v[234:235], v[182:183] op_sel_hi:[1,0,1]
  v_cvt_pk_bf16_f32 v151, v182, v183
  s_waitcnt lgkmcnt(3)
  s_nop 0
  v_pk_add_f32 v[4:5], v[4:5], v[124:125]
  v_pk_fma_f32 v[184:185], v[4:5], v[234:235], v[184:185] op_sel_hi:[1,0,1]
  v_cvt_pk_bf16_f32 v152, v184, v185
  v_pk_add_f32 v[6:7], v[6:7], v[126:127]
  v_pk_fma_f32 v[186:187], v[6:7], v[234:235], v[186:187] op_sel_hi:[1,0,1]
  v_cvt_pk_bf16_f32 v153, v186, v187
  s_waitcnt lgkmcnt(2)
  s_nop 0
  v_pk_add_f32 v[8:9], v[8:9], v[128:129]
  v_pk_fma_f32 v[188:189], v[8:9], v[234:235], v[188:189] op_sel_hi:[1,0,1]
  v_cvt_pk_bf16_f32 v154, v188, v189
  v_pk_add_f32 v[10:11], v[10:11], v[130:131]
  v_pk_fma_f32 v[190:191], v[10:11], v[234:235], v[190:191] op_sel_hi:[1,0,1]
  v_cvt_pk_bf16_f32 v155, v190, v191
  s_waitcnt lgkmcnt(1)
  s_nop 0
  v_pk_add_f32 v[12:13], v[12:13], v[132:133]
  v_pk_fma_f32 v[192:193], v[12:13], v[234:235], v[192:193] op_sel_hi:[1,0,1]
  v_cvt_pk_bf16_f32 v156, v192, v193
  v_pk_add_f32 v[14:15], v[14:15], v[134:135]
  v_pk_fma_f32 v[194:195], v[14:15], v[234:235], v[194:195] op_sel_hi:[1,0,1]
  v_cvt_pk_bf16_f32 v157, v194, v195
  s_waitcnt lgkmcnt(0)
  s_nop 0
  v_pk_add_f32 v[16:17], v[16:17], v[136:137]
  v_pk_fma_f32 v[196:197], v[16:17], v[234:235], v[196:197] op_sel_hi:[1,0,1]
  v_cvt_pk_bf16_f32 v158, v196, v197
  v_pk_add_f32 v[18:19], v[18:19], v[138:139]
  v_pk_fma_f32 v[198:199], v[18:19], v[234:235], v[198:199] op_sel_hi:[1,0,1]
  v_cvt_pk_bf16_f32 v159, v198, v199
  buffer_store_dwordx4 v[150:153], v240, s[28:31], 0 offen nt
  buffer_store_dwordx4 v[154:157], v240, s[28:31], 0 offen offset:64 nt
  buffer_store_dwordx2 v[158:159], v242, s[28:31], 0 offen offset:128 nt
L_end:
s_endpgm
L_codeend:
.section .rodata,"a"
.p2align 6
.amdhsa_kernel parallel_sum__sliding_local_dilated__dense_activation_relu__prompt_kernel
  .amdhsa_next_free_vgpr 512
  .amdhsa_next_free_sgpr 102
  .amdhsa_accum_offset 256
  .amdhsa_group_segment_fixed_size 0
  .amdhsa_kernarg_size 72
  .amdhsa_user_sgpr_count 2
  .amdhsa_user_sgpr_kernarg_segment_ptr 1
  .amdhsa_system_sgpr_workgroup_id_x 1
  .amdhsa_float_denorm_mode_32 3
.end_amdhsa_kernel
```
